```python
import torch

def _softmax(x, axis=-1):
    return torch.softmax(x, dim=axis)

def _gelu(x):
    return torch.nn.functional.gelu(x, approximate='tanh')

def _silu(x):
    return torch.nn.functional.silu(x)

def _sigmoid(x):
    return torch.sigmoid(x)

def _layernorm(x, axis=-1, eps=1e-05):
    m = x.mean(dim=axis, keepdim=True)
    v = x.var(dim=axis, keepdim=True, unbiased=False)
    return (x - m) / torch.sqrt(v + eps)

def _scatter_add(tgt, idx, src, axis=0):
    return tgt.clone().index_add_(axis, idx, src)

def _segment_sum(src, seg, n):
    out = torch.zeros((n,) + src.shape[1:], dtype=src.dtype)
    return out.index_add_(0, seg, src)

def _pad(x, pw):
    flat = tuple((v for pair in reversed(pw) for v in pair))
    return torch.nn.functional.pad(x, flat)
kernel_name = 'parallel_sum__memory_aug_recurrent_mem_tr__geglu_ffn__prompt'

def setup_inputs():

    _w = lambda a: (lambda t: t.to(torch.bfloat16) if t.is_floating_point() else t)(torch.as_tensor(a))

    def _A_setup():
        B, S, Dm = (1, 2048, 640)
        H, Dh = (32, 192)
        M, seg = (8, 32)
        seg = min(seg, S)
        S = S // seg * seg
        return {'x': _w((lambda *s: torch.randn(*s, dtype=torch.bfloat16) * 0.05)(B, S, Dm)), 'mem0': _w((lambda *s: torch.randn(*s, dtype=torch.bfloat16) * 1.6)(B, M, Dm)), 'Wq': _w((lambda *s: torch.randn(*s, dtype=torch.bfloat16) * 0.8)(Dm, H, Dh) * Dm ** (-0.5)), 'Wk': _w((lambda *s: torch.randn(*s, dtype=torch.bfloat16) * 0.8)(Dm, H, Dh) * Dm ** (-0.5)), 'Wv': _w((lambda *s: torch.randn(*s, dtype=torch.bfloat16) * 1.6)(Dm, H, Dh) * Dm ** (-0.5)), 'Wo': _w((lambda *s: torch.randn(*s, dtype=torch.bfloat16) * 1.6)(H, Dh, Dm) * (H * Dh) ** (-0.5)), 'seg_len': seg}
    _A_in = _A_setup()

    def _B_setup():
        B, S, D, F = (1, 2048, 640, 1536)
        return {'x': _w((lambda *s: torch.randn(*s, dtype=torch.bfloat16) * 0.05)(B, S, D)), 'w_gate': _w((lambda *s: torch.randn(*s, dtype=torch.bfloat16) * 0.05)(D, F)), 'w_up': _w((lambda *s: torch.randn(*s, dtype=torch.bfloat16) * 0.05)(D, F)), 'w_down': _w((lambda *s: torch.randn(*s, dtype=torch.bfloat16) * 0.05)(F, D))}
    _B_in = _B_setup()
    return {'A_x': _A_in['x'], 'A_mem0': _A_in['mem0'], 'A_Wq': _A_in['Wq'], 'A_Wk': _A_in['Wk'], 'A_Wv': _A_in['Wv'], 'A_Wo': _A_in['Wo'], 'A_seg_len': _A_in['seg_len'], 'B_x': _B_in['x'], 'B_w_gate': _B_in['w_gate'], 'B_w_up': _B_in['w_up'], 'B_w_down': _B_in['w_down']}

def reference(A_x, A_mem0, A_Wq, A_Wk, A_Wv, A_Wo, A_seg_len, B_x, B_w_gate, B_w_up, B_w_down):

    def _A_ref(x, mem0, Wq, Wk, Wv, Wo, seg_len):
        B, S, Dm = x.shape
        H, Dh = (Wq.shape[1], Wq.shape[2])
        M = mem0.shape[1]
        scale = Dh ** (-0.5)
        n_seg = S // seg_len
        L = M + seg_len
        idx = torch.arange(L)
        mask = (idx[:, None] < M) | (idx[:, None] >= idx[None, :])
        mem = mem0
        outs = []
        for s in range(n_seg):
            xs = x[:, s * seg_len:(s + 1) * seg_len, :].clone()
            h = torch.concatenate([mem, xs], axis=1)
            q = torch.einsum('btd,dhe->bhte', h, Wq)
            k = torch.einsum('btd,dhe->bhte', h, Wk)
            v = torch.einsum('btd,dhe->bhte', h, Wv)
            scores = torch.einsum('bhqe,bhke->bhqk', q, k) * scale
            scores = torch.where(mask[None, None], scores, -1000000000.0)
            p = _softmax(scores, axis=-1)
            o = torch.einsum('bhqk,bhke->bhqe', p, v)
            o = torch.einsum('bhte,hed->btd', o, Wo)
            mem = o[:, :M, :].clone()
            outs.append(o[:, M:, :])
        return torch.concatenate(outs, axis=1)

    def _B_ref(x, w_gate, w_up, w_down):
        return _gelu(x @ w_gate) * (x @ w_up) @ w_down
    x = A_x
    xn = _layernorm(x, axis=-1)
    return x + _A_ref(xn, A_mem0, A_Wq, A_Wk, A_Wv, A_Wo, A_seg_len) + _B_ref(xn, B_w_gate, B_w_up, B_w_down)
```

```asm
; @launch grid=(256,1,1) block=(256,1,1) lds=147456
.amdgcn_target "amdgcn-amd-amdhsa--gfx950"
.text
.globl parallel_sum__memory_aug_recurrent_mem_tr__geglu_ffn__prompt_kernel
.p2align 8
.type parallel_sum__memory_aug_recurrent_mem_tr__geglu_ffn__prompt_kernel,@function
parallel_sum__memory_aug_recurrent_mem_tr__geglu_ffn__prompt_kernel:
  s_cmp_ge_u32 s2, 256
  s_cbranch_scc1 MK_END
  s_load_dwordx2 s[74:75], s[0:1], 104
  s_load_dwordx2 s[76:77], s[0:1], 96
  s_getreg_b32 s78, hwreg(HW_REG_XCC_ID)
  s_and_b32 s78, s78, 7
  s_waitcnt lgkmcnt(0)
  s_mov_b32 s4, s74
  s_and_b32 s5, s75, 0xffff
  s_mov_b32 s6, 268435456
  s_mov_b32 s7, 0x00020000
  v_lshrrev_b32 v2, 6, v0
  s_nop 0
  v_readfirstlane_b32 s24, v2
  v_and_b32 v1, 63, v0
  v_lshrrev_b32 v2, 4, v1
  v_and_b32 v3, 15, v1
  s_cmp_lg_u32 s24, 0
  s_cbranch_scc1 MK_NORANK
  v_mov_b32 v10, 1
  s_lshl_b32 s79, s78, 2
  v_mov_b32 v11, s79
  s_mov_b64 exec, 1
  global_atomic_add v12, v11, v10, s[76:77] sc0 sc1
  s_waitcnt vmcnt(0)
  v_readfirstlane_b32 s79, v12
  s_mov_b32 s80, s78
  s_cmp_lt_u32 s79, 32
  s_nop 1
  s_cbranch_scc1 MK_HAVE
  v_mov_b32 v11, 32
  global_atomic_add v12, v11, v10, s[76:77] sc0 sc1
  s_waitcnt vmcnt(0)
  v_readfirstlane_b32 s81, v12
  s_mov_b64 exec, 0xff
  v_lshlrev_b32 v11, 2, v1
  s_mov_b32 s82, 0
  s_nop 1
MK_OVW:
  global_load_dword v12, v11, s[76:77] sc1
  s_waitcnt vmcnt(0)
  s_mov_b32 s83, 0
  v_readlane_b32 s84, v12, 0
  s_nop 0
  s_add_u32 s83, s83, s84
  v_readlane_b32 s84, v12, 1
  s_nop 0
  s_add_u32 s83, s83, s84
  v_readlane_b32 s84, v12, 2
  s_nop 0
  s_add_u32 s83, s83, s84
  v_readlane_b32 s84, v12, 3
  s_nop 0
  s_add_u32 s83, s83, s84
  v_readlane_b32 s84, v12, 4
  s_nop 0
  s_add_u32 s83, s83, s84
  v_readlane_b32 s84, v12, 5
  s_nop 0
  s_add_u32 s83, s83, s84
  v_readlane_b32 s84, v12, 6
  s_nop 0
  s_add_u32 s83, s83, s84
  v_readlane_b32 s84, v12, 7
  s_nop 0
  s_add_u32 s83, s83, s84
  s_cmp_ge_u32 s83, 256
  s_nop 0
  s_cbranch_scc1 MK_OVK
  s_sleep 8
  s_add_u32 s82, s82, 1
  s_cmp_lt_u32 s82, 0x200000
  s_cbranch_scc1 MK_OVW
MK_OVK:
  v_readlane_b32 s84, v12, 0
  s_nop 0
  s_min_u32 s84, s84, 32
  s_sub_u32 s85, 32, s84
  s_cmp_lt_u32 s81, s85
  s_cbranch_scc0 MK_NX0
  s_mov_b32 s80, 0
  s_add_u32 s79, s84, s81
  s_branch MK_HAVE
MK_NX0:
  s_sub_u32 s81, s81, s85
  v_readlane_b32 s84, v12, 1
  s_nop 0
  s_min_u32 s84, s84, 32
  s_sub_u32 s85, 32, s84
  s_cmp_lt_u32 s81, s85
  s_cbranch_scc0 MK_NX1
  s_mov_b32 s80, 1
  s_add_u32 s79, s84, s81
  s_branch MK_HAVE
MK_NX1:
  s_sub_u32 s81, s81, s85
  v_readlane_b32 s84, v12, 2
  s_nop 0
  s_min_u32 s84, s84, 32
  s_sub_u32 s85, 32, s84
  s_cmp_lt_u32 s81, s85
  s_cbranch_scc0 MK_NX2
  s_mov_b32 s80, 2
  s_add_u32 s79, s84, s81
  s_branch MK_HAVE
MK_NX2:
  s_sub_u32 s81, s81, s85
  v_readlane_b32 s84, v12, 3
  s_nop 0
  s_min_u32 s84, s84, 32
  s_sub_u32 s85, 32, s84
  s_cmp_lt_u32 s81, s85
  s_cbranch_scc0 MK_NX3
  s_mov_b32 s80, 3
  s_add_u32 s79, s84, s81
  s_branch MK_HAVE
MK_NX3:
  s_sub_u32 s81, s81, s85
  v_readlane_b32 s84, v12, 4
  s_nop 0
  s_min_u32 s84, s84, 32
  s_sub_u32 s85, 32, s84
  s_cmp_lt_u32 s81, s85
  s_cbranch_scc0 MK_NX4
  s_mov_b32 s80, 4
  s_add_u32 s79, s84, s81
  s_branch MK_HAVE
MK_NX4:
  s_sub_u32 s81, s81, s85
  v_readlane_b32 s84, v12, 5
  s_nop 0
  s_min_u32 s84, s84, 32
  s_sub_u32 s85, 32, s84
  s_cmp_lt_u32 s81, s85
  s_cbranch_scc0 MK_NX5
  s_mov_b32 s80, 5
  s_add_u32 s79, s84, s81
  s_branch MK_HAVE
MK_NX5:
  s_sub_u32 s81, s81, s85
  v_readlane_b32 s84, v12, 6
  s_nop 0
  s_min_u32 s84, s84, 32
  s_sub_u32 s85, 32, s84
  s_cmp_lt_u32 s81, s85
  s_cbranch_scc0 MK_NX6
  s_mov_b32 s80, 6
  s_add_u32 s79, s84, s81
  s_branch MK_HAVE
MK_NX6:
  s_sub_u32 s81, s81, s85
  v_readlane_b32 s84, v12, 7
  s_nop 0
  s_min_u32 s84, s84, 32
  s_sub_u32 s85, 32, s84
  s_cmp_lt_u32 s81, s85
  s_cbranch_scc0 MK_NX7
  s_mov_b32 s80, 7
  s_add_u32 s79, s84, s81
  s_branch MK_HAVE
MK_NX7:
  s_sub_u32 s81, s81, s85
  s_mov_b32 s80, 7
  s_mov_b32 s79, 31
MK_HAVE:
  s_mov_b64 exec, 1
  s_lshl_b32 s80, s80, 8
  s_or_b32 s80, s80, s79
  v_mov_b32 v12, s80
  v_mov_b32 v11, 0
  ds_write_b32 v11, v12
  s_waitcnt lgkmcnt(0)
  s_mov_b64 exec, -1
MK_NORANK:
  s_barrier
  v_mov_b32 v11, 0
  ds_read_b32 v12, v11
  s_waitcnt lgkmcnt(0)
  v_readfirstlane_b32 s79, v12
  s_barrier
  s_lshr_b32 s80, s79, 8
  s_and_b32 s79, s79, 255
  s_cmp_ge_u32 s80, 4
  s_cbranch_scc1 MK_GEMM
  s_lshl_b32 s27, s80, 5
  s_add_u32 s27, s27, s79
  s_mov_b32 s97, s27
  s_load_dwordx4 s[64:67], s[0:1], 16
  s_load_dwordx4 s[68:71], s[0:1], 32
  s_load_dwordx2 s[72:73], s[0:1], 8
  s_waitcnt lgkmcnt(0)
  s_mov_b32 s8, s64
  s_and_b32 s9, s65, 0xffff
  s_mov_b32 s10, 7864320
  s_mov_b32 s11, 0x00020000
  s_mov_b32 s12, s66
  s_and_b32 s13, s67, 0xffff
  s_mov_b32 s14, 7864320
  s_mov_b32 s15, 0x00020000
  s_mov_b32 s16, s68
  s_and_b32 s17, s69, 0xffff
  s_mov_b32 s18, 7864320
  s_mov_b32 s19, 0x00020000
  s_mov_b32 s20, s70
  s_and_b32 s21, s71, 0xffff
  s_mov_b32 s22, 7864320
  s_mov_b32 s23, 0x00020000
  s_mov_b32 s88, s72
  s_and_b32 s89, s73, 0xffff
  s_mov_b32 s90, 10240
  s_mov_b32 s91, 0x00020000
  s_lshr_b32 s25, s27, 2
  s_and_b32 s26, s27, 3
  s_cmp_eq_u32 s24, 0
  s_cbranch_scc1 RK_W0
  s_cmp_eq_u32 s24, 1
  s_cbranch_scc1 RK_W1
  s_cmp_eq_u32 s24, 2
  s_cbranch_scc1 RK_W2
  s_branch RK_W3
RK_W0:
  v_add_u32 v4, 0, v1
  v_and_b32 v5, 7, v4
  v_mul_u32_u24 v5, 1280, v5
  v_lshrrev_b32 v212, 5, v4
  v_lshlrev_b32 v212, 6, v212
  v_add_u32 v5, v5, v212
  v_bfe_u32 v4, v4, 3, 2
  v_lshlrev_b32 v4, 3, v4
  v_add_u32 v4, v4, v5
  buffer_load_dwordx2 v[200:201], v4, s[88:91], 0 offen
  buffer_load_dwordx2 v[202:203], v4, s[88:91], 0 offen offset:32
  v_add_u32 v4, 64, v1
  v_and_b32 v5, 7, v4
  v_mul_u32_u24 v5, 1280, v5
  v_lshrrev_b32 v212, 5, v4
  v_lshlrev_b32 v212, 6, v212
  v_add_u32 v5, v5, v212
  v_bfe_u32 v4, v4, 3, 2
  v_lshlrev_b32 v4, 3, v4
  v_add_u32 v4, v4, v5
  buffer_load_dwordx2 v[204:205], v4, s[88:91], 0 offen
  buffer_load_dwordx2 v[206:207], v4, s[88:91], 0 offen offset:32
  v_add_u32 v4, 128, v1
  v_and_b32 v5, 7, v4
  v_mul_u32_u24 v5, 1280, v5
  v_lshrrev_b32 v212, 5, v4
  v_lshlrev_b32 v212, 6, v212
  v_add_u32 v5, v5, v212
  v_bfe_u32 v4, v4, 3, 2
  v_lshlrev_b32 v4, 3, v4
  v_add_u32 v4, v4, v5
  buffer_load_dwordx2 v[208:209], v4, s[88:91], 0 offen
  buffer_load_dwordx2 v[210:211], v4, s[88:91], 0 offen offset:32
  s_lshl_b32 s54, s24, 15
  v_lshrrev_b32 v4, 3, v1
  v_add_u32 v4, 0, v4
  s_mov_b32 s55, 12288
  v_mul_lo_u32 v32, v4, s55
  v_and_b32 v4, 7, v1
  v_lshlrev_b32 v4, 4, v4
  v_add_u32 v32, v32, v4
  v_bfe_u32 v33, v1, 4, 1
  v_lshlrev_b32 v33, 4, v33
  v_bfe_u32 v4, v1, 5, 1
  v_lshlrev_b32 v4, 3, v4
  v_add_u32 v33, v33, v4
  v_bfe_u32 v4, v1, 2, 1
  v_add_u32 v33, v33, v4
  v_bfe_u32 v4, v1, 3, 1
  v_lshlrev_b32 v4, 2, v4
  v_add_u32 v33, v33, v4
  v_lshlrev_b32 v33, 7, v33
  v_and_b32 v4, 3, v1
  v_lshlrev_b32 v4, 3, v4
  v_add_u32 v33, v33, v4
  s_mul_i32 s56, s25, 384
  s_mul_i32 s40, s26, 96
  s_add_u32 s56, s56, s40
  v_add_u32 v34, 61440, v33
  v_lshlrev_b32 v35, 4, v1
  v_add_u32 v35, 0, v35
  v_add_u32 v36, 61440, v35
  s_add_u32 s40, s56, 0
  s_mov_b32 m0, 0
  s_nop 0
  buffer_load_dwordx4 v32, s[8:11], s40 offen lds
  s_add_u32 s40, s56, 0
  s_mov_b32 m0, 4096
  s_nop 0
  buffer_load_dwordx4 v32, s[12:15], s40 offen lds
  s_add_u32 s40, s56, 0
  s_mov_b32 m0, 8192
  s_nop 0
  buffer_load_dwordx4 v32, s[16:19], s40 offen lds
  s_add_u32 s40, s56, 393216
  s_mov_b32 m0, 12288
  s_nop 0
  buffer_load_dwordx4 v32, s[8:11], s40 offen lds
  s_add_u32 s40, s56, 393216
  s_mov_b32 m0, 16384
  s_nop 0
  buffer_load_dwordx4 v32, s[12:15], s40 offen lds
  s_add_u32 s40, s56, 393216
  s_mov_b32 m0, 20480
  s_nop 0
  buffer_load_dwordx4 v32, s[16:19], s40 offen lds
  s_add_u32 s40, s56, 786432
  s_mov_b32 m0, 24576
  s_nop 0
  buffer_load_dwordx4 v32, s[8:11], s40 offen lds
  s_add_u32 s40, s56, 786432
  s_mov_b32 m0, 28672
  s_nop 0
  buffer_load_dwordx4 v32, s[12:15], s40 offen lds
  s_add_u32 s40, s56, 786432
  s_mov_b32 m0, 32768
  s_nop 0
  buffer_load_dwordx4 v32, s[16:19], s40 offen lds
  s_add_u32 s40, s56, 1179648
  s_mov_b32 m0, 36864
  s_nop 0
  buffer_load_dwordx4 v32, s[8:11], s40 offen lds
  s_add_u32 s40, s56, 1179648
  s_mov_b32 m0, 40960
  s_nop 0
  buffer_load_dwordx4 v32, s[12:15], s40 offen lds
  s_add_u32 s40, s56, 1179648
  s_mov_b32 m0, 45056
  s_nop 0
  buffer_load_dwordx4 v32, s[16:19], s40 offen lds
  s_add_u32 s40, s56, 1572864
  s_mov_b32 m0, 49152
  s_nop 0
  buffer_load_dwordx4 v32, s[8:11], s40 offen lds
  s_add_u32 s40, s56, 1572864
  s_mov_b32 m0, 53248
  s_nop 0
  buffer_load_dwordx4 v32, s[12:15], s40 offen lds
  s_add_u32 s40, s56, 1572864
  s_mov_b32 m0, 57344
  s_nop 0
  buffer_load_dwordx4 v32, s[16:19], s40 offen lds
  s_add_u32 s40, s56, 1966080
  s_mov_b32 m0, 61440
  s_nop 0
  buffer_load_dwordx4 v32, s[8:11], s40 offen lds
  s_add_u32 s40, s56, 1966080
  s_mov_b32 m0, 65536
  s_nop 0
  buffer_load_dwordx4 v32, s[12:15], s40 offen lds
  s_add_u32 s40, s56, 1966080
  s_mov_b32 m0, 69632
  s_nop 0
  buffer_load_dwordx4 v32, s[16:19], s40 offen lds
  s_add_u32 s40, s56, 2359296
  s_mov_b32 m0, 73728
  s_nop 0
  buffer_load_dwordx4 v32, s[8:11], s40 offen lds
  s_add_u32 s40, s56, 2359296
  s_mov_b32 m0, 77824
  s_nop 0
  buffer_load_dwordx4 v32, s[12:15], s40 offen lds
  s_add_u32 s40, s56, 2359296
  s_mov_b32 m0, 81920
  s_nop 0
  buffer_load_dwordx4 v32, s[16:19], s40 offen lds
  s_add_u32 s40, s56, 2752512
  s_mov_b32 m0, 86016
  s_nop 0
  buffer_load_dwordx4 v32, s[8:11], s40 offen lds
  s_add_u32 s40, s56, 2752512
  s_mov_b32 m0, 90112
  s_nop 0
  buffer_load_dwordx4 v32, s[12:15], s40 offen lds
  s_add_u32 s40, s56, 2752512
  s_mov_b32 m0, 94208
  s_nop 0
  buffer_load_dwordx4 v32, s[16:19], s40 offen lds
  s_add_u32 s40, s56, 3145728
  s_mov_b32 m0, 98304
  s_nop 0
  buffer_load_dwordx4 v32, s[8:11], s40 offen lds
  s_add_u32 s40, s56, 3145728
  s_mov_b32 m0, 102400
  s_nop 0
  buffer_load_dwordx4 v32, s[12:15], s40 offen lds
  s_add_u32 s40, s56, 3145728
  s_mov_b32 m0, 106496
  s_nop 0
  buffer_load_dwordx4 v32, s[16:19], s40 offen lds
  s_add_u32 s40, s56, 3538944
  s_mov_b32 m0, 110592
  s_nop 0
  buffer_load_dwordx4 v32, s[8:11], s40 offen lds
  s_add_u32 s40, s56, 3538944
  s_mov_b32 m0, 114688
  s_nop 0
  buffer_load_dwordx4 v32, s[12:15], s40 offen lds
  s_add_u32 s40, s56, 3538944
  s_mov_b32 m0, 118784
  s_nop 0
  buffer_load_dwordx4 v32, s[16:19], s40 offen lds
  s_add_u32 s40, s56, 3932160
  buffer_load_dwordx4 v[64:67], v32, s[8:11], s40 offen
  s_add_u32 s40, s56, 3932160
  buffer_load_dwordx4 v[68:71], v32, s[12:15], s40 offen
  s_add_u32 s40, s56, 3932160
  buffer_load_dwordx4 v[72:75], v32, s[16:19], s40 offen
  s_add_u32 s40, s56, 4325376
  buffer_load_dwordx4 v[76:79], v32, s[8:11], s40 offen
  s_add_u32 s40, s56, 4325376
  buffer_load_dwordx4 v[80:83], v32, s[12:15], s40 offen
  s_add_u32 s40, s56, 4325376
  buffer_load_dwordx4 v[84:87], v32, s[16:19], s40 offen
  s_add_u32 s40, s56, 4718592
  buffer_load_dwordx4 v[88:91], v32, s[8:11], s40 offen
  s_add_u32 s40, s56, 4718592
  buffer_load_dwordx4 v[92:95], v32, s[12:15], s40 offen
  s_add_u32 s40, s56, 4718592
  buffer_load_dwordx4 v[96:99], v32, s[16:19], s40 offen
  s_add_u32 s40, s56, 5111808
  buffer_load_dwordx4 v[100:103], v32, s[8:11], s40 offen
  s_add_u32 s40, s56, 5111808
  buffer_load_dwordx4 v[104:107], v32, s[12:15], s40 offen
  s_add_u32 s40, s56, 5111808
  buffer_load_dwordx4 v[108:111], v32, s[16:19], s40 offen
  s_add_u32 s40, s56, 5505024
  buffer_load_dwordx4 v[112:115], v32, s[8:11], s40 offen
  s_add_u32 s40, s56, 5505024
  buffer_load_dwordx4 v[116:119], v32, s[12:15], s40 offen
  s_add_u32 s40, s56, 5505024
  buffer_load_dwordx4 v[120:123], v32, s[16:19], s40 offen
  s_add_u32 s40, s56, 5898240
  buffer_load_dwordx4 v[124:127], v32, s[8:11], s40 offen
  s_add_u32 s40, s56, 5898240
  buffer_load_dwordx4 v[128:131], v32, s[12:15], s40 offen
  s_add_u32 s40, s56, 5898240
  buffer_load_dwordx4 v[132:135], v32, s[16:19], s40 offen
  s_add_u32 s40, s56, 6291456
  buffer_load_dwordx4 v[136:139], v32, s[8:11], s40 offen
  s_add_u32 s40, s56, 6291456
  buffer_load_dwordx4 v[140:143], v32, s[12:15], s40 offen
  s_add_u32 s40, s56, 6291456
  buffer_load_dwordx4 v[144:147], v32, s[16:19], s40 offen
  s_add_u32 s40, s56, 6684672
  buffer_load_dwordx4 v[148:151], v32, s[8:11], s40 offen
  s_add_u32 s40, s56, 6684672
  buffer_load_dwordx4 v[152:155], v32, s[12:15], s40 offen
  s_add_u32 s40, s56, 6684672
  buffer_load_dwordx4 v[156:159], v32, s[16:19], s40 offen
  s_add_u32 s40, s56, 7077888
  buffer_load_dwordx4 v[160:163], v32, s[8:11], s40 offen
  s_add_u32 s40, s56, 7077888
  buffer_load_dwordx4 v[164:167], v32, s[12:15], s40 offen
  s_add_u32 s40, s56, 7077888
  buffer_load_dwordx4 v[168:171], v32, s[16:19], s40 offen
  s_add_u32 s40, s56, 7471104
  buffer_load_dwordx4 v[172:175], v32, s[8:11], s40 offen
  s_add_u32 s40, s56, 7471104
  buffer_load_dwordx4 v[176:179], v32, s[12:15], s40 offen
  s_add_u32 s40, s56, 7471104
  buffer_load_dwordx4 v[180:183], v32, s[16:19], s40 offen
  s_waitcnt vmcnt(45)
  s_barrier
  ds_read_b64_tr_b16 a[0:1], v33 offset:0
  ds_read_b64_tr_b16 a[2:3], v33 offset:256
  ds_read_b64_tr_b16 a[80:81], v33 offset:4096
  ds_read_b64_tr_b16 a[82:83], v33 offset:4352
  ds_read_b64_tr_b16 a[4:5], v33 offset:12288
  ds_read_b64_tr_b16 a[6:7], v33 offset:12544
  ds_read_b64_tr_b16 a[84:85], v33 offset:16384
  ds_read_b64_tr_b16 a[86:87], v33 offset:16640
  ds_read_b64_tr_b16 a[8:9], v33 offset:24576
  ds_read_b64_tr_b16 a[10:11], v33 offset:24832
  ds_read_b64_tr_b16 a[88:89], v33 offset:28672
  ds_read_b64_tr_b16 a[90:91], v33 offset:28928
  s_waitcnt lgkmcnt(4)
  ds_read_b64_tr_b16 a[12:13], v33 offset:36864
  ds_read_b64_tr_b16 a[14:15], v33 offset:37120
  ds_read_b64_tr_b16 a[92:93], v33 offset:40960
  ds_read_b64_tr_b16 a[94:95], v33 offset:41216
  ds_read_b64_tr_b16 a[16:17], v33 offset:49152
  ds_read_b64_tr_b16 a[18:19], v33 offset:49408
  ds_read_b64_tr_b16 a[96:97], v33 offset:53248
  ds_read_b64_tr_b16 a[98:99], v33 offset:53504
  s_waitcnt lgkmcnt(0)
  s_barrier
  s_waitcnt vmcnt(30)
  s_barrier
  ds_read_b64_tr_b16 a[20:21], v33 offset:61440
  ds_read_b64_tr_b16 a[22:23], v33 offset:61696
  ds_read_b64_tr_b16 a[100:101], v34 offset:4096
  ds_read_b64_tr_b16 a[102:103], v34 offset:4352
  ds_read_b64_tr_b16 a[24:25], v34 offset:12288
  ds_read_b64_tr_b16 a[26:27], v34 offset:12544
  ds_read_b64_tr_b16 a[104:105], v34 offset:16384
  ds_read_b64_tr_b16 a[106:107], v34 offset:16640
  ds_read_b64_tr_b16 a[28:29], v34 offset:24576
  ds_read_b64_tr_b16 a[30:31], v34 offset:24832
  ds_read_b64_tr_b16 a[108:109], v34 offset:28672
  ds_read_b64_tr_b16 a[110:111], v34 offset:28928
  s_waitcnt lgkmcnt(4)
  ds_read_b64_tr_b16 a[32:33], v34 offset:36864
  ds_read_b64_tr_b16 a[34:35], v34 offset:37120
  ds_read_b64_tr_b16 a[112:113], v34 offset:40960
  ds_read_b64_tr_b16 a[114:115], v34 offset:41216
  ds_read_b64_tr_b16 a[36:37], v34 offset:49152
  ds_read_b64_tr_b16 a[38:39], v34 offset:49408
  ds_read_b64_tr_b16 a[116:117], v34 offset:53248
  ds_read_b64_tr_b16 a[118:119], v34 offset:53504
  s_waitcnt lgkmcnt(0)
  s_barrier
  s_waitcnt vmcnt(15)
  ds_write_b128 v35, v[64:67] offset:0
  ds_write_b128 v35, v[68:71] offset:4096
  ds_write_b128 v35, v[72:75] offset:8192
  ds_write_b128 v35, v[76:79] offset:12288
  ds_write_b128 v35, v[80:83] offset:16384
  ds_write_b128 v35, v[84:87] offset:20480
  s_waitcnt lgkmcnt(6)
  ds_write_b128 v35, v[88:91] offset:24576
  ds_write_b128 v35, v[92:95] offset:28672
  ds_write_b128 v35, v[96:99] offset:32768
  ds_write_b128 v35, v[100:103] offset:36864
  ds_write_b128 v35, v[104:107] offset:40960
  ds_write_b128 v35, v[108:111] offset:45056
  s_waitcnt lgkmcnt(6)
  ds_write_b128 v35, v[112:115] offset:49152
  ds_write_b128 v35, v[116:119] offset:53248
  ds_write_b128 v35, v[120:123] offset:57344
  s_waitcnt lgkmcnt(0)
  s_barrier
  ds_read_b64_tr_b16 a[40:41], v33 offset:0
  ds_read_b64_tr_b16 a[42:43], v33 offset:256
  ds_read_b64_tr_b16 a[120:121], v33 offset:4096
  ds_read_b64_tr_b16 a[122:123], v33 offset:4352
  ds_read_b64_tr_b16 a[44:45], v33 offset:12288
  ds_read_b64_tr_b16 a[46:47], v33 offset:12544
  ds_read_b64_tr_b16 a[124:125], v33 offset:16384
  ds_read_b64_tr_b16 a[126:127], v33 offset:16640
  ds_read_b64_tr_b16 a[48:49], v33 offset:24576
  ds_read_b64_tr_b16 a[50:51], v33 offset:24832
  ds_read_b64_tr_b16 a[128:129], v33 offset:28672
  ds_read_b64_tr_b16 a[130:131], v33 offset:28928
  s_waitcnt lgkmcnt(4)
  ds_read_b64_tr_b16 a[52:53], v33 offset:36864
  ds_read_b64_tr_b16 a[54:55], v33 offset:37120
  ds_read_b64_tr_b16 a[132:133], v33 offset:40960
  ds_read_b64_tr_b16 a[134:135], v33 offset:41216
  ds_read_b64_tr_b16 a[56:57], v33 offset:49152
  ds_read_b64_tr_b16 a[58:59], v33 offset:49408
  ds_read_b64_tr_b16 a[136:137], v33 offset:53248
  ds_read_b64_tr_b16 a[138:139], v33 offset:53504
  s_waitcnt lgkmcnt(0)
  s_barrier
  s_waitcnt vmcnt(0)
  ds_write_b128 v36, v[124:127] offset:0
  ds_write_b128 v36, v[128:131] offset:4096
  ds_write_b128 v36, v[132:135] offset:8192
  ds_write_b128 v36, v[136:139] offset:12288
  ds_write_b128 v36, v[140:143] offset:16384
  ds_write_b128 v36, v[144:147] offset:20480
  s_waitcnt lgkmcnt(6)
  ds_write_b128 v36, v[148:151] offset:24576
  ds_write_b128 v36, v[152:155] offset:28672
  ds_write_b128 v36, v[156:159] offset:32768
  ds_write_b128 v36, v[160:163] offset:36864
  ds_write_b128 v36, v[164:167] offset:40960
  ds_write_b128 v36, v[168:171] offset:45056
  s_waitcnt lgkmcnt(6)
  ds_write_b128 v36, v[172:175] offset:49152
  ds_write_b128 v36, v[176:179] offset:53248
  ds_write_b128 v36, v[180:183] offset:57344
  s_waitcnt lgkmcnt(0)
  s_barrier
  ds_read_b64_tr_b16 a[60:61], v33 offset:61440
  ds_read_b64_tr_b16 a[62:63], v33 offset:61696
  ds_read_b64_tr_b16 a[140:141], v34 offset:4096
  ds_read_b64_tr_b16 a[142:143], v34 offset:4352
  ds_read_b64_tr_b16 a[64:65], v34 offset:12288
  ds_read_b64_tr_b16 a[66:67], v34 offset:12544
  ds_read_b64_tr_b16 a[144:145], v34 offset:16384
  ds_read_b64_tr_b16 a[146:147], v34 offset:16640
  ds_read_b64_tr_b16 a[68:69], v34 offset:24576
  ds_read_b64_tr_b16 a[70:71], v34 offset:24832
  ds_read_b64_tr_b16 a[148:149], v34 offset:28672
  ds_read_b64_tr_b16 a[150:151], v34 offset:28928
  s_waitcnt lgkmcnt(4)
  ds_read_b64_tr_b16 a[72:73], v34 offset:36864
  ds_read_b64_tr_b16 a[74:75], v34 offset:37120
  ds_read_b64_tr_b16 a[152:153], v34 offset:40960
  ds_read_b64_tr_b16 a[154:155], v34 offset:41216
  ds_read_b64_tr_b16 a[76:77], v34 offset:49152
  ds_read_b64_tr_b16 a[78:79], v34 offset:49408
  ds_read_b64_tr_b16 a[156:157], v34 offset:53248
  ds_read_b64_tr_b16 a[158:159], v34 offset:53504
  s_waitcnt lgkmcnt(0)
  s_barrier
  s_mul_i32 s56, s25, 245760
  s_mul_i32 s40, s26, 320
  s_add_u32 s56, s56, s40
  s_add_u32 s56, s56, 0
  v_lshrrev_b32 v4, 2, v1
  s_mov_b32 s55, 1280
  v_mul_lo_u32 v32, v4, s55
  v_and_b32 v4, 3, v1
  v_lshlrev_b32 v4, 4, v4
  v_add_u32 v32, v32, v4
  v_lshrrev_b32 v33, 4, v1
  v_lshlrev_b32 v33, 2, v33
  v_bfe_u32 v4, v1, 2, 2
  v_add_u32 v33, v33, v4
  v_mul_u32_u24 v33, 64, v33
  v_and_b32 v4, 3, v1
  v_lshlrev_b32 v4, 3, v4
  v_add_u32 v33, v33, v4
  v_add_u32 v33, s54, v33
  s_add_u32 s40, s56, 0
  s_add_u32 m0, s54, 0
  s_nop 0
  buffer_load_dwordx4 v32, s[20:23], s40 offen lds
  s_add_u32 s40, s56, 20480
  s_add_u32 m0, s54, 1024
  s_nop 0
  buffer_load_dwordx4 v32, s[20:23], s40 offen lds
  s_add_u32 s40, s56, 64
  s_add_u32 m0, s54, 2048
  s_nop 0
  buffer_load_dwordx4 v32, s[20:23], s40 offen lds
  s_add_u32 s40, s56, 20544
  s_add_u32 m0, s54, 3072
  s_nop 0
  buffer_load_dwordx4 v32, s[20:23], s40 offen lds
  s_add_u32 s40, s56, 40960
  s_add_u32 m0, s54, 4096
  s_nop 0
  buffer_load_dwordx4 v32, s[20:23], s40 offen lds
  s_add_u32 s40, s56, 61440
  s_add_u32 m0, s54, 5120
  s_nop 0
  buffer_load_dwordx4 v32, s[20:23], s40 offen lds
  s_add_u32 s40, s56, 41024
  s_add_u32 m0, s54, 6144
  s_nop 0
  buffer_load_dwordx4 v32, s[20:23], s40 offen lds
  s_add_u32 s40, s56, 61504
  s_add_u32 m0, s54, 7168
  s_nop 0
  buffer_load_dwordx4 v32, s[20:23], s40 offen lds
  s_add_u32 s40, s56, 81920
  s_add_u32 m0, s54, 8192
  s_nop 0
  buffer_load_dwordx4 v32, s[20:23], s40 offen lds
  s_add_u32 s40, s56, 102400
  s_add_u32 m0, s54, 9216
  s_nop 0
  buffer_load_dwordx4 v32, s[20:23], s40 offen lds
  s_add_u32 s40, s56, 81984
  s_add_u32 m0, s54, 10240
  s_nop 0
  buffer_load_dwordx4 v32, s[20:23], s40 offen lds
  s_add_u32 s40, s56, 102464
  s_add_u32 m0, s54, 11264
  s_nop 0
  buffer_load_dwordx4 v32, s[20:23], s40 offen lds
  s_add_u32 s40, s56, 122880
  s_add_u32 m0, s54, 12288
  s_nop 0
  buffer_load_dwordx4 v32, s[20:23], s40 offen lds
  s_add_u32 s40, s56, 143360
  s_add_u32 m0, s54, 13312
  s_nop 0
  buffer_load_dwordx4 v32, s[20:23], s40 offen lds
  s_add_u32 s40, s56, 122944
  s_add_u32 m0, s54, 14336
  s_nop 0
  buffer_load_dwordx4 v32, s[20:23], s40 offen lds
  s_add_u32 s40, s56, 143424
  s_add_u32 m0, s54, 15360
  s_nop 0
  buffer_load_dwordx4 v32, s[20:23], s40 offen lds
  s_add_u32 s40, s56, 163840
  s_add_u32 m0, s54, 16384
  s_nop 0
  buffer_load_dwordx4 v32, s[20:23], s40 offen lds
  s_add_u32 s40, s56, 184320
  s_add_u32 m0, s54, 17408
  s_nop 0
  buffer_load_dwordx4 v32, s[20:23], s40 offen lds
  s_add_u32 s40, s56, 163904
  s_add_u32 m0, s54, 18432
  s_nop 0
  buffer_load_dwordx4 v32, s[20:23], s40 offen lds
  s_add_u32 s40, s56, 184384
  s_add_u32 m0, s54, 19456
  s_nop 0
  buffer_load_dwordx4 v32, s[20:23], s40 offen lds
  s_add_u32 s40, s56, 204800
  s_add_u32 m0, s54, 20480
  s_nop 0
  buffer_load_dwordx4 v32, s[20:23], s40 offen lds
  s_add_u32 s40, s56, 225280
  s_add_u32 m0, s54, 21504
  s_nop 0
  buffer_load_dwordx4 v32, s[20:23], s40 offen lds
  s_add_u32 s40, s56, 204864
  s_add_u32 m0, s54, 22528
  s_nop 0
  buffer_load_dwordx4 v32, s[20:23], s40 offen lds
  s_add_u32 s40, s56, 225344
  s_add_u32 m0, s54, 23552
  s_nop 0
  buffer_load_dwordx4 v32, s[20:23], s40 offen lds
  s_waitcnt vmcnt(20)
  ds_read_b64_tr_b16 a[160:161], v33 offset:0
  ds_read_b64_tr_b16 a[162:163], v33 offset:1024
  ds_read_b64_tr_b16 a[184:185], v33 offset:32
  ds_read_b64_tr_b16 a[186:187], v33 offset:1056
  ds_read_b64_tr_b16 a[208:209], v33 offset:2048
  ds_read_b64_tr_b16 a[210:211], v33 offset:3072
  ds_read_b64_tr_b16 a[232:233], v33 offset:2080
  ds_read_b64_tr_b16 a[234:235], v33 offset:3104
  s_waitcnt vmcnt(16)
  ds_read_b64_tr_b16 a[164:165], v33 offset:4096
  ds_read_b64_tr_b16 a[166:167], v33 offset:5120
  ds_read_b64_tr_b16 a[188:189], v33 offset:4128
  ds_read_b64_tr_b16 a[190:191], v33 offset:5152
  ds_read_b64_tr_b16 a[212:213], v33 offset:6144
  ds_read_b64_tr_b16 a[214:215], v33 offset:7168
  ds_read_b64_tr_b16 a[236:237], v33 offset:6176
  ds_read_b64_tr_b16 a[238:239], v33 offset:7200
  s_waitcnt vmcnt(12)
  ds_read_b64_tr_b16 a[168:169], v33 offset:8192
  ds_read_b64_tr_b16 a[170:171], v33 offset:9216
  ds_read_b64_tr_b16 a[192:193], v33 offset:8224
  ds_read_b64_tr_b16 a[194:195], v33 offset:9248
  ds_read_b64_tr_b16 a[216:217], v33 offset:10240
  ds_read_b64_tr_b16 a[218:219], v33 offset:11264
  ds_read_b64_tr_b16 a[240:241], v33 offset:10272
  ds_read_b64_tr_b16 a[242:243], v33 offset:11296
  s_waitcnt vmcnt(8)
  ds_read_b64_tr_b16 a[172:173], v33 offset:12288
  ds_read_b64_tr_b16 a[174:175], v33 offset:13312
  ds_read_b64_tr_b16 a[196:197], v33 offset:12320
  ds_read_b64_tr_b16 a[198:199], v33 offset:13344
  ds_read_b64_tr_b16 a[220:221], v33 offset:14336
  ds_read_b64_tr_b16 a[222:223], v33 offset:15360
  ds_read_b64_tr_b16 a[244:245], v33 offset:14368
  ds_read_b64_tr_b16 a[246:247], v33 offset:15392
  s_waitcnt vmcnt(4)
  ds_read_b64_tr_b16 a[176:177], v33 offset:16384
  ds_read_b64_tr_b16 a[178:179], v33 offset:17408
  ds_read_b64_tr_b16 a[200:201], v33 offset:16416
  ds_read_b64_tr_b16 a[202:203], v33 offset:17440
  ds_read_b64_tr_b16 a[224:225], v33 offset:18432
  ds_read_b64_tr_b16 a[226:227], v33 offset:19456
  ds_read_b64_tr_b16 a[248:249], v33 offset:18464
  ds_read_b64_tr_b16 a[250:251], v33 offset:19488
  s_waitcnt vmcnt(0)
  ds_read_b64_tr_b16 a[180:181], v33 offset:20480
  ds_read_b64_tr_b16 a[182:183], v33 offset:21504
  ds_read_b64_tr_b16 a[204:205], v33 offset:20512
  ds_read_b64_tr_b16 a[206:207], v33 offset:21536
  ds_read_b64_tr_b16 a[228:229], v33 offset:22528
  ds_read_b64_tr_b16 a[230:231], v33 offset:23552
  ds_read_b64_tr_b16 a[252:253], v33 offset:22560
  ds_read_b64_tr_b16 a[254:255], v33 offset:23584
  s_waitcnt lgkmcnt(0)
  v_lshlrev_b32 v6, 4, v1
  v_lshlrev_b32 v29, 3, v1
  v_mov_b32 v31, 0
  s_mov_b32 s34, 0x00ff00ff
  s_mov_b32 s35, 0x00ff00ff
  s_mov_b32 s38, 0xff00ff00
  s_mov_b32 s39, 0xff00ff00
  s_mov_b32 s20, 0
  s_mov_b32 s21, -1
  v_mov_b32 v248, 0xff800000
  s_mov_b32 s16, 0x0000ffff
  s_mov_b32 s17, 0x0000ffff
  v_mov_b32 v21, 0x44444444
  v_mov_b32 v4, 0xeeeeeeee
  v_cndmask_b32 v21, v21, v4, s[38:39]
  s_mov_b32 s60, 0x3dd53b95
  s_mov_b32 s61, 400000
  s_mov_b32 s28, 0
  s_mov_b32 s80, 0
  s_mov_b32 s81, 0
  s_mov_b32 s82, 0
  s_mov_b32 s83, 0
  s_mov_b32 s84, 0
  s_mov_b32 s85, 0
  s_mov_b32 s86, 0
  s_mov_b32 s87, 0
  s_mov_b32 s92, 0
  s_mov_b32 s93, 0
  s_mov_b32 s94, 0
  s_lshr_b32 s40, s27, 5
  s_mul_i32 s40, s40, 10240
  s_add_u32 s40, s40, 622592
  v_add_u32 v23, s40, v6
  v_lshrrev_b32 v5, 13, v23
  v_lshlrev_b32 v5, 14, v5
  v_and_b32 v23, 0x1fff, v23
  v_or_b32 v23, v23, v5
  v_add_u32 v24, s40, v6
  v_add_u32 v24, 1024, v24
  v_lshrrev_b32 v5, 13, v24
  v_lshlrev_b32 v5, 14, v5
  v_and_b32 v24, 0x1fff, v24
  v_or_b32 v24, v24, v5
  v_add_u32 v25, s40, v6
  v_add_u32 v25, 2048, v25
  v_lshrrev_b32 v5, 13, v25
  v_lshlrev_b32 v5, 14, v5
  v_and_b32 v25, 0x1fff, v25
  v_or_b32 v25, v25, v5
  v_mov_b32 v4, 0x80000000
  v_cmp_gt_u32 vcc, 32, v1
  s_nop 1
  v_cndmask_b32 v25, v4, v25, vcc
  v_add_u32 v10, 0, v6
  v_lshlrev_b32 v15, 7, v2
  v_and_b32 v4, 7, v1
  v_lshlrev_b32 v4, 4, v4
  v_add_u32 v15, v15, v4
  v_add_u32 v15, 0, v15
  v_lshrrev_b32 v12, 1, v2
  v_mul_u32_u24 v12, 3072, v12
  v_lshlrev_b32 v4, 4, v3
  v_add_u32 v12, v12, v4
  v_and_b32 v4, 1, v2
  v_lshlrev_b32 v4, 3, v4
  v_add_u32 v12, v12, v4
  s_mul_i32 s40, s26, 3
  s_add_u32 s40, s40, 0
  s_lshl_b32 s40, s40, 8
  s_mul_i32 s41, s25, 9216
  s_add_u32 s40, s40, s41
  v_add_u32 v12, s40, v12
  v_lshrrev_b32 v4, 13, v12
  v_lshlrev_b32 v4, 14, v4
  v_and_b32 v12, 0x1fff, v12
  v_or_b32 v12, v12, v4
  s_add_u32 s40, s41, 0
  v_add_u32 v16, s40, v6
  v_add_u32 v17, 1024, v16
  v_add_u32 v19, 10240, v6
  v_lshrrev_b32 v4, 13, v16
  v_lshlrev_b32 v4, 14, v4
  v_and_b32 v16, 0x1fff, v16
  v_or_b32 v16, v16, v4
  v_lshrrev_b32 v4, 13, v17
  v_lshlrev_b32 v4, 14, v4
  v_and_b32 v17, 0x1fff, v17
  v_or_b32 v17, v17, v4
  v_lshlrev_b32 v20, 2, v2
  v_bfe_u32 v4, v1, 2, 2
  v_add_u32 v20, v20, v4
  v_lshlrev_b32 v20, 4, v20
  v_and_b32 v4, 1, v1
  v_lshlrev_b32 v4, 3, v4
  v_add_u32 v20, v20, v4
  v_add_u32 v20, 10240, v20
  v_bfe_u32 v22, v1, 5, 1
  v_lshlrev_b32 v22, 5, v22
  v_bfe_u32 v4, v1, 4, 1
  v_lshlrev_b32 v4, 3, v4
  v_add_u32 v22, v22, v4
  v_bfe_u32 v4, v1, 2, 1
  v_add_u32 v22, v22, v4
  v_bfe_u32 v4, v1, 3, 1
  v_lshlrev_b32 v4, 4, v4
  v_add_u32 v22, v22, v4
  v_bfe_u32 v4, v1, 1, 1
  v_lshlrev_b32 v4, 1, v4
  v_add_u32 v22, v22, v4
  v_lshlrev_b32 v22, 4, v22
  v_and_b32 v4, 1, v1
  v_lshlrev_b32 v4, 3, v4
  v_add_u32 v22, v22, v4
  v_add_u32 v22, 16384, v22
  v_lshrrev_b32 v28, 1, v2
  v_lshlrev_b32 v28, 14, v28
  v_and_b32 v4, 1, v2
  v_lshlrev_b32 v4, 12, v4
  v_add_u32 v28, v28, v4
  v_and_b32 v4, 7, v1
  v_lshlrev_b32 v4, 4, v4
  v_add_u32 v28, v28, v4
  s_lshl_b32 s40, s25, 7
  v_add_u32 v28, s40, v28
  v_lshlrev_b32 v9, 10, v2
  v_and_b32 v4, 7, v1
  v_lshlrev_b32 v4, 4, v4
  v_add_u32 v9, v9, v4
  s_and_b32 s40, s25, 7
  s_lshl_b32 s40, s40, 7
  v_add_u32 v9, s40, v9
  s_lshr_b32 s76, s27, 5
  s_mul_i32 s76, s76, 81920
  s_mul_i32 s40, s26, 20480
  s_add_u32 s76, s76, s40
  s_add_u32 s76, s76, 0
  s_lshr_b32 s40, s76, 13
  s_lshl_b32 s40, s40, 14
  s_and_b32 s76, s76, 0x1fff
  s_or_b32 s76, s76, s40
  s_add_u32 s76, s76, 589824
  s_lshr_b32 s77, s27, 5
  s_mul_i32 s77, s77, 81920
  s_mul_i32 s40, s26, 20480
  s_add_u32 s77, s77, s40
  s_add_u32 s77, s77, 4096
  s_lshr_b32 s40, s77, 13
  s_lshl_b32 s40, s40, 14
  s_and_b32 s77, s77, 0x1fff
  s_or_b32 s77, s77, s40
  s_add_u32 s77, s77, 589824
  s_mul_i32 s48, s26, 163840
  s_add_u32 s48, s48, 589824
  s_mul_i32 s40, s25, 12288
  s_add_u32 s44, s40, 12582912
  s_mul_i32 s40, s25, 40
  s_mul_i32 s41, s26, 10
  s_add_u32 s40, s40, s41
  s_add_u32 s40, s40, 0
  s_lshl_b32 s45, s40, 10
  s_add_u32 s45, s45, 132120576
  s_lshl_b32 s46, s40, 8
  s_add_u32 s46, s46, 111149056
  s_mul_i32 s47, s25, 3072
  s_add_u32 s47, s47, 99614720
  s_mov_b32 s49, 20480
  s_mov_b32 s50, 20480
  s_lshl_b32 s53, s27, 7
  s_add_u32 s53, s53, 8392704
  s_mul_i32 s40, s25, 6
  s_lshr_b32 s41, s40, 3
  s_add_u32 s40, s40, 5
  s_lshr_b32 s40, s40, 3
  v_mov_b32 v249, s40
  v_mov_b32 v4, s41
  v_and_b32 v5, 1, v1
  v_cmp_eq_u32 vcc, 0, v5
  s_nop 1
  v_cndmask_b32 v249, v249, v4, vcc
  v_cmp_lt_u32 vcc, 1, v1
  v_mov_b32 v4, 24
  s_nop 0
  v_cndmask_b32 v4, 0, v4, vcc
  v_add_u32 v249, v249, v4
  v_lshlrev_b32 v249, 7, v249
  v_add_u32 v249, 8437760, v249
  s_mov_b32 s33, 0
  s_mov_b32 s22, 0
  s_add_u32 s40, s25, 94
  s_lshl_b32 s40, s40, 7
  s_add_u32 s40, s40, 8437760
  v_mov_b32 v11, s40
  s_load_dwordx2 s[96:97], s[0:1], 96
  v_and_b32 v5, 15, v1
  v_lshlrev_b32 v5, 2, v5
  s_mov_b32 s43, 0
  s_waitcnt lgkmcnt(0)
RM0_MD:
  global_load_dword v4, v5, s[96:97] sc1
  s_waitcnt vmcnt(0)
  s_mov_b32 s40, 0
  s_mov_b32 s57, 1
  v_readlane_b32 s41, v4, 0
  s_nop 0
  s_add_u32 s40, s40, s41
  s_cmp_eq_u32 s41, 32
  s_cselect_b32 s57, s57, 0
  v_readlane_b32 s41, v4, 1
  s_nop 0
  s_add_u32 s40, s40, s41
  s_cmp_eq_u32 s41, 32
  s_cselect_b32 s57, s57, 0
  v_readlane_b32 s41, v4, 2
  s_nop 0
  s_add_u32 s40, s40, s41
  s_cmp_eq_u32 s41, 32
  s_cselect_b32 s57, s57, 0
  v_readlane_b32 s41, v4, 3
  s_nop 0
  s_add_u32 s40, s40, s41
  s_cmp_eq_u32 s41, 32
  s_cselect_b32 s57, s57, 0
  v_readlane_b32 s41, v4, 4
  s_nop 0
  s_add_u32 s40, s40, s41
  s_cmp_eq_u32 s41, 32
  s_cselect_b32 s57, s57, 0
  v_readlane_b32 s41, v4, 5
  s_nop 0
  s_add_u32 s40, s40, s41
  s_cmp_eq_u32 s41, 32
  s_cselect_b32 s57, s57, 0
  v_readlane_b32 s41, v4, 6
  s_nop 0
  s_add_u32 s40, s40, s41
  s_cmp_eq_u32 s41, 32
  s_cselect_b32 s57, s57, 0
  v_readlane_b32 s41, v4, 7
  s_nop 0
  s_add_u32 s40, s40, s41
  s_cmp_eq_u32 s41, 32
  s_cselect_b32 s57, s57, 0
  v_readlane_b32 s41, v4, 12
  v_readlane_b32 s42, v4, 13
  s_cmp_ge_u32 s40, 256
  s_nop 2
  s_cbranch_scc0 RM0_MDN
  s_cmp_ge_u32 s41, 80
  s_cbranch_scc0 RM0_MDN
  s_and_b32 s40, s42, 0xaa
  s_cmp_eq_u32 s40, 0xaa
  s_cbranch_scc1 RM0_POLOK
RM0_MDN:
  s_sleep 4
  s_add_u32 s43, s43, 1
  s_cmp_lt_u32 s43, 0x200000
  s_cbranch_scc1 RM0_MD
  s_mov_b32 s57, 0
RM0_POLOK:
  s_and_b32 s40, s42, 0x55
  s_xor_b32 s40, s40, 0x44
  s_bcnt1_i32_b32 s41, s40
  s_cmp_ge_u32 s41, 3
  s_cselect_b32 s40, 0x55, s40
  s_cmp_le_u32 s41, 1
  s_cselect_b32 s40, 0, s40
  s_xor_b32 s42, s40, 0x44
  s_bfe_u32 s40, s42, 65536
  s_lshl_b32 s40, s40, 13
  s_add_u32 s30, s40, 0
  s_bfe_u32 s40, s42, 65538
  s_lshl_b32 s40, s40, 13
  s_add_u32 s31, s40, 2097152
  s_bfe_u32 s40, s42, 65540
  s_lshl_b32 s40, s40, 13
  s_add_u32 s32, s40, 4194304
  s_bfe_u32 s40, s42, 65542
  s_lshl_b32 s40, s40, 13
  s_add_u32 s29, s40, 6291456
  s_barrier
  ds_write_b128 v10, v[200:203]
  ds_write_b128 v10, v[204:207] offset:1024
  s_mov_b32 exec_hi, 0
  ds_write_b128 v10, v[208:211] offset:2048
  s_mov_b64 exec, -1
  s_mov_b32 s88, 0
  s_mov_b32 s89, 0
  s_add_u32 s33, s33, 2
  s_min_u32 s42, s33, 128
  s_cmp_ge_u32 s22, s42
  s_cbranch_scc1 RM0_WKV1_D
  s_mov_b32 s23, 0
RM0_WKV1:
  buffer_load_dword v4, v249, s[4:7], 0 offen sc1
  s_waitcnt vmcnt(0)
  v_cmp_gt_u32 vcc, s42, v4
  s_nop 3
  s_cbranch_vccz RM0_WKV1_K
  s_sleep 4
  s_add_u32 s23, s23, 1
  s_cmp_lt_u32 s23, 0x100000
  s_cbranch_scc1 RM0_WKV1
RM0_WKV1_K:
  v_readlane_b32 s22, v4, 0
  v_readlane_b32 s41, v4, 1
  s_nop 0
  s_min_u32 s22, s22, s41
  v_readlane_b32 s41, v4, 2
  s_nop 0
  s_min_u32 s22, s22, s41
  v_readlane_b32 s41, v4, 3
  s_nop 0
  s_min_u32 s22, s22, s41
  s_nop 2
RM0_WKV1_D:
  s_add_u32 m0, s49, 0
  s_add_u32 s40, s44, 0
  buffer_load_dwordx4 v6, s[4:7], s40 offen offset:0 sc1 lds
  buffer_load_dwordx4 v6, s[4:7], s40 offen offset:1024 sc1 lds
  buffer_load_dwordx4 v6, s[4:7], s40 offen offset:2048 sc1 lds
  buffer_load_dwordx4 v6, s[4:7], s40 offen offset:3072 sc1 lds
  s_add_u32 m0, s49, 4096
  s_add_u32 s40, s44, 4096
  buffer_load_dwordx4 v6, s[4:7], s40 offen offset:0 sc1 lds
  buffer_load_dwordx4 v6, s[4:7], s40 offen offset:1024 sc1 lds
  buffer_load_dwordx4 v6, s[4:7], s40 offen offset:2048 sc1 lds
  buffer_load_dwordx4 v6, s[4:7], s40 offen offset:3072 sc1 lds
  s_add_u32 m0, s49, 8192
  s_add_u32 s40, s44, 8192
  buffer_load_dwordx4 v6, s[4:7], s40 offen offset:0 sc1 lds
  buffer_load_dwordx4 v6, s[4:7], s40 offen offset:1024 sc1 lds
  buffer_load_dwordx4 v6, s[4:7], s40 offen offset:2048 sc1 lds
  buffer_load_dwordx4 v6, s[4:7], s40 offen offset:3072 sc1 lds
  s_add_u32 s44, s44, 393216
  s_xor_b32 s49, s49, 57344
  s_waitcnt vmcnt(0) lgkmcnt(0)
  s_barrier
  v_add_u32 v4, s50, v6
  ds_read_b128 v[148:151], v4 offset:12288
  ds_read_b128 v[152:155], v4 offset:13312
  ds_read_b128 v[156:159], v4 offset:14336
  ds_read_b128 v[160:163], v4 offset:15360
  ds_read_b128 v[164:167], v4 offset:16384
  ds_read_b128 v[168:171], v4 offset:17408
  ds_read_b128 v[172:175], v4 offset:18432
  ds_read_b128 v[176:179], v4 offset:19456
  s_waitcnt lgkmcnt(4)
  ds_read_b128 v[180:183], v4 offset:20480
  ds_read_b128 v[184:187], v4 offset:21504
  ds_read_b128 v[188:191], v4 offset:22528
  ds_read_b128 v[192:195], v4 offset:23552
  s_waitcnt lgkmcnt(0)
  ds_read_b128 v[100:103], v4 offset:0
  ds_read_b128 v[104:107], v4 offset:1024
  ds_read_b128 v[108:111], v4 offset:2048
  ds_read_b128 v[112:115], v4 offset:3072
  ds_read_b128 v[116:119], v4 offset:4096
  ds_read_b128 v[120:123], v4 offset:5120
  ds_read_b128 v[124:127], v4 offset:6144
  ds_read_b128 v[128:131], v4 offset:7168
  ds_read_b128 v[132:135], v4 offset:8192
  ds_read_b128 v[136:139], v4 offset:9216
  ds_read_b128 v[140:143], v4 offset:10240
  ds_read_b128 v[144:147], v4 offset:11264
  v_mfma_f32_16x16x32_bf16 v[48:51], v[148:151], a[160:163], 0
  v_mfma_f32_16x16x32_bf16 v[52:55], v[172:175], a[160:163], 0
  v_mfma_f32_16x16x32_bf16 v[56:59], v[148:151], a[184:187], 0
  v_mfma_f32_16x16x32_bf16 v[60:63], v[172:175], a[184:187], 0
  v_mfma_f32_16x16x32_bf16 v[64:67], v[148:151], a[208:211], 0
  v_mfma_f32_16x16x32_bf16 v[68:71], v[172:175], a[208:211], 0
  v_mfma_f32_16x16x32_bf16 v[72:75], v[148:151], a[232:235], 0
  v_mfma_f32_16x16x32_bf16 v[76:79], v[172:175], a[232:235], 0
  v_mfma_f32_16x16x32_bf16 v[48:51], v[152:155], a[164:167], v[48:51]
  v_mfma_f32_16x16x32_bf16 v[52:55], v[176:179], a[164:167], v[52:55]
  v_mfma_f32_16x16x32_bf16 v[56:59], v[152:155], a[188:191], v[56:59]
  v_mfma_f32_16x16x32_bf16 v[60:63], v[176:179], a[188:191], v[60:63]
  v_mfma_f32_16x16x32_bf16 v[64:67], v[152:155], a[212:215], v[64:67]
  v_mfma_f32_16x16x32_bf16 v[68:71], v[176:179], a[212:215], v[68:71]
  v_mfma_f32_16x16x32_bf16 v[72:75], v[152:155], a[236:239], v[72:75]
  v_mfma_f32_16x16x32_bf16 v[76:79], v[176:179], a[236:239], v[76:79]
  v_mfma_f32_16x16x32_bf16 v[48:51], v[156:159], a[168:171], v[48:51]
  v_mfma_f32_16x16x32_bf16 v[52:55], v[180:183], a[168:171], v[52:55]
  v_mfma_f32_16x16x32_bf16 v[56:59], v[156:159], a[192:195], v[56:59]
  v_mfma_f32_16x16x32_bf16 v[60:63], v[180:183], a[192:195], v[60:63]
  v_mfma_f32_16x16x32_bf16 v[64:67], v[156:159], a[216:219], v[64:67]
  v_mfma_f32_16x16x32_bf16 v[68:71], v[180:183], a[216:219], v[68:71]
  v_mfma_f32_16x16x32_bf16 v[72:75], v[156:159], a[240:243], v[72:75]
  v_mfma_f32_16x16x32_bf16 v[76:79], v[180:183], a[240:243], v[76:79]
  v_mfma_f32_16x16x32_bf16 v[48:51], v[160:163], a[172:175], v[48:51]
  v_mfma_f32_16x16x32_bf16 v[52:55], v[184:187], a[172:175], v[52:55]
  v_mfma_f32_16x16x32_bf16 v[56:59], v[160:163], a[196:199], v[56:59]
  v_mfma_f32_16x16x32_bf16 v[60:63], v[184:187], a[196:199], v[60:63]
  v_mfma_f32_16x16x32_bf16 v[64:67], v[160:163], a[220:223], v[64:67]
  v_mfma_f32_16x16x32_bf16 v[68:71], v[184:187], a[220:223], v[68:71]
  v_mfma_f32_16x16x32_bf16 v[72:75], v[160:163], a[244:247], v[72:75]
  v_mfma_f32_16x16x32_bf16 v[76:79], v[184:187], a[244:247], v[76:79]
  v_mfma_f32_16x16x32_bf16 v[48:51], v[164:167], a[176:179], v[48:51]
  v_mfma_f32_16x16x32_bf16 v[52:55], v[188:191], a[176:179], v[52:55]
  v_mfma_f32_16x16x32_bf16 v[56:59], v[164:167], a[200:203], v[56:59]
  v_mfma_f32_16x16x32_bf16 v[60:63], v[188:191], a[200:203], v[60:63]
  v_mfma_f32_16x16x32_bf16 v[64:67], v[164:167], a[224:227], v[64:67]
  v_mfma_f32_16x16x32_bf16 v[68:71], v[188:191], a[224:227], v[68:71]
  v_mfma_f32_16x16x32_bf16 v[72:75], v[164:167], a[248:251], v[72:75]
  v_mfma_f32_16x16x32_bf16 v[76:79], v[188:191], a[248:251], v[76:79]
  v_mfma_f32_16x16x32_bf16 v[48:51], v[168:171], a[180:183], v[48:51]
  v_mfma_f32_16x16x32_bf16 v[52:55], v[192:195], a[180:183], v[52:55]
  v_mfma_f32_16x16x32_bf16 v[56:59], v[168:171], a[204:207], v[56:59]
  v_mfma_f32_16x16x32_bf16 v[60:63], v[192:195], a[204:207], v[60:63]
  v_mfma_f32_16x16x32_bf16 v[64:67], v[168:171], a[228:231], v[64:67]
  v_mfma_f32_16x16x32_bf16 v[68:71], v[192:195], a[228:231], v[68:71]
  v_mfma_f32_16x16x32_bf16 v[72:75], v[168:171], a[252:255], v[72:75]
  v_mfma_f32_16x16x32_bf16 v[76:79], v[192:195], a[252:255], v[76:79]
  s_nop 0
  v_cvt_pk_bf16_f32 v232, v48, v49
  v_cvt_pk_bf16_f32 v233, v50, v51
  v_cvt_pk_bf16_f32 v234, v52, v53
  v_cvt_pk_bf16_f32 v235, v54, v55
  s_add_u32 s40, s45, 0
  v_cvt_pk_bf16_f32 v236, v56, v57
  v_cvt_pk_bf16_f32 v237, v58, v59
  v_cvt_pk_bf16_f32 v238, v60, v61
  v_cvt_pk_bf16_f32 v239, v62, v63
  s_add_u32 s40, s45, 1024
  v_cvt_pk_bf16_f32 v240, v64, v65
  v_cvt_pk_bf16_f32 v241, v66, v67
  v_cvt_pk_bf16_f32 v242, v68, v69
  v_cvt_pk_bf16_f32 v243, v70, v71
  s_add_u32 s40, s45, 2048
  v_cvt_pk_bf16_f32 v244, v72, v73
  v_cvt_pk_bf16_f32 v245, v74, v75
  v_cvt_pk_bf16_f32 v246, v76, v77
  v_cvt_pk_bf16_f32 v247, v78, v79
  s_add_u32 s40, s45, 3072
  s_add_u32 s45, s45, 1310720
  s_waitcnt lgkmcnt(0)
  s_xor_b32 s50, s50, 57344
  s_cmp_eq_u32 s57, 0
  s_cbranch_scc1 RM0S_B0
  s_branch RM0F_B0
RM0F_LOOP:
WU_2:
  s_memtime s[58:59]
  s_waitcnt lgkmcnt(0)
  s_sub_u32 s58, s58, s96
  s_cmp_ge_u32 s58, 2600
  s_cbranch_scc1 WU_2_D
  s_sub_u32 s58, 2600, s58
  s_cmp_lt_u32 s58, 96
  s_cbranch_scc1 WU_2
  s_sleep 1
  s_branch WU_2
WU_2_D:
  s_mov_b32 s43, 0
RM0F_AGP:
  buffer_load_dwordx4 v[48:51], v23, s[4:7], s29 offen sc1
  buffer_load_dwordx4 v[52:55], v24, s[4:7], s29 offen sc1
  buffer_load_dwordx4 v[56:59], v25, s[4:7], s29 offen sc1
  s_waitcnt vmcnt(0)
  v_max3_u32 v4, v48, v49, v50
  v_max3_u32 v4, v4, v51, v52
  v_max3_u32 v4, v4, v53, v54
  v_max3_u32 v4, v4, v55, v56
  v_max3_u32 v4, v4, v57, v58
  v_max_u32 v4, v4, v59
  v_cmp_eq_u32 vcc, -1, v4
  s_nop 3
  s_cbranch_vccz RM0F_AGP_OK
  s_add_u32 s43, s43, 1
  s_cmp_lt_u32 s43, s61
  s_cbranch_scc1 RM0F_AGP
  s_mov_b32 s61, 0
RM0F_AGP_OK:
  ds_write_b128 v10, v[48:51]
  ds_write_b128 v10, v[52:55] offset:1024
  s_mov_b32 exec_hi, 0
  ds_write_b128 v10, v[56:59] offset:2048
  s_mov_b64 exec, -1
RM0F_B0:
  s_waitcnt lgkmcnt(0)
  s_barrier
  s_memtime s[98:99]
  ds_read_b128 v[48:51], v6 offset:0
  ds_read_b128 v[52:55], v6 offset:1024
  ds_read_b128 v[56:59], v6 offset:2048
  ds_read_b128 v[60:63], v6 offset:3072
  ds_read_b128 v[64:67], v6 offset:4096
  ds_read_b128 v[68:71], v6 offset:5120
  ds_read_b128 v[72:75], v6 offset:6144
  ds_read_b128 v[76:79], v6 offset:7168
  ds_read_b128 v[80:83], v6 offset:8192
  ds_read_b128 v[84:87], v6 offset:9216
  v_mov_b32 v88, 0
  v_mov_b32 v89, 0
  v_mov_b32 v90, 0
  v_mov_b32 v91, 0
  v_mov_b32 v92, 0
  v_mov_b32 v93, 0
  v_mov_b32 v94, 0
  v_mov_b32 v95, 0
  s_waitcnt lgkmcnt(9)
  v_smfmac_f32_16x16x64_bf16 v[88:91], v[48:51], a[0:7], v21
  v_smfmac_f32_16x16x64_bf16 v[92:95], v[48:51], a[80:87], v21
  s_waitcnt lgkmcnt(8)
  v_smfmac_f32_16x16x64_bf16 v[88:91], v[52:55], a[8:15], v21
  v_smfmac_f32_16x16x64_bf16 v[92:95], v[52:55], a[88:95], v21
  s_waitcnt lgkmcnt(7)
  v_smfmac_f32_16x16x64_bf16 v[88:91], v[56:59], a[16:23], v21
  v_smfmac_f32_16x16x64_bf16 v[92:95], v[56:59], a[96:103], v21
  s_waitcnt lgkmcnt(6)
  v_smfmac_f32_16x16x64_bf16 v[88:91], v[60:63], a[24:31], v21
  v_smfmac_f32_16x16x64_bf16 v[92:95], v[60:63], a[104:111], v21
  s_waitcnt lgkmcnt(5)
  v_smfmac_f32_16x16x64_bf16 v[88:91], v[64:67], a[32:39], v21
  v_smfmac_f32_16x16x64_bf16 v[92:95], v[64:67], a[112:119], v21
  s_waitcnt lgkmcnt(4)
  v_smfmac_f32_16x16x64_bf16 v[88:91], v[68:71], a[40:47], v21
  v_smfmac_f32_16x16x64_bf16 v[92:95], v[68:71], a[120:127], v21
  s_waitcnt lgkmcnt(3)
  v_smfmac_f32_16x16x64_bf16 v[88:91], v[72:75], a[48:55], v21
  v_smfmac_f32_16x16x64_bf16 v[92:95], v[72:75], a[128:135], v21
  s_waitcnt lgkmcnt(2)
  v_smfmac_f32_16x16x64_bf16 v[88:91], v[76:79], a[56:63], v21
  v_smfmac_f32_16x16x64_bf16 v[92:95], v[76:79], a[136:143], v21
  s_waitcnt lgkmcnt(1)
  v_smfmac_f32_16x16x64_bf16 v[88:91], v[80:83], a[64:71], v21
  v_smfmac_f32_16x16x64_bf16 v[92:95], v[80:83], a[144:151], v21
  s_waitcnt lgkmcnt(0)
  v_smfmac_f32_16x16x64_bf16 v[88:91], v[84:87], a[72:79], v21
  v_smfmac_f32_16x16x64_bf16 v[92:95], v[84:87], a[152:159], v21
  s_nop 7
  v_permlane32_swap_b32 v88, v92
  v_permlane32_swap_b32 v89, v93
  v_permlane32_swap_b32 v90, v94
  v_permlane32_swap_b32 v91, v95
  v_add_f32 v88, v88, v92
  v_add_f32 v89, v89, v93
  v_add_f32 v90, v90, v94
  v_add_f32 v91, v91, v95
  v_cvt_pk_bf16_f32 v252, v88, v89
  v_cvt_pk_bf16_f32 v253, v90, v91
  buffer_store_dwordx2 v[252:253], v12, s[4:7], s30 offen
  s_cmp_lg_u32 s28, 0
  s_cbranch_scc1 RM0F_NOS1
  s_add_u32 s33, s33, 2
  s_min_u32 s42, s33, 128
  s_cmp_ge_u32 s22, s42
  s_cbranch_scc1 RM0F_WKV3_D
  s_mov_b32 s23, 0
RM0F_WKV3:
  buffer_load_dword v4, v249, s[4:7], 0 offen sc1
  s_waitcnt vmcnt(0)
  v_cmp_gt_u32 vcc, s42, v4
  s_nop 3
  s_cbranch_vccz RM0F_WKV3_K
  s_sleep 4
  s_add_u32 s23, s23, 1
  s_cmp_lt_u32 s23, 0x100000
  s_cbranch_scc1 RM0F_WKV3
RM0F_WKV3_K:
  v_readlane_b32 s22, v4, 0
  v_readlane_b32 s41, v4, 1
  s_nop 0
  s_min_u32 s22, s22, s41
  v_readlane_b32 s41, v4, 2
  s_nop 0
  s_min_u32 s22, s22, s41
  v_readlane_b32 s41, v4, 3
  s_nop 0
  s_min_u32 s22, s22, s41
  s_nop 2
RM0F_WKV3_D:
  s_add_u32 m0, s49, 0
  s_add_u32 s40, s44, 0
  buffer_load_dwordx4 v6, s[4:7], s40 offen offset:0 sc1 lds
  buffer_load_dwordx4 v6, s[4:7], s40 offen offset:1024 sc1 lds
  buffer_load_dwordx4 v6, s[4:7], s40 offen offset:2048 sc1 lds
  buffer_load_dwordx4 v6, s[4:7], s40 offen offset:3072 sc1 lds
  s_add_u32 m0, s49, 4096
  s_add_u32 s40, s44, 4096
  buffer_load_dwordx4 v6, s[4:7], s40 offen offset:0 sc1 lds
  buffer_load_dwordx4 v6, s[4:7], s40 offen offset:1024 sc1 lds
  buffer_load_dwordx4 v6, s[4:7], s40 offen offset:2048 sc1 lds
  buffer_load_dwordx4 v6, s[4:7], s40 offen offset:3072 sc1 lds
  s_add_u32 m0, s49, 8192
  s_add_u32 s40, s44, 8192
  buffer_load_dwordx4 v6, s[4:7], s40 offen offset:0 sc1 lds
  buffer_load_dwordx4 v6, s[4:7], s40 offen offset:1024 sc1 lds
  buffer_load_dwordx4 v6, s[4:7], s40 offen offset:2048 sc1 lds
  buffer_load_dwordx4 v6, s[4:7], s40 offen offset:3072 sc1 lds
  s_add_u32 s44, s44, 393216
  s_xor_b32 s49, s49, 57344
RM0F_NOS1:
  v_mov_b32 v48, 0
  v_mov_b32 v49, 0
  v_mov_b32 v50, 0
  v_mov_b32 v51, 0
  v_mov_b32 v52, 0
  v_mov_b32 v53, 0
  v_mov_b32 v54, 0
  v_mov_b32 v55, 0
  v_mov_b32 v56, 0
  v_mov_b32 v57, 0
  v_mov_b32 v58, 0
  v_mov_b32 v59, 0
  v_mov_b32 v60, 0
  v_mov_b32 v61, 0
  v_mov_b32 v62, 0
  v_mov_b32 v63, 0
  s_mov_b32 s43, 0
  s_nop 0
RM0F_AP:
  buffer_load_dwordx4 v[32:35], v16, s[4:7], s30 offen sc1
  buffer_load_dwordx4 v[36:39], v17, s[4:7], s30 offen sc1
  s_waitcnt vmcnt(0)
  v_max3_u32 v4, v32, v33, v34
  v_max3_u32 v4, v4, v35, v36
  v_max3_u32 v4, v4, v37, v38
  v_max_u32 v4, v4, v39
  v_cmp_eq_u32 vcc, -1, v4
  s_nop 3
  s_cbranch_vccz RM0F_AP_OK
  s_add_u32 s43, s43, 1
  s_cmp_lt_u32 s43, s61
  s_cbranch_scc1 RM0F_AP
  s_mov_b32 s61, 0
RM0F_AP_OK:
  ds_write_b128 v19, v[32:35]
  ds_write_b128 v19, v[36:39] offset:1024
  s_waitcnt lgkmcnt(0)
  s_barrier
  ds_read_b64_tr_b16 v[148:149], v20 offset:0
  ds_read_b64_tr_b16 v[150:151], v20 offset:256
  ds_read_b64_tr_b16 v[172:173], v20 offset:3072
  ds_read_b64_tr_b16 v[174:175], v20 offset:3328
  ds_read_b64_tr_b16 v[152:153], v20 offset:512
  ds_read_b64_tr_b16 v[154:155], v20 offset:768
  ds_read_b64_tr_b16 v[176:177], v20 offset:3584
  ds_read_b64_tr_b16 v[178:179], v20 offset:3840
  ds_read_b64_tr_b16 v[156:157], v20 offset:1024
  ds_read_b64_tr_b16 v[158:159], v20 offset:1280
  ds_read_b64_tr_b16 v[180:181], v20 offset:4096
  ds_read_b64_tr_b16 v[182:183], v20 offset:4352
  s_waitcnt lgkmcnt(8)
  v_mfma_f32_16x16x32_bf16 v[224:227], v[100:103], v[148:151], 0
  v_mfma_f32_16x16x32_bf16 v[228:231], v[124:127], v[148:151], 0
  v_mfma_f32_16x16x32_bf16 v[220:223], v[172:175], v[148:151], 0
  ds_read_b64_tr_b16 v[160:161], v20 offset:1536
  ds_read_b64_tr_b16 v[162:163], v20 offset:1792
  ds_read_b64_tr_b16 v[184:185], v20 offset:4608
  ds_read_b64_tr_b16 v[186:187], v20 offset:4864
  s_waitcnt lgkmcnt(8)
  v_mfma_f32_16x16x32_bf16 v[224:227], v[104:107], v[152:155], v[224:227]
  v_mfma_f32_16x16x32_bf16 v[228:231], v[128:131], v[152:155], v[228:231]
  v_mfma_f32_16x16x32_bf16 v[220:223], v[176:179], v[152:155], v[220:223]
  ds_read_b64_tr_b16 v[164:165], v20 offset:2048
  ds_read_b64_tr_b16 v[166:167], v20 offset:2304
  ds_read_b64_tr_b16 v[188:189], v20 offset:5120
  ds_read_b64_tr_b16 v[190:191], v20 offset:5376
  s_waitcnt lgkmcnt(8)
  v_mfma_f32_16x16x32_bf16 v[224:227], v[108:111], v[156:159], v[224:227]
  v_mfma_f32_16x16x32_bf16 v[228:231], v[132:135], v[156:159], v[228:231]
  v_mfma_f32_16x16x32_bf16 v[220:223], v[180:183], v[156:159], v[220:223]
  ds_read_b64_tr_b16 v[168:169], v20 offset:2560
  ds_read_b64_tr_b16 v[170:171], v20 offset:2816
  ds_read_b64_tr_b16 v[192:193], v20 offset:5632
  ds_read_b64_tr_b16 v[194:195], v20 offset:5888
  s_waitcnt lgkmcnt(8)
  v_mfma_f32_16x16x32_bf16 v[224:227], v[112:115], v[160:163], v[224:227]
  v_mfma_f32_16x16x32_bf16 v[228:231], v[136:139], v[160:163], v[228:231]
  v_mfma_f32_16x16x32_bf16 v[220:223], v[184:187], v[160:163], v[220:223]
  s_waitcnt lgkmcnt(4)
  v_mfma_f32_16x16x32_bf16 v[224:227], v[116:119], v[164:167], v[224:227]
  v_mfma_f32_16x16x32_bf16 v[228:231], v[140:143], v[164:167], v[228:231]
  v_mfma_f32_16x16x32_bf16 v[220:223], v[188:191], v[164:167], v[220:223]
  s_waitcnt lgkmcnt(0)
  v_mfma_f32_16x16x32_bf16 v[224:227], v[120:123], v[168:171], v[224:227]
  v_mfma_f32_16x16x32_bf16 v[228:231], v[144:147], v[168:171], v[228:231]
  v_mfma_f32_16x16x32_bf16 v[220:223], v[192:195], v[168:171], v[220:223]
  s_barrier
  s_memtime s[96:97]
  ds_read_b64_tr_b16 v[196:197], v22 offset:0
  ds_read_b64_tr_b16 v[198:199], v22 offset:64
  ds_read_b64_tr_b16 v[200:201], v22 offset:1024
  ds_read_b64_tr_b16 v[202:203], v22 offset:1088
  ds_read_b64_tr_b16 v[204:205], v22 offset:2048
  ds_read_b64_tr_b16 v[206:207], v22 offset:2112
  v_cndmask_b32 v148, v224, v228, s[38:39]
  v_cndmask_b32 v149, v225, v229, s[38:39]
  s_waitcnt lgkmcnt(4)
  v_smfmac_f32_16x16x64_bf16 v[48:51], v[196:199], a[160:167], v21
  v_cndmask_b32 v150, v226, v230, s[38:39]
  v_smfmac_f32_16x16x64_bf16 v[52:55], v[196:199], a[184:191], v21
  v_cndmask_b32 v151, v227, v231, s[38:39]
  v_smfmac_f32_16x16x64_bf16 v[56:59], v[196:199], a[208:215], v21
  v_cndmask_b32 v152, v220, v222, s[38:39]
  v_smfmac_f32_16x16x64_bf16 v[60:63], v[196:199], a[232:239], v21
  v_cndmask_b32 v153, v221, v223, s[38:39]
  s_waitcnt lgkmcnt(2)
  v_smfmac_f32_16x16x64_bf16 v[48:51], v[200:203], a[168:175], v21
  v_max3_f32 v154, v148, v149, v150
  v_smfmac_f32_16x16x64_bf16 v[52:55], v[200:203], a[192:199], v21
  v_max3_f32 v155, v151, v152, v153
  v_smfmac_f32_16x16x64_bf16 v[56:59], v[200:203], a[216:223], v21
  v_max_f32 v154, v154, v155
  v_smfmac_f32_16x16x64_bf16 v[60:63], v[200:203], a[240:247], v21
  s_nop 0
  v_max_f32_dpp v154, v154, v154 row_ror:8 row_mask:0xf bank_mask:0xf
  s_waitcnt lgkmcnt(0)
  v_smfmac_f32_16x16x64_bf16 v[48:51], v[204:207], a[176:183], v21
  v_mov_b32 v155, v154
  v_smfmac_f32_16x16x64_bf16 v[52:55], v[204:207], a[200:207], v21
  s_nop 0
  v_permlane16_swap_b32 v154, v155
  v_smfmac_f32_16x16x64_bf16 v[56:59], v[204:207], a[224:231], v21
  v_max_f32 v154, v154, v155
  v_smfmac_f32_16x16x64_bf16 v[60:63], v[204:207], a[248:255], v21
  v_mov_b32 v155, v154
  s_nop 1
  v_permlane32_swap_b32 v154, v155
  v_max_f32 v154, v154, v155
  v_mul_f32 v154, s60, v154
  v_fma_f32 v148, v148, s60, -v154
  v_fma_f32 v149, v149, s60, -v154
  v_fma_f32 v150, v150, s60, -v154
  v_fma_f32 v151, v151, s60, -v154
  v_fma_f32 v152, v152, s60, -v154
  v_fma_f32 v153, v153, s60, -v154
  v_exp_f32 v148, v148
  v_exp_f32 v149, v149
  v_exp_f32 v150, v150
  v_exp_f32 v151, v151
  v_exp_f32 v152, v152
  v_exp_f32 v153, v153
  v_cvt_pk_bf16_f32 v160, v148, v149
  v_cvt_pk_bf16_f32 v161, v150, v151
  v_cvt_pk_bf16_f32 v158, v152, v153
  v_mov_b32_dpp v162, v160 row_ror:8 row_mask:0xf bank_mask:0xf
  v_mov_b32_dpp v163, v161 row_ror:8 row_mask:0xf bank_mask:0xf
  v_mov_b32_dpp v159, v158 row_ror:8 row_mask:0xf bank_mask:0xf
  s_nop 0
  v_mfma_f32_16x16x32_bf16 v[64:67], v[232:235], v[160:163], 0
  v_cvt_pk_bf16_f32 v220, v48, v49
  v_cvt_pk_bf16_f32 v221, v50, v51
  v_mfma_f32_16x16x32_bf16 v[68:71], v[236:239], v[160:163], 0
  v_cvt_pk_bf16_f32 v222, v52, v53
  v_cvt_pk_bf16_f32 v223, v54, v55
  v_mfma_f32_16x16x32_bf16 v[72:75], v[240:243], v[160:163], 0
  v_cvt_pk_bf16_f32 v224, v56, v57
  v_cvt_pk_bf16_f32 v225, v58, v59
  v_mfma_f32_16x16x32_bf16 v[76:79], v[244:247], v[160:163], 0
  v_cvt_pk_bf16_f32 v226, v60, v61
  v_cvt_pk_bf16_f32 v227, v62, v63
  v_mfma_f32_16x16x16_bf16 v[64:67], v[220:221], v[158:159], v[64:67]
  v_cndmask_b32 v152, v152, v31, s[20:21]
  v_cndmask_b32 v153, v153, v31, s[20:21]
  v_add_f32 v156, v148, v149
  v_add_f32 v155, v150, v151
  v_mfma_f32_16x16x16_bf16 v[68:71], v[222:223], v[158:159], v[68:71]
  v_add_f32 v157, v152, v153
  v_add_f32 v156, v156, v155
  v_add_f32 v156, v156, v157
  s_nop 1
  v_add_f32_dpp v156, v156, v156 row_ror:8 row_mask:0xf bank_mask:0xf
  v_mfma_f32_16x16x16_bf16 v[72:75], v[224:225], v[158:159], v[72:75]
  v_mov_b32 v155, v156
  s_nop 1
  v_permlane16_swap_b32 v156, v155
  v_add_f32 v156, v156, v155
  v_mov_b32 v155, v156
  v_mfma_f32_16x16x16_bf16 v[76:79], v[226:227], v[158:159], v[76:79]
  s_nop 0
  v_permlane32_swap_b32 v156, v155
  v_add_f32 v156, v156, v155
  v_rcp_f32 v156, v156
  s_nop 0
  v_mov_b32 v157, v156
  v_pk_mul_f32 v[64:65], v[64:65], v[156:157]
  v_pk_mul_f32 v[66:67], v[66:67], v[156:157]
  v_pk_mul_f32 v[68:69], v[68:69], v[156:157]
  v_pk_mul_f32 v[70:71], v[70:71], v[156:157]
  v_pk_mul_f32 v[72:73], v[72:73], v[156:157]
  v_pk_mul_f32 v[74:75], v[74:75], v[156:157]
  v_pk_mul_f32 v[76:77], v[76:77], v[156:157]
  v_pk_mul_f32 v[78:79], v[78:79], v[156:157]
  v_cvt_pk_bf16_f32 v80, v64, v65
  v_cvt_pk_bf16_f32 v81, v66, v67
  v_cvt_pk_bf16_f32 v82, v68, v69
  v_cvt_pk_bf16_f32 v83, v70, v71
  v_cvt_pk_bf16_f32 v84, v72, v73
  v_cvt_pk_bf16_f32 v85, v74, v75
  v_cvt_pk_bf16_f32 v86, v76, v77
  v_cvt_pk_bf16_f32 v87, v78, v79
  s_add_u32 s40, s30, s48
  s_mov_b64 exec, s[34:35]
  buffer_store_dwordx4 v[80:83], v28, s[4:7], s40 offen sc1
  s_add_u32 s40, s40, 32768
  buffer_store_dwordx4 v[84:87], v28, s[4:7], s40 offen sc1
  s_mov_b64 exec, -1
  s_cmp_eq_u32 s28, 63
  s_cbranch_scc1 RM0F_NODMA
  s_add_u32 s33, s33, 2
  s_min_u32 s42, s33, 128
  s_cmp_ge_u32 s22, s42
  s_cbranch_scc1 RM0F_WKV4_D
  s_mov_b32 s23, 0
RM0F_WKV4:
  buffer_load_dword v4, v249, s[4:7], 0 offen sc1
  s_waitcnt vmcnt(0)
  v_cmp_gt_u32 vcc, s42, v4
  s_nop 3
  s_cbranch_vccz RM0F_WKV4_K
  s_sleep 4
  s_add_u32 s23, s23, 1
  s_cmp_lt_u32 s23, 0x100000
  s_cbranch_scc1 RM0F_WKV4
RM0F_WKV4_K:
  v_readlane_b32 s22, v4, 0
  v_readlane_b32 s41, v4, 1
  s_nop 0
  s_min_u32 s22, s22, s41
  v_readlane_b32 s41, v4, 2
  s_nop 0
  s_min_u32 s22, s22, s41
  v_readlane_b32 s41, v4, 3
  s_nop 0
  s_min_u32 s22, s22, s41
  s_nop 2
RM0F_WKV4_D:
  s_add_u32 m0, s49, 0
  s_add_u32 s40, s44, 0
  buffer_load_dwordx4 v6, s[4:7], s40 offen offset:0 sc1 lds
  buffer_load_dwordx4 v6, s[4:7], s40 offen offset:1024 sc1 lds
  buffer_load_dwordx4 v6, s[4:7], s40 offen offset:2048 sc1 lds
  buffer_load_dwordx4 v6, s[4:7], s40 offen offset:3072 sc1 lds
  s_add_u32 m0, s49, 4096
  s_add_u32 s40, s44, 4096
  buffer_load_dwordx4 v6, s[4:7], s40 offen offset:0 sc1 lds
  buffer_load_dwordx4 v6, s[4:7], s40 offen offset:1024 sc1 lds
  buffer_load_dwordx4 v6, s[4:7], s40 offen offset:2048 sc1 lds
  buffer_load_dwordx4 v6, s[4:7], s40 offen offset:3072 sc1 lds
  s_add_u32 m0, s49, 8192
  s_add_u32 s40, s44, 8192
  buffer_load_dwordx4 v6, s[4:7], s40 offen offset:0 sc1 lds
  buffer_load_dwordx4 v6, s[4:7], s40 offen offset:1024 sc1 lds
  buffer_load_dwordx4 v6, s[4:7], s40 offen offset:2048 sc1 lds
  buffer_load_dwordx4 v6, s[4:7], s40 offen offset:3072 sc1 lds
  s_add_u32 s44, s44, 393216
  s_xor_b32 s49, s49, 57344
RM0F_NODMA:
  s_mov_b64 exec, s[34:35]
  s_cmp_lg_u32 s26, 0
  s_cbranch_scc1 RM0F_NOKM
  buffer_store_dwordx4 v[172:175], v15, s[4:7], s47 offen offset:0 sc1
  buffer_store_dwordx4 v[176:179], v15, s[4:7], s47 offen offset:512 sc1
  s_nop 1
RM0F_NOKM:
  s_mov_b64 exec, -1
  s_add_u32 s47, s47, 98304
  v_mov_b32 v64, v48
  v_mov_b32 v65, v49
  v_mov_b32 v66, v50
  v_mov_b32 v67, v51
  v_permlane32_swap_b32 v48, v64
  v_permlane32_swap_b32 v49, v65
  v_permlane32_swap_b32 v50, v66
  v_permlane32_swap_b32 v51, v67
  v_add_f32 v48, v48, v64
  v_add_f32 v49, v49, v65
  v_add_f32 v50, v50, v66
  v_add_f32 v51, v51, v67
  v_cvt_pk_bf16_f32 v220, v48, v49
  v_cvt_pk_bf16_f32 v221, v50, v51
  v_mov_b32 v64, v52
  v_mov_b32 v65, v53
  v_mov_b32 v66, v54
  v_mov_b32 v67, v55
  v_permlane32_swap_b32 v52, v64
  v_permlane32_swap_b32 v53, v65
  v_permlane32_swap_b32 v54, v66
  v_permlane32_swap_b32 v55, v67
  v_add_f32 v52, v52, v64
  v_add_f32 v53, v53, v65
  v_add_f32 v54, v54, v66
  v_add_f32 v55, v55, v67
  v_cvt_pk_bf16_f32 v222, v52, v53
  v_cvt_pk_bf16_f32 v223, v54, v55
  v_mov_b32 v64, v56
  v_mov_b32 v65, v57
  v_mov_b32 v66, v58
  v_mov_b32 v67, v59
  v_permlane32_swap_b32 v56, v64
  v_permlane32_swap_b32 v57, v65
  v_permlane32_swap_b32 v58, v66
  v_permlane32_swap_b32 v59, v67
  v_add_f32 v56, v56, v64
  v_add_f32 v57, v57, v65
  v_add_f32 v58, v58, v66
  v_add_f32 v59, v59, v67
  v_cvt_pk_bf16_f32 v224, v56, v57
  v_cvt_pk_bf16_f32 v225, v58, v59
  v_mov_b32 v64, v60
  v_mov_b32 v65, v61
  v_mov_b32 v66, v62
  v_mov_b32 v67, v63
  v_permlane32_swap_b32 v60, v64
  v_permlane32_swap_b32 v61, v65
  v_permlane32_swap_b32 v62, v66
  v_permlane32_swap_b32 v63, v67
  v_add_f32 v60, v60, v64
  v_add_f32 v61, v61, v65
  v_add_f32 v62, v62, v66
  v_add_f32 v63, v63, v67
  v_cvt_pk_bf16_f32 v226, v60, v61
  v_cvt_pk_bf16_f32 v227, v62, v63
  s_mov_b32 exec_hi, 0
  buffer_store_dwordx2 v[220:221], v29, s[4:7], s46 offen offset:0 sc1
  buffer_store_dwordx2 v[222:223], v29, s[4:7], s46 offen offset:256 sc1
  buffer_store_dwordx2 v[224:225], v29, s[4:7], s46 offen offset:512 sc1
  buffer_store_dwordx2 v[226:227], v29, s[4:7], s46 offen offset:768 sc1
  s_mov_b64 exec, -1
  s_add_u32 s46, s46, 327680
  s_add_u32 s28, s28, 1
  s_cmp_ge_u32 s28, 64
  s_cbranch_scc1 RM0F_DONE
  v_add_u32 v4, s50, v6
  ds_read_b128 v[148:151], v4 offset:12288
  ds_read_b128 v[152:155], v4 offset:13312
  ds_read_b128 v[156:159], v4 offset:14336
  ds_read_b128 v[160:163], v4 offset:15360
  ds_read_b128 v[164:167], v4 offset:16384
  ds_read_b128 v[168:171], v4 offset:17408
  ds_read_b128 v[172:175], v4 offset:18432
  ds_read_b128 v[176:179], v4 offset:19456
  s_waitcnt lgkmcnt(4)
  ds_read_b128 v[180:183], v4 offset:20480
  ds_read_b128 v[184:187], v4 offset:21504
  ds_read_b128 v[188:191], v4 offset:22528
  ds_read_b128 v[192:195], v4 offset:23552
  s_waitcnt lgkmcnt(0)
  ds_read_b128 v[100:103], v4 offset:0
  ds_read_b128 v[104:107], v4 offset:1024
  ds_read_b128 v[108:111], v4 offset:2048
  ds_read_b128 v[112:115], v4 offset:3072
  ds_read_b128 v[116:119], v4 offset:4096
  ds_read_b128 v[120:123], v4 offset:5120
  ds_read_b128 v[124:127], v4 offset:6144
  ds_read_b128 v[128:131], v4 offset:7168
  ds_read_b128 v[132:135], v4 offset:8192
  ds_read_b128 v[136:139], v4 offset:9216
  ds_read_b128 v[140:143], v4 offset:10240
  ds_read_b128 v[144:147], v4 offset:11264
  v_mfma_f32_16x16x32_bf16 v[48:51], v[148:151], a[160:163], 0
  v_mfma_f32_16x16x32_bf16 v[52:55], v[172:175], a[160:163], 0
  v_mfma_f32_16x16x32_bf16 v[56:59], v[148:151], a[184:187], 0
  v_mfma_f32_16x16x32_bf16 v[60:63], v[172:175], a[184:187], 0
  v_mfma_f32_16x16x32_bf16 v[64:67], v[148:151], a[208:211], 0
  v_mfma_f32_16x16x32_bf16 v[68:71], v[172:175], a[208:211], 0
  v_mfma_f32_16x16x32_bf16 v[72:75], v[148:151], a[232:235], 0
  v_mfma_f32_16x16x32_bf16 v[76:79], v[172:175], a[232:235], 0
  v_mfma_f32_16x16x32_bf16 v[48:51], v[152:155], a[164:167], v[48:51]
  v_mfma_f32_16x16x32_bf16 v[52:55], v[176:179], a[164:167], v[52:55]
  v_mfma_f32_16x16x32_bf16 v[56:59], v[152:155], a[188:191], v[56:59]
  v_mfma_f32_16x16x32_bf16 v[60:63], v[176:179], a[188:191], v[60:63]
  v_mfma_f32_16x16x32_bf16 v[64:67], v[152:155], a[212:215], v[64:67]
  v_mfma_f32_16x16x32_bf16 v[68:71], v[176:179], a[212:215], v[68:71]
  v_mfma_f32_16x16x32_bf16 v[72:75], v[152:155], a[236:239], v[72:75]
  v_mfma_f32_16x16x32_bf16 v[76:79], v[176:179], a[236:239], v[76:79]
  v_mfma_f32_16x16x32_bf16 v[48:51], v[156:159], a[168:171], v[48:51]
  v_mfma_f32_16x16x32_bf16 v[52:55], v[180:183], a[168:171], v[52:55]
  v_mfma_f32_16x16x32_bf16 v[56:59], v[156:159], a[192:195], v[56:59]
  v_mfma_f32_16x16x32_bf16 v[60:63], v[180:183], a[192:195], v[60:63]
  v_mfma_f32_16x16x32_bf16 v[64:67], v[156:159], a[216:219], v[64:67]
  v_mfma_f32_16x16x32_bf16 v[68:71], v[180:183], a[216:219], v[68:71]
  v_mfma_f32_16x16x32_bf16 v[72:75], v[156:159], a[240:243], v[72:75]
  v_mfma_f32_16x16x32_bf16 v[76:79], v[180:183], a[240:243], v[76:79]
  v_mfma_f32_16x16x32_bf16 v[48:51], v[160:163], a[172:175], v[48:51]
  v_mfma_f32_16x16x32_bf16 v[52:55], v[184:187], a[172:175], v[52:55]
  v_mfma_f32_16x16x32_bf16 v[56:59], v[160:163], a[196:199], v[56:59]
  v_mfma_f32_16x16x32_bf16 v[60:63], v[184:187], a[196:199], v[60:63]
  v_mfma_f32_16x16x32_bf16 v[64:67], v[160:163], a[220:223], v[64:67]
  v_mfma_f32_16x16x32_bf16 v[68:71], v[184:187], a[220:223], v[68:71]
  v_mfma_f32_16x16x32_bf16 v[72:75], v[160:163], a[244:247], v[72:75]
  v_mfma_f32_16x16x32_bf16 v[76:79], v[184:187], a[244:247], v[76:79]
  v_mfma_f32_16x16x32_bf16 v[48:51], v[164:167], a[176:179], v[48:51]
  v_mfma_f32_16x16x32_bf16 v[52:55], v[188:191], a[176:179], v[52:55]
  v_mfma_f32_16x16x32_bf16 v[56:59], v[164:167], a[200:203], v[56:59]
  v_mfma_f32_16x16x32_bf16 v[60:63], v[188:191], a[200:203], v[60:63]
  v_mfma_f32_16x16x32_bf16 v[64:67], v[164:167], a[224:227], v[64:67]
  v_mfma_f32_16x16x32_bf16 v[68:71], v[188:191], a[224:227], v[68:71]
  v_mfma_f32_16x16x32_bf16 v[72:75], v[164:167], a[248:251], v[72:75]
  v_mfma_f32_16x16x32_bf16 v[76:79], v[188:191], a[248:251], v[76:79]
  v_mfma_f32_16x16x32_bf16 v[48:51], v[168:171], a[180:183], v[48:51]
  v_mfma_f32_16x16x32_bf16 v[52:55], v[192:195], a[180:183], v[52:55]
  v_mfma_f32_16x16x32_bf16 v[56:59], v[168:171], a[204:207], v[56:59]
  v_mfma_f32_16x16x32_bf16 v[60:63], v[192:195], a[204:207], v[60:63]
  v_mfma_f32_16x16x32_bf16 v[64:67], v[168:171], a[228:231], v[64:67]
  v_mfma_f32_16x16x32_bf16 v[68:71], v[192:195], a[228:231], v[68:71]
  v_mfma_f32_16x16x32_bf16 v[72:75], v[168:171], a[252:255], v[72:75]
  v_mfma_f32_16x16x32_bf16 v[76:79], v[192:195], a[252:255], v[76:79]
  s_nop 0
  v_cvt_pk_bf16_f32 v232, v48, v49
  v_cvt_pk_bf16_f32 v233, v50, v51
  v_cvt_pk_bf16_f32 v234, v52, v53
  v_cvt_pk_bf16_f32 v235, v54, v55
  s_add_u32 s40, s45, 0
  v_cvt_pk_bf16_f32 v236, v56, v57
  v_cvt_pk_bf16_f32 v237, v58, v59
  v_cvt_pk_bf16_f32 v238, v60, v61
  v_cvt_pk_bf16_f32 v239, v62, v63
  s_add_u32 s40, s45, 1024
  v_cvt_pk_bf16_f32 v240, v64, v65
  v_cvt_pk_bf16_f32 v241, v66, v67
  v_cvt_pk_bf16_f32 v242, v68, v69
  v_cvt_pk_bf16_f32 v243, v70, v71
  s_add_u32 s40, s45, 2048
  v_cvt_pk_bf16_f32 v244, v72, v73
  v_cvt_pk_bf16_f32 v245, v74, v75
  v_cvt_pk_bf16_f32 v246, v76, v77
  v_cvt_pk_bf16_f32 v247, v78, v79
  s_add_u32 s40, s45, 3072
  s_add_u32 s45, s45, 1310720
  s_waitcnt lgkmcnt(0)
  s_xor_b32 s50, s50, 57344
  s_mov_b32 s40, s29
  s_mov_b32 s29, s30
  s_mov_b32 s30, s31
  s_mov_b32 s31, s32
  s_mov_b32 s32, s40
  s_branch RM0F_LOOP
RM0F_DONE:
  s_waitcnt vmcnt(0)
  s_barrier
  s_endpgm
RM0S_LOOP:
WU_5:
  s_memtime s[58:59]
  s_waitcnt lgkmcnt(0)
  s_sub_u32 s58, s58, s96
  s_cmp_ge_u32 s58, 2600
  s_cbranch_scc1 WU_5_D
  s_sub_u32 s58, 2600, s58
  s_cmp_lt_u32 s58, 96
  s_cbranch_scc1 WU_5
  s_sleep 1
  s_branch WU_5
WU_5_D:
  s_mov_b32 s43, 0
RM0S_AGP:
  buffer_load_dwordx4 v[48:51], v23, s[4:7], s29 offen sc1
  buffer_load_dwordx4 v[52:55], v24, s[4:7], s29 offen sc1
  buffer_load_dwordx4 v[56:59], v25, s[4:7], s29 offen sc1
  s_waitcnt vmcnt(0)
  v_max3_u32 v4, v48, v49, v50
  v_max3_u32 v4, v4, v51, v52
  v_max3_u32 v4, v4, v53, v54
  v_max3_u32 v4, v4, v55, v56
  v_max3_u32 v4, v4, v57, v58
  v_max_u32 v4, v4, v59
  v_cmp_eq_u32 vcc, -1, v4
  s_nop 3
  s_cbranch_vccz RM0S_AGP_OK
  s_add_u32 s43, s43, 1
  s_cmp_lt_u32 s43, s61
  s_cbranch_scc1 RM0S_AGP
  s_mov_b32 s61, 0
RM0S_AGP_OK:
  ds_write_b128 v10, v[48:51]
  ds_write_b128 v10, v[52:55] offset:1024
  s_mov_b32 exec_hi, 0
  ds_write_b128 v10, v[56:59] offset:2048
  s_mov_b64 exec, -1
RM0S_B0:
  s_waitcnt lgkmcnt(0)
  s_barrier
  s_memtime s[98:99]
  ds_read_b128 v[48:51], v6 offset:0
  ds_read_b128 v[52:55], v6 offset:1024
  ds_read_b128 v[56:59], v6 offset:2048
  ds_read_b128 v[60:63], v6 offset:3072
  ds_read_b128 v[64:67], v6 offset:4096
  ds_read_b128 v[68:71], v6 offset:5120
  ds_read_b128 v[72:75], v6 offset:6144
  ds_read_b128 v[76:79], v6 offset:7168
  ds_read_b128 v[80:83], v6 offset:8192
  ds_read_b128 v[84:87], v6 offset:9216
  v_mov_b32 v88, 0
  v_mov_b32 v89, 0
  v_mov_b32 v90, 0
  v_mov_b32 v91, 0
  v_mov_b32 v92, 0
  v_mov_b32 v93, 0
  v_mov_b32 v94, 0
  v_mov_b32 v95, 0
  s_waitcnt lgkmcnt(9)
  v_smfmac_f32_16x16x64_bf16 v[88:91], v[48:51], a[0:7], v21
  v_smfmac_f32_16x16x64_bf16 v[92:95], v[48:51], a[80:87], v21
  s_waitcnt lgkmcnt(8)
  v_smfmac_f32_16x16x64_bf16 v[88:91], v[52:55], a[8:15], v21
  v_smfmac_f32_16x16x64_bf16 v[92:95], v[52:55], a[88:95], v21
  s_waitcnt lgkmcnt(7)
  v_smfmac_f32_16x16x64_bf16 v[88:91], v[56:59], a[16:23], v21
  v_smfmac_f32_16x16x64_bf16 v[92:95], v[56:59], a[96:103], v21
  s_waitcnt lgkmcnt(6)
  v_smfmac_f32_16x16x64_bf16 v[88:91], v[60:63], a[24:31], v21
  v_smfmac_f32_16x16x64_bf16 v[92:95], v[60:63], a[104:111], v21
  s_waitcnt lgkmcnt(5)
  v_smfmac_f32_16x16x64_bf16 v[88:91], v[64:67], a[32:39], v21
  v_smfmac_f32_16x16x64_bf16 v[92:95], v[64:67], a[112:119], v21
  s_waitcnt lgkmcnt(4)
  v_smfmac_f32_16x16x64_bf16 v[88:91], v[68:71], a[40:47], v21
  v_smfmac_f32_16x16x64_bf16 v[92:95], v[68:71], a[120:127], v21
  s_waitcnt lgkmcnt(3)
  v_smfmac_f32_16x16x64_bf16 v[88:91], v[72:75], a[48:55], v21
  v_smfmac_f32_16x16x64_bf16 v[92:95], v[72:75], a[128:135], v21
  s_waitcnt lgkmcnt(2)
  v_smfmac_f32_16x16x64_bf16 v[88:91], v[76:79], a[56:63], v21
  v_smfmac_f32_16x16x64_bf16 v[92:95], v[76:79], a[136:143], v21
  s_waitcnt lgkmcnt(1)
  v_smfmac_f32_16x16x64_bf16 v[88:91], v[80:83], a[64:71], v21
  v_smfmac_f32_16x16x64_bf16 v[92:95], v[80:83], a[144:151], v21
  s_waitcnt lgkmcnt(0)
  v_smfmac_f32_16x16x64_bf16 v[88:91], v[84:87], a[72:79], v21
  v_smfmac_f32_16x16x64_bf16 v[92:95], v[84:87], a[152:159], v21
  s_nop 7
  v_permlane32_swap_b32 v88, v92
  v_permlane32_swap_b32 v89, v93
  v_permlane32_swap_b32 v90, v94
  v_permlane32_swap_b32 v91, v95
  v_add_f32 v88, v88, v92
  v_add_f32 v89, v89, v93
  v_add_f32 v90, v90, v94
  v_add_f32 v91, v91, v95
  v_cvt_pk_bf16_f32 v252, v88, v89
  v_cvt_pk_bf16_f32 v253, v90, v91
  buffer_store_dwordx2 v[252:253], v12, s[4:7], s30 offen sc1
  s_cmp_lg_u32 s28, 0
  s_cbranch_scc1 RM0S_NOS1
  s_add_u32 s33, s33, 2
  s_min_u32 s42, s33, 128
  s_cmp_ge_u32 s22, s42
  s_cbranch_scc1 RM0S_WKV6_D
  s_mov_b32 s23, 0
RM0S_WKV6:
  buffer_load_dword v4, v249, s[4:7], 0 offen sc1
  s_waitcnt vmcnt(0)
  v_cmp_gt_u32 vcc, s42, v4
  s_nop 3
  s_cbranch_vccz RM0S_WKV6_K
  s_sleep 4
  s_add_u32 s23, s23, 1
  s_cmp_lt_u32 s23, 0x100000
  s_cbranch_scc1 RM0S_WKV6
RM0S_WKV6_K:
  v_readlane_b32 s22, v4, 0
  v_readlane_b32 s41, v4, 1
  s_nop 0
  s_min_u32 s22, s22, s41
  v_readlane_b32 s41, v4, 2
  s_nop 0
  s_min_u32 s22, s22, s41
  v_readlane_b32 s41, v4, 3
  s_nop 0
  s_min_u32 s22, s22, s41
  s_nop 2
RM0S_WKV6_D:
  s_add_u32 m0, s49, 0
  s_add_u32 s40, s44, 0
  buffer_load_dwordx4 v6, s[4:7], s40 offen offset:0 sc1 lds
  buffer_load_dwordx4 v6, s[4:7], s40 offen offset:1024 sc1 lds
  buffer_load_dwordx4 v6, s[4:7], s40 offen offset:2048 sc1 lds
  buffer_load_dwordx4 v6, s[4:7], s40 offen offset:3072 sc1 lds
  s_add_u32 m0, s49, 4096
  s_add_u32 s40, s44, 4096
  buffer_load_dwordx4 v6, s[4:7], s40 offen offset:0 sc1 lds
  buffer_load_dwordx4 v6, s[4:7], s40 offen offset:1024 sc1 lds
  buffer_load_dwordx4 v6, s[4:7], s40 offen offset:2048 sc1 lds
  buffer_load_dwordx4 v6, s[4:7], s40 offen offset:3072 sc1 lds
  s_add_u32 m0, s49, 8192
  s_add_u32 s40, s44, 8192
  buffer_load_dwordx4 v6, s[4:7], s40 offen offset:0 sc1 lds
  buffer_load_dwordx4 v6, s[4:7], s40 offen offset:1024 sc1 lds
  buffer_load_dwordx4 v6, s[4:7], s40 offen offset:2048 sc1 lds
  buffer_load_dwordx4 v6, s[4:7], s40 offen offset:3072 sc1 lds
  s_add_u32 s44, s44, 393216
  s_xor_b32 s49, s49, 57344
RM0S_NOS1:
  v_mov_b32 v48, 0
  v_mov_b32 v49, 0
  v_mov_b32 v50, 0
  v_mov_b32 v51, 0
  v_mov_b32 v52, 0
  v_mov_b32 v53, 0
  v_mov_b32 v54, 0
  v_mov_b32 v55, 0
  v_mov_b32 v56, 0
  v_mov_b32 v57, 0
  v_mov_b32 v58, 0
  v_mov_b32 v59, 0
  v_mov_b32 v60, 0
  v_mov_b32 v61, 0
  v_mov_b32 v62, 0
  v_mov_b32 v63, 0
  s_nop 1
WU_7:
  s_memtime s[58:59]
  s_waitcnt lgkmcnt(0)
  s_sub_u32 s58, s58, s98
  s_cmp_ge_u32 s58, 1150
  s_cbranch_scc1 WU_7_D
  s_sub_u32 s58, 1150, s58
  s_cmp_lt_u32 s58, 96
  s_cbranch_scc1 WU_7
  s_sleep 1
  s_branch WU_7
WU_7_D:
  s_mov_b32 s43, 0
RM0S_AP:
  buffer_load_dwordx4 v[32:35], v16, s[4:7], s30 offen sc1
  buffer_load_dwordx4 v[36:39], v17, s[4:7], s30 offen sc1
  s_waitcnt vmcnt(0)
  v_max3_u32 v4, v32, v33, v34
  v_max3_u32 v4, v4, v35, v36
  v_max3_u32 v4, v4, v37, v38
  v_max_u32 v4, v4, v39
  v_cmp_eq_u32 vcc, -1, v4
  s_nop 3
  s_cbranch_vccz RM0S_AP_OK
  s_add_u32 s43, s43, 1
  s_cmp_lt_u32 s43, s61
  s_cbranch_scc1 RM0S_AP
  s_mov_b32 s61, 0
RM0S_AP_OK:
  ds_write_b128 v19, v[32:35]
  ds_write_b128 v19, v[36:39] offset:1024
  s_waitcnt lgkmcnt(0)
  s_barrier
  ds_read_b64_tr_b16 v[148:149], v20 offset:0
  ds_read_b64_tr_b16 v[150:151], v20 offset:256
  ds_read_b64_tr_b16 v[172:173], v20 offset:3072
  ds_read_b64_tr_b16 v[174:175], v20 offset:3328
  ds_read_b64_tr_b16 v[152:153], v20 offset:512
  ds_read_b64_tr_b16 v[154:155], v20 offset:768
  ds_read_b64_tr_b16 v[176:177], v20 offset:3584
  ds_read_b64_tr_b16 v[178:179], v20 offset:3840
  ds_read_b64_tr_b16 v[156:157], v20 offset:1024
  ds_read_b64_tr_b16 v[158:159], v20 offset:1280
  ds_read_b64_tr_b16 v[180:181], v20 offset:4096
  ds_read_b64_tr_b16 v[182:183], v20 offset:4352
  s_waitcnt lgkmcnt(8)
  v_mfma_f32_16x16x32_bf16 v[224:227], v[100:103], v[148:151], 0
  v_mfma_f32_16x16x32_bf16 v[228:231], v[124:127], v[148:151], 0
  v_mfma_f32_16x16x32_bf16 v[220:223], v[172:175], v[148:151], 0
  ds_read_b64_tr_b16 v[160:161], v20 offset:1536
  ds_read_b64_tr_b16 v[162:163], v20 offset:1792
  ds_read_b64_tr_b16 v[184:185], v20 offset:4608
  ds_read_b64_tr_b16 v[186:187], v20 offset:4864
  s_waitcnt lgkmcnt(8)
  v_mfma_f32_16x16x32_bf16 v[224:227], v[104:107], v[152:155], v[224:227]
  v_mfma_f32_16x16x32_bf16 v[228:231], v[128:131], v[152:155], v[228:231]
  v_mfma_f32_16x16x32_bf16 v[220:223], v[176:179], v[152:155], v[220:223]
  ds_read_b64_tr_b16 v[164:165], v20 offset:2048
  ds_read_b64_tr_b16 v[166:167], v20 offset:2304
  ds_read_b64_tr_b16 v[188:189], v20 offset:5120
  ds_read_b64_tr_b16 v[190:191], v20 offset:5376
  s_waitcnt lgkmcnt(8)
  v_mfma_f32_16x16x32_bf16 v[224:227], v[108:111], v[156:159], v[224:227]
  v_mfma_f32_16x16x32_bf16 v[228:231], v[132:135], v[156:159], v[228:231]
  v_mfma_f32_16x16x32_bf16 v[220:223], v[180:183], v[156:159], v[220:223]
  ds_read_b64_tr_b16 v[168:169], v20 offset:2560
  ds_read_b64_tr_b16 v[170:171], v20 offset:2816
  ds_read_b64_tr_b16 v[192:193], v20 offset:5632
  ds_read_b64_tr_b16 v[194:195], v20 offset:5888
  s_waitcnt lgkmcnt(8)
  v_mfma_f32_16x16x32_bf16 v[224:227], v[112:115], v[160:163], v[224:227]
  v_mfma_f32_16x16x32_bf16 v[228:231], v[136:139], v[160:163], v[228:231]
  v_mfma_f32_16x16x32_bf16 v[220:223], v[184:187], v[160:163], v[220:223]
  s_waitcnt lgkmcnt(4)
  v_mfma_f32_16x16x32_bf16 v[224:227], v[116:119], v[164:167], v[224:227]
  v_mfma_f32_16x16x32_bf16 v[228:231], v[140:143], v[164:167], v[228:231]
  v_mfma_f32_16x16x32_bf16 v[220:223], v[188:191], v[164:167], v[220:223]
  s_waitcnt lgkmcnt(0)
  v_mfma_f32_16x16x32_bf16 v[224:227], v[120:123], v[168:171], v[224:227]
  v_mfma_f32_16x16x32_bf16 v[228:231], v[144:147], v[168:171], v[228:231]
  v_mfma_f32_16x16x32_bf16 v[220:223], v[192:195], v[168:171], v[220:223]
  s_barrier
  s_memtime s[96:97]
  ds_read_b64_tr_b16 v[196:197], v22 offset:0
  ds_read_b64_tr_b16 v[198:199], v22 offset:64
  ds_read_b64_tr_b16 v[200:201], v22 offset:1024
  ds_read_b64_tr_b16 v[202:203], v22 offset:1088
  ds_read_b64_tr_b16 v[204:205], v22 offset:2048
  ds_read_b64_tr_b16 v[206:207], v22 offset:2112
  v_cndmask_b32 v148, v224, v228, s[38:39]
  v_cndmask_b32 v149, v225, v229, s[38:39]
  s_waitcnt lgkmcnt(4)
  v_smfmac_f32_16x16x64_bf16 v[48:51], v[196:199], a[160:167], v21
  v_cndmask_b32 v150, v226, v230, s[38:39]
  v_smfmac_f32_16x16x64_bf16 v[52:55], v[196:199], a[184:191], v21
  v_cndmask_b32 v151, v227, v231, s[38:39]
  v_smfmac_f32_16x16x64_bf16 v[56:59], v[196:199], a[208:215], v21
  v_cndmask_b32 v152, v220, v222, s[38:39]
  v_smfmac_f32_16x16x64_bf16 v[60:63], v[196:199], a[232:239], v21
  v_cndmask_b32 v153, v221, v223, s[38:39]
  s_waitcnt lgkmcnt(2)
  v_smfmac_f32_16x16x64_bf16 v[48:51], v[200:203], a[168:175], v21
  v_max3_f32 v154, v148, v149, v150
  v_smfmac_f32_16x16x64_bf16 v[52:55], v[200:203], a[192:199], v21
  v_max3_f32 v155, v151, v152, v153
  v_smfmac_f32_16x16x64_bf16 v[56:59], v[200:203], a[216:223], v21
  v_max_f32 v154, v154, v155
  v_smfmac_f32_16x16x64_bf16 v[60:63], v[200:203], a[240:247], v21
  s_nop 0
  v_max_f32_dpp v154, v154, v154 row_ror:8 row_mask:0xf bank_mask:0xf
  s_waitcnt lgkmcnt(0)
  v_smfmac_f32_16x16x64_bf16 v[48:51], v[204:207], a[176:183], v21
  v_mov_b32 v155, v154
  v_smfmac_f32_16x16x64_bf16 v[52:55], v[204:207], a[200:207], v21
  s_nop 0
  v_permlane16_swap_b32 v154, v155
  v_smfmac_f32_16x16x64_bf16 v[56:59], v[204:207], a[224:231], v21
  v_max_f32 v154, v154, v155
  v_smfmac_f32_16x16x64_bf16 v[60:63], v[204:207], a[248:255], v21
  v_mov_b32 v155, v154
  s_nop 1
  v_permlane32_swap_b32 v154, v155
  v_max_f32 v154, v154, v155
  v_mul_f32 v154, s60, v154
  v_fma_f32 v148, v148, s60, -v154
  v_fma_f32 v149, v149, s60, -v154
  v_fma_f32 v150, v150, s60, -v154
  v_fma_f32 v151, v151, s60, -v154
  v_fma_f32 v152, v152, s60, -v154
  v_fma_f32 v153, v153, s60, -v154
  v_exp_f32 v148, v148
  v_exp_f32 v149, v149
  v_exp_f32 v150, v150
  v_exp_f32 v151, v151
  v_exp_f32 v152, v152
  v_exp_f32 v153, v153
  v_cvt_pk_bf16_f32 v160, v148, v149
  v_cvt_pk_bf16_f32 v161, v150, v151
  v_cvt_pk_bf16_f32 v158, v152, v153
  v_mov_b32_dpp v162, v160 row_ror:8 row_mask:0xf bank_mask:0xf
  v_mov_b32_dpp v163, v161 row_ror:8 row_mask:0xf bank_mask:0xf
  v_mov_b32_dpp v159, v158 row_ror:8 row_mask:0xf bank_mask:0xf
  s_nop 0
  v_mfma_f32_16x16x32_bf16 v[64:67], v[232:235], v[160:163], 0
  v_cvt_pk_bf16_f32 v220, v48, v49
  v_cvt_pk_bf16_f32 v221, v50, v51
  v_mfma_f32_16x16x32_bf16 v[68:71], v[236:239], v[160:163], 0
  v_cvt_pk_bf16_f32 v222, v52, v53
  v_cvt_pk_bf16_f32 v223, v54, v55
  v_mfma_f32_16x16x32_bf16 v[72:75], v[240:243], v[160:163], 0
  v_cvt_pk_bf16_f32 v224, v56, v57
  v_cvt_pk_bf16_f32 v225, v58, v59
  v_mfma_f32_16x16x32_bf16 v[76:79], v[244:247], v[160:163], 0
  v_cvt_pk_bf16_f32 v226, v60, v61
  v_cvt_pk_bf16_f32 v227, v62, v63
  v_mfma_f32_16x16x16_bf16 v[64:67], v[220:221], v[158:159], v[64:67]
  v_cndmask_b32 v152, v152, v31, s[20:21]
  v_cndmask_b32 v153, v153, v31, s[20:21]
  v_add_f32 v156, v148, v149
  v_add_f32 v155, v150, v151
  v_mfma_f32_16x16x16_bf16 v[68:71], v[222:223], v[158:159], v[68:71]
  v_add_f32 v157, v152, v153
  v_add_f32 v156, v156, v155
  v_add_f32 v156, v156, v157
  s_nop 1
  v_add_f32_dpp v156, v156, v156 row_ror:8 row_mask:0xf bank_mask:0xf
  v_mfma_f32_16x16x16_bf16 v[72:75], v[224:225], v[158:159], v[72:75]
  v_mov_b32 v155, v156
  s_nop 1
  v_permlane16_swap_b32 v156, v155
  v_add_f32 v156, v156, v155
  v_mov_b32 v155, v156
  v_mfma_f32_16x16x16_bf16 v[76:79], v[226:227], v[158:159], v[76:79]
  s_nop 0
  v_permlane32_swap_b32 v156, v155
  v_add_f32 v156, v156, v155
  v_rcp_f32 v156, v156
  s_nop 0
  v_mov_b32 v157, v156
  v_pk_mul_f32 v[64:65], v[64:65], v[156:157]
  v_pk_mul_f32 v[66:67], v[66:67], v[156:157]
  v_pk_mul_f32 v[68:69], v[68:69], v[156:157]
  v_pk_mul_f32 v[70:71], v[70:71], v[156:157]
  v_pk_mul_f32 v[72:73], v[72:73], v[156:157]
  v_pk_mul_f32 v[74:75], v[74:75], v[156:157]
  v_pk_mul_f32 v[76:77], v[76:77], v[156:157]
  v_pk_mul_f32 v[78:79], v[78:79], v[156:157]
  v_cvt_pk_bf16_f32 v80, v64, v65
  v_cvt_pk_bf16_f32 v81, v66, v67
  v_cvt_pk_bf16_f32 v82, v68, v69
  v_cvt_pk_bf16_f32 v83, v70, v71
  v_cvt_pk_bf16_f32 v84, v72, v73
  v_cvt_pk_bf16_f32 v85, v74, v75
  v_cvt_pk_bf16_f32 v86, v76, v77
  v_cvt_pk_bf16_f32 v87, v78, v79
  s_add_u32 s40, s30, s48
  s_mov_b64 exec, s[34:35]
  buffer_store_dwordx4 v[80:83], v28, s[4:7], s40 offen sc1
  s_add_u32 s40, s40, 32768
  buffer_store_dwordx4 v[84:87], v28, s[4:7], s40 offen sc1
  s_mov_b64 exec, -1
  s_cmp_eq_u32 s28, 63
  s_cbranch_scc1 RM0S_NODMA
  s_add_u32 s33, s33, 2
  s_min_u32 s42, s33, 128
  s_cmp_ge_u32 s22, s42
  s_cbranch_scc1 RM0S_WKV8_D
  s_mov_b32 s23, 0
RM0S_WKV8:
  buffer_load_dword v4, v249, s[4:7], 0 offen sc1
  s_waitcnt vmcnt(0)
  v_cmp_gt_u32 vcc, s42, v4
  s_nop 3
  s_cbranch_vccz RM0S_WKV8_K
  s_sleep 4
  s_add_u32 s23, s23, 1
  s_cmp_lt_u32 s23, 0x100000
  s_cbranch_scc1 RM0S_WKV8
RM0S_WKV8_K:
  v_readlane_b32 s22, v4, 0
  v_readlane_b32 s41, v4, 1
  s_nop 0
  s_min_u32 s22, s22, s41
  v_readlane_b32 s41, v4, 2
  s_nop 0
  s_min_u32 s22, s22, s41
  v_readlane_b32 s41, v4, 3
  s_nop 0
  s_min_u32 s22, s22, s41
  s_nop 2
RM0S_WKV8_D:
  s_add_u32 m0, s49, 0
  s_add_u32 s40, s44, 0
  buffer_load_dwordx4 v6, s[4:7], s40 offen offset:0 sc1 lds
  buffer_load_dwordx4 v6, s[4:7], s40 offen offset:1024 sc1 lds
  buffer_load_dwordx4 v6, s[4:7], s40 offen offset:2048 sc1 lds
  buffer_load_dwordx4 v6, s[4:7], s40 offen offset:3072 sc1 lds
  s_add_u32 m0, s49, 4096
  s_add_u32 s40, s44, 4096
  buffer_load_dwordx4 v6, s[4:7], s40 offen offset:0 sc1 lds
  buffer_load_dwordx4 v6, s[4:7], s40 offen offset:1024 sc1 lds
  buffer_load_dwordx4 v6, s[4:7], s40 offen offset:2048 sc1 lds
  buffer_load_dwordx4 v6, s[4:7], s40 offen offset:3072 sc1 lds
  s_add_u32 m0, s49, 8192
  s_add_u32 s40, s44, 8192
  buffer_load_dwordx4 v6, s[4:7], s40 offen offset:0 sc1 lds
  buffer_load_dwordx4 v6, s[4:7], s40 offen offset:1024 sc1 lds
  buffer_load_dwordx4 v6, s[4:7], s40 offen offset:2048 sc1 lds
  buffer_load_dwordx4 v6, s[4:7], s40 offen offset:3072 sc1 lds
  s_add_u32 s44, s44, 393216
  s_xor_b32 s49, s49, 57344
RM0S_NODMA:
  s_mov_b64 exec, s[34:35]
  s_cmp_lg_u32 s26, 0
  s_cbranch_scc1 RM0S_NOKM
  buffer_store_dwordx4 v[172:175], v15, s[4:7], s47 offen offset:0 sc1
  buffer_store_dwordx4 v[176:179], v15, s[4:7], s47 offen offset:512 sc1
  s_nop 1
RM0S_NOKM:
  s_mov_b64 exec, -1
  s_add_u32 s47, s47, 98304
  v_mov_b32 v64, v48
  v_mov_b32 v65, v49
  v_mov_b32 v66, v50
  v_mov_b32 v67, v51
  v_permlane32_swap_b32 v48, v64
  v_permlane32_swap_b32 v49, v65
  v_permlane32_swap_b32 v50, v66
  v_permlane32_swap_b32 v51, v67
  v_add_f32 v48, v48, v64
  v_add_f32 v49, v49, v65
  v_add_f32 v50, v50, v66
  v_add_f32 v51, v51, v67
  v_cvt_pk_bf16_f32 v220, v48, v49
  v_cvt_pk_bf16_f32 v221, v50, v51
  v_mov_b32 v64, v52
  v_mov_b32 v65, v53
  v_mov_b32 v66, v54
  v_mov_b32 v67, v55
  v_permlane32_swap_b32 v52, v64
  v_permlane32_swap_b32 v53, v65
  v_permlane32_swap_b32 v54, v66
  v_permlane32_swap_b32 v55, v67
  v_add_f32 v52, v52, v64
  v_add_f32 v53, v53, v65
  v_add_f32 v54, v54, v66
  v_add_f32 v55, v55, v67
  v_cvt_pk_bf16_f32 v222, v52, v53
  v_cvt_pk_bf16_f32 v223, v54, v55
  v_mov_b32 v64, v56
  v_mov_b32 v65, v57
  v_mov_b32 v66, v58
  v_mov_b32 v67, v59
  v_permlane32_swap_b32 v56, v64
  v_permlane32_swap_b32 v57, v65
  v_permlane32_swap_b32 v58, v66
  v_permlane32_swap_b32 v59, v67
  v_add_f32 v56, v56, v64
  v_add_f32 v57, v57, v65
  v_add_f32 v58, v58, v66
  v_add_f32 v59, v59, v67
  v_cvt_pk_bf16_f32 v224, v56, v57
  v_cvt_pk_bf16_f32 v225, v58, v59
  v_mov_b32 v64, v60
  v_mov_b32 v65, v61
  v_mov_b32 v66, v62
  v_mov_b32 v67, v63
  v_permlane32_swap_b32 v60, v64
  v_permlane32_swap_b32 v61, v65
  v_permlane32_swap_b32 v62, v66
  v_permlane32_swap_b32 v63, v67
  v_add_f32 v60, v60, v64
  v_add_f32 v61, v61, v65
  v_add_f32 v62, v62, v66
  v_add_f32 v63, v63, v67
  v_cvt_pk_bf16_f32 v226, v60, v61
  v_cvt_pk_bf16_f32 v227, v62, v63
  s_mov_b32 exec_hi, 0
  buffer_store_dwordx2 v[220:221], v29, s[4:7], s46 offen offset:0 sc1
  buffer_store_dwordx2 v[222:223], v29, s[4:7], s46 offen offset:256 sc1
  buffer_store_dwordx2 v[224:225], v29, s[4:7], s46 offen offset:512 sc1
  buffer_store_dwordx2 v[226:227], v29, s[4:7], s46 offen offset:768 sc1
  s_mov_b64 exec, -1
  s_add_u32 s46, s46, 327680
  s_add_u32 s28, s28, 1
  s_cmp_ge_u32 s28, 64
  s_cbranch_scc1 RM0S_DONE
  v_add_u32 v4, s50, v6
  ds_read_b128 v[148:151], v4 offset:12288
  ds_read_b128 v[152:155], v4 offset:13312
  ds_read_b128 v[156:159], v4 offset:14336
  ds_read_b128 v[160:163], v4 offset:15360
  ds_read_b128 v[164:167], v4 offset:16384
  ds_read_b128 v[168:171], v4 offset:17408
  ds_read_b128 v[172:175], v4 offset:18432
  ds_read_b128 v[176:179], v4 offset:19456
  s_waitcnt lgkmcnt(4)
  ds_read_b128 v[180:183], v4 offset:20480
  ds_read_b128 v[184:187], v4 offset:21504
  ds_read_b128 v[188:191], v4 offset:22528
  ds_read_b128 v[192:195], v4 offset:23552
  s_waitcnt lgkmcnt(0)
  ds_read_b128 v[100:103], v4 offset:0
  ds_read_b128 v[104:107], v4 offset:1024
  ds_read_b128 v[108:111], v4 offset:2048
  ds_read_b128 v[112:115], v4 offset:3072
  ds_read_b128 v[116:119], v4 offset:4096
  ds_read_b128 v[120:123], v4 offset:5120
  ds_read_b128 v[124:127], v4 offset:6144
  ds_read_b128 v[128:131], v4 offset:7168
  ds_read_b128 v[132:135], v4 offset:8192
  ds_read_b128 v[136:139], v4 offset:9216
  ds_read_b128 v[140:143], v4 offset:10240
  ds_read_b128 v[144:147], v4 offset:11264
  v_mfma_f32_16x16x32_bf16 v[48:51], v[148:151], a[160:163], 0
  v_mfma_f32_16x16x32_bf16 v[52:55], v[172:175], a[160:163], 0
  v_mfma_f32_16x16x32_bf16 v[56:59], v[148:151], a[184:187], 0
  v_mfma_f32_16x16x32_bf16 v[60:63], v[172:175], a[184:187], 0
  v_mfma_f32_16x16x32_bf16 v[64:67], v[148:151], a[208:211], 0
  v_mfma_f32_16x16x32_bf16 v[68:71], v[172:175], a[208:211], 0
  v_mfma_f32_16x16x32_bf16 v[72:75], v[148:151], a[232:235], 0
  v_mfma_f32_16x16x32_bf16 v[76:79], v[172:175], a[232:235], 0
  v_mfma_f32_16x16x32_bf16 v[48:51], v[152:155], a[164:167], v[48:51]
  v_mfma_f32_16x16x32_bf16 v[52:55], v[176:179], a[164:167], v[52:55]
  v_mfma_f32_16x16x32_bf16 v[56:59], v[152:155], a[188:191], v[56:59]
  v_mfma_f32_16x16x32_bf16 v[60:63], v[176:179], a[188:191], v[60:63]
  v_mfma_f32_16x16x32_bf16 v[64:67], v[152:155], a[212:215], v[64:67]
  v_mfma_f32_16x16x32_bf16 v[68:71], v[176:179], a[212:215], v[68:71]
  v_mfma_f32_16x16x32_bf16 v[72:75], v[152:155], a[236:239], v[72:75]
  v_mfma_f32_16x16x32_bf16 v[76:79], v[176:179], a[236:239], v[76:79]
  v_mfma_f32_16x16x32_bf16 v[48:51], v[156:159], a[168:171], v[48:51]
  v_mfma_f32_16x16x32_bf16 v[52:55], v[180:183], a[168:171], v[52:55]
  v_mfma_f32_16x16x32_bf16 v[56:59], v[156:159], a[192:195], v[56:59]
  v_mfma_f32_16x16x32_bf16 v[60:63], v[180:183], a[192:195], v[60:63]
  v_mfma_f32_16x16x32_bf16 v[64:67], v[156:159], a[216:219], v[64:67]
  v_mfma_f32_16x16x32_bf16 v[68:71], v[180:183], a[216:219], v[68:71]
  v_mfma_f32_16x16x32_bf16 v[72:75], v[156:159], a[240:243], v[72:75]
  v_mfma_f32_16x16x32_bf16 v[76:79], v[180:183], a[240:243], v[76:79]
  v_mfma_f32_16x16x32_bf16 v[48:51], v[160:163], a[172:175], v[48:51]
  v_mfma_f32_16x16x32_bf16 v[52:55], v[184:187], a[172:175], v[52:55]
  v_mfma_f32_16x16x32_bf16 v[56:59], v[160:163], a[196:199], v[56:59]
  v_mfma_f32_16x16x32_bf16 v[60:63], v[184:187], a[196:199], v[60:63]
  v_mfma_f32_16x16x32_bf16 v[64:67], v[160:163], a[220:223], v[64:67]
  v_mfma_f32_16x16x32_bf16 v[68:71], v[184:187], a[220:223], v[68:71]
  v_mfma_f32_16x16x32_bf16 v[72:75], v[160:163], a[244:247], v[72:75]
  v_mfma_f32_16x16x32_bf16 v[76:79], v[184:187], a[244:247], v[76:79]
  v_mfma_f32_16x16x32_bf16 v[48:51], v[164:167], a[176:179], v[48:51]
  v_mfma_f32_16x16x32_bf16 v[52:55], v[188:191], a[176:179], v[52:55]
  v_mfma_f32_16x16x32_bf16 v[56:59], v[164:167], a[200:203], v[56:59]
  v_mfma_f32_16x16x32_bf16 v[60:63], v[188:191], a[200:203], v[60:63]
  v_mfma_f32_16x16x32_bf16 v[64:67], v[164:167], a[224:227], v[64:67]
  v_mfma_f32_16x16x32_bf16 v[68:71], v[188:191], a[224:227], v[68:71]
  v_mfma_f32_16x16x32_bf16 v[72:75], v[164:167], a[248:251], v[72:75]
  v_mfma_f32_16x16x32_bf16 v[76:79], v[188:191], a[248:251], v[76:79]
  v_mfma_f32_16x16x32_bf16 v[48:51], v[168:171], a[180:183], v[48:51]
  v_mfma_f32_16x16x32_bf16 v[52:55], v[192:195], a[180:183], v[52:55]
  v_mfma_f32_16x16x32_bf16 v[56:59], v[168:171], a[204:207], v[56:59]
  v_mfma_f32_16x16x32_bf16 v[60:63], v[192:195], a[204:207], v[60:63]
  v_mfma_f32_16x16x32_bf16 v[64:67], v[168:171], a[228:231], v[64:67]
  v_mfma_f32_16x16x32_bf16 v[68:71], v[192:195], a[228:231], v[68:71]
  v_mfma_f32_16x16x32_bf16 v[72:75], v[168:171], a[252:255], v[72:75]
  v_mfma_f32_16x16x32_bf16 v[76:79], v[192:195], a[252:255], v[76:79]
  s_nop 0
  v_cvt_pk_bf16_f32 v232, v48, v49
  v_cvt_pk_bf16_f32 v233, v50, v51
  v_cvt_pk_bf16_f32 v234, v52, v53
  v_cvt_pk_bf16_f32 v235, v54, v55
  s_add_u32 s40, s45, 0
  v_cvt_pk_bf16_f32 v236, v56, v57
  v_cvt_pk_bf16_f32 v237, v58, v59
  v_cvt_pk_bf16_f32 v238, v60, v61
  v_cvt_pk_bf16_f32 v239, v62, v63
  s_add_u32 s40, s45, 1024
  v_cvt_pk_bf16_f32 v240, v64, v65
  v_cvt_pk_bf16_f32 v241, v66, v67
  v_cvt_pk_bf16_f32 v242, v68, v69
  v_cvt_pk_bf16_f32 v243, v70, v71
  s_add_u32 s40, s45, 2048
  v_cvt_pk_bf16_f32 v244, v72, v73
  v_cvt_pk_bf16_f32 v245, v74, v75
  v_cvt_pk_bf16_f32 v246, v76, v77
  v_cvt_pk_bf16_f32 v247, v78, v79
  s_add_u32 s40, s45, 3072
  s_add_u32 s45, s45, 1310720
  s_waitcnt lgkmcnt(0)
  s_xor_b32 s50, s50, 57344
  s_mov_b32 s40, s29
  s_mov_b32 s29, s30
  s_mov_b32 s30, s31
  s_mov_b32 s31, s32
  s_mov_b32 s32, s40
  s_branch RM0S_LOOP
RM0S_DONE:
  s_waitcnt vmcnt(0)
  s_barrier
  s_endpgm
RK_W1:
  v_add_u32 v4, 160, v1
  v_and_b32 v5, 7, v4
  v_mul_u32_u24 v5, 1280, v5
  v_lshrrev_b32 v212, 5, v4
  v_lshlrev_b32 v212, 6, v212
  v_add_u32 v5, v5, v212
  v_bfe_u32 v4, v4, 3, 2
  v_lshlrev_b32 v4, 3, v4
  v_add_u32 v4, v4, v5
  buffer_load_dwordx2 v[200:201], v4, s[88:91], 0 offen
  buffer_load_dwordx2 v[202:203], v4, s[88:91], 0 offen offset:32
  v_add_u32 v4, 224, v1
  v_and_b32 v5, 7, v4
  v_mul_u32_u24 v5, 1280, v5
  v_lshrrev_b32 v212, 5, v4
  v_lshlrev_b32 v212, 6, v212
  v_add_u32 v5, v5, v212
  v_bfe_u32 v4, v4, 3, 2
  v_lshlrev_b32 v4, 3, v4
  v_add_u32 v4, v4, v5
  buffer_load_dwordx2 v[204:205], v4, s[88:91], 0 offen
  buffer_load_dwordx2 v[206:207], v4, s[88:91], 0 offen offset:32
  v_add_u32 v4, 288, v1
  v_and_b32 v5, 7, v4
  v_mul_u32_u24 v5, 1280, v5
  v_lshrrev_b32 v212, 5, v4
  v_lshlrev_b32 v212, 6, v212
  v_add_u32 v5, v5, v212
  v_bfe_u32 v4, v4, 3, 2
  v_lshlrev_b32 v4, 3, v4
  v_add_u32 v4, v4, v5
  buffer_load_dwordx2 v[208:209], v4, s[88:91], 0 offen
  buffer_load_dwordx2 v[210:211], v4, s[88:91], 0 offen offset:32
  s_lshl_b32 s54, s24, 15
  v_lshrrev_b32 v4, 3, v1
  v_add_u32 v4, 8, v4
  s_mov_b32 s55, 12288
  v_mul_lo_u32 v32, v4, s55
  v_and_b32 v4, 7, v1
  v_lshlrev_b32 v4, 4, v4
  v_add_u32 v32, v32, v4
  v_bfe_u32 v33, v1, 4, 1
  v_lshlrev_b32 v33, 4, v33
  v_bfe_u32 v4, v1, 5, 1
  v_lshlrev_b32 v4, 3, v4
  v_add_u32 v33, v33, v4
  v_bfe_u32 v4, v1, 2, 1
  v_add_u32 v33, v33, v4
  v_bfe_u32 v4, v1, 3, 1
  v_lshlrev_b32 v4, 2, v4
  v_add_u32 v33, v33, v4
  v_lshlrev_b32 v33, 7, v33
  v_and_b32 v4, 3, v1
  v_lshlrev_b32 v4, 3, v4
  v_add_u32 v33, v33, v4
  s_mul_i32 s56, s25, 384
  s_mul_i32 s40, s26, 96
  s_add_u32 s56, s56, s40
  v_add_u32 v34, 61440, v33
  v_lshlrev_b32 v35, 4, v1
  v_add_u32 v35, 1024, v35
  v_add_u32 v36, 61440, v35
  s_add_u32 s40, s56, 0
  s_mov_b32 m0, 1024
  s_nop 0
  buffer_load_dwordx4 v32, s[8:11], s40 offen lds
  s_add_u32 s40, s56, 0
  s_mov_b32 m0, 5120
  s_nop 0
  buffer_load_dwordx4 v32, s[12:15], s40 offen lds
  s_add_u32 s40, s56, 0
  s_mov_b32 m0, 9216
  s_nop 0
  buffer_load_dwordx4 v32, s[16:19], s40 offen lds
  s_add_u32 s40, s56, 393216
  s_mov_b32 m0, 13312
  s_nop 0
  buffer_load_dwordx4 v32, s[8:11], s40 offen lds
  s_add_u32 s40, s56, 393216
  s_mov_b32 m0, 17408
  s_nop 0
  buffer_load_dwordx4 v32, s[12:15], s40 offen lds
  s_add_u32 s40, s56, 393216
  s_mov_b32 m0, 21504
  s_nop 0
  buffer_load_dwordx4 v32, s[16:19], s40 offen lds
  s_add_u32 s40, s56, 786432
  s_mov_b32 m0, 25600
  s_nop 0
  buffer_load_dwordx4 v32, s[8:11], s40 offen lds
  s_add_u32 s40, s56, 786432
  s_mov_b32 m0, 29696
  s_nop 0
  buffer_load_dwordx4 v32, s[12:15], s40 offen lds
  s_add_u32 s40, s56, 786432
  s_mov_b32 m0, 33792
  s_nop 0
  buffer_load_dwordx4 v32, s[16:19], s40 offen lds
  s_add_u32 s40, s56, 1179648
  s_mov_b32 m0, 37888
  s_nop 0
  buffer_load_dwordx4 v32, s[8:11], s40 offen lds
  s_add_u32 s40, s56, 1179648
  s_mov_b32 m0, 41984
  s_nop 0
  buffer_load_dwordx4 v32, s[12:15], s40 offen lds
  s_add_u32 s40, s56, 1179648
  s_mov_b32 m0, 46080
  s_nop 0
  buffer_load_dwordx4 v32, s[16:19], s40 offen lds
  s_add_u32 s40, s56, 1572864
  s_mov_b32 m0, 50176
  s_nop 0
  buffer_load_dwordx4 v32, s[8:11], s40 offen lds
  s_add_u32 s40, s56, 1572864
  s_mov_b32 m0, 54272
  s_nop 0
  buffer_load_dwordx4 v32, s[12:15], s40 offen lds
  s_add_u32 s40, s56, 1572864
  s_mov_b32 m0, 58368
  s_nop 0
  buffer_load_dwordx4 v32, s[16:19], s40 offen lds
  s_add_u32 s40, s56, 1966080
  s_mov_b32 m0, 62464
  s_nop 0
  buffer_load_dwordx4 v32, s[8:11], s40 offen lds
  s_add_u32 s40, s56, 1966080
  s_mov_b32 m0, 66560
  s_nop 0
  buffer_load_dwordx4 v32, s[12:15], s40 offen lds
  s_add_u32 s40, s56, 1966080
  s_mov_b32 m0, 70656
  s_nop 0
  buffer_load_dwordx4 v32, s[16:19], s40 offen lds
  s_add_u32 s40, s56, 2359296
  s_mov_b32 m0, 74752
  s_nop 0
  buffer_load_dwordx4 v32, s[8:11], s40 offen lds
  s_add_u32 s40, s56, 2359296
  s_mov_b32 m0, 78848
  s_nop 0
  buffer_load_dwordx4 v32, s[12:15], s40 offen lds
  s_add_u32 s40, s56, 2359296
  s_mov_b32 m0, 82944
  s_nop 0
  buffer_load_dwordx4 v32, s[16:19], s40 offen lds
  s_add_u32 s40, s56, 2752512
  s_mov_b32 m0, 87040
  s_nop 0
  buffer_load_dwordx4 v32, s[8:11], s40 offen lds
  s_add_u32 s40, s56, 2752512
  s_mov_b32 m0, 91136
  s_nop 0
  buffer_load_dwordx4 v32, s[12:15], s40 offen lds
  s_add_u32 s40, s56, 2752512
  s_mov_b32 m0, 95232
  s_nop 0
  buffer_load_dwordx4 v32, s[16:19], s40 offen lds
  s_add_u32 s40, s56, 3145728
  s_mov_b32 m0, 99328
  s_nop 0
  buffer_load_dwordx4 v32, s[8:11], s40 offen lds
  s_add_u32 s40, s56, 3145728
  s_mov_b32 m0, 103424
  s_nop 0
  buffer_load_dwordx4 v32, s[12:15], s40 offen lds
  s_add_u32 s40, s56, 3145728
  s_mov_b32 m0, 107520
  s_nop 0
  buffer_load_dwordx4 v32, s[16:19], s40 offen lds
  s_add_u32 s40, s56, 3538944
  s_mov_b32 m0, 111616
  s_nop 0
  buffer_load_dwordx4 v32, s[8:11], s40 offen lds
  s_add_u32 s40, s56, 3538944
  s_mov_b32 m0, 115712
  s_nop 0
  buffer_load_dwordx4 v32, s[12:15], s40 offen lds
  s_add_u32 s40, s56, 3538944
  s_mov_b32 m0, 119808
  s_nop 0
  buffer_load_dwordx4 v32, s[16:19], s40 offen lds
  s_add_u32 s40, s56, 3932160
  buffer_load_dwordx4 v[64:67], v32, s[8:11], s40 offen
  s_add_u32 s40, s56, 3932160
  buffer_load_dwordx4 v[68:71], v32, s[12:15], s40 offen
  s_add_u32 s40, s56, 3932160
  buffer_load_dwordx4 v[72:75], v32, s[16:19], s40 offen
  s_add_u32 s40, s56, 4325376
  buffer_load_dwordx4 v[76:79], v32, s[8:11], s40 offen
  s_add_u32 s40, s56, 4325376
  buffer_load_dwordx4 v[80:83], v32, s[12:15], s40 offen
  s_add_u32 s40, s56, 4325376
  buffer_load_dwordx4 v[84:87], v32, s[16:19], s40 offen
  s_add_u32 s40, s56, 4718592
  buffer_load_dwordx4 v[88:91], v32, s[8:11], s40 offen
  s_add_u32 s40, s56, 4718592
  buffer_load_dwordx4 v[92:95], v32, s[12:15], s40 offen
  s_add_u32 s40, s56, 4718592
  buffer_load_dwordx4 v[96:99], v32, s[16:19], s40 offen
  s_add_u32 s40, s56, 5111808
  buffer_load_dwordx4 v[100:103], v32, s[8:11], s40 offen
  s_add_u32 s40, s56, 5111808
  buffer_load_dwordx4 v[104:107], v32, s[12:15], s40 offen
  s_add_u32 s40, s56, 5111808
  buffer_load_dwordx4 v[108:111], v32, s[16:19], s40 offen
  s_add_u32 s40, s56, 5505024
  buffer_load_dwordx4 v[112:115], v32, s[8:11], s40 offen
  s_add_u32 s40, s56, 5505024
  buffer_load_dwordx4 v[116:119], v32, s[12:15], s40 offen
  s_add_u32 s40, s56, 5505024
  buffer_load_dwordx4 v[120:123], v32, s[16:19], s40 offen
  s_add_u32 s40, s56, 5898240
  buffer_load_dwordx4 v[124:127], v32, s[8:11], s40 offen
  s_add_u32 s40, s56, 5898240
  buffer_load_dwordx4 v[128:131], v32, s[12:15], s40 offen
  s_add_u32 s40, s56, 5898240
  buffer_load_dwordx4 v[132:135], v32, s[16:19], s40 offen
  s_add_u32 s40, s56, 6291456
  buffer_load_dwordx4 v[136:139], v32, s[8:11], s40 offen
  s_add_u32 s40, s56, 6291456
  buffer_load_dwordx4 v[140:143], v32, s[12:15], s40 offen
  s_add_u32 s40, s56, 6291456
  buffer_load_dwordx4 v[144:147], v32, s[16:19], s40 offen
  s_add_u32 s40, s56, 6684672
  buffer_load_dwordx4 v[148:151], v32, s[8:11], s40 offen
  s_add_u32 s40, s56, 6684672
  buffer_load_dwordx4 v[152:155], v32, s[12:15], s40 offen
  s_add_u32 s40, s56, 6684672
  buffer_load_dwordx4 v[156:159], v32, s[16:19], s40 offen
  s_add_u32 s40, s56, 7077888
  buffer_load_dwordx4 v[160:163], v32, s[8:11], s40 offen
  s_add_u32 s40, s56, 7077888
  buffer_load_dwordx4 v[164:167], v32, s[12:15], s40 offen
  s_add_u32 s40, s56, 7077888
  buffer_load_dwordx4 v[168:171], v32, s[16:19], s40 offen
  s_add_u32 s40, s56, 7471104
  buffer_load_dwordx4 v[172:175], v32, s[8:11], s40 offen
  s_add_u32 s40, s56, 7471104
  buffer_load_dwordx4 v[176:179], v32, s[12:15], s40 offen
  s_add_u32 s40, s56, 7471104
  buffer_load_dwordx4 v[180:183], v32, s[16:19], s40 offen
  s_waitcnt vmcnt(45)
  s_barrier
  ds_read_b64_tr_b16 a[0:1], v33 offset:32
  ds_read_b64_tr_b16 a[2:3], v33 offset:288
  ds_read_b64_tr_b16 a[80:81], v33 offset:4128
  ds_read_b64_tr_b16 a[82:83], v33 offset:4384
  ds_read_b64_tr_b16 a[4:5], v33 offset:12320
  ds_read_b64_tr_b16 a[6:7], v33 offset:12576
  ds_read_b64_tr_b16 a[84:85], v33 offset:16416
  ds_read_b64_tr_b16 a[86:87], v33 offset:16672
  ds_read_b64_tr_b16 a[8:9], v33 offset:24608
  ds_read_b64_tr_b16 a[10:11], v33 offset:24864
  ds_read_b64_tr_b16 a[88:89], v33 offset:28704
  ds_read_b64_tr_b16 a[90:91], v33 offset:28960
  s_waitcnt lgkmcnt(4)
  ds_read_b64_tr_b16 a[12:13], v33 offset:36896
  ds_read_b64_tr_b16 a[14:15], v33 offset:37152
  ds_read_b64_tr_b16 a[92:93], v33 offset:40992
  ds_read_b64_tr_b16 a[94:95], v33 offset:41248
  ds_read_b64_tr_b16 a[16:17], v33 offset:49184
  ds_read_b64_tr_b16 a[18:19], v33 offset:49440
  ds_read_b64_tr_b16 a[96:97], v33 offset:53280
  ds_read_b64_tr_b16 a[98:99], v33 offset:53536
  s_waitcnt lgkmcnt(0)
  s_barrier
  s_waitcnt vmcnt(30)
  s_barrier
  ds_read_b64_tr_b16 a[20:21], v33 offset:61472
  ds_read_b64_tr_b16 a[22:23], v33 offset:61728
  ds_read_b64_tr_b16 a[100:101], v34 offset:4128
  ds_read_b64_tr_b16 a[102:103], v34 offset:4384
  ds_read_b64_tr_b16 a[24:25], v34 offset:12320
  ds_read_b64_tr_b16 a[26:27], v34 offset:12576
  ds_read_b64_tr_b16 a[104:105], v34 offset:16416
  ds_read_b64_tr_b16 a[106:107], v34 offset:16672
  ds_read_b64_tr_b16 a[28:29], v34 offset:24608
  ds_read_b64_tr_b16 a[30:31], v34 offset:24864
  ds_read_b64_tr_b16 a[108:109], v34 offset:28704
  ds_read_b64_tr_b16 a[110:111], v34 offset:28960
  s_waitcnt lgkmcnt(4)
  ds_read_b64_tr_b16 a[32:33], v34 offset:36896
  ds_read_b64_tr_b16 a[34:35], v34 offset:37152
  ds_read_b64_tr_b16 a[112:113], v34 offset:40992
  ds_read_b64_tr_b16 a[114:115], v34 offset:41248
  ds_read_b64_tr_b16 a[36:37], v34 offset:49184
  ds_read_b64_tr_b16 a[38:39], v34 offset:49440
  ds_read_b64_tr_b16 a[116:117], v34 offset:53280
  ds_read_b64_tr_b16 a[118:119], v34 offset:53536
  s_waitcnt lgkmcnt(0)
  s_barrier
  s_waitcnt vmcnt(15)
  ds_write_b128 v35, v[64:67] offset:0
  ds_write_b128 v35, v[68:71] offset:4096
  ds_write_b128 v35, v[72:75] offset:8192
  ds_write_b128 v35, v[76:79] offset:12288
  ds_write_b128 v35, v[80:83] offset:16384
  ds_write_b128 v35, v[84:87] offset:20480
  s_waitcnt lgkmcnt(6)
  ds_write_b128 v35, v[88:91] offset:24576
  ds_write_b128 v35, v[92:95] offset:28672
  ds_write_b128 v35, v[96:99] offset:32768
  ds_write_b128 v35, v[100:103] offset:36864
  ds_write_b128 v35, v[104:107] offset:40960
  ds_write_b128 v35, v[108:111] offset:45056
  s_waitcnt lgkmcnt(6)
  ds_write_b128 v35, v[112:115] offset:49152
  ds_write_b128 v35, v[116:119] offset:53248
  ds_write_b128 v35, v[120:123] offset:57344
  s_waitcnt lgkmcnt(0)
  s_barrier
  ds_read_b64_tr_b16 a[40:41], v33 offset:32
  ds_read_b64_tr_b16 a[42:43], v33 offset:288
  ds_read_b64_tr_b16 a[120:121], v33 offset:4128
  ds_read_b64_tr_b16 a[122:123], v33 offset:4384
  ds_read_b64_tr_b16 a[44:45], v33 offset:12320
  ds_read_b64_tr_b16 a[46:47], v33 offset:12576
  ds_read_b64_tr_b16 a[124:125], v33 offset:16416
  ds_read_b64_tr_b16 a[126:127], v33 offset:16672
  ds_read_b64_tr_b16 a[48:49], v33 offset:24608
  ds_read_b64_tr_b16 a[50:51], v33 offset:24864
  ds_read_b64_tr_b16 a[128:129], v33 offset:28704
  ds_read_b64_tr_b16 a[130:131], v33 offset:28960
  s_waitcnt lgkmcnt(4)
  ds_read_b64_tr_b16 a[52:53], v33 offset:36896
  ds_read_b64_tr_b16 a[54:55], v33 offset:37152
  ds_read_b64_tr_b16 a[132:133], v33 offset:40992
  ds_read_b64_tr_b16 a[134:135], v33 offset:41248
  ds_read_b64_tr_b16 a[56:57], v33 offset:49184
  ds_read_b64_tr_b16 a[58:59], v33 offset:49440
  ds_read_b64_tr_b16 a[136:137], v33 offset:53280
  ds_read_b64_tr_b16 a[138:139], v33 offset:53536
  s_waitcnt lgkmcnt(0)
  s_barrier
  s_waitcnt vmcnt(0)
  ds_write_b128 v36, v[124:127] offset:0
  ds_write_b128 v36, v[128:131] offset:4096
  ds_write_b128 v36, v[132:135] offset:8192
  ds_write_b128 v36, v[136:139] offset:12288
  ds_write_b128 v36, v[140:143] offset:16384
  ds_write_b128 v36, v[144:147] offset:20480
  s_waitcnt lgkmcnt(6)
  ds_write_b128 v36, v[148:151] offset:24576
  ds_write_b128 v36, v[152:155] offset:28672
  ds_write_b128 v36, v[156:159] offset:32768
  ds_write_b128 v36, v[160:163] offset:36864
  ds_write_b128 v36, v[164:167] offset:40960
  ds_write_b128 v36, v[168:171] offset:45056
  s_waitcnt lgkmcnt(6)
  ds_write_b128 v36, v[172:175] offset:49152
  ds_write_b128 v36, v[176:179] offset:53248
  ds_write_b128 v36, v[180:183] offset:57344
  s_waitcnt lgkmcnt(0)
  s_barrier
  ds_read_b64_tr_b16 a[60:61], v33 offset:61472
  ds_read_b64_tr_b16 a[62:63], v33 offset:61728
  ds_read_b64_tr_b16 a[140:141], v34 offset:4128
  ds_read_b64_tr_b16 a[142:143], v34 offset:4384
  ds_read_b64_tr_b16 a[64:65], v34 offset:12320
  ds_read_b64_tr_b16 a[66:67], v34 offset:12576
  ds_read_b64_tr_b16 a[144:145], v34 offset:16416
  ds_read_b64_tr_b16 a[146:147], v34 offset:16672
  ds_read_b64_tr_b16 a[68:69], v34 offset:24608
  ds_read_b64_tr_b16 a[70:71], v34 offset:24864
  ds_read_b64_tr_b16 a[148:149], v34 offset:28704
  ds_read_b64_tr_b16 a[150:151], v34 offset:28960
  s_waitcnt lgkmcnt(4)
  ds_read_b64_tr_b16 a[72:73], v34 offset:36896
  ds_read_b64_tr_b16 a[74:75], v34 offset:37152
  ds_read_b64_tr_b16 a[152:153], v34 offset:40992
  ds_read_b64_tr_b16 a[154:155], v34 offset:41248
  ds_read_b64_tr_b16 a[76:77], v34 offset:49184
  ds_read_b64_tr_b16 a[78:79], v34 offset:49440
  ds_read_b64_tr_b16 a[156:157], v34 offset:53280
  ds_read_b64_tr_b16 a[158:159], v34 offset:53536
  s_waitcnt lgkmcnt(0)
  s_barrier
  s_mul_i32 s56, s25, 245760
  s_mul_i32 s40, s26, 320
  s_add_u32 s56, s56, s40
  s_add_u32 s56, s56, 128
  v_lshrrev_b32 v4, 2, v1
  s_mov_b32 s55, 1280
  v_mul_lo_u32 v32, v4, s55
  v_and_b32 v4, 3, v1
  v_lshlrev_b32 v4, 4, v4
  v_add_u32 v32, v32, v4
  v_lshrrev_b32 v33, 4, v1
  v_lshlrev_b32 v33, 2, v33
  v_bfe_u32 v4, v1, 2, 2
  v_add_u32 v33, v33, v4
  v_mul_u32_u24 v33, 64, v33
  v_and_b32 v4, 3, v1
  v_lshlrev_b32 v4, 3, v4
  v_add_u32 v33, v33, v4
  v_add_u32 v33, s54, v33
  s_add_u32 s40, s56, 0
  s_add_u32 m0, s54, 0
  s_nop 0
  buffer_load_dwordx4 v32, s[20:23], s40 offen lds
  s_add_u32 s40, s56, 20480
  s_add_u32 m0, s54, 1024
  s_nop 0
  buffer_load_dwordx4 v32, s[20:23], s40 offen lds
  s_add_u32 s40, s56, 64
  s_add_u32 m0, s54, 2048
  s_nop 0
  buffer_load_dwordx4 v32, s[20:23], s40 offen lds
  s_add_u32 s40, s56, 20544
  s_add_u32 m0, s54, 3072
  s_nop 0
  buffer_load_dwordx4 v32, s[20:23], s40 offen lds
  s_add_u32 s40, s56, 40960
  s_add_u32 m0, s54, 4096
  s_nop 0
  buffer_load_dwordx4 v32, s[20:23], s40 offen lds
  s_add_u32 s40, s56, 61440
  s_add_u32 m0, s54, 5120
  s_nop 0
  buffer_load_dwordx4 v32, s[20:23], s40 offen lds
  s_add_u32 s40, s56, 41024
  s_add_u32 m0, s54, 6144
  s_nop 0
  buffer_load_dwordx4 v32, s[20:23], s40 offen lds
  s_add_u32 s40, s56, 61504
  s_add_u32 m0, s54, 7168
  s_nop 0
  buffer_load_dwordx4 v32, s[20:23], s40 offen lds
  s_add_u32 s40, s56, 81920
  s_add_u32 m0, s54, 8192
  s_nop 0
  buffer_load_dwordx4 v32, s[20:23], s40 offen lds
  s_add_u32 s40, s56, 102400
  s_add_u32 m0, s54, 9216
  s_nop 0
  buffer_load_dwordx4 v32, s[20:23], s40 offen lds
  s_add_u32 s40, s56, 81984
  s_add_u32 m0, s54, 10240
  s_nop 0
  buffer_load_dwordx4 v32, s[20:23], s40 offen lds
  s_add_u32 s40, s56, 102464
  s_add_u32 m0, s54, 11264
  s_nop 0
  buffer_load_dwordx4 v32, s[20:23], s40 offen lds
  s_add_u32 s40, s56, 122880
  s_add_u32 m0, s54, 12288
  s_nop 0
  buffer_load_dwordx4 v32, s[20:23], s40 offen lds
  s_add_u32 s40, s56, 143360
  s_add_u32 m0, s54, 13312
  s_nop 0
  buffer_load_dwordx4 v32, s[20:23], s40 offen lds
  s_add_u32 s40, s56, 122944
  s_add_u32 m0, s54, 14336
  s_nop 0
  buffer_load_dwordx4 v32, s[20:23], s40 offen lds
  s_add_u32 s40, s56, 143424
  s_add_u32 m0, s54, 15360
  s_nop 0
  buffer_load_dwordx4 v32, s[20:23], s40 offen lds
  s_add_u32 s40, s56, 163840
  s_add_u32 m0, s54, 16384
  s_nop 0
  buffer_load_dwordx4 v32, s[20:23], s40 offen lds
  s_add_u32 s40, s56, 184320
  s_add_u32 m0, s54, 17408
  s_nop 0
  buffer_load_dwordx4 v32, s[20:23], s40 offen lds
  s_add_u32 s40, s56, 163904
  s_add_u32 m0, s54, 18432
  s_nop 0
  buffer_load_dwordx4 v32, s[20:23], s40 offen lds
  s_add_u32 s40, s56, 184384
  s_add_u32 m0, s54, 19456
  s_nop 0
  buffer_load_dwordx4 v32, s[20:23], s40 offen lds
  s_add_u32 s40, s56, 204800
  s_add_u32 m0, s54, 20480
  s_nop 0
  buffer_load_dwordx4 v32, s[20:23], s40 offen lds
  s_add_u32 s40, s56, 225280
  s_add_u32 m0, s54, 21504
  s_nop 0
  buffer_load_dwordx4 v32, s[20:23], s40 offen lds
  s_add_u32 s40, s56, 204864
  s_add_u32 m0, s54, 22528
  s_nop 0
  buffer_load_dwordx4 v32, s[20:23], s40 offen lds
  s_add_u32 s40, s56, 225344
  s_add_u32 m0, s54, 23552
  s_nop 0
  buffer_load_dwordx4 v32, s[20:23], s40 offen lds
  s_waitcnt vmcnt(20)
  ds_read_b64_tr_b16 a[160:161], v33 offset:0
  ds_read_b64_tr_b16 a[162:163], v33 offset:1024
  ds_read_b64_tr_b16 a[184:185], v33 offset:32
  ds_read_b64_tr_b16 a[186:187], v33 offset:1056
  ds_read_b64_tr_b16 a[208:209], v33 offset:2048
  ds_read_b64_tr_b16 a[210:211], v33 offset:3072
  ds_read_b64_tr_b16 a[232:233], v33 offset:2080
  ds_read_b64_tr_b16 a[234:235], v33 offset:3104
  s_waitcnt vmcnt(16)
  ds_read_b64_tr_b16 a[164:165], v33 offset:4096
  ds_read_b64_tr_b16 a[166:167], v33 offset:5120
  ds_read_b64_tr_b16 a[188:189], v33 offset:4128
  ds_read_b64_tr_b16 a[190:191], v33 offset:5152
  ds_read_b64_tr_b16 a[212:213], v33 offset:6144
  ds_read_b64_tr_b16 a[214:215], v33 offset:7168
  ds_read_b64_tr_b16 a[236:237], v33 offset:6176
  ds_read_b64_tr_b16 a[238:239], v33 offset:7200
  s_waitcnt vmcnt(12)
  ds_read_b64_tr_b16 a[168:169], v33 offset:8192
  ds_read_b64_tr_b16 a[170:171], v33 offset:9216
  ds_read_b64_tr_b16 a[192:193], v33 offset:8224
  ds_read_b64_tr_b16 a[194:195], v33 offset:9248
  ds_read_b64_tr_b16 a[216:217], v33 offset:10240
  ds_read_b64_tr_b16 a[218:219], v33 offset:11264
  ds_read_b64_tr_b16 a[240:241], v33 offset:10272
  ds_read_b64_tr_b16 a[242:243], v33 offset:11296
  s_waitcnt vmcnt(8)
  ds_read_b64_tr_b16 a[172:173], v33 offset:12288
  ds_read_b64_tr_b16 a[174:175], v33 offset:13312
  ds_read_b64_tr_b16 a[196:197], v33 offset:12320
  ds_read_b64_tr_b16 a[198:199], v33 offset:13344
  ds_read_b64_tr_b16 a[220:221], v33 offset:14336
  ds_read_b64_tr_b16 a[222:223], v33 offset:15360
  ds_read_b64_tr_b16 a[244:245], v33 offset:14368
  ds_read_b64_tr_b16 a[246:247], v33 offset:15392
  s_waitcnt vmcnt(4)
  ds_read_b64_tr_b16 a[176:177], v33 offset:16384
  ds_read_b64_tr_b16 a[178:179], v33 offset:17408
  ds_read_b64_tr_b16 a[200:201], v33 offset:16416
  ds_read_b64_tr_b16 a[202:203], v33 offset:17440
  ds_read_b64_tr_b16 a[224:225], v33 offset:18432
  ds_read_b64_tr_b16 a[226:227], v33 offset:19456
  ds_read_b64_tr_b16 a[248:249], v33 offset:18464
  ds_read_b64_tr_b16 a[250:251], v33 offset:19488
  s_waitcnt vmcnt(0)
  ds_read_b64_tr_b16 a[180:181], v33 offset:20480
  ds_read_b64_tr_b16 a[182:183], v33 offset:21504
  ds_read_b64_tr_b16 a[204:205], v33 offset:20512
  ds_read_b64_tr_b16 a[206:207], v33 offset:21536
  ds_read_b64_tr_b16 a[228:229], v33 offset:22528
  ds_read_b64_tr_b16 a[230:231], v33 offset:23552
  ds_read_b64_tr_b16 a[252:253], v33 offset:22560
  ds_read_b64_tr_b16 a[254:255], v33 offset:23584
  s_waitcnt lgkmcnt(0)
  v_lshlrev_b32 v6, 4, v1
  v_lshlrev_b32 v29, 3, v1
  v_mov_b32 v31, 0
  s_mov_b32 s34, 0x00ff00ff
  s_mov_b32 s35, 0x00ff00ff
  s_mov_b32 s38, 0xff00ff00
  s_mov_b32 s39, 0xff00ff00
  s_mov_b32 s20, 0
  s_mov_b32 s21, -1
  v_mov_b32 v248, 0xff800000
  s_mov_b32 s16, 0x0000ffff
  s_mov_b32 s17, 0x0000ffff
  v_mov_b32 v21, 0x44444444
  v_mov_b32 v4, 0xeeeeeeee
  v_cndmask_b32 v21, v21, v4, s[38:39]
  s_mov_b32 s60, 0x3dd53b95
  s_mov_b32 s61, 400000
  s_mov_b32 s28, 0
  s_mov_b32 s80, 0
  s_mov_b32 s81, 0
  s_mov_b32 s82, 0
  s_mov_b32 s83, 0
  s_mov_b32 s84, 0
  s_mov_b32 s85, 0
  s_mov_b32 s86, 0
  s_mov_b32 s87, 0
  s_mov_b32 s92, 0
  s_mov_b32 s93, 0
  s_mov_b32 s94, 0
  s_lshr_b32 s40, s27, 5
  s_mul_i32 s40, s40, 10240
  s_add_u32 s40, s40, 625152
  v_add_u32 v23, s40, v6
  v_lshrrev_b32 v5, 13, v23
  v_lshlrev_b32 v5, 14, v5
  v_and_b32 v23, 0x1fff, v23
  v_or_b32 v23, v23, v5
  v_add_u32 v24, s40, v6
  v_add_u32 v24, 1024, v24
  v_lshrrev_b32 v5, 13, v24
  v_lshlrev_b32 v5, 14, v5
  v_and_b32 v24, 0x1fff, v24
  v_or_b32 v24, v24, v5
  v_add_u32 v25, s40, v6
  v_add_u32 v25, 2048, v25
  v_lshrrev_b32 v5, 13, v25
  v_lshlrev_b32 v5, 14, v5
  v_and_b32 v25, 0x1fff, v25
  v_or_b32 v25, v25, v5
  v_mov_b32 v4, 0x80000000
  v_cmp_gt_u32 vcc, 32, v1
  s_nop 1
  v_cndmask_b32 v25, v4, v25, vcc
  v_add_u32 v10, 2560, v6
  v_lshlrev_b32 v15, 7, v2
  v_and_b32 v4, 7, v1
  v_lshlrev_b32 v4, 4, v4
  v_add_u32 v15, v15, v4
  v_add_u32 v15, 1024, v15
  v_lshrrev_b32 v12, 1, v2
  v_mul_u32_u24 v12, 3072, v12
  v_lshlrev_b32 v4, 4, v3
  v_add_u32 v12, v12, v4
  v_and_b32 v4, 1, v2
  v_lshlrev_b32 v4, 3, v4
  v_add_u32 v12, v12, v4
  s_mul_i32 s40, s26, 3
  s_add_u32 s40, s40, 1
  s_lshl_b32 s40, s40, 8
  s_mul_i32 s41, s25, 9216
  s_add_u32 s40, s40, s41
  v_add_u32 v12, s40, v12
  v_lshrrev_b32 v4, 13, v12
  v_lshlrev_b32 v4, 14, v4
  v_and_b32 v12, 0x1fff, v12
  v_or_b32 v12, v12, v4
  s_add_u32 s40, s41, 2048
  v_add_u32 v16, s40, v6
  v_add_u32 v17, 1024, v16
  v_add_u32 v19, 12288, v6
  v_lshrrev_b32 v4, 13, v16
  v_lshlrev_b32 v4, 14, v4
  v_and_b32 v16, 0x1fff, v16
  v_or_b32 v16, v16, v4
  v_lshrrev_b32 v4, 13, v17
  v_lshlrev_b32 v4, 14, v4
  v_and_b32 v17, 0x1fff, v17
  v_or_b32 v17, v17, v4
  v_lshlrev_b32 v20, 2, v2
  v_bfe_u32 v4, v1, 2, 2
  v_add_u32 v20, v20, v4
  v_lshlrev_b32 v20, 4, v20
  v_and_b32 v4, 1, v1
  v_lshlrev_b32 v4, 3, v4
  v_add_u32 v20, v20, v4
  v_add_u32 v20, 10240, v20
  v_bfe_u32 v22, v1, 5, 1
  v_lshlrev_b32 v22, 5, v22
  v_bfe_u32 v4, v1, 4, 1
  v_lshlrev_b32 v4, 3, v4
  v_add_u32 v22, v22, v4
  v_bfe_u32 v4, v1, 2, 1
  v_add_u32 v22, v22, v4
  v_bfe_u32 v4, v1, 3, 1
  v_lshlrev_b32 v4, 4, v4
  v_add_u32 v22, v22, v4
  v_bfe_u32 v4, v1, 1, 1
  v_lshlrev_b32 v4, 1, v4
  v_add_u32 v22, v22, v4
  v_lshlrev_b32 v22, 4, v22
  v_and_b32 v4, 1, v1
  v_lshlrev_b32 v4, 3, v4
  v_add_u32 v22, v22, v4
  v_add_u32 v22, 16384, v22
  v_lshrrev_b32 v28, 1, v2
  v_lshlrev_b32 v28, 14, v28
  v_and_b32 v4, 1, v2
  v_lshlrev_b32 v4, 12, v4
  v_add_u32 v28, v28, v4
  v_and_b32 v4, 7, v1
  v_lshlrev_b32 v4, 4, v4
  v_add_u32 v28, v28, v4
  s_lshl_b32 s40, s25, 7
  v_add_u32 v28, s40, v28
  v_lshlrev_b32 v9, 10, v2
  v_and_b32 v4, 7, v1
  v_lshlrev_b32 v4, 4, v4
  v_add_u32 v9, v9, v4
  s_and_b32 s40, s25, 7
  s_lshl_b32 s40, s40, 7
  v_add_u32 v9, s40, v9
  s_lshr_b32 s76, s27, 5
  s_mul_i32 s76, s76, 81920
  s_mul_i32 s40, s26, 20480
  s_add_u32 s76, s76, s40
  s_add_u32 s76, s76, 8192
  s_lshr_b32 s40, s76, 13
  s_lshl_b32 s40, s40, 14
  s_and_b32 s76, s76, 0x1fff
  s_or_b32 s76, s76, s40
  s_add_u32 s76, s76, 589824
  s_lshr_b32 s77, s27, 5
  s_mul_i32 s77, s77, 81920
  s_mul_i32 s40, s26, 20480
  s_add_u32 s77, s77, s40
  s_add_u32 s77, s77, 12288
  s_lshr_b32 s40, s77, 13
  s_lshl_b32 s40, s40, 14
  s_and_b32 s77, s77, 0x1fff
  s_or_b32 s77, s77, s40
  s_add_u32 s77, s77, 589824
  s_mul_i32 s48, s26, 163840
  s_add_u32 s48, s48, 655360
  s_mul_i32 s40, s25, 12288
  s_add_u32 s44, s40, 37748736
  s_mul_i32 s40, s25, 40
  s_mul_i32 s41, s26, 10
  s_add_u32 s40, s40, s41
  s_add_u32 s40, s40, 4
  s_lshl_b32 s45, s40, 10
  s_add_u32 s45, s45, 132120576
  s_lshl_b32 s46, s40, 8
  s_add_u32 s46, s46, 111149056
  s_mul_i32 s47, s25, 3072
  s_add_u32 s47, s47, 99614720
  s_mov_b32 s49, 20480
  s_mov_b32 s50, 20480
  s_lshl_b32 s53, s27, 7
  s_add_u32 s53, s53, 8392704
  s_mul_i32 s40, s25, 6
  s_lshr_b32 s41, s40, 3
  s_add_u32 s40, s40, 5
  s_lshr_b32 s40, s40, 3
  v_mov_b32 v249, s40
  v_mov_b32 v4, s41
  v_and_b32 v5, 1, v1
  v_cmp_eq_u32 vcc, 0, v5
  s_nop 1
  v_cndmask_b32 v249, v249, v4, vcc
  v_cmp_lt_u32 vcc, 1, v1
  v_mov_b32 v4, 24
  s_nop 0
  v_cndmask_b32 v4, 0, v4, vcc
  v_add_u32 v249, v249, v4
  v_lshlrev_b32 v249, 7, v249
  v_add_u32 v249, 8437760, v249
  s_mov_b32 s33, 0
  s_mov_b32 s22, 0
  s_add_u32 s40, s25, 94
  s_lshl_b32 s40, s40, 7
  s_add_u32 s40, s40, 8437760
  v_mov_b32 v11, s40
  s_load_dwordx2 s[96:97], s[0:1], 96
  v_and_b32 v5, 15, v1
  v_lshlrev_b32 v5, 2, v5
  s_mov_b32 s43, 0
  s_waitcnt lgkmcnt(0)
RM1_MD:
  global_load_dword v4, v5, s[96:97] sc1
  s_waitcnt vmcnt(0)
  s_mov_b32 s40, 0
  s_mov_b32 s57, 1
  v_readlane_b32 s41, v4, 0
  s_nop 0
  s_add_u32 s40, s40, s41
  s_cmp_eq_u32 s41, 32
  s_cselect_b32 s57, s57, 0
  v_readlane_b32 s41, v4, 1
  s_nop 0
  s_add_u32 s40, s40, s41
  s_cmp_eq_u32 s41, 32
  s_cselect_b32 s57, s57, 0
  v_readlane_b32 s41, v4, 2
  s_nop 0
  s_add_u32 s40, s40, s41
  s_cmp_eq_u32 s41, 32
  s_cselect_b32 s57, s57, 0
  v_readlane_b32 s41, v4, 3
  s_nop 0
  s_add_u32 s40, s40, s41
  s_cmp_eq_u32 s41, 32
  s_cselect_b32 s57, s57, 0
  v_readlane_b32 s41, v4, 4
  s_nop 0
  s_add_u32 s40, s40, s41
  s_cmp_eq_u32 s41, 32
  s_cselect_b32 s57, s57, 0
  v_readlane_b32 s41, v4, 5
  s_nop 0
  s_add_u32 s40, s40, s41
  s_cmp_eq_u32 s41, 32
  s_cselect_b32 s57, s57, 0
  v_readlane_b32 s41, v4, 6
  s_nop 0
  s_add_u32 s40, s40, s41
  s_cmp_eq_u32 s41, 32
  s_cselect_b32 s57, s57, 0
  v_readlane_b32 s41, v4, 7
  s_nop 0
  s_add_u32 s40, s40, s41
  s_cmp_eq_u32 s41, 32
  s_cselect_b32 s57, s57, 0
  v_readlane_b32 s41, v4, 12
  v_readlane_b32 s42, v4, 13
  s_cmp_ge_u32 s40, 256
  s_nop 2
  s_cbranch_scc0 RM1_MDN
  s_cmp_ge_u32 s41, 80
  s_cbranch_scc0 RM1_MDN
  s_and_b32 s40, s42, 0xaa
  s_cmp_eq_u32 s40, 0xaa
  s_cbranch_scc1 RM1_POLOK
RM1_MDN:
  s_sleep 4
  s_add_u32 s43, s43, 1
  s_cmp_lt_u32 s43, 0x200000
  s_cbranch_scc1 RM1_MD
  s_mov_b32 s57, 0
RM1_POLOK:
  s_and_b32 s40, s42, 0x55
  s_xor_b32 s40, s40, 0x44
  s_bcnt1_i32_b32 s41, s40
  s_cmp_ge_u32 s41, 3
  s_cselect_b32 s40, 0x55, s40
  s_cmp_le_u32 s41, 1
  s_cselect_b32 s40, 0, s40
  s_xor_b32 s42, s40, 0x44
  s_bfe_u32 s40, s42, 65536
  s_lshl_b32 s40, s40, 13
  s_add_u32 s30, s40, 0
  s_bfe_u32 s40, s42, 65538
  s_lshl_b32 s40, s40, 13
  s_add_u32 s31, s40, 2097152
  s_bfe_u32 s40, s42, 65540
  s_lshl_b32 s40, s40, 13
  s_add_u32 s32, s40, 4194304
  s_bfe_u32 s40, s42, 65542
  s_lshl_b32 s40, s40, 13
  s_add_u32 s29, s40, 6291456
  s_barrier
  ds_write_b128 v10, v[200:203]
  ds_write_b128 v10, v[204:207] offset:1024
  s_mov_b32 exec_hi, 0
  ds_write_b128 v10, v[208:211] offset:2048
  s_mov_b64 exec, -1
  s_mov_b32 s88, 0
  s_mov_b32 s89, 0
  s_add_u32 s33, s33, 2
  s_min_u32 s42, s33, 128
  s_cmp_ge_u32 s22, s42
  s_cbranch_scc1 RM1_WKV9_D
  s_mov_b32 s23, 0
RM1_WKV9:
  buffer_load_dword v4, v249, s[4:7], 0 offen sc1
  s_waitcnt vmcnt(0)
  v_cmp_gt_u32 vcc, s42, v4
  s_nop 3
  s_cbranch_vccz RM1_WKV9_K
  s_sleep 4
  s_add_u32 s23, s23, 1
  s_cmp_lt_u32 s23, 0x100000
  s_cbranch_scc1 RM1_WKV9
RM1_WKV9_K:
  v_readlane_b32 s22, v4, 0
  v_readlane_b32 s41, v4, 1
  s_nop 0
  s_min_u32 s22, s22, s41
  v_readlane_b32 s41, v4, 2
  s_nop 0
  s_min_u32 s22, s22, s41
  v_readlane_b32 s41, v4, 3
  s_nop 0
  s_min_u32 s22, s22, s41
  s_nop 2
RM1_WKV9_D:
  s_add_u32 m0, s49, 12288
  s_add_u32 s40, s44, 0
  buffer_load_dwordx4 v6, s[4:7], s40 offen offset:0 sc1 lds
  buffer_load_dwordx4 v6, s[4:7], s40 offen offset:1024 sc1 lds
  buffer_load_dwordx4 v6, s[4:7], s40 offen offset:2048 sc1 lds
  buffer_load_dwordx4 v6, s[4:7], s40 offen offset:3072 sc1 lds
  s_add_u32 m0, s49, 16384
  s_add_u32 s40, s44, 4096
  buffer_load_dwordx4 v6, s[4:7], s40 offen offset:0 sc1 lds
  buffer_load_dwordx4 v6, s[4:7], s40 offen offset:1024 sc1 lds
  buffer_load_dwordx4 v6, s[4:7], s40 offen offset:2048 sc1 lds
  buffer_load_dwordx4 v6, s[4:7], s40 offen offset:3072 sc1 lds
  s_add_u32 m0, s49, 20480
  s_add_u32 s40, s44, 8192
  buffer_load_dwordx4 v6, s[4:7], s40 offen offset:0 sc1 lds
  buffer_load_dwordx4 v6, s[4:7], s40 offen offset:1024 sc1 lds
  buffer_load_dwordx4 v6, s[4:7], s40 offen offset:2048 sc1 lds
  buffer_load_dwordx4 v6, s[4:7], s40 offen offset:3072 sc1 lds
  s_add_u32 s44, s44, 393216
  s_xor_b32 s49, s49, 57344
  s_waitcnt vmcnt(0) lgkmcnt(0)
  s_barrier
  v_add_u32 v4, s50, v6
  ds_read_b128 v[148:151], v4 offset:12288
  ds_read_b128 v[152:155], v4 offset:13312
  ds_read_b128 v[156:159], v4 offset:14336
  ds_read_b128 v[160:163], v4 offset:15360
  ds_read_b128 v[164:167], v4 offset:16384
  ds_read_b128 v[168:171], v4 offset:17408
  ds_read_b128 v[172:175], v4 offset:18432
  ds_read_b128 v[176:179], v4 offset:19456
  s_waitcnt lgkmcnt(4)
  ds_read_b128 v[180:183], v4 offset:20480
  ds_read_b128 v[184:187], v4 offset:21504
  ds_read_b128 v[188:191], v4 offset:22528
  ds_read_b128 v[192:195], v4 offset:23552
  s_waitcnt lgkmcnt(0)
  ds_read_b128 v[100:103], v4 offset:0
  ds_read_b128 v[104:107], v4 offset:1024
  ds_read_b128 v[108:111], v4 offset:2048
  ds_read_b128 v[112:115], v4 offset:3072
  ds_read_b128 v[116:119], v4 offset:4096
  ds_read_b128 v[120:123], v4 offset:5120
  ds_read_b128 v[124:127], v4 offset:6144
  ds_read_b128 v[128:131], v4 offset:7168
  ds_read_b128 v[132:135], v4 offset:8192
  ds_read_b128 v[136:139], v4 offset:9216
  ds_read_b128 v[140:143], v4 offset:10240
  ds_read_b128 v[144:147], v4 offset:11264
  v_mfma_f32_16x16x32_bf16 v[48:51], v[148:151], a[160:163], 0
  v_mfma_f32_16x16x32_bf16 v[52:55], v[172:175], a[160:163], 0
  v_mfma_f32_16x16x32_bf16 v[56:59], v[148:151], a[184:187], 0
  v_mfma_f32_16x16x32_bf16 v[60:63], v[172:175], a[184:187], 0
  v_mfma_f32_16x16x32_bf16 v[64:67], v[148:151], a[208:211], 0
  v_mfma_f32_16x16x32_bf16 v[68:71], v[172:175], a[208:211], 0
  v_mfma_f32_16x16x32_bf16 v[72:75], v[148:151], a[232:235], 0
  v_mfma_f32_16x16x32_bf16 v[76:79], v[172:175], a[232:235], 0
  v_mfma_f32_16x16x32_bf16 v[48:51], v[152:155], a[164:167], v[48:51]
  v_mfma_f32_16x16x32_bf16 v[52:55], v[176:179], a[164:167], v[52:55]
  v_mfma_f32_16x16x32_bf16 v[56:59], v[152:155], a[188:191], v[56:59]
  v_mfma_f32_16x16x32_bf16 v[60:63], v[176:179], a[188:191], v[60:63]
  v_mfma_f32_16x16x32_bf16 v[64:67], v[152:155], a[212:215], v[64:67]
  v_mfma_f32_16x16x32_bf16 v[68:71], v[176:179], a[212:215], v[68:71]
  v_mfma_f32_16x16x32_bf16 v[72:75], v[152:155], a[236:239], v[72:75]
  v_mfma_f32_16x16x32_bf16 v[76:79], v[176:179], a[236:239], v[76:79]
  v_mfma_f32_16x16x32_bf16 v[48:51], v[156:159], a[168:171], v[48:51]
  v_mfma_f32_16x16x32_bf16 v[52:55], v[180:183], a[168:171], v[52:55]
  v_mfma_f32_16x16x32_bf16 v[56:59], v[156:159], a[192:195], v[56:59]
  v_mfma_f32_16x16x32_bf16 v[60:63], v[180:183], a[192:195], v[60:63]
  v_mfma_f32_16x16x32_bf16 v[64:67], v[156:159], a[216:219], v[64:67]
  v_mfma_f32_16x16x32_bf16 v[68:71], v[180:183], a[216:219], v[68:71]
  v_mfma_f32_16x16x32_bf16 v[72:75], v[156:159], a[240:243], v[72:75]
  v_mfma_f32_16x16x32_bf16 v[76:79], v[180:183], a[240:243], v[76:79]
  v_mfma_f32_16x16x32_bf16 v[48:51], v[160:163], a[172:175], v[48:51]
  v_mfma_f32_16x16x32_bf16 v[52:55], v[184:187], a[172:175], v[52:55]
  v_mfma_f32_16x16x32_bf16 v[56:59], v[160:163], a[196:199], v[56:59]
  v_mfma_f32_16x16x32_bf16 v[60:63], v[184:187], a[196:199], v[60:63]
  v_mfma_f32_16x16x32_bf16 v[64:67], v[160:163], a[220:223], v[64:67]
  v_mfma_f32_16x16x32_bf16 v[68:71], v[184:187], a[220:223], v[68:71]
  v_mfma_f32_16x16x32_bf16 v[72:75], v[160:163], a[244:247], v[72:75]
  v_mfma_f32_16x16x32_bf16 v[76:79], v[184:187], a[244:247], v[76:79]
  v_mfma_f32_16x16x32_bf16 v[48:51], v[164:167], a[176:179], v[48:51]
  v_mfma_f32_16x16x32_bf16 v[52:55], v[188:191], a[176:179], v[52:55]
  v_mfma_f32_16x16x32_bf16 v[56:59], v[164:167], a[200:203], v[56:59]
  v_mfma_f32_16x16x32_bf16 v[60:63], v[188:191], a[200:203], v[60:63]
  v_mfma_f32_16x16x32_bf16 v[64:67], v[164:167], a[224:227], v[64:67]
  v_mfma_f32_16x16x32_bf16 v[68:71], v[188:191], a[224:227], v[68:71]
  v_mfma_f32_16x16x32_bf16 v[72:75], v[164:167], a[248:251], v[72:75]
  v_mfma_f32_16x16x32_bf16 v[76:79], v[188:191], a[248:251], v[76:79]
  v_mfma_f32_16x16x32_bf16 v[48:51], v[168:171], a[180:183], v[48:51]
  v_mfma_f32_16x16x32_bf16 v[52:55], v[192:195], a[180:183], v[52:55]
  v_mfma_f32_16x16x32_bf16 v[56:59], v[168:171], a[204:207], v[56:59]
  v_mfma_f32_16x16x32_bf16 v[60:63], v[192:195], a[204:207], v[60:63]
  v_mfma_f32_16x16x32_bf16 v[64:67], v[168:171], a[228:231], v[64:67]
  v_mfma_f32_16x16x32_bf16 v[68:71], v[192:195], a[228:231], v[68:71]
  v_mfma_f32_16x16x32_bf16 v[72:75], v[168:171], a[252:255], v[72:75]
  v_mfma_f32_16x16x32_bf16 v[76:79], v[192:195], a[252:255], v[76:79]
  s_nop 0
  v_cvt_pk_bf16_f32 v232, v48, v49
  v_cvt_pk_bf16_f32 v233, v50, v51
  v_cvt_pk_bf16_f32 v234, v52, v53
  v_cvt_pk_bf16_f32 v235, v54, v55
  s_add_u32 s40, s45, 0
  v_cvt_pk_bf16_f32 v236, v56, v57
  v_cvt_pk_bf16_f32 v237, v58, v59
  v_cvt_pk_bf16_f32 v238, v60, v61
  v_cvt_pk_bf16_f32 v239, v62, v63
  s_add_u32 s40, s45, 1024
  v_cvt_pk_bf16_f32 v240, v64, v65
  v_cvt_pk_bf16_f32 v241, v66, v67
  v_cvt_pk_bf16_f32 v242, v68, v69
  v_cvt_pk_bf16_f32 v243, v70, v71
  s_add_u32 s40, s45, 2048
  v_cvt_pk_bf16_f32 v244, v72, v73
  v_cvt_pk_bf16_f32 v245, v74, v75
  v_cvt_pk_bf16_f32 v246, v76, v77
  v_cvt_pk_bf16_f32 v247, v78, v79
  s_add_u32 s40, s45, 3072
  s_add_u32 s45, s45, 1310720
  s_waitcnt lgkmcnt(0)
  s_xor_b32 s50, s50, 57344
  s_cmp_eq_u32 s57, 0
  s_cbranch_scc1 RM1S_B0
  s_branch RM1F_B0
RM1F_LOOP:
WU_10:
  s_memtime s[58:59]
  s_waitcnt lgkmcnt(0)
  s_sub_u32 s58, s58, s96
  s_cmp_ge_u32 s58, 2600
  s_cbranch_scc1 WU_10_D
  s_sub_u32 s58, 2600, s58
  s_cmp_lt_u32 s58, 96
  s_cbranch_scc1 WU_10
  s_sleep 1
  s_branch WU_10
WU_10_D:
  s_mov_b32 s43, 0
RM1F_AGP:
  buffer_load_dwordx4 v[48:51], v23, s[4:7], s29 offen sc1
  buffer_load_dwordx4 v[52:55], v24, s[4:7], s29 offen sc1
  buffer_load_dwordx4 v[56:59], v25, s[4:7], s29 offen sc1
  s_waitcnt vmcnt(0)
  v_max3_u32 v4, v48, v49, v50
  v_max3_u32 v4, v4, v51, v52
  v_max3_u32 v4, v4, v53, v54
  v_max3_u32 v4, v4, v55, v56
  v_max3_u32 v4, v4, v57, v58
  v_max_u32 v4, v4, v59
  v_cmp_eq_u32 vcc, -1, v4
  s_nop 3
  s_cbranch_vccz RM1F_AGP_OK
  s_add_u32 s43, s43, 1
  s_cmp_lt_u32 s43, s61
  s_cbranch_scc1 RM1F_AGP
  s_mov_b32 s61, 0
RM1F_AGP_OK:
  ds_write_b128 v10, v[48:51]
  ds_write_b128 v10, v[52:55] offset:1024
  s_mov_b32 exec_hi, 0
  ds_write_b128 v10, v[56:59] offset:2048
  s_mov_b64 exec, -1
RM1F_B0:
  s_waitcnt lgkmcnt(0)
  s_barrier
  s_memtime s[98:99]
  ds_read_b128 v[48:51], v6 offset:0
  ds_read_b128 v[52:55], v6 offset:1024
  ds_read_b128 v[56:59], v6 offset:2048
  ds_read_b128 v[60:63], v6 offset:3072
  ds_read_b128 v[64:67], v6 offset:4096
  ds_read_b128 v[68:71], v6 offset:5120
  ds_read_b128 v[72:75], v6 offset:6144
  ds_read_b128 v[76:79], v6 offset:7168
  ds_read_b128 v[80:83], v6 offset:8192
  ds_read_b128 v[84:87], v6 offset:9216
  v_mov_b32 v88, 0
  v_mov_b32 v89, 0
  v_mov_b32 v90, 0
  v_mov_b32 v91, 0
  v_mov_b32 v92, 0
  v_mov_b32 v93, 0
  v_mov_b32 v94, 0
  v_mov_b32 v95, 0
  s_waitcnt lgkmcnt(9)
  v_smfmac_f32_16x16x64_bf16 v[88:91], v[48:51], a[0:7], v21
  v_smfmac_f32_16x16x64_bf16 v[92:95], v[48:51], a[80:87], v21
  s_waitcnt lgkmcnt(8)
  v_smfmac_f32_16x16x64_bf16 v[88:91], v[52:55], a[8:15], v21
  v_smfmac_f32_16x16x64_bf16 v[92:95], v[52:55], a[88:95], v21
  s_waitcnt lgkmcnt(7)
  v_smfmac_f32_16x16x64_bf16 v[88:91], v[56:59], a[16:23], v21
  v_smfmac_f32_16x16x64_bf16 v[92:95], v[56:59], a[96:103], v21
  s_waitcnt lgkmcnt(6)
  v_smfmac_f32_16x16x64_bf16 v[88:91], v[60:63], a[24:31], v21
  v_smfmac_f32_16x16x64_bf16 v[92:95], v[60:63], a[104:111], v21
  s_waitcnt lgkmcnt(5)
  v_smfmac_f32_16x16x64_bf16 v[88:91], v[64:67], a[32:39], v21
  v_smfmac_f32_16x16x64_bf16 v[92:95], v[64:67], a[112:119], v21
  s_waitcnt lgkmcnt(4)
  v_smfmac_f32_16x16x64_bf16 v[88:91], v[68:71], a[40:47], v21
  v_smfmac_f32_16x16x64_bf16 v[92:95], v[68:71], a[120:127], v21
  s_waitcnt lgkmcnt(3)
  v_smfmac_f32_16x16x64_bf16 v[88:91], v[72:75], a[48:55], v21
  v_smfmac_f32_16x16x64_bf16 v[92:95], v[72:75], a[128:135], v21
  s_waitcnt lgkmcnt(2)
  v_smfmac_f32_16x16x64_bf16 v[88:91], v[76:79], a[56:63], v21
  v_smfmac_f32_16x16x64_bf16 v[92:95], v[76:79], a[136:143], v21
  s_waitcnt lgkmcnt(1)
  v_smfmac_f32_16x16x64_bf16 v[88:91], v[80:83], a[64:71], v21
  v_smfmac_f32_16x16x64_bf16 v[92:95], v[80:83], a[144:151], v21
  s_waitcnt lgkmcnt(0)
  v_smfmac_f32_16x16x64_bf16 v[88:91], v[84:87], a[72:79], v21
  v_smfmac_f32_16x16x64_bf16 v[92:95], v[84:87], a[152:159], v21
  s_nop 7
  v_permlane32_swap_b32 v88, v92
  v_permlane32_swap_b32 v89, v93
  v_permlane32_swap_b32 v90, v94
  v_permlane32_swap_b32 v91, v95
  v_add_f32 v88, v88, v92
  v_add_f32 v89, v89, v93
  v_add_f32 v90, v90, v94
  v_add_f32 v91, v91, v95
  v_cvt_pk_bf16_f32 v252, v88, v89
  v_cvt_pk_bf16_f32 v253, v90, v91
  buffer_store_dwordx2 v[252:253], v12, s[4:7], s30 offen
  s_cmp_lg_u32 s28, 0
  s_cbranch_scc1 RM1F_NOS1
  s_add_u32 s33, s33, 2
  s_min_u32 s42, s33, 128
  s_cmp_ge_u32 s22, s42
  s_cbranch_scc1 RM1F_WKV11_D
  s_mov_b32 s23, 0
RM1F_WKV11:
  buffer_load_dword v4, v249, s[4:7], 0 offen sc1
  s_waitcnt vmcnt(0)
  v_cmp_gt_u32 vcc, s42, v4
  s_nop 3
  s_cbranch_vccz RM1F_WKV11_K
  s_sleep 4
  s_add_u32 s23, s23, 1
  s_cmp_lt_u32 s23, 0x100000
  s_cbranch_scc1 RM1F_WKV11
RM1F_WKV11_K:
  v_readlane_b32 s22, v4, 0
  v_readlane_b32 s41, v4, 1
  s_nop 0
  s_min_u32 s22, s22, s41
  v_readlane_b32 s41, v4, 2
  s_nop 0
  s_min_u32 s22, s22, s41
  v_readlane_b32 s41, v4, 3
  s_nop 0
  s_min_u32 s22, s22, s41
  s_nop 2
RM1F_WKV11_D:
  s_add_u32 m0, s49, 12288
  s_add_u32 s40, s44, 0
  buffer_load_dwordx4 v6, s[4:7], s40 offen offset:0 sc1 lds
  buffer_load_dwordx4 v6, s[4:7], s40 offen offset:1024 sc1 lds
  buffer_load_dwordx4 v6, s[4:7], s40 offen offset:2048 sc1 lds
  buffer_load_dwordx4 v6, s[4:7], s40 offen offset:3072 sc1 lds
  s_add_u32 m0, s49, 16384
  s_add_u32 s40, s44, 4096
  buffer_load_dwordx4 v6, s[4:7], s40 offen offset:0 sc1 lds
  buffer_load_dwordx4 v6, s[4:7], s40 offen offset:1024 sc1 lds
  buffer_load_dwordx4 v6, s[4:7], s40 offen offset:2048 sc1 lds
  buffer_load_dwordx4 v6, s[4:7], s40 offen offset:3072 sc1 lds
  s_add_u32 m0, s49, 20480
  s_add_u32 s40, s44, 8192
  buffer_load_dwordx4 v6, s[4:7], s40 offen offset:0 sc1 lds
  buffer_load_dwordx4 v6, s[4:7], s40 offen offset:1024 sc1 lds
  buffer_load_dwordx4 v6, s[4:7], s40 offen offset:2048 sc1 lds
  buffer_load_dwordx4 v6, s[4:7], s40 offen offset:3072 sc1 lds
  s_add_u32 s44, s44, 393216
  s_xor_b32 s49, s49, 57344
RM1F_NOS1:
  v_mov_b32 v48, 0
  v_mov_b32 v49, 0
  v_mov_b32 v50, 0
  v_mov_b32 v51, 0
  v_mov_b32 v52, 0
  v_mov_b32 v53, 0
  v_mov_b32 v54, 0
  v_mov_b32 v55, 0
  v_mov_b32 v56, 0
  v_mov_b32 v57, 0
  v_mov_b32 v58, 0
  v_mov_b32 v59, 0
  v_mov_b32 v60, 0
  v_mov_b32 v61, 0
  v_mov_b32 v62, 0
  v_mov_b32 v63, 0
  s_mov_b32 s43, 0
  s_nop 0
RM1F_AP:
  buffer_load_dwordx4 v[32:35], v16, s[4:7], s30 offen sc1
  buffer_load_dwordx4 v[36:39], v17, s[4:7], s30 offen sc1
  s_waitcnt vmcnt(0)
  v_max3_u32 v4, v32, v33, v34
  v_max3_u32 v4, v4, v35, v36
  v_max3_u32 v4, v4, v37, v38
  v_max_u32 v4, v4, v39
  v_cmp_eq_u32 vcc, -1, v4
  s_nop 3
  s_cbranch_vccz RM1F_AP_OK
  s_add_u32 s43, s43, 1
  s_cmp_lt_u32 s43, s61
  s_cbranch_scc1 RM1F_AP
  s_mov_b32 s61, 0
RM1F_AP_OK:
  ds_write_b128 v19, v[32:35]
  ds_write_b128 v19, v[36:39] offset:1024
  s_waitcnt lgkmcnt(0)
  s_barrier
  ds_read_b64_tr_b16 v[148:149], v20 offset:0
  ds_read_b64_tr_b16 v[150:151], v20 offset:256
  ds_read_b64_tr_b16 v[172:173], v20 offset:3072
  ds_read_b64_tr_b16 v[174:175], v20 offset:3328
  ds_read_b64_tr_b16 v[152:153], v20 offset:512
  ds_read_b64_tr_b16 v[154:155], v20 offset:768
  ds_read_b64_tr_b16 v[176:177], v20 offset:3584
  ds_read_b64_tr_b16 v[178:179], v20 offset:3840
  ds_read_b64_tr_b16 v[156:157], v20 offset:1024
  ds_read_b64_tr_b16 v[158:159], v20 offset:1280
  ds_read_b64_tr_b16 v[180:181], v20 offset:4096
  ds_read_b64_tr_b16 v[182:183], v20 offset:4352
  s_waitcnt lgkmcnt(8)
  v_mfma_f32_16x16x32_bf16 v[224:227], v[100:103], v[148:151], 0
  v_mfma_f32_16x16x32_bf16 v[228:231], v[124:127], v[148:151], 0
  v_mfma_f32_16x16x32_bf16 v[220:223], v[172:175], v[148:151], 0
  ds_read_b64_tr_b16 v[160:161], v20 offset:1536
  ds_read_b64_tr_b16 v[162:163], v20 offset:1792
  ds_read_b64_tr_b16 v[184:185], v20 offset:4608
  ds_read_b64_tr_b16 v[186:187], v20 offset:4864
  s_waitcnt lgkmcnt(8)
  v_mfma_f32_16x16x32_bf16 v[224:227], v[104:107], v[152:155], v[224:227]
  v_mfma_f32_16x16x32_bf16 v[228:231], v[128:131], v[152:155], v[228:231]
  v_mfma_f32_16x16x32_bf16 v[220:223], v[176:179], v[152:155], v[220:223]
  ds_read_b64_tr_b16 v[164:165], v20 offset:2048
  ds_read_b64_tr_b16 v[166:167], v20 offset:2304
  ds_read_b64_tr_b16 v[188:189], v20 offset:5120
  ds_read_b64_tr_b16 v[190:191], v20 offset:5376
  s_waitcnt lgkmcnt(8)
  v_mfma_f32_16x16x32_bf16 v[224:227], v[108:111], v[156:159], v[224:227]
  v_mfma_f32_16x16x32_bf16 v[228:231], v[132:135], v[156:159], v[228:231]
  v_mfma_f32_16x16x32_bf16 v[220:223], v[180:183], v[156:159], v[220:223]
  ds_read_b64_tr_b16 v[168:169], v20 offset:2560
  ds_read_b64_tr_b16 v[170:171], v20 offset:2816
  ds_read_b64_tr_b16 v[192:193], v20 offset:5632
  ds_read_b64_tr_b16 v[194:195], v20 offset:5888
  s_waitcnt lgkmcnt(8)
  v_mfma_f32_16x16x32_bf16 v[224:227], v[112:115], v[160:163], v[224:227]
  v_mfma_f32_16x16x32_bf16 v[228:231], v[136:139], v[160:163], v[228:231]
  v_mfma_f32_16x16x32_bf16 v[220:223], v[184:187], v[160:163], v[220:223]
  s_waitcnt lgkmcnt(4)
  v_mfma_f32_16x16x32_bf16 v[224:227], v[116:119], v[164:167], v[224:227]
  v_mfma_f32_16x16x32_bf16 v[228:231], v[140:143], v[164:167], v[228:231]
  v_mfma_f32_16x16x32_bf16 v[220:223], v[188:191], v[164:167], v[220:223]
  s_waitcnt lgkmcnt(0)
  v_mfma_f32_16x16x32_bf16 v[224:227], v[120:123], v[168:171], v[224:227]
  v_mfma_f32_16x16x32_bf16 v[228:231], v[144:147], v[168:171], v[228:231]
  v_mfma_f32_16x16x32_bf16 v[220:223], v[192:195], v[168:171], v[220:223]
  s_barrier
  s_memtime s[96:97]
  ds_read_b64_tr_b16 v[196:197], v22 offset:0
  ds_read_b64_tr_b16 v[198:199], v22 offset:64
  ds_read_b64_tr_b16 v[200:201], v22 offset:1024
  ds_read_b64_tr_b16 v[202:203], v22 offset:1088
  ds_read_b64_tr_b16 v[204:205], v22 offset:2048
  ds_read_b64_tr_b16 v[206:207], v22 offset:2112
  v_cndmask_b32 v148, v224, v228, s[38:39]
  v_cndmask_b32 v149, v225, v229, s[38:39]
  s_waitcnt lgkmcnt(4)
  v_smfmac_f32_16x16x64_bf16 v[48:51], v[196:199], a[160:167], v21
  v_cndmask_b32 v150, v226, v230, s[38:39]
  v_smfmac_f32_16x16x64_bf16 v[52:55], v[196:199], a[184:191], v21
  v_cndmask_b32 v151, v227, v231, s[38:39]
  v_smfmac_f32_16x16x64_bf16 v[56:59], v[196:199], a[208:215], v21
  v_cndmask_b32 v152, v220, v222, s[38:39]
  v_smfmac_f32_16x16x64_bf16 v[60:63], v[196:199], a[232:239], v21
  v_cndmask_b32 v153, v221, v223, s[38:39]
  s_waitcnt lgkmcnt(2)
  v_smfmac_f32_16x16x64_bf16 v[48:51], v[200:203], a[168:175], v21
  v_max3_f32 v154, v148, v149, v150
  v_smfmac_f32_16x16x64_bf16 v[52:55], v[200:203], a[192:199], v21
  v_max3_f32 v155, v151, v152, v153
  v_smfmac_f32_16x16x64_bf16 v[56:59], v[200:203], a[216:223], v21
  v_max_f32 v154, v154, v155
  v_smfmac_f32_16x16x64_bf16 v[60:63], v[200:203], a[240:247], v21
  s_nop 0
  v_max_f32_dpp v154, v154, v154 row_ror:8 row_mask:0xf bank_mask:0xf
  s_waitcnt lgkmcnt(0)
  v_smfmac_f32_16x16x64_bf16 v[48:51], v[204:207], a[176:183], v21
  v_mov_b32 v155, v154
  v_smfmac_f32_16x16x64_bf16 v[52:55], v[204:207], a[200:207], v21
  s_nop 0
  v_permlane16_swap_b32 v154, v155
  v_smfmac_f32_16x16x64_bf16 v[56:59], v[204:207], a[224:231], v21
  v_max_f32 v154, v154, v155
  v_smfmac_f32_16x16x64_bf16 v[60:63], v[204:207], a[248:255], v21
  v_mov_b32 v155, v154
  s_nop 1
  v_permlane32_swap_b32 v154, v155
  v_max_f32 v154, v154, v155
  v_mul_f32 v154, s60, v154
  v_fma_f32 v148, v148, s60, -v154
  v_fma_f32 v149, v149, s60, -v154
  v_fma_f32 v150, v150, s60, -v154
  v_fma_f32 v151, v151, s60, -v154
  v_fma_f32 v152, v152, s60, -v154
  v_fma_f32 v153, v153, s60, -v154
  v_exp_f32 v148, v148
  v_exp_f32 v149, v149
  v_exp_f32 v150, v150
  v_exp_f32 v151, v151
  v_exp_f32 v152, v152
  v_exp_f32 v153, v153
  v_cvt_pk_bf16_f32 v160, v148, v149
  v_cvt_pk_bf16_f32 v161, v150, v151
  v_cvt_pk_bf16_f32 v158, v152, v153
  v_mov_b32_dpp v162, v160 row_ror:8 row_mask:0xf bank_mask:0xf
  v_mov_b32_dpp v163, v161 row_ror:8 row_mask:0xf bank_mask:0xf
  v_mov_b32_dpp v159, v158 row_ror:8 row_mask:0xf bank_mask:0xf
  s_nop 0
  v_mfma_f32_16x16x32_bf16 v[64:67], v[232:235], v[160:163], 0
  v_cvt_pk_bf16_f32 v220, v48, v49
  v_cvt_pk_bf16_f32 v221, v50, v51
  v_mfma_f32_16x16x32_bf16 v[68:71], v[236:239], v[160:163], 0
  v_cvt_pk_bf16_f32 v222, v52, v53
  v_cvt_pk_bf16_f32 v223, v54, v55
  v_mfma_f32_16x16x32_bf16 v[72:75], v[240:243], v[160:163], 0
  v_cvt_pk_bf16_f32 v224, v56, v57
  v_cvt_pk_bf16_f32 v225, v58, v59
  v_mfma_f32_16x16x32_bf16 v[76:79], v[244:247], v[160:163], 0
  v_cvt_pk_bf16_f32 v226, v60, v61
  v_cvt_pk_bf16_f32 v227, v62, v63
  v_mfma_f32_16x16x16_bf16 v[64:67], v[220:221], v[158:159], v[64:67]
  v_cndmask_b32 v152, v152, v31, s[20:21]
  v_cndmask_b32 v153, v153, v31, s[20:21]
  v_add_f32 v156, v148, v149
  v_add_f32 v155, v150, v151
  v_mfma_f32_16x16x16_bf16 v[68:71], v[222:223], v[158:159], v[68:71]
  v_add_f32 v157, v152, v153
  v_add_f32 v156, v156, v155
  v_add_f32 v156, v156, v157
  s_nop 1
  v_add_f32_dpp v156, v156, v156 row_ror:8 row_mask:0xf bank_mask:0xf
  v_mfma_f32_16x16x16_bf16 v[72:75], v[224:225], v[158:159], v[72:75]
  v_mov_b32 v155, v156
  s_nop 1
  v_permlane16_swap_b32 v156, v155
  v_add_f32 v156, v156, v155
  v_mov_b32 v155, v156
  v_mfma_f32_16x16x16_bf16 v[76:79], v[226:227], v[158:159], v[76:79]
  s_nop 0
  v_permlane32_swap_b32 v156, v155
  v_add_f32 v156, v156, v155
  v_rcp_f32 v156, v156
  s_nop 0
  v_mov_b32 v157, v156
  v_pk_mul_f32 v[64:65], v[64:65], v[156:157]
  v_pk_mul_f32 v[66:67], v[66:67], v[156:157]
  v_pk_mul_f32 v[68:69], v[68:69], v[156:157]
  v_pk_mul_f32 v[70:71], v[70:71], v[156:157]
  v_pk_mul_f32 v[72:73], v[72:73], v[156:157]
  v_pk_mul_f32 v[74:75], v[74:75], v[156:157]
  v_pk_mul_f32 v[76:77], v[76:77], v[156:157]
  v_pk_mul_f32 v[78:79], v[78:79], v[156:157]
  v_cvt_pk_bf16_f32 v80, v64, v65
  v_cvt_pk_bf16_f32 v81, v66, v67
  v_cvt_pk_bf16_f32 v82, v68, v69
  v_cvt_pk_bf16_f32 v83, v70, v71
  v_cvt_pk_bf16_f32 v84, v72, v73
  v_cvt_pk_bf16_f32 v85, v74, v75
  v_cvt_pk_bf16_f32 v86, v76, v77
  v_cvt_pk_bf16_f32 v87, v78, v79
  s_add_u32 s40, s30, s48
  s_mov_b64 exec, s[34:35]
  buffer_store_dwordx4 v[80:83], v28, s[4:7], s40 offen sc1
  s_add_u32 s40, s40, 32768
  buffer_store_dwordx4 v[84:87], v28, s[4:7], s40 offen sc1
  s_mov_b64 exec, -1
  s_cmp_eq_u32 s28, 63
  s_cbranch_scc1 RM1F_NODMA
  s_add_u32 s33, s33, 2
  s_min_u32 s42, s33, 128
  s_cmp_ge_u32 s22, s42
  s_cbranch_scc1 RM1F_WKV12_D
  s_mov_b32 s23, 0
RM1F_WKV12:
  buffer_load_dword v4, v249, s[4:7], 0 offen sc1
  s_waitcnt vmcnt(0)
  v_cmp_gt_u32 vcc, s42, v4
  s_nop 3
  s_cbranch_vccz RM1F_WKV12_K
  s_sleep 4
  s_add_u32 s23, s23, 1
  s_cmp_lt_u32 s23, 0x100000
  s_cbranch_scc1 RM1F_WKV12
RM1F_WKV12_K:
  v_readlane_b32 s22, v4, 0
  v_readlane_b32 s41, v4, 1
  s_nop 0
  s_min_u32 s22, s22, s41
  v_readlane_b32 s41, v4, 2
  s_nop 0
  s_min_u32 s22, s22, s41
  v_readlane_b32 s41, v4, 3
  s_nop 0
  s_min_u32 s22, s22, s41
  s_nop 2
RM1F_WKV12_D:
  s_add_u32 m0, s49, 12288
  s_add_u32 s40, s44, 0
  buffer_load_dwordx4 v6, s[4:7], s40 offen offset:0 sc1 lds
  buffer_load_dwordx4 v6, s[4:7], s40 offen offset:1024 sc1 lds
  buffer_load_dwordx4 v6, s[4:7], s40 offen offset:2048 sc1 lds
  buffer_load_dwordx4 v6, s[4:7], s40 offen offset:3072 sc1 lds
  s_add_u32 m0, s49, 16384
  s_add_u32 s40, s44, 4096
  buffer_load_dwordx4 v6, s[4:7], s40 offen offset:0 sc1 lds
  buffer_load_dwordx4 v6, s[4:7], s40 offen offset:1024 sc1 lds
  buffer_load_dwordx4 v6, s[4:7], s40 offen offset:2048 sc1 lds
  buffer_load_dwordx4 v6, s[4:7], s40 offen offset:3072 sc1 lds
  s_add_u32 m0, s49, 20480
  s_add_u32 s40, s44, 8192
  buffer_load_dwordx4 v6, s[4:7], s40 offen offset:0 sc1 lds
  buffer_load_dwordx4 v6, s[4:7], s40 offen offset:1024 sc1 lds
  buffer_load_dwordx4 v6, s[4:7], s40 offen offset:2048 sc1 lds
  buffer_load_dwordx4 v6, s[4:7], s40 offen offset:3072 sc1 lds
  s_add_u32 s44, s44, 393216
  s_xor_b32 s49, s49, 57344
RM1F_NODMA:
  s_mov_b64 exec, s[34:35]
  s_cmp_lg_u32 s26, 0
  s_cbranch_scc1 RM1F_NOKM
  buffer_store_dwordx4 v[180:183], v15, s[4:7], s47 offen offset:0 sc1
  buffer_store_dwordx4 v[184:187], v15, s[4:7], s47 offen offset:512 sc1
  s_nop 1
RM1F_NOKM:
  s_mov_b64 exec, -1
  s_add_u32 s47, s47, 98304
  v_mov_b32 v64, v48
  v_mov_b32 v65, v49
  v_mov_b32 v66, v50
  v_mov_b32 v67, v51
  v_permlane32_swap_b32 v48, v64
  v_permlane32_swap_b32 v49, v65
  v_permlane32_swap_b32 v50, v66
  v_permlane32_swap_b32 v51, v67
  v_add_f32 v48, v48, v64
  v_add_f32 v49, v49, v65
  v_add_f32 v50, v50, v66
  v_add_f32 v51, v51, v67
  v_cvt_pk_bf16_f32 v220, v48, v49
  v_cvt_pk_bf16_f32 v221, v50, v51
  v_mov_b32 v64, v52
  v_mov_b32 v65, v53
  v_mov_b32 v66, v54
  v_mov_b32 v67, v55
  v_permlane32_swap_b32 v52, v64
  v_permlane32_swap_b32 v53, v65
  v_permlane32_swap_b32 v54, v66
  v_permlane32_swap_b32 v55, v67
  v_add_f32 v52, v52, v64
  v_add_f32 v53, v53, v65
  v_add_f32 v54, v54, v66
  v_add_f32 v55, v55, v67
  v_cvt_pk_bf16_f32 v222, v52, v53
  v_cvt_pk_bf16_f32 v223, v54, v55
  v_mov_b32 v64, v56
  v_mov_b32 v65, v57
  v_mov_b32 v66, v58
  v_mov_b32 v67, v59
  v_permlane32_swap_b32 v56, v64
  v_permlane32_swap_b32 v57, v65
  v_permlane32_swap_b32 v58, v66
  v_permlane32_swap_b32 v59, v67
  v_add_f32 v56, v56, v64
  v_add_f32 v57, v57, v65
  v_add_f32 v58, v58, v66
  v_add_f32 v59, v59, v67
  v_cvt_pk_bf16_f32 v224, v56, v57
  v_cvt_pk_bf16_f32 v225, v58, v59
  v_mov_b32 v64, v60
  v_mov_b32 v65, v61
  v_mov_b32 v66, v62
  v_mov_b32 v67, v63
  v_permlane32_swap_b32 v60, v64
  v_permlane32_swap_b32 v61, v65
  v_permlane32_swap_b32 v62, v66
  v_permlane32_swap_b32 v63, v67
  v_add_f32 v60, v60, v64
  v_add_f32 v61, v61, v65
  v_add_f32 v62, v62, v66
  v_add_f32 v63, v63, v67
  v_cvt_pk_bf16_f32 v226, v60, v61
  v_cvt_pk_bf16_f32 v227, v62, v63
  s_mov_b32 exec_hi, 0
  buffer_store_dwordx2 v[220:221], v29, s[4:7], s46 offen offset:0 sc1
  buffer_store_dwordx2 v[222:223], v29, s[4:7], s46 offen offset:256 sc1
  buffer_store_dwordx2 v[224:225], v29, s[4:7], s46 offen offset:512 sc1
  buffer_store_dwordx2 v[226:227], v29, s[4:7], s46 offen offset:768 sc1
  s_mov_b64 exec, -1
  s_add_u32 s46, s46, 327680
  v_mov_b32 v4, s28
  s_mov_b64 exec, 1
  buffer_store_dword v4, v31, s[4:7], s53 offen sc1
  s_cmp_lg_u32 s27, 0
  s_cbranch_scc1 RM1F_NOPROG
  s_mov_b32 s40, 8390656
  buffer_store_dword v4, v31, s[4:7], s40 offen sc1
RM1F_NOPROG:
  s_mov_b64 exec, -1
  s_add_u32 s28, s28, 1
  s_cmp_ge_u32 s28, 64
  s_cbranch_scc1 RM1F_DONE
  v_add_u32 v4, s50, v6
  ds_read_b128 v[148:151], v4 offset:12288
  ds_read_b128 v[152:155], v4 offset:13312
  ds_read_b128 v[156:159], v4 offset:14336
  ds_read_b128 v[160:163], v4 offset:15360
  ds_read_b128 v[164:167], v4 offset:16384
  ds_read_b128 v[168:171], v4 offset:17408
  ds_read_b128 v[172:175], v4 offset:18432
  ds_read_b128 v[176:179], v4 offset:19456
  s_waitcnt lgkmcnt(4)
  ds_read_b128 v[180:183], v4 offset:20480
  ds_read_b128 v[184:187], v4 offset:21504
  ds_read_b128 v[188:191], v4 offset:22528
  ds_read_b128 v[192:195], v4 offset:23552
  s_waitcnt lgkmcnt(0)
  ds_read_b128 v[100:103], v4 offset:0
  ds_read_b128 v[104:107], v4 offset:1024
  ds_read_b128 v[108:111], v4 offset:2048
  ds_read_b128 v[112:115], v4 offset:3072
  ds_read_b128 v[116:119], v4 offset:4096
  ds_read_b128 v[120:123], v4 offset:5120
  ds_read_b128 v[124:127], v4 offset:6144
  ds_read_b128 v[128:131], v4 offset:7168
  ds_read_b128 v[132:135], v4 offset:8192
  ds_read_b128 v[136:139], v4 offset:9216
  ds_read_b128 v[140:143], v4 offset:10240
  ds_read_b128 v[144:147], v4 offset:11264
  v_mfma_f32_16x16x32_bf16 v[48:51], v[148:151], a[160:163], 0
  v_mfma_f32_16x16x32_bf16 v[52:55], v[172:175], a[160:163], 0
  v_mfma_f32_16x16x32_bf16 v[56:59], v[148:151], a[184:187], 0
  v_mfma_f32_16x16x32_bf16 v[60:63], v[172:175], a[184:187], 0
  v_mfma_f32_16x16x32_bf16 v[64:67], v[148:151], a[208:211], 0
  v_mfma_f32_16x16x32_bf16 v[68:71], v[172:175], a[208:211], 0
  v_mfma_f32_16x16x32_bf16 v[72:75], v[148:151], a[232:235], 0
  v_mfma_f32_16x16x32_bf16 v[76:79], v[172:175], a[232:235], 0
  v_mfma_f32_16x16x32_bf16 v[48:51], v[152:155], a[164:167], v[48:51]
  v_mfma_f32_16x16x32_bf16 v[52:55], v[176:179], a[164:167], v[52:55]
  v_mfma_f32_16x16x32_bf16 v[56:59], v[152:155], a[188:191], v[56:59]
  v_mfma_f32_16x16x32_bf16 v[60:63], v[176:179], a[188:191], v[60:63]
  v_mfma_f32_16x16x32_bf16 v[64:67], v[152:155], a[212:215], v[64:67]
  v_mfma_f32_16x16x32_bf16 v[68:71], v[176:179], a[212:215], v[68:71]
  v_mfma_f32_16x16x32_bf16 v[72:75], v[152:155], a[236:239], v[72:75]
  v_mfma_f32_16x16x32_bf16 v[76:79], v[176:179], a[236:239], v[76:79]
  v_mfma_f32_16x16x32_bf16 v[48:51], v[156:159], a[168:171], v[48:51]
  v_mfma_f32_16x16x32_bf16 v[52:55], v[180:183], a[168:171], v[52:55]
  v_mfma_f32_16x16x32_bf16 v[56:59], v[156:159], a[192:195], v[56:59]
  v_mfma_f32_16x16x32_bf16 v[60:63], v[180:183], a[192:195], v[60:63]
  v_mfma_f32_16x16x32_bf16 v[64:67], v[156:159], a[216:219], v[64:67]
  v_mfma_f32_16x16x32_bf16 v[68:71], v[180:183], a[216:219], v[68:71]
  v_mfma_f32_16x16x32_bf16 v[72:75], v[156:159], a[240:243], v[72:75]
  v_mfma_f32_16x16x32_bf16 v[76:79], v[180:183], a[240:243], v[76:79]
  v_mfma_f32_16x16x32_bf16 v[48:51], v[160:163], a[172:175], v[48:51]
  v_mfma_f32_16x16x32_bf16 v[52:55], v[184:187], a[172:175], v[52:55]
  v_mfma_f32_16x16x32_bf16 v[56:59], v[160:163], a[196:199], v[56:59]
  v_mfma_f32_16x16x32_bf16 v[60:63], v[184:187], a[196:199], v[60:63]
  v_mfma_f32_16x16x32_bf16 v[64:67], v[160:163], a[220:223], v[64:67]
  v_mfma_f32_16x16x32_bf16 v[68:71], v[184:187], a[220:223], v[68:71]
  v_mfma_f32_16x16x32_bf16 v[72:75], v[160:163], a[244:247], v[72:75]
  v_mfma_f32_16x16x32_bf16 v[76:79], v[184:187], a[244:247], v[76:79]
  v_mfma_f32_16x16x32_bf16 v[48:51], v[164:167], a[176:179], v[48:51]
  v_mfma_f32_16x16x32_bf16 v[52:55], v[188:191], a[176:179], v[52:55]
  v_mfma_f32_16x16x32_bf16 v[56:59], v[164:167], a[200:203], v[56:59]
  v_mfma_f32_16x16x32_bf16 v[60:63], v[188:191], a[200:203], v[60:63]
  v_mfma_f32_16x16x32_bf16 v[64:67], v[164:167], a[224:227], v[64:67]
  v_mfma_f32_16x16x32_bf16 v[68:71], v[188:191], a[224:227], v[68:71]
  v_mfma_f32_16x16x32_bf16 v[72:75], v[164:167], a[248:251], v[72:75]
  v_mfma_f32_16x16x32_bf16 v[76:79], v[188:191], a[248:251], v[76:79]
  v_mfma_f32_16x16x32_bf16 v[48:51], v[168:171], a[180:183], v[48:51]
  v_mfma_f32_16x16x32_bf16 v[52:55], v[192:195], a[180:183], v[52:55]
  v_mfma_f32_16x16x32_bf16 v[56:59], v[168:171], a[204:207], v[56:59]
  v_mfma_f32_16x16x32_bf16 v[60:63], v[192:195], a[204:207], v[60:63]
  v_mfma_f32_16x16x32_bf16 v[64:67], v[168:171], a[228:231], v[64:67]
  v_mfma_f32_16x16x32_bf16 v[68:71], v[192:195], a[228:231], v[68:71]
  v_mfma_f32_16x16x32_bf16 v[72:75], v[168:171], a[252:255], v[72:75]
  v_mfma_f32_16x16x32_bf16 v[76:79], v[192:195], a[252:255], v[76:79]
  s_nop 0
  v_cvt_pk_bf16_f32 v232, v48, v49
  v_cvt_pk_bf16_f32 v233, v50, v51
  v_cvt_pk_bf16_f32 v234, v52, v53
  v_cvt_pk_bf16_f32 v235, v54, v55
  s_add_u32 s40, s45, 0
  v_cvt_pk_bf16_f32 v236, v56, v57
  v_cvt_pk_bf16_f32 v237, v58, v59
  v_cvt_pk_bf16_f32 v238, v60, v61
  v_cvt_pk_bf16_f32 v239, v62, v63
  s_add_u32 s40, s45, 1024
  v_cvt_pk_bf16_f32 v240, v64, v65
  v_cvt_pk_bf16_f32 v241, v66, v67
  v_cvt_pk_bf16_f32 v242, v68, v69
  v_cvt_pk_bf16_f32 v243, v70, v71
  s_add_u32 s40, s45, 2048
  v_cvt_pk_bf16_f32 v244, v72, v73
  v_cvt_pk_bf16_f32 v245, v74, v75
  v_cvt_pk_bf16_f32 v246, v76, v77
  v_cvt_pk_bf16_f32 v247, v78, v79
  s_add_u32 s40, s45, 3072
  s_add_u32 s45, s45, 1310720
  s_waitcnt lgkmcnt(0)
  s_xor_b32 s50, s50, 57344
  s_mov_b32 s40, s29
  s_mov_b32 s29, s30
  s_mov_b32 s30, s31
  s_mov_b32 s31, s32
  s_mov_b32 s32, s40
  s_branch RM1F_LOOP
RM1F_DONE:
  s_waitcnt vmcnt(0)
  s_barrier
  v_mov_b32 v4, 64
  s_mov_b64 exec, 1
  buffer_store_dword v4, v31, s[4:7], s53 offen sc1
  s_cmp_lg_u32 s27, 0
  s_cbranch_scc1 RM1F_NOPROG2
  s_mov_b32 s40, 8390656
  buffer_store_dword v4, v31, s[4:7], s40 offen sc1
RM1F_NOPROG2:
  s_waitcnt vmcnt(0)
  s_mov_b64 exec, -1
  s_endpgm
RM1S_LOOP:
WU_13:
  s_memtime s[58:59]
  s_waitcnt lgkmcnt(0)
  s_sub_u32 s58, s58, s96
  s_cmp_ge_u32 s58, 2600
  s_cbranch_scc1 WU_13_D
  s_sub_u32 s58, 2600, s58
  s_cmp_lt_u32 s58, 96
  s_cbranch_scc1 WU_13
  s_sleep 1
  s_branch WU_13
WU_13_D:
  s_mov_b32 s43, 0
RM1S_AGP:
  buffer_load_dwordx4 v[48:51], v23, s[4:7], s29 offen sc1
  buffer_load_dwordx4 v[52:55], v24, s[4:7], s29 offen sc1
  buffer_load_dwordx4 v[56:59], v25, s[4:7], s29 offen sc1
  s_waitcnt vmcnt(0)
  v_max3_u32 v4, v48, v49, v50
  v_max3_u32 v4, v4, v51, v52
  v_max3_u32 v4, v4, v53, v54
  v_max3_u32 v4, v4, v55, v56
  v_max3_u32 v4, v4, v57, v58
  v_max_u32 v4, v4, v59
  v_cmp_eq_u32 vcc, -1, v4
  s_nop 3
  s_cbranch_vccz RM1S_AGP_OK
  s_add_u32 s43, s43, 1
  s_cmp_lt_u32 s43, s61
  s_cbranch_scc1 RM1S_AGP
  s_mov_b32 s61, 0
RM1S_AGP_OK:
  ds_write_b128 v10, v[48:51]
  ds_write_b128 v10, v[52:55] offset:1024
  s_mov_b32 exec_hi, 0
  ds_write_b128 v10, v[56:59] offset:2048
  s_mov_b64 exec, -1
RM1S_B0:
  s_waitcnt lgkmcnt(0)
  s_barrier
  s_memtime s[98:99]
  ds_read_b128 v[48:51], v6 offset:0
  ds_read_b128 v[52:55], v6 offset:1024
  ds_read_b128 v[56:59], v6 offset:2048
  ds_read_b128 v[60:63], v6 offset:3072
  ds_read_b128 v[64:67], v6 offset:4096
  ds_read_b128 v[68:71], v6 offset:5120
  ds_read_b128 v[72:75], v6 offset:6144
  ds_read_b128 v[76:79], v6 offset:7168
  ds_read_b128 v[80:83], v6 offset:8192
  ds_read_b128 v[84:87], v6 offset:9216
  v_mov_b32 v88, 0
  v_mov_b32 v89, 0
  v_mov_b32 v90, 0
  v_mov_b32 v91, 0
  v_mov_b32 v92, 0
  v_mov_b32 v93, 0
  v_mov_b32 v94, 0
  v_mov_b32 v95, 0
  s_waitcnt lgkmcnt(9)
  v_smfmac_f32_16x16x64_bf16 v[88:91], v[48:51], a[0:7], v21
  v_smfmac_f32_16x16x64_bf16 v[92:95], v[48:51], a[80:87], v21
  s_waitcnt lgkmcnt(8)
  v_smfmac_f32_16x16x64_bf16 v[88:91], v[52:55], a[8:15], v21
  v_smfmac_f32_16x16x64_bf16 v[92:95], v[52:55], a[88:95], v21
  s_waitcnt lgkmcnt(7)
  v_smfmac_f32_16x16x64_bf16 v[88:91], v[56:59], a[16:23], v21
  v_smfmac_f32_16x16x64_bf16 v[92:95], v[56:59], a[96:103], v21
  s_waitcnt lgkmcnt(6)
  v_smfmac_f32_16x16x64_bf16 v[88:91], v[60:63], a[24:31], v21
  v_smfmac_f32_16x16x64_bf16 v[92:95], v[60:63], a[104:111], v21
  s_waitcnt lgkmcnt(5)
  v_smfmac_f32_16x16x64_bf16 v[88:91], v[64:67], a[32:39], v21
  v_smfmac_f32_16x16x64_bf16 v[92:95], v[64:67], a[112:119], v21
  s_waitcnt lgkmcnt(4)
  v_smfmac_f32_16x16x64_bf16 v[88:91], v[68:71], a[40:47], v21
  v_smfmac_f32_16x16x64_bf16 v[92:95], v[68:71], a[120:127], v21
  s_waitcnt lgkmcnt(3)
  v_smfmac_f32_16x16x64_bf16 v[88:91], v[72:75], a[48:55], v21
  v_smfmac_f32_16x16x64_bf16 v[92:95], v[72:75], a[128:135], v21
  s_waitcnt lgkmcnt(2)
  v_smfmac_f32_16x16x64_bf16 v[88:91], v[76:79], a[56:63], v21
  v_smfmac_f32_16x16x64_bf16 v[92:95], v[76:79], a[136:143], v21
  s_waitcnt lgkmcnt(1)
  v_smfmac_f32_16x16x64_bf16 v[88:91], v[80:83], a[64:71], v21
  v_smfmac_f32_16x16x64_bf16 v[92:95], v[80:83], a[144:151], v21
  s_waitcnt lgkmcnt(0)
  v_smfmac_f32_16x16x64_bf16 v[88:91], v[84:87], a[72:79], v21
  v_smfmac_f32_16x16x64_bf16 v[92:95], v[84:87], a[152:159], v21
  s_nop 7
  v_permlane32_swap_b32 v88, v92
  v_permlane32_swap_b32 v89, v93
  v_permlane32_swap_b32 v90, v94
  v_permlane32_swap_b32 v91, v95
  v_add_f32 v88, v88, v92
  v_add_f32 v89, v89, v93
  v_add_f32 v90, v90, v94
  v_add_f32 v91, v91, v95
  v_cvt_pk_bf16_f32 v252, v88, v89
  v_cvt_pk_bf16_f32 v253, v90, v91
  buffer_store_dwordx2 v[252:253], v12, s[4:7], s30 offen sc1
  s_cmp_lg_u32 s28, 0
  s_cbranch_scc1 RM1S_NOS1
  s_add_u32 s33, s33, 2
  s_min_u32 s42, s33, 128
  s_cmp_ge_u32 s22, s42
  s_cbranch_scc1 RM1S_WKV14_D
  s_mov_b32 s23, 0
RM1S_WKV14:
  buffer_load_dword v4, v249, s[4:7], 0 offen sc1
  s_waitcnt vmcnt(0)
  v_cmp_gt_u32 vcc, s42, v4
  s_nop 3
  s_cbranch_vccz RM1S_WKV14_K
  s_sleep 4
  s_add_u32 s23, s23, 1
  s_cmp_lt_u32 s23, 0x100000
  s_cbranch_scc1 RM1S_WKV14
RM1S_WKV14_K:
  v_readlane_b32 s22, v4, 0
  v_readlane_b32 s41, v4, 1
  s_nop 0
  s_min_u32 s22, s22, s41
  v_readlane_b32 s41, v4, 2
  s_nop 0
  s_min_u32 s22, s22, s41
  v_readlane_b32 s41, v4, 3
  s_nop 0
  s_min_u32 s22, s22, s41
  s_nop 2
RM1S_WKV14_D:
  s_add_u32 m0, s49, 12288
  s_add_u32 s40, s44, 0
  buffer_load_dwordx4 v6, s[4:7], s40 offen offset:0 sc1 lds
  buffer_load_dwordx4 v6, s[4:7], s40 offen offset:1024 sc1 lds
  buffer_load_dwordx4 v6, s[4:7], s40 offen offset:2048 sc1 lds
  buffer_load_dwordx4 v6, s[4:7], s40 offen offset:3072 sc1 lds
  s_add_u32 m0, s49, 16384
  s_add_u32 s40, s44, 4096
  buffer_load_dwordx4 v6, s[4:7], s40 offen offset:0 sc1 lds
  buffer_load_dwordx4 v6, s[4:7], s40 offen offset:1024 sc1 lds
  buffer_load_dwordx4 v6, s[4:7], s40 offen offset:2048 sc1 lds
  buffer_load_dwordx4 v6, s[4:7], s40 offen offset:3072 sc1 lds
  s_add_u32 m0, s49, 20480
  s_add_u32 s40, s44, 8192
  buffer_load_dwordx4 v6, s[4:7], s40 offen offset:0 sc1 lds
  buffer_load_dwordx4 v6, s[4:7], s40 offen offset:1024 sc1 lds
  buffer_load_dwordx4 v6, s[4:7], s40 offen offset:2048 sc1 lds
  buffer_load_dwordx4 v6, s[4:7], s40 offen offset:3072 sc1 lds
  s_add_u32 s44, s44, 393216
  s_xor_b32 s49, s49, 57344
RM1S_NOS1:
  v_mov_b32 v48, 0
  v_mov_b32 v49, 0
  v_mov_b32 v50, 0
  v_mov_b32 v51, 0
  v_mov_b32 v52, 0
  v_mov_b32 v53, 0
  v_mov_b32 v54, 0
  v_mov_b32 v55, 0
  v_mov_b32 v56, 0
  v_mov_b32 v57, 0
  v_mov_b32 v58, 0
  v_mov_b32 v59, 0
  v_mov_b32 v60, 0
  v_mov_b32 v61, 0
  v_mov_b32 v62, 0
  v_mov_b32 v63, 0
  s_nop 1
WU_15:
  s_memtime s[58:59]
  s_waitcnt lgkmcnt(0)
  s_sub_u32 s58, s58, s98
  s_cmp_ge_u32 s58, 1150
  s_cbranch_scc1 WU_15_D
  s_sub_u32 s58, 1150, s58
  s_cmp_lt_u32 s58, 96
  s_cbranch_scc1 WU_15
  s_sleep 1
  s_branch WU_15
WU_15_D:
  s_mov_b32 s43, 0
RM1S_AP:
  buffer_load_dwordx4 v[32:35], v16, s[4:7], s30 offen sc1
  buffer_load_dwordx4 v[36:39], v17, s[4:7], s30 offen sc1
  s_waitcnt vmcnt(0)
  v_max3_u32 v4, v32, v33, v34
  v_max3_u32 v4, v4, v35, v36
  v_max3_u32 v4, v4, v37, v38
  v_max_u32 v4, v4, v39
  v_cmp_eq_u32 vcc, -1, v4
  s_nop 3
  s_cbranch_vccz RM1S_AP_OK
  s_add_u32 s43, s43, 1
  s_cmp_lt_u32 s43, s61
  s_cbranch_scc1 RM1S_AP
  s_mov_b32 s61, 0
RM1S_AP_OK:
  ds_write_b128 v19, v[32:35]
  ds_write_b128 v19, v[36:39] offset:1024
  s_waitcnt lgkmcnt(0)
  s_barrier
  ds_read_b64_tr_b16 v[148:149], v20 offset:0
  ds_read_b64_tr_b16 v[150:151], v20 offset:256
  ds_read_b64_tr_b16 v[172:173], v20 offset:3072
  ds_read_b64_tr_b16 v[174:175], v20 offset:3328
  ds_read_b64_tr_b16 v[152:153], v20 offset:512
  ds_read_b64_tr_b16 v[154:155], v20 offset:768
  ds_read_b64_tr_b16 v[176:177], v20 offset:3584
  ds_read_b64_tr_b16 v[178:179], v20 offset:3840
  ds_read_b64_tr_b16 v[156:157], v20 offset:1024
  ds_read_b64_tr_b16 v[158:159], v20 offset:1280
  ds_read_b64_tr_b16 v[180:181], v20 offset:4096
  ds_read_b64_tr_b16 v[182:183], v20 offset:4352
  s_waitcnt lgkmcnt(8)
  v_mfma_f32_16x16x32_bf16 v[224:227], v[100:103], v[148:151], 0
  v_mfma_f32_16x16x32_bf16 v[228:231], v[124:127], v[148:151], 0
  v_mfma_f32_16x16x32_bf16 v[220:223], v[172:175], v[148:151], 0
  ds_read_b64_tr_b16 v[160:161], v20 offset:1536
  ds_read_b64_tr_b16 v[162:163], v20 offset:1792
  ds_read_b64_tr_b16 v[184:185], v20 offset:4608
  ds_read_b64_tr_b16 v[186:187], v20 offset:4864
  s_waitcnt lgkmcnt(8)
  v_mfma_f32_16x16x32_bf16 v[224:227], v[104:107], v[152:155], v[224:227]
  v_mfma_f32_16x16x32_bf16 v[228:231], v[128:131], v[152:155], v[228:231]
  v_mfma_f32_16x16x32_bf16 v[220:223], v[176:179], v[152:155], v[220:223]
  ds_read_b64_tr_b16 v[164:165], v20 offset:2048
  ds_read_b64_tr_b16 v[166:167], v20 offset:2304
  ds_read_b64_tr_b16 v[188:189], v20 offset:5120
  ds_read_b64_tr_b16 v[190:191], v20 offset:5376
  s_waitcnt lgkmcnt(8)
  v_mfma_f32_16x16x32_bf16 v[224:227], v[108:111], v[156:159], v[224:227]
  v_mfma_f32_16x16x32_bf16 v[228:231], v[132:135], v[156:159], v[228:231]
  v_mfma_f32_16x16x32_bf16 v[220:223], v[180:183], v[156:159], v[220:223]
  ds_read_b64_tr_b16 v[168:169], v20 offset:2560
  ds_read_b64_tr_b16 v[170:171], v20 offset:2816
  ds_read_b64_tr_b16 v[192:193], v20 offset:5632
  ds_read_b64_tr_b16 v[194:195], v20 offset:5888
  s_waitcnt lgkmcnt(8)
  v_mfma_f32_16x16x32_bf16 v[224:227], v[112:115], v[160:163], v[224:227]
  v_mfma_f32_16x16x32_bf16 v[228:231], v[136:139], v[160:163], v[228:231]
  v_mfma_f32_16x16x32_bf16 v[220:223], v[184:187], v[160:163], v[220:223]
  s_waitcnt lgkmcnt(4)
  v_mfma_f32_16x16x32_bf16 v[224:227], v[116:119], v[164:167], v[224:227]
  v_mfma_f32_16x16x32_bf16 v[228:231], v[140:143], v[164:167], v[228:231]
  v_mfma_f32_16x16x32_bf16 v[220:223], v[188:191], v[164:167], v[220:223]
  s_waitcnt lgkmcnt(0)
  v_mfma_f32_16x16x32_bf16 v[224:227], v[120:123], v[168:171], v[224:227]
  v_mfma_f32_16x16x32_bf16 v[228:231], v[144:147], v[168:171], v[228:231]
  v_mfma_f32_16x16x32_bf16 v[220:223], v[192:195], v[168:171], v[220:223]
  s_barrier
  s_memtime s[96:97]
  ds_read_b64_tr_b16 v[196:197], v22 offset:0
  ds_read_b64_tr_b16 v[198:199], v22 offset:64
  ds_read_b64_tr_b16 v[200:201], v22 offset:1024
  ds_read_b64_tr_b16 v[202:203], v22 offset:1088
  ds_read_b64_tr_b16 v[204:205], v22 offset:2048
  ds_read_b64_tr_b16 v[206:207], v22 offset:2112
  v_cndmask_b32 v148, v224, v228, s[38:39]
  v_cndmask_b32 v149, v225, v229, s[38:39]
  s_waitcnt lgkmcnt(4)
  v_smfmac_f32_16x16x64_bf16 v[48:51], v[196:199], a[160:167], v21
  v_cndmask_b32 v150, v226, v230, s[38:39]
  v_smfmac_f32_16x16x64_bf16 v[52:55], v[196:199], a[184:191], v21
  v_cndmask_b32 v151, v227, v231, s[38:39]
  v_smfmac_f32_16x16x64_bf16 v[56:59], v[196:199], a[208:215], v21
  v_cndmask_b32 v152, v220, v222, s[38:39]
  v_smfmac_f32_16x16x64_bf16 v[60:63], v[196:199], a[232:239], v21
  v_cndmask_b32 v153, v221, v223, s[38:39]
  s_waitcnt lgkmcnt(2)
  v_smfmac_f32_16x16x64_bf16 v[48:51], v[200:203], a[168:175], v21
  v_max3_f32 v154, v148, v149, v150
  v_smfmac_f32_16x16x64_bf16 v[52:55], v[200:203], a[192:199], v21
  v_max3_f32 v155, v151, v152, v153
  v_smfmac_f32_16x16x64_bf16 v[56:59], v[200:203], a[216:223], v21
  v_max_f32 v154, v154, v155
  v_smfmac_f32_16x16x64_bf16 v[60:63], v[200:203], a[240:247], v21
  s_nop 0
  v_max_f32_dpp v154, v154, v154 row_ror:8 row_mask:0xf bank_mask:0xf
  s_waitcnt lgkmcnt(0)
  v_smfmac_f32_16x16x64_bf16 v[48:51], v[204:207], a[176:183], v21
  v_mov_b32 v155, v154
  v_smfmac_f32_16x16x64_bf16 v[52:55], v[204:207], a[200:207], v21
  s_nop 0
  v_permlane16_swap_b32 v154, v155
  v_smfmac_f32_16x16x64_bf16 v[56:59], v[204:207], a[224:231], v21
  v_max_f32 v154, v154, v155
  v_smfmac_f32_16x16x64_bf16 v[60:63], v[204:207], a[248:255], v21
  v_mov_b32 v155, v154
  s_nop 1
  v_permlane32_swap_b32 v154, v155
  v_max_f32 v154, v154, v155
  v_mul_f32 v154, s60, v154
  v_fma_f32 v148, v148, s60, -v154
  v_fma_f32 v149, v149, s60, -v154
  v_fma_f32 v150, v150, s60, -v154
  v_fma_f32 v151, v151, s60, -v154
  v_fma_f32 v152, v152, s60, -v154
  v_fma_f32 v153, v153, s60, -v154
  v_exp_f32 v148, v148
  v_exp_f32 v149, v149
  v_exp_f32 v150, v150
  v_exp_f32 v151, v151
  v_exp_f32 v152, v152
  v_exp_f32 v153, v153
  v_cvt_pk_bf16_f32 v160, v148, v149
  v_cvt_pk_bf16_f32 v161, v150, v151
  v_cvt_pk_bf16_f32 v158, v152, v153
  v_mov_b32_dpp v162, v160 row_ror:8 row_mask:0xf bank_mask:0xf
  v_mov_b32_dpp v163, v161 row_ror:8 row_mask:0xf bank_mask:0xf
  v_mov_b32_dpp v159, v158 row_ror:8 row_mask:0xf bank_mask:0xf
  s_nop 0
  v_mfma_f32_16x16x32_bf16 v[64:67], v[232:235], v[160:163], 0
  v_cvt_pk_bf16_f32 v220, v48, v49
  v_cvt_pk_bf16_f32 v221, v50, v51
  v_mfma_f32_16x16x32_bf16 v[68:71], v[236:239], v[160:163], 0
  v_cvt_pk_bf16_f32 v222, v52, v53
  v_cvt_pk_bf16_f32 v223, v54, v55
  v_mfma_f32_16x16x32_bf16 v[72:75], v[240:243], v[160:163], 0
  v_cvt_pk_bf16_f32 v224, v56, v57
  v_cvt_pk_bf16_f32 v225, v58, v59
  v_mfma_f32_16x16x32_bf16 v[76:79], v[244:247], v[160:163], 0
  v_cvt_pk_bf16_f32 v226, v60, v61
  v_cvt_pk_bf16_f32 v227, v62, v63
  v_mfma_f32_16x16x16_bf16 v[64:67], v[220:221], v[158:159], v[64:67]
  v_cndmask_b32 v152, v152, v31, s[20:21]
  v_cndmask_b32 v153, v153, v31, s[20:21]
  v_add_f32 v156, v148, v149
  v_add_f32 v155, v150, v151
  v_mfma_f32_16x16x16_bf16 v[68:71], v[222:223], v[158:159], v[68:71]
  v_add_f32 v157, v152, v153
  v_add_f32 v156, v156, v155
  v_add_f32 v156, v156, v157
  s_nop 1
  v_add_f32_dpp v156, v156, v156 row_ror:8 row_mask:0xf bank_mask:0xf
  v_mfma_f32_16x16x16_bf16 v[72:75], v[224:225], v[158:159], v[72:75]
  v_mov_b32 v155, v156
  s_nop 1
  v_permlane16_swap_b32 v156, v155
  v_add_f32 v156, v156, v155
  v_mov_b32 v155, v156
  v_mfma_f32_16x16x16_bf16 v[76:79], v[226:227], v[158:159], v[76:79]
  s_nop 0
  v_permlane32_swap_b32 v156, v155
  v_add_f32 v156, v156, v155
  v_rcp_f32 v156, v156
  s_nop 0
  v_mov_b32 v157, v156
  v_pk_mul_f32 v[64:65], v[64:65], v[156:157]
  v_pk_mul_f32 v[66:67], v[66:67], v[156:157]
  v_pk_mul_f32 v[68:69], v[68:69], v[156:157]
  v_pk_mul_f32 v[70:71], v[70:71], v[156:157]
  v_pk_mul_f32 v[72:73], v[72:73], v[156:157]
  v_pk_mul_f32 v[74:75], v[74:75], v[156:157]
  v_pk_mul_f32 v[76:77], v[76:77], v[156:157]
  v_pk_mul_f32 v[78:79], v[78:79], v[156:157]
  v_cvt_pk_bf16_f32 v80, v64, v65
  v_cvt_pk_bf16_f32 v81, v66, v67
  v_cvt_pk_bf16_f32 v82, v68, v69
  v_cvt_pk_bf16_f32 v83, v70, v71
  v_cvt_pk_bf16_f32 v84, v72, v73
  v_cvt_pk_bf16_f32 v85, v74, v75
  v_cvt_pk_bf16_f32 v86, v76, v77
  v_cvt_pk_bf16_f32 v87, v78, v79
  s_add_u32 s40, s30, s48
  s_mov_b64 exec, s[34:35]
  buffer_store_dwordx4 v[80:83], v28, s[4:7], s40 offen sc1
  s_add_u32 s40, s40, 32768
  buffer_store_dwordx4 v[84:87], v28, s[4:7], s40 offen sc1
  s_mov_b64 exec, -1
  s_cmp_eq_u32 s28, 63
  s_cbranch_scc1 RM1S_NODMA
  s_add_u32 s33, s33, 2
  s_min_u32 s42, s33, 128
  s_cmp_ge_u32 s22, s42
  s_cbranch_scc1 RM1S_WKV16_D
  s_mov_b32 s23, 0
RM1S_WKV16:
  buffer_load_dword v4, v249, s[4:7], 0 offen sc1
  s_waitcnt vmcnt(0)
  v_cmp_gt_u32 vcc, s42, v4
  s_nop 3
  s_cbranch_vccz RM1S_WKV16_K
  s_sleep 4
  s_add_u32 s23, s23, 1
  s_cmp_lt_u32 s23, 0x100000
  s_cbranch_scc1 RM1S_WKV16
RM1S_WKV16_K:
  v_readlane_b32 s22, v4, 0
  v_readlane_b32 s41, v4, 1
  s_nop 0
  s_min_u32 s22, s22, s41
  v_readlane_b32 s41, v4, 2
  s_nop 0
  s_min_u32 s22, s22, s41
  v_readlane_b32 s41, v4, 3
  s_nop 0
  s_min_u32 s22, s22, s41
  s_nop 2
RM1S_WKV16_D:
  s_add_u32 m0, s49, 12288
  s_add_u32 s40, s44, 0
  buffer_load_dwordx4 v6, s[4:7], s40 offen offset:0 sc1 lds
  buffer_load_dwordx4 v6, s[4:7], s40 offen offset:1024 sc1 lds
  buffer_load_dwordx4 v6, s[4:7], s40 offen offset:2048 sc1 lds
  buffer_load_dwordx4 v6, s[4:7], s40 offen offset:3072 sc1 lds
  s_add_u32 m0, s49, 16384
  s_add_u32 s40, s44, 4096
  buffer_load_dwordx4 v6, s[4:7], s40 offen offset:0 sc1 lds
  buffer_load_dwordx4 v6, s[4:7], s40 offen offset:1024 sc1 lds
  buffer_load_dwordx4 v6, s[4:7], s40 offen offset:2048 sc1 lds
  buffer_load_dwordx4 v6, s[4:7], s40 offen offset:3072 sc1 lds
  s_add_u32 m0, s49, 20480
  s_add_u32 s40, s44, 8192
  buffer_load_dwordx4 v6, s[4:7], s40 offen offset:0 sc1 lds
  buffer_load_dwordx4 v6, s[4:7], s40 offen offset:1024 sc1 lds
  buffer_load_dwordx4 v6, s[4:7], s40 offen offset:2048 sc1 lds
  buffer_load_dwordx4 v6, s[4:7], s40 offen offset:3072 sc1 lds
  s_add_u32 s44, s44, 393216
  s_xor_b32 s49, s49, 57344
RM1S_NODMA:
  s_mov_b64 exec, s[34:35]
  s_cmp_lg_u32 s26, 0
  s_cbranch_scc1 RM1S_NOKM
  buffer_store_dwordx4 v[180:183], v15, s[4:7], s47 offen offset:0 sc1
  buffer_store_dwordx4 v[184:187], v15, s[4:7], s47 offen offset:512 sc1
  s_nop 1
RM1S_NOKM:
  s_mov_b64 exec, -1
  s_add_u32 s47, s47, 98304
  v_mov_b32 v64, v48
  v_mov_b32 v65, v49
  v_mov_b32 v66, v50
  v_mov_b32 v67, v51
  v_permlane32_swap_b32 v48, v64
  v_permlane32_swap_b32 v49, v65
  v_permlane32_swap_b32 v50, v66
  v_permlane32_swap_b32 v51, v67
  v_add_f32 v48, v48, v64
  v_add_f32 v49, v49, v65
  v_add_f32 v50, v50, v66
  v_add_f32 v51, v51, v67
  v_cvt_pk_bf16_f32 v220, v48, v49
  v_cvt_pk_bf16_f32 v221, v50, v51
  v_mov_b32 v64, v52
  v_mov_b32 v65, v53
  v_mov_b32 v66, v54
  v_mov_b32 v67, v55
  v_permlane32_swap_b32 v52, v64
  v_permlane32_swap_b32 v53, v65
  v_permlane32_swap_b32 v54, v66
  v_permlane32_swap_b32 v55, v67
  v_add_f32 v52, v52, v64
  v_add_f32 v53, v53, v65
  v_add_f32 v54, v54, v66
  v_add_f32 v55, v55, v67
  v_cvt_pk_bf16_f32 v222, v52, v53
  v_cvt_pk_bf16_f32 v223, v54, v55
  v_mov_b32 v64, v56
  v_mov_b32 v65, v57
  v_mov_b32 v66, v58
  v_mov_b32 v67, v59
  v_permlane32_swap_b32 v56, v64
  v_permlane32_swap_b32 v57, v65
  v_permlane32_swap_b32 v58, v66
  v_permlane32_swap_b32 v59, v67
  v_add_f32 v56, v56, v64
  v_add_f32 v57, v57, v65
  v_add_f32 v58, v58, v66
  v_add_f32 v59, v59, v67
  v_cvt_pk_bf16_f32 v224, v56, v57
  v_cvt_pk_bf16_f32 v225, v58, v59
  v_mov_b32 v64, v60
  v_mov_b32 v65, v61
  v_mov_b32 v66, v62
  v_mov_b32 v67, v63
  v_permlane32_swap_b32 v60, v64
  v_permlane32_swap_b32 v61, v65
  v_permlane32_swap_b32 v62, v66
  v_permlane32_swap_b32 v63, v67
  v_add_f32 v60, v60, v64
  v_add_f32 v61, v61, v65
  v_add_f32 v62, v62, v66
  v_add_f32 v63, v63, v67
  v_cvt_pk_bf16_f32 v226, v60, v61
  v_cvt_pk_bf16_f32 v227, v62, v63
  s_mov_b32 exec_hi, 0
  buffer_store_dwordx2 v[220:221], v29, s[4:7], s46 offen offset:0 sc1
  buffer_store_dwordx2 v[222:223], v29, s[4:7], s46 offen offset:256 sc1
  buffer_store_dwordx2 v[224:225], v29, s[4:7], s46 offen offset:512 sc1
  buffer_store_dwordx2 v[226:227], v29, s[4:7], s46 offen offset:768 sc1
  s_mov_b64 exec, -1
  s_add_u32 s46, s46, 327680
  v_mov_b32 v4, s28
  s_mov_b64 exec, 1
  buffer_store_dword v4, v31, s[4:7], s53 offen sc1
  s_cmp_lg_u32 s27, 0
  s_cbranch_scc1 RM1S_NOPROG
  s_mov_b32 s40, 8390656
  buffer_store_dword v4, v31, s[4:7], s40 offen sc1
RM1S_NOPROG:
  s_mov_b64 exec, -1
  s_add_u32 s28, s28, 1
  s_cmp_ge_u32 s28, 64
  s_cbranch_scc1 RM1S_DONE
  v_add_u32 v4, s50, v6
  ds_read_b128 v[148:151], v4 offset:12288
  ds_read_b128 v[152:155], v4 offset:13312
  ds_read_b128 v[156:159], v4 offset:14336
  ds_read_b128 v[160:163], v4 offset:15360
  ds_read_b128 v[164:167], v4 offset:16384
  ds_read_b128 v[168:171], v4 offset:17408
  ds_read_b128 v[172:175], v4 offset:18432
  ds_read_b128 v[176:179], v4 offset:19456
  s_waitcnt lgkmcnt(4)
  ds_read_b128 v[180:183], v4 offset:20480
  ds_read_b128 v[184:187], v4 offset:21504
  ds_read_b128 v[188:191], v4 offset:22528
  ds_read_b128 v[192:195], v4 offset:23552
  s_waitcnt lgkmcnt(0)
  ds_read_b128 v[100:103], v4 offset:0
  ds_read_b128 v[104:107], v4 offset:1024
  ds_read_b128 v[108:111], v4 offset:2048
  ds_read_b128 v[112:115], v4 offset:3072
  ds_read_b128 v[116:119], v4 offset:4096
  ds_read_b128 v[120:123], v4 offset:5120
  ds_read_b128 v[124:127], v4 offset:6144
  ds_read_b128 v[128:131], v4 offset:7168
  ds_read_b128 v[132:135], v4 offset:8192
  ds_read_b128 v[136:139], v4 offset:9216
  ds_read_b128 v[140:143], v4 offset:10240
  ds_read_b128 v[144:147], v4 offset:11264
  v_mfma_f32_16x16x32_bf16 v[48:51], v[148:151], a[160:163], 0
  v_mfma_f32_16x16x32_bf16 v[52:55], v[172:175], a[160:163], 0
  v_mfma_f32_16x16x32_bf16 v[56:59], v[148:151], a[184:187], 0
  v_mfma_f32_16x16x32_bf16 v[60:63], v[172:175], a[184:187], 0
  v_mfma_f32_16x16x32_bf16 v[64:67], v[148:151], a[208:211], 0
  v_mfma_f32_16x16x32_bf16 v[68:71], v[172:175], a[208:211], 0
  v_mfma_f32_16x16x32_bf16 v[72:75], v[148:151], a[232:235], 0
  v_mfma_f32_16x16x32_bf16 v[76:79], v[172:175], a[232:235], 0
  v_mfma_f32_16x16x32_bf16 v[48:51], v[152:155], a[164:167], v[48:51]
  v_mfma_f32_16x16x32_bf16 v[52:55], v[176:179], a[164:167], v[52:55]
  v_mfma_f32_16x16x32_bf16 v[56:59], v[152:155], a[188:191], v[56:59]
  v_mfma_f32_16x16x32_bf16 v[60:63], v[176:179], a[188:191], v[60:63]
  v_mfma_f32_16x16x32_bf16 v[64:67], v[152:155], a[212:215], v[64:67]
  v_mfma_f32_16x16x32_bf16 v[68:71], v[176:179], a[212:215], v[68:71]
  v_mfma_f32_16x16x32_bf16 v[72:75], v[152:155], a[236:239], v[72:75]
  v_mfma_f32_16x16x32_bf16 v[76:79], v[176:179], a[236:239], v[76:79]
  v_mfma_f32_16x16x32_bf16 v[48:51], v[156:159], a[168:171], v[48:51]
  v_mfma_f32_16x16x32_bf16 v[52:55], v[180:183], a[168:171], v[52:55]
  v_mfma_f32_16x16x32_bf16 v[56:59], v[156:159], a[192:195], v[56:59]
  v_mfma_f32_16x16x32_bf16 v[60:63], v[180:183], a[192:195], v[60:63]
  v_mfma_f32_16x16x32_bf16 v[64:67], v[156:159], a[216:219], v[64:67]
  v_mfma_f32_16x16x32_bf16 v[68:71], v[180:183], a[216:219], v[68:71]
  v_mfma_f32_16x16x32_bf16 v[72:75], v[156:159], a[240:243], v[72:75]
  v_mfma_f32_16x16x32_bf16 v[76:79], v[180:183], a[240:243], v[76:79]
  v_mfma_f32_16x16x32_bf16 v[48:51], v[160:163], a[172:175], v[48:51]
  v_mfma_f32_16x16x32_bf16 v[52:55], v[184:187], a[172:175], v[52:55]
  v_mfma_f32_16x16x32_bf16 v[56:59], v[160:163], a[196:199], v[56:59]
  v_mfma_f32_16x16x32_bf16 v[60:63], v[184:187], a[196:199], v[60:63]
  v_mfma_f32_16x16x32_bf16 v[64:67], v[160:163], a[220:223], v[64:67]
  v_mfma_f32_16x16x32_bf16 v[68:71], v[184:187], a[220:223], v[68:71]
  v_mfma_f32_16x16x32_bf16 v[72:75], v[160:163], a[244:247], v[72:75]
  v_mfma_f32_16x16x32_bf16 v[76:79], v[184:187], a[244:247], v[76:79]
  v_mfma_f32_16x16x32_bf16 v[48:51], v[164:167], a[176:179], v[48:51]
  v_mfma_f32_16x16x32_bf16 v[52:55], v[188:191], a[176:179], v[52:55]
  v_mfma_f32_16x16x32_bf16 v[56:59], v[164:167], a[200:203], v[56:59]
  v_mfma_f32_16x16x32_bf16 v[60:63], v[188:191], a[200:203], v[60:63]
  v_mfma_f32_16x16x32_bf16 v[64:67], v[164:167], a[224:227], v[64:67]
  v_mfma_f32_16x16x32_bf16 v[68:71], v[188:191], a[224:227], v[68:71]
  v_mfma_f32_16x16x32_bf16 v[72:75], v[164:167], a[248:251], v[72:75]
  v_mfma_f32_16x16x32_bf16 v[76:79], v[188:191], a[248:251], v[76:79]
  v_mfma_f32_16x16x32_bf16 v[48:51], v[168:171], a[180:183], v[48:51]
  v_mfma_f32_16x16x32_bf16 v[52:55], v[192:195], a[180:183], v[52:55]
  v_mfma_f32_16x16x32_bf16 v[56:59], v[168:171], a[204:207], v[56:59]
  v_mfma_f32_16x16x32_bf16 v[60:63], v[192:195], a[204:207], v[60:63]
  v_mfma_f32_16x16x32_bf16 v[64:67], v[168:171], a[228:231], v[64:67]
  v_mfma_f32_16x16x32_bf16 v[68:71], v[192:195], a[228:231], v[68:71]
  v_mfma_f32_16x16x32_bf16 v[72:75], v[168:171], a[252:255], v[72:75]
  v_mfma_f32_16x16x32_bf16 v[76:79], v[192:195], a[252:255], v[76:79]
  s_nop 0
  v_cvt_pk_bf16_f32 v232, v48, v49
  v_cvt_pk_bf16_f32 v233, v50, v51
  v_cvt_pk_bf16_f32 v234, v52, v53
  v_cvt_pk_bf16_f32 v235, v54, v55
  s_add_u32 s40, s45, 0
  v_cvt_pk_bf16_f32 v236, v56, v57
  v_cvt_pk_bf16_f32 v237, v58, v59
  v_cvt_pk_bf16_f32 v238, v60, v61
  v_cvt_pk_bf16_f32 v239, v62, v63
  s_add_u32 s40, s45, 1024
  v_cvt_pk_bf16_f32 v240, v64, v65
  v_cvt_pk_bf16_f32 v241, v66, v67
  v_cvt_pk_bf16_f32 v242, v68, v69
  v_cvt_pk_bf16_f32 v243, v70, v71
  s_add_u32 s40, s45, 2048
  v_cvt_pk_bf16_f32 v244, v72, v73
  v_cvt_pk_bf16_f32 v245, v74, v75
  v_cvt_pk_bf16_f32 v246, v76, v77
  v_cvt_pk_bf16_f32 v247, v78, v79
  s_add_u32 s40, s45, 3072
  s_add_u32 s45, s45, 1310720
  s_waitcnt lgkmcnt(0)
  s_xor_b32 s50, s50, 57344
  s_mov_b32 s40, s29
  s_mov_b32 s29, s30
  s_mov_b32 s30, s31
  s_mov_b32 s31, s32
  s_mov_b32 s32, s40
  s_branch RM1S_LOOP
RM1S_DONE:
  s_waitcnt vmcnt(0)
  s_barrier
  v_mov_b32 v4, 64
  s_mov_b64 exec, 1
  buffer_store_dword v4, v31, s[4:7], s53 offen sc1
  s_cmp_lg_u32 s27, 0
  s_cbranch_scc1 RM1S_NOPROG2
  s_mov_b32 s40, 8390656
  buffer_store_dword v4, v31, s[4:7], s40 offen sc1
RM1S_NOPROG2:
  s_waitcnt vmcnt(0)
  s_mov_b64 exec, -1
  s_endpgm
RK_W2:
  v_add_u32 v4, 320, v1
  v_and_b32 v5, 7, v4
  v_mul_u32_u24 v5, 1280, v5
  v_lshrrev_b32 v212, 5, v4
  v_lshlrev_b32 v212, 6, v212
  v_add_u32 v5, v5, v212
  v_bfe_u32 v4, v4, 3, 2
  v_lshlrev_b32 v4, 3, v4
  v_add_u32 v4, v4, v5
  buffer_load_dwordx2 v[200:201], v4, s[88:91], 0 offen
  buffer_load_dwordx2 v[202:203], v4, s[88:91], 0 offen offset:32
  v_add_u32 v4, 384, v1
  v_and_b32 v5, 7, v4
  v_mul_u32_u24 v5, 1280, v5
  v_lshrrev_b32 v212, 5, v4
  v_lshlrev_b32 v212, 6, v212
  v_add_u32 v5, v5, v212
  v_bfe_u32 v4, v4, 3, 2
  v_lshlrev_b32 v4, 3, v4
  v_add_u32 v4, v4, v5
  buffer_load_dwordx2 v[204:205], v4, s[88:91], 0 offen
  buffer_load_dwordx2 v[206:207], v4, s[88:91], 0 offen offset:32
  v_add_u32 v4, 448, v1
  v_and_b32 v5, 7, v4
  v_mul_u32_u24 v5, 1280, v5
  v_lshrrev_b32 v212, 5, v4
  v_lshlrev_b32 v212, 6, v212
  v_add_u32 v5, v5, v212
  v_bfe_u32 v4, v4, 3, 2
  v_lshlrev_b32 v4, 3, v4
  v_add_u32 v4, v4, v5
  buffer_load_dwordx2 v[208:209], v4, s[88:91], 0 offen
  buffer_load_dwordx2 v[210:211], v4, s[88:91], 0 offen offset:32
  s_lshl_b32 s54, s24, 15
  v_lshrrev_b32 v4, 3, v1
  v_add_u32 v4, 16, v4
  s_mov_b32 s55, 12288
  v_mul_lo_u32 v32, v4, s55
  v_and_b32 v4, 7, v1
  v_lshlrev_b32 v4, 4, v4
  v_add_u32 v32, v32, v4
  v_bfe_u32 v33, v1, 4, 1
  v_lshlrev_b32 v33, 4, v33
  v_bfe_u32 v4, v1, 5, 1
  v_lshlrev_b32 v4, 3, v4
  v_add_u32 v33, v33, v4
  v_bfe_u32 v4, v1, 2, 1
  v_add_u32 v33, v33, v4
  v_bfe_u32 v4, v1, 3, 1
  v_lshlrev_b32 v4, 2, v4
  v_add_u32 v33, v33, v4
  v_lshlrev_b32 v33, 7, v33
  v_and_b32 v4, 3, v1
  v_lshlrev_b32 v4, 3, v4
  v_add_u32 v33, v33, v4
  s_mul_i32 s56, s25, 384
  s_mul_i32 s40, s26, 96
  s_add_u32 s56, s56, s40
  v_add_u32 v34, 61440, v33
  v_lshlrev_b32 v35, 4, v1
  v_add_u32 v35, 2048, v35
  v_add_u32 v36, 61440, v35
  s_add_u32 s40, s56, 0
  s_mov_b32 m0, 2048
  s_nop 0
  buffer_load_dwordx4 v32, s[8:11], s40 offen lds
  s_add_u32 s40, s56, 0
  s_mov_b32 m0, 6144
  s_nop 0
  buffer_load_dwordx4 v32, s[12:15], s40 offen lds
  s_add_u32 s40, s56, 0
  s_mov_b32 m0, 10240
  s_nop 0
  buffer_load_dwordx4 v32, s[16:19], s40 offen lds
  s_add_u32 s40, s56, 393216
  s_mov_b32 m0, 14336
  s_nop 0
  buffer_load_dwordx4 v32, s[8:11], s40 offen lds
  s_add_u32 s40, s56, 393216
  s_mov_b32 m0, 18432
  s_nop 0
  buffer_load_dwordx4 v32, s[12:15], s40 offen lds
  s_add_u32 s40, s56, 393216
  s_mov_b32 m0, 22528
  s_nop 0
  buffer_load_dwordx4 v32, s[16:19], s40 offen lds
  s_add_u32 s40, s56, 786432
  s_mov_b32 m0, 26624
  s_nop 0
  buffer_load_dwordx4 v32, s[8:11], s40 offen lds
  s_add_u32 s40, s56, 786432
  s_mov_b32 m0, 30720
  s_nop 0
  buffer_load_dwordx4 v32, s[12:15], s40 offen lds
  s_add_u32 s40, s56, 786432
  s_mov_b32 m0, 34816
  s_nop 0
  buffer_load_dwordx4 v32, s[16:19], s40 offen lds
  s_add_u32 s40, s56, 1179648
  s_mov_b32 m0, 38912
  s_nop 0
  buffer_load_dwordx4 v32, s[8:11], s40 offen lds
  s_add_u32 s40, s56, 1179648
  s_mov_b32 m0, 43008
  s_nop 0
  buffer_load_dwordx4 v32, s[12:15], s40 offen lds
  s_add_u32 s40, s56, 1179648
  s_mov_b32 m0, 47104
  s_nop 0
  buffer_load_dwordx4 v32, s[16:19], s40 offen lds
  s_add_u32 s40, s56, 1572864
  s_mov_b32 m0, 51200
  s_nop 0
  buffer_load_dwordx4 v32, s[8:11], s40 offen lds
  s_add_u32 s40, s56, 1572864
  s_mov_b32 m0, 55296
  s_nop 0
  buffer_load_dwordx4 v32, s[12:15], s40 offen lds
  s_add_u32 s40, s56, 1572864
  s_mov_b32 m0, 59392
  s_nop 0
  buffer_load_dwordx4 v32, s[16:19], s40 offen lds
  s_add_u32 s40, s56, 1966080
  s_mov_b32 m0, 63488
  s_nop 0
  buffer_load_dwordx4 v32, s[8:11], s40 offen lds
  s_add_u32 s40, s56, 1966080
  s_mov_b32 m0, 67584
  s_nop 0
  buffer_load_dwordx4 v32, s[12:15], s40 offen lds
  s_add_u32 s40, s56, 1966080
  s_mov_b32 m0, 71680
  s_nop 0
  buffer_load_dwordx4 v32, s[16:19], s40 offen lds
  s_add_u32 s40, s56, 2359296
  s_mov_b32 m0, 75776
  s_nop 0
  buffer_load_dwordx4 v32, s[8:11], s40 offen lds
  s_add_u32 s40, s56, 2359296
  s_mov_b32 m0, 79872
  s_nop 0
  buffer_load_dwordx4 v32, s[12:15], s40 offen lds
  s_add_u32 s40, s56, 2359296
  s_mov_b32 m0, 83968
  s_nop 0
  buffer_load_dwordx4 v32, s[16:19], s40 offen lds
  s_add_u32 s40, s56, 2752512
  s_mov_b32 m0, 88064
  s_nop 0
  buffer_load_dwordx4 v32, s[8:11], s40 offen lds
  s_add_u32 s40, s56, 2752512
  s_mov_b32 m0, 92160
  s_nop 0
  buffer_load_dwordx4 v32, s[12:15], s40 offen lds
  s_add_u32 s40, s56, 2752512
  s_mov_b32 m0, 96256
  s_nop 0
  buffer_load_dwordx4 v32, s[16:19], s40 offen lds
  s_add_u32 s40, s56, 3145728
  s_mov_b32 m0, 100352
  s_nop 0
  buffer_load_dwordx4 v32, s[8:11], s40 offen lds
  s_add_u32 s40, s56, 3145728
  s_mov_b32 m0, 104448
  s_nop 0
  buffer_load_dwordx4 v32, s[12:15], s40 offen lds
  s_add_u32 s40, s56, 3145728
  s_mov_b32 m0, 108544
  s_nop 0
  buffer_load_dwordx4 v32, s[16:19], s40 offen lds
  s_add_u32 s40, s56, 3538944
  s_mov_b32 m0, 112640
  s_nop 0
  buffer_load_dwordx4 v32, s[8:11], s40 offen lds
  s_add_u32 s40, s56, 3538944
  s_mov_b32 m0, 116736
  s_nop 0
  buffer_load_dwordx4 v32, s[12:15], s40 offen lds
  s_add_u32 s40, s56, 3538944
  s_mov_b32 m0, 120832
  s_nop 0
  buffer_load_dwordx4 v32, s[16:19], s40 offen lds
  s_add_u32 s40, s56, 3932160
  buffer_load_dwordx4 v[64:67], v32, s[8:11], s40 offen
  s_add_u32 s40, s56, 3932160
  buffer_load_dwordx4 v[68:71], v32, s[12:15], s40 offen
  s_add_u32 s40, s56, 3932160
  buffer_load_dwordx4 v[72:75], v32, s[16:19], s40 offen
  s_add_u32 s40, s56, 4325376
  buffer_load_dwordx4 v[76:79], v32, s[8:11], s40 offen
  s_add_u32 s40, s56, 4325376
  buffer_load_dwordx4 v[80:83], v32, s[12:15], s40 offen
  s_add_u32 s40, s56, 4325376
  buffer_load_dwordx4 v[84:87], v32, s[16:19], s40 offen
  s_add_u32 s40, s56, 4718592
  buffer_load_dwordx4 v[88:91], v32, s[8:11], s40 offen
  s_add_u32 s40, s56, 4718592
  buffer_load_dwordx4 v[92:95], v32, s[12:15], s40 offen
  s_add_u32 s40, s56, 4718592
  buffer_load_dwordx4 v[96:99], v32, s[16:19], s40 offen
  s_add_u32 s40, s56, 5111808
  buffer_load_dwordx4 v[100:103], v32, s[8:11], s40 offen
  s_add_u32 s40, s56, 5111808
  buffer_load_dwordx4 v[104:107], v32, s[12:15], s40 offen
  s_add_u32 s40, s56, 5111808
  buffer_load_dwordx4 v[108:111], v32, s[16:19], s40 offen
  s_add_u32 s40, s56, 5505024
  buffer_load_dwordx4 v[112:115], v32, s[8:11], s40 offen
  s_add_u32 s40, s56, 5505024
  buffer_load_dwordx4 v[116:119], v32, s[12:15], s40 offen
  s_add_u32 s40, s56, 5505024
  buffer_load_dwordx4 v[120:123], v32, s[16:19], s40 offen
  s_add_u32 s40, s56, 5898240
  buffer_load_dwordx4 v[124:127], v32, s[8:11], s40 offen
  s_add_u32 s40, s56, 5898240
  buffer_load_dwordx4 v[128:131], v32, s[12:15], s40 offen
  s_add_u32 s40, s56, 5898240
  buffer_load_dwordx4 v[132:135], v32, s[16:19], s40 offen
  s_add_u32 s40, s56, 6291456
  buffer_load_dwordx4 v[136:139], v32, s[8:11], s40 offen
  s_add_u32 s40, s56, 6291456
  buffer_load_dwordx4 v[140:143], v32, s[12:15], s40 offen
  s_add_u32 s40, s56, 6291456
  buffer_load_dwordx4 v[144:147], v32, s[16:19], s40 offen
  s_add_u32 s40, s56, 6684672
  buffer_load_dwordx4 v[148:151], v32, s[8:11], s40 offen
  s_add_u32 s40, s56, 6684672
  buffer_load_dwordx4 v[152:155], v32, s[12:15], s40 offen
  s_add_u32 s40, s56, 6684672
  buffer_load_dwordx4 v[156:159], v32, s[16:19], s40 offen
  s_add_u32 s40, s56, 7077888
  buffer_load_dwordx4 v[160:163], v32, s[8:11], s40 offen
  s_add_u32 s40, s56, 7077888
  buffer_load_dwordx4 v[164:167], v32, s[12:15], s40 offen
  s_add_u32 s40, s56, 7077888
  buffer_load_dwordx4 v[168:171], v32, s[16:19], s40 offen
  s_add_u32 s40, s56, 7471104
  buffer_load_dwordx4 v[172:175], v32, s[8:11], s40 offen
  s_add_u32 s40, s56, 7471104
  buffer_load_dwordx4 v[176:179], v32, s[12:15], s40 offen
  s_add_u32 s40, s56, 7471104
  buffer_load_dwordx4 v[180:183], v32, s[16:19], s40 offen
  s_waitcnt vmcnt(45)
  s_barrier
  ds_read_b64_tr_b16 a[0:1], v33 offset:64
  ds_read_b64_tr_b16 a[2:3], v33 offset:320
  ds_read_b64_tr_b16 a[80:81], v33 offset:4160
  ds_read_b64_tr_b16 a[82:83], v33 offset:4416
  ds_read_b64_tr_b16 a[4:5], v33 offset:12352
  ds_read_b64_tr_b16 a[6:7], v33 offset:12608
  ds_read_b64_tr_b16 a[84:85], v33 offset:16448
  ds_read_b64_tr_b16 a[86:87], v33 offset:16704
  ds_read_b64_tr_b16 a[8:9], v33 offset:24640
  ds_read_b64_tr_b16 a[10:11], v33 offset:24896
  ds_read_b64_tr_b16 a[88:89], v33 offset:28736
  ds_read_b64_tr_b16 a[90:91], v33 offset:28992
  s_waitcnt lgkmcnt(4)
  ds_read_b64_tr_b16 a[12:13], v33 offset:36928
  ds_read_b64_tr_b16 a[14:15], v33 offset:37184
  ds_read_b64_tr_b16 a[92:93], v33 offset:41024
  ds_read_b64_tr_b16 a[94:95], v33 offset:41280
  ds_read_b64_tr_b16 a[16:17], v33 offset:49216
  ds_read_b64_tr_b16 a[18:19], v33 offset:49472
  ds_read_b64_tr_b16 a[96:97], v33 offset:53312
  ds_read_b64_tr_b16 a[98:99], v33 offset:53568
  s_waitcnt lgkmcnt(0)
  s_barrier
  s_waitcnt vmcnt(30)
  s_barrier
  ds_read_b64_tr_b16 a[20:21], v33 offset:61504
  ds_read_b64_tr_b16 a[22:23], v33 offset:61760
  ds_read_b64_tr_b16 a[100:101], v34 offset:4160
  ds_read_b64_tr_b16 a[102:103], v34 offset:4416
  ds_read_b64_tr_b16 a[24:25], v34 offset:12352
  ds_read_b64_tr_b16 a[26:27], v34 offset:12608
  ds_read_b64_tr_b16 a[104:105], v34 offset:16448
  ds_read_b64_tr_b16 a[106:107], v34 offset:16704
  ds_read_b64_tr_b16 a[28:29], v34 offset:24640
  ds_read_b64_tr_b16 a[30:31], v34 offset:24896
  ds_read_b64_tr_b16 a[108:109], v34 offset:28736
  ds_read_b64_tr_b16 a[110:111], v34 offset:28992
  s_waitcnt lgkmcnt(4)
  ds_read_b64_tr_b16 a[32:33], v34 offset:36928
  ds_read_b64_tr_b16 a[34:35], v34 offset:37184
  ds_read_b64_tr_b16 a[112:113], v34 offset:41024
  ds_read_b64_tr_b16 a[114:115], v34 offset:41280
  ds_read_b64_tr_b16 a[36:37], v34 offset:49216
  ds_read_b64_tr_b16 a[38:39], v34 offset:49472
  ds_read_b64_tr_b16 a[116:117], v34 offset:53312
  ds_read_b64_tr_b16 a[118:119], v34 offset:53568
  s_waitcnt lgkmcnt(0)
  s_barrier
  s_waitcnt vmcnt(15)
  ds_write_b128 v35, v[64:67] offset:0
  ds_write_b128 v35, v[68:71] offset:4096
  ds_write_b128 v35, v[72:75] offset:8192
  ds_write_b128 v35, v[76:79] offset:12288
  ds_write_b128 v35, v[80:83] offset:16384
  ds_write_b128 v35, v[84:87] offset:20480
  s_waitcnt lgkmcnt(6)
  ds_write_b128 v35, v[88:91] offset:24576
  ds_write_b128 v35, v[92:95] offset:28672
  ds_write_b128 v35, v[96:99] offset:32768
  ds_write_b128 v35, v[100:103] offset:36864
  ds_write_b128 v35, v[104:107] offset:40960
  ds_write_b128 v35, v[108:111] offset:45056
  s_waitcnt lgkmcnt(6)
  ds_write_b128 v35, v[112:115] offset:49152
  ds_write_b128 v35, v[116:119] offset:53248
  ds_write_b128 v35, v[120:123] offset:57344
  s_waitcnt lgkmcnt(0)
  s_barrier
  ds_read_b64_tr_b16 a[40:41], v33 offset:64
  ds_read_b64_tr_b16 a[42:43], v33 offset:320
  ds_read_b64_tr_b16 a[120:121], v33 offset:4160
  ds_read_b64_tr_b16 a[122:123], v33 offset:4416
  ds_read_b64_tr_b16 a[44:45], v33 offset:12352
  ds_read_b64_tr_b16 a[46:47], v33 offset:12608
  ds_read_b64_tr_b16 a[124:125], v33 offset:16448
  ds_read_b64_tr_b16 a[126:127], v33 offset:16704
  ds_read_b64_tr_b16 a[48:49], v33 offset:24640
  ds_read_b64_tr_b16 a[50:51], v33 offset:24896
  ds_read_b64_tr_b16 a[128:129], v33 offset:28736
  ds_read_b64_tr_b16 a[130:131], v33 offset:28992
  s_waitcnt lgkmcnt(4)
  ds_read_b64_tr_b16 a[52:53], v33 offset:36928
  ds_read_b64_tr_b16 a[54:55], v33 offset:37184
  ds_read_b64_tr_b16 a[132:133], v33 offset:41024
  ds_read_b64_tr_b16 a[134:135], v33 offset:41280
  ds_read_b64_tr_b16 a[56:57], v33 offset:49216
  ds_read_b64_tr_b16 a[58:59], v33 offset:49472
  ds_read_b64_tr_b16 a[136:137], v33 offset:53312
  ds_read_b64_tr_b16 a[138:139], v33 offset:53568
  s_waitcnt lgkmcnt(0)
  s_barrier
  s_waitcnt vmcnt(0)
  ds_write_b128 v36, v[124:127] offset:0
  ds_write_b128 v36, v[128:131] offset:4096
  ds_write_b128 v36, v[132:135] offset:8192
  ds_write_b128 v36, v[136:139] offset:12288
  ds_write_b128 v36, v[140:143] offset:16384
  ds_write_b128 v36, v[144:147] offset:20480
  s_waitcnt lgkmcnt(6)
  ds_write_b128 v36, v[148:151] offset:24576
  ds_write_b128 v36, v[152:155] offset:28672
  ds_write_b128 v36, v[156:159] offset:32768
  ds_write_b128 v36, v[160:163] offset:36864
  ds_write_b128 v36, v[164:167] offset:40960
  ds_write_b128 v36, v[168:171] offset:45056
  s_waitcnt lgkmcnt(6)
  ds_write_b128 v36, v[172:175] offset:49152
  ds_write_b128 v36, v[176:179] offset:53248
  ds_write_b128 v36, v[180:183] offset:57344
  s_waitcnt lgkmcnt(0)
  s_barrier
  ds_read_b64_tr_b16 a[60:61], v33 offset:61504
  ds_read_b64_tr_b16 a[62:63], v33 offset:61760
  ds_read_b64_tr_b16 a[140:141], v34 offset:4160
  ds_read_b64_tr_b16 a[142:143], v34 offset:4416
  ds_read_b64_tr_b16 a[64:65], v34 offset:12352
  ds_read_b64_tr_b16 a[66:67], v34 offset:12608
  ds_read_b64_tr_b16 a[144:145], v34 offset:16448
  ds_read_b64_tr_b16 a[146:147], v34 offset:16704
  ds_read_b64_tr_b16 a[68:69], v34 offset:24640
  ds_read_b64_tr_b16 a[70:71], v34 offset:24896
  ds_read_b64_tr_b16 a[148:149], v34 offset:28736
  ds_read_b64_tr_b16 a[150:151], v34 offset:28992
  s_waitcnt lgkmcnt(4)
  ds_read_b64_tr_b16 a[72:73], v34 offset:36928
  ds_read_b64_tr_b16 a[74:75], v34 offset:37184
  ds_read_b64_tr_b16 a[152:153], v34 offset:41024
  ds_read_b64_tr_b16 a[154:155], v34 offset:41280
  ds_read_b64_tr_b16 a[76:77], v34 offset:49216
  ds_read_b64_tr_b16 a[78:79], v34 offset:49472
  ds_read_b64_tr_b16 a[156:157], v34 offset:53312
  ds_read_b64_tr_b16 a[158:159], v34 offset:53568
  s_waitcnt lgkmcnt(0)
  s_barrier
  s_mul_i32 s56, s25, 245760
  s_mul_i32 s40, s26, 320
  s_add_u32 s56, s56, s40
  s_add_u32 s56, s56, 256
  v_lshrrev_b32 v4, 2, v1
  s_mov_b32 s55, 1280
  v_mul_lo_u32 v32, v4, s55
  v_and_b32 v4, 3, v1
  v_lshlrev_b32 v4, 4, v4
  v_add_u32 v32, v32, v4
  v_lshrrev_b32 v33, 4, v1
  v_lshlrev_b32 v33, 2, v33
  v_bfe_u32 v4, v1, 2, 2
  v_add_u32 v33, v33, v4
  v_mul_u32_u24 v33, 64, v33
  v_and_b32 v4, 3, v1
  v_lshlrev_b32 v4, 3, v4
  v_add_u32 v33, v33, v4
  v_add_u32 v33, s54, v33
  s_add_u32 s40, s56, 0
  s_add_u32 m0, s54, 0
  s_nop 0
  buffer_load_dwordx4 v32, s[20:23], s40 offen lds
  s_add_u32 s40, s56, 20480
  s_add_u32 m0, s54, 1024
  s_nop 0
  buffer_load_dwordx4 v32, s[20:23], s40 offen lds
  s_add_u32 s40, s56, 40960
  s_add_u32 m0, s54, 2048
  s_nop 0
  buffer_load_dwordx4 v32, s[20:23], s40 offen lds
  s_add_u32 s40, s56, 61440
  s_add_u32 m0, s54, 3072
  s_nop 0
  buffer_load_dwordx4 v32, s[20:23], s40 offen lds
  s_add_u32 s40, s56, 81920
  s_add_u32 m0, s54, 4096
  s_nop 0
  buffer_load_dwordx4 v32, s[20:23], s40 offen lds
  s_add_u32 s40, s56, 102400
  s_add_u32 m0, s54, 5120
  s_nop 0
  buffer_load_dwordx4 v32, s[20:23], s40 offen lds
  s_add_u32 s40, s56, 122880
  s_add_u32 m0, s54, 6144
  s_nop 0
  buffer_load_dwordx4 v32, s[20:23], s40 offen lds
  s_add_u32 s40, s56, 143360
  s_add_u32 m0, s54, 7168
  s_nop 0
  buffer_load_dwordx4 v32, s[20:23], s40 offen lds
  s_add_u32 s40, s56, 163840
  s_add_u32 m0, s54, 8192
  s_nop 0
  buffer_load_dwordx4 v32, s[20:23], s40 offen lds
  s_add_u32 s40, s56, 184320
  s_add_u32 m0, s54, 9216
  s_nop 0
  buffer_load_dwordx4 v32, s[20:23], s40 offen lds
  s_add_u32 s40, s56, 204800
  s_add_u32 m0, s54, 10240
  s_nop 0
  buffer_load_dwordx4 v32, s[20:23], s40 offen lds
  s_add_u32 s40, s56, 225280
  s_add_u32 m0, s54, 11264
  s_nop 0
  buffer_load_dwordx4 v32, s[20:23], s40 offen lds
  s_waitcnt vmcnt(8)
  ds_read_b64_tr_b16 a[160:161], v33 offset:0
  ds_read_b64_tr_b16 a[162:163], v33 offset:1024
  ds_read_b64_tr_b16 a[184:185], v33 offset:32
  ds_read_b64_tr_b16 a[186:187], v33 offset:1056
  ds_read_b64_tr_b16 a[164:165], v33 offset:2048
  ds_read_b64_tr_b16 a[166:167], v33 offset:3072
  ds_read_b64_tr_b16 a[188:189], v33 offset:2080
  ds_read_b64_tr_b16 a[190:191], v33 offset:3104
  s_waitcnt vmcnt(4)
  ds_read_b64_tr_b16 a[168:169], v33 offset:4096
  ds_read_b64_tr_b16 a[170:171], v33 offset:5120
  ds_read_b64_tr_b16 a[192:193], v33 offset:4128
  ds_read_b64_tr_b16 a[194:195], v33 offset:5152
  ds_read_b64_tr_b16 a[172:173], v33 offset:6144
  ds_read_b64_tr_b16 a[174:175], v33 offset:7168
  ds_read_b64_tr_b16 a[196:197], v33 offset:6176
  ds_read_b64_tr_b16 a[198:199], v33 offset:7200
  s_waitcnt vmcnt(0)
  ds_read_b64_tr_b16 a[176:177], v33 offset:8192
  ds_read_b64_tr_b16 a[178:179], v33 offset:9216
  ds_read_b64_tr_b16 a[200:201], v33 offset:8224
  ds_read_b64_tr_b16 a[202:203], v33 offset:9248
  ds_read_b64_tr_b16 a[180:181], v33 offset:10240
  ds_read_b64_tr_b16 a[182:183], v33 offset:11264
  ds_read_b64_tr_b16 a[204:205], v33 offset:10272
  ds_read_b64_tr_b16 a[206:207], v33 offset:11296
  s_waitcnt lgkmcnt(0)
  v_lshlrev_b32 v6, 4, v1
  v_lshlrev_b32 v29, 3, v1
  v_mov_b32 v31, 0
  s_mov_b32 s34, 0x00ff00ff
  s_mov_b32 s35, 0x00ff00ff
  s_mov_b32 s38, 0xff00ff00
  s_mov_b32 s39, 0xff00ff00
  s_mov_b32 s20, 0
  s_mov_b32 s21, -1
  v_mov_b32 v248, 0xff800000
  s_mov_b32 s16, 0x0000ffff
  s_mov_b32 s17, 0x0000ffff
  v_mov_b32 v21, 0x44444444
  v_mov_b32 v4, 0xeeeeeeee
  v_cndmask_b32 v21, v21, v4, s[38:39]
  s_mov_b32 s60, 0x3dd53b95
  s_mov_b32 s61, 400000
  s_mov_b32 s28, 0
  s_mov_b32 s80, 0
  s_mov_b32 s81, 0
  s_mov_b32 s82, 0
  s_mov_b32 s83, 0
  s_mov_b32 s84, 0
  s_mov_b32 s85, 0
  s_mov_b32 s86, 0
  s_mov_b32 s87, 0
  s_mov_b32 s92, 0
  s_mov_b32 s93, 0
  s_mov_b32 s94, 0
  s_lshr_b32 s40, s27, 5
  s_mul_i32 s40, s40, 10240
  s_add_u32 s40, s40, 627712
  v_add_u32 v23, s40, v6
  v_lshrrev_b32 v5, 13, v23
  v_lshlrev_b32 v5, 14, v5
  v_and_b32 v23, 0x1fff, v23
  v_or_b32 v23, v23, v5
  v_add_u32 v24, s40, v6
  v_add_u32 v24, 1024, v24
  v_lshrrev_b32 v5, 13, v24
  v_lshlrev_b32 v5, 14, v5
  v_and_b32 v24, 0x1fff, v24
  v_or_b32 v24, v24, v5
  v_add_u32 v25, s40, v6
  v_add_u32 v25, 2048, v25
  v_lshrrev_b32 v5, 13, v25
  v_lshlrev_b32 v5, 14, v5
  v_and_b32 v25, 0x1fff, v25
  v_or_b32 v25, v25, v5
  v_mov_b32 v4, 0x80000000
  v_cmp_gt_u32 vcc, 32, v1
  s_nop 1
  v_cndmask_b32 v25, v4, v25, vcc
  v_add_u32 v10, 5120, v6
  v_lshlrev_b32 v15, 7, v2
  v_and_b32 v4, 7, v1
  v_lshlrev_b32 v4, 4, v4
  v_add_u32 v15, v15, v4
  v_add_u32 v15, 2048, v15
  v_lshrrev_b32 v12, 1, v2
  v_mul_u32_u24 v12, 3072, v12
  v_lshlrev_b32 v4, 4, v3
  v_add_u32 v12, v12, v4
  v_and_b32 v4, 1, v2
  v_lshlrev_b32 v4, 3, v4
  v_add_u32 v12, v12, v4
  s_mul_i32 s40, s26, 3
  s_add_u32 s40, s40, 2
  s_lshl_b32 s40, s40, 8
  s_mul_i32 s41, s25, 9216
  s_add_u32 s40, s40, s41
  v_add_u32 v12, s40, v12
  v_lshrrev_b32 v4, 13, v12
  v_lshlrev_b32 v4, 14, v4
  v_and_b32 v12, 0x1fff, v12
  v_or_b32 v12, v12, v4
  s_add_u32 s40, s41, 4096
  v_add_u32 v16, s40, v6
  v_add_u32 v17, 1024, v16
  v_add_u32 v19, 14336, v6
  v_lshrrev_b32 v4, 13, v16
  v_lshlrev_b32 v4, 14, v4
  v_and_b32 v16, 0x1fff, v16
  v_or_b32 v16, v16, v4
  v_lshrrev_b32 v4, 13, v17
  v_lshlrev_b32 v4, 14, v4
  v_and_b32 v17, 0x1fff, v17
  v_or_b32 v17, v17, v4
  v_lshlrev_b32 v20, 2, v2
  v_bfe_u32 v4, v1, 2, 2
  v_add_u32 v20, v20, v4
  v_lshlrev_b32 v20, 4, v20
  v_and_b32 v4, 1, v1
  v_lshlrev_b32 v4, 3, v4
  v_add_u32 v20, v20, v4
  v_add_u32 v20, 10240, v20
  v_bfe_u32 v22, v1, 5, 1
  v_lshlrev_b32 v22, 5, v22
  v_bfe_u32 v4, v1, 4, 1
  v_lshlrev_b32 v4, 3, v4
  v_add_u32 v22, v22, v4
  v_bfe_u32 v4, v1, 2, 1
  v_add_u32 v22, v22, v4
  v_bfe_u32 v4, v1, 3, 1
  v_lshlrev_b32 v4, 4, v4
  v_add_u32 v22, v22, v4
  v_bfe_u32 v4, v1, 1, 1
  v_lshlrev_b32 v4, 1, v4
  v_add_u32 v22, v22, v4
  v_lshlrev_b32 v22, 4, v22
  v_and_b32 v4, 1, v1
  v_lshlrev_b32 v4, 3, v4
  v_add_u32 v22, v22, v4
  v_add_u32 v22, 16384, v22
  v_lshrrev_b32 v28, 1, v2
  v_lshlrev_b32 v28, 14, v28
  v_and_b32 v4, 1, v2
  v_lshlrev_b32 v4, 12, v4
  v_add_u32 v28, v28, v4
  v_and_b32 v4, 7, v1
  v_lshlrev_b32 v4, 4, v4
  v_add_u32 v28, v28, v4
  s_lshl_b32 s40, s25, 7
  v_add_u32 v28, s40, v28
  v_lshlrev_b32 v9, 10, v2
  v_and_b32 v4, 7, v1
  v_lshlrev_b32 v4, 4, v4
  v_add_u32 v9, v9, v4
  s_and_b32 s40, s25, 7
  s_lshl_b32 s40, s40, 7
  v_add_u32 v9, s40, v9
  s_lshr_b32 s76, s27, 5
  s_mul_i32 s76, s76, 81920
  s_mul_i32 s40, s26, 20480
  s_add_u32 s76, s76, s40
  s_add_u32 s76, s76, 16384
  s_lshr_b32 s40, s76, 13
  s_lshl_b32 s40, s40, 14
  s_and_b32 s76, s76, 0x1fff
  s_or_b32 s76, s76, s40
  s_add_u32 s76, s76, 589824
  s_mul_i32 s48, s26, 163840
  s_add_u32 s48, s48, 720896
  s_mul_i32 s40, s25, 12288
  s_add_u32 s44, s40, 37748736
  s_mul_i32 s40, s25, 40
  s_mul_i32 s41, s26, 10
  s_add_u32 s40, s40, s41
  s_add_u32 s40, s40, 8
  s_lshl_b32 s45, s40, 10
  s_add_u32 s45, s45, 132120576
  s_lshl_b32 s46, s40, 8
  s_add_u32 s46, s46, 111149056
  s_mul_i32 s47, s25, 3072
  s_add_u32 s47, s47, 99614720
  s_mov_b32 s49, 20480
  s_mov_b32 s50, 20480
  s_lshl_b32 s53, s27, 7
  s_add_u32 s53, s53, 8392704
  s_and_b32 s56, s27, 31
  s_cmp_lt_u32 s56, 16
  s_cselect_b32 s51, 1, 0
  s_add_u32 s56, s56, 64
  s_lshr_b32 s52, s56, 1
  s_lshl_b32 s52, s52, 14
  s_and_b32 s40, s56, 1
  s_lshl_b32 s40, s40, 12
  s_add_u32 s52, s52, s40
  s_add_u32 s52, s52, 589824
  s_lshr_b32 s72, s27, 5
  s_mul_i32 s72, s72, 81920
  s_lshl_b32 s40, s56, 10
  s_add_u32 s72, s72, s40
  s_lshr_b32 s40, s72, 13
  s_lshl_b32 s40, s40, 14
  s_and_b32 s72, s72, 0x1fff
  s_or_b32 s72, s72, s40
  s_add_u32 s72, s72, 589824
  s_lshr_b32 s40, s27, 5
  s_mul_i32 s40, s40, 10240
  s_add_u32 s40, s40, 622592
  s_lshl_b32 s42, s56, 7
  s_add_u32 s40, s40, s42
  v_add_u32 v30, s40, v6
  v_lshrrev_b32 v4, 13, v30
  v_lshlrev_b32 v4, 14, v4
  v_and_b32 v30, 0x1fff, v30
  v_or_b32 v30, v30, v4
  v_mov_b32 v4, 0x80000000
  v_cmp_gt_u32 vcc, 8, v1
  s_nop 1
  v_cndmask_b32 v30, v4, v30, vcc
  v_mov_b32 v240, 0
  v_mov_b32 v4, 0x3f80
  v_cmp_eq_u32 vcc, 0, v3
  s_nop 1
  v_cndmask_b32 v240, v240, v4, vcc
  v_mov_b32 v4, 0x3f800000
  v_cmp_eq_u32 vcc, 1, v3
  s_nop 1
  v_cndmask_b32 v240, v240, v4, vcc
  v_mov_b32 v241, 0
  v_mov_b32 v4, 0x3f80
  v_cmp_eq_u32 vcc, 2, v3
  s_nop 1
  v_cndmask_b32 v241, v241, v4, vcc
  v_mov_b32 v4, 0x3f800000
  v_cmp_eq_u32 vcc, 3, v3
  s_nop 1
  v_cndmask_b32 v241, v241, v4, vcc
  v_mov_b32 v242, 0
  v_mov_b32 v4, 0x3f80
  v_cmp_eq_u32 vcc, 4, v3
  s_nop 1
  v_cndmask_b32 v242, v242, v4, vcc
  v_mov_b32 v4, 0x3f800000
  v_cmp_eq_u32 vcc, 5, v3
  s_nop 1
  v_cndmask_b32 v242, v242, v4, vcc
  v_mov_b32 v243, 0
  v_mov_b32 v4, 0x3f80
  v_cmp_eq_u32 vcc, 6, v3
  s_nop 1
  v_cndmask_b32 v243, v243, v4, vcc
  v_mov_b32 v4, 0x3f800000
  v_cmp_eq_u32 vcc, 7, v3
  s_nop 1
  v_cndmask_b32 v243, v243, v4, vcc
  s_mul_i32 s40, s25, 6
  s_lshr_b32 s41, s40, 3
  s_add_u32 s40, s40, 5
  s_lshr_b32 s40, s40, 3
  v_mov_b32 v249, s40
  v_mov_b32 v4, s41
  v_and_b32 v5, 1, v1
  v_cmp_eq_u32 vcc, 0, v5
  s_nop 1
  v_cndmask_b32 v249, v249, v4, vcc
  v_cmp_lt_u32 vcc, 1, v1
  v_mov_b32 v4, 24
  s_nop 0
  v_cndmask_b32 v4, 0, v4, vcc
  v_add_u32 v249, v249, v4
  v_lshlrev_b32 v249, 7, v249
  v_add_u32 v249, 8437760, v249
  s_mov_b32 s33, 0
  s_mov_b32 s22, 0
  s_add_u32 s40, s25, 94
  s_lshl_b32 s40, s40, 7
  s_add_u32 s40, s40, 8437760
  v_mov_b32 v11, s40
  s_load_dwordx2 s[96:97], s[0:1], 96
  v_and_b32 v5, 15, v1
  v_lshlrev_b32 v5, 2, v5
  s_mov_b32 s43, 0
  s_waitcnt lgkmcnt(0)
RM2_MD:
  global_load_dword v4, v5, s[96:97] sc1
  s_waitcnt vmcnt(0)
  s_mov_b32 s40, 0
  s_mov_b32 s57, 1
  v_readlane_b32 s41, v4, 0
  s_nop 0
  s_add_u32 s40, s40, s41
  s_cmp_eq_u32 s41, 32
  s_cselect_b32 s57, s57, 0
  v_readlane_b32 s41, v4, 1
  s_nop 0
  s_add_u32 s40, s40, s41
  s_cmp_eq_u32 s41, 32
  s_cselect_b32 s57, s57, 0
  v_readlane_b32 s41, v4, 2
  s_nop 0
  s_add_u32 s40, s40, s41
  s_cmp_eq_u32 s41, 32
  s_cselect_b32 s57, s57, 0
  v_readlane_b32 s41, v4, 3
  s_nop 0
  s_add_u32 s40, s40, s41
  s_cmp_eq_u32 s41, 32
  s_cselect_b32 s57, s57, 0
  v_readlane_b32 s41, v4, 4
  s_nop 0
  s_add_u32 s40, s40, s41
  s_cmp_eq_u32 s41, 32
  s_cselect_b32 s57, s57, 0
  v_readlane_b32 s41, v4, 5
  s_nop 0
  s_add_u32 s40, s40, s41
  s_cmp_eq_u32 s41, 32
  s_cselect_b32 s57, s57, 0
  v_readlane_b32 s41, v4, 6
  s_nop 0
  s_add_u32 s40, s40, s41
  s_cmp_eq_u32 s41, 32
  s_cselect_b32 s57, s57, 0
  v_readlane_b32 s41, v4, 7
  s_nop 0
  s_add_u32 s40, s40, s41
  s_cmp_eq_u32 s41, 32
  s_cselect_b32 s57, s57, 0
  v_readlane_b32 s41, v4, 12
  v_readlane_b32 s42, v4, 13
  s_cmp_ge_u32 s40, 256
  s_nop 2
  s_cbranch_scc0 RM2_MDN
  s_cmp_ge_u32 s41, 80
  s_cbranch_scc0 RM2_MDN
  s_and_b32 s40, s42, 0xaa
  s_cmp_eq_u32 s40, 0xaa
  s_cbranch_scc1 RM2_POLOK
RM2_MDN:
  s_sleep 4
  s_add_u32 s43, s43, 1
  s_cmp_lt_u32 s43, 0x200000
  s_cbranch_scc1 RM2_MD
  s_mov_b32 s57, 0
RM2_POLOK:
  s_and_b32 s40, s42, 0x55
  s_xor_b32 s40, s40, 0x44
  s_bcnt1_i32_b32 s41, s40
  s_cmp_ge_u32 s41, 3
  s_cselect_b32 s40, 0x55, s40
  s_cmp_le_u32 s41, 1
  s_cselect_b32 s40, 0, s40
  s_xor_b32 s42, s40, 0x44
  s_bfe_u32 s40, s42, 65536
  s_lshl_b32 s40, s40, 13
  s_add_u32 s30, s40, 0
  s_bfe_u32 s40, s42, 65538
  s_lshl_b32 s40, s40, 13
  s_add_u32 s31, s40, 2097152
  s_bfe_u32 s40, s42, 65540
  s_lshl_b32 s40, s40, 13
  s_add_u32 s32, s40, 4194304
  s_bfe_u32 s40, s42, 65542
  s_lshl_b32 s40, s40, 13
  s_add_u32 s29, s40, 6291456
  s_barrier
  ds_write_b128 v10, v[200:203]
  ds_write_b128 v10, v[204:207] offset:1024
  s_mov_b32 exec_hi, 0
  ds_write_b128 v10, v[208:211] offset:2048
  s_mov_b64 exec, -1
  s_mov_b32 s88, 0
  s_mov_b32 s89, 0
  s_xor_b32 s49, s49, 57344
  s_waitcnt vmcnt(0) lgkmcnt(0)
  s_barrier
  v_add_u32 v4, s50, v6
  ds_read_b128 v[148:151], v4 offset:12288
  ds_read_b128 v[152:155], v4 offset:13312
  ds_read_b128 v[156:159], v4 offset:14336
  ds_read_b128 v[160:163], v4 offset:15360
  ds_read_b128 v[164:167], v4 offset:16384
  ds_read_b128 v[168:171], v4 offset:17408
  ds_read_b128 v[172:175], v4 offset:18432
  ds_read_b128 v[176:179], v4 offset:19456
  s_waitcnt lgkmcnt(4)
  ds_read_b128 v[180:183], v4 offset:20480
  ds_read_b128 v[184:187], v4 offset:21504
  ds_read_b128 v[188:191], v4 offset:22528
  ds_read_b128 v[192:195], v4 offset:23552
  s_waitcnt lgkmcnt(0)
  ds_read_b128 v[100:103], v4 offset:0
  ds_read_b128 v[104:107], v4 offset:1024
  ds_read_b128 v[108:111], v4 offset:2048
  ds_read_b128 v[112:115], v4 offset:3072
  ds_read_b128 v[116:119], v4 offset:4096
  ds_read_b128 v[120:123], v4 offset:5120
  ds_read_b128 v[124:127], v4 offset:6144
  ds_read_b128 v[128:131], v4 offset:7168
  ds_read_b128 v[132:135], v4 offset:8192
  ds_read_b128 v[136:139], v4 offset:9216
  ds_read_b128 v[140:143], v4 offset:10240
  ds_read_b128 v[144:147], v4 offset:11264
  v_mfma_f32_16x16x32_bf16 v[48:51], v[148:151], a[160:163], 0
  v_mfma_f32_16x16x32_bf16 v[52:55], v[172:175], a[160:163], 0
  v_mfma_f32_16x16x32_bf16 v[56:59], v[148:151], a[184:187], 0
  v_mfma_f32_16x16x32_bf16 v[60:63], v[172:175], a[184:187], 0
  v_mfma_f32_16x16x32_bf16 v[48:51], v[152:155], a[164:167], v[48:51]
  v_mfma_f32_16x16x32_bf16 v[52:55], v[176:179], a[164:167], v[52:55]
  v_mfma_f32_16x16x32_bf16 v[56:59], v[152:155], a[188:191], v[56:59]
  v_mfma_f32_16x16x32_bf16 v[60:63], v[176:179], a[188:191], v[60:63]
  v_mfma_f32_16x16x32_bf16 v[48:51], v[156:159], a[168:171], v[48:51]
  v_mfma_f32_16x16x32_bf16 v[52:55], v[180:183], a[168:171], v[52:55]
  v_mfma_f32_16x16x32_bf16 v[56:59], v[156:159], a[192:195], v[56:59]
  v_mfma_f32_16x16x32_bf16 v[60:63], v[180:183], a[192:195], v[60:63]
  v_mfma_f32_16x16x32_bf16 v[48:51], v[160:163], a[172:175], v[48:51]
  v_mfma_f32_16x16x32_bf16 v[52:55], v[184:187], a[172:175], v[52:55]
  v_mfma_f32_16x16x32_bf16 v[56:59], v[160:163], a[196:199], v[56:59]
  v_mfma_f32_16x16x32_bf16 v[60:63], v[184:187], a[196:199], v[60:63]
  v_mfma_f32_16x16x32_bf16 v[48:51], v[164:167], a[176:179], v[48:51]
  v_mfma_f32_16x16x32_bf16 v[52:55], v[188:191], a[176:179], v[52:55]
  v_mfma_f32_16x16x32_bf16 v[56:59], v[164:167], a[200:203], v[56:59]
  v_mfma_f32_16x16x32_bf16 v[60:63], v[188:191], a[200:203], v[60:63]
  v_mfma_f32_16x16x32_bf16 v[48:51], v[168:171], a[180:183], v[48:51]
  v_mfma_f32_16x16x32_bf16 v[52:55], v[192:195], a[180:183], v[52:55]
  v_mfma_f32_16x16x32_bf16 v[56:59], v[168:171], a[204:207], v[56:59]
  v_mfma_f32_16x16x32_bf16 v[60:63], v[192:195], a[204:207], v[60:63]
  s_nop 4
  v_cvt_pk_bf16_f32 v232, v48, v49
  v_cvt_pk_bf16_f32 v233, v50, v51
  v_cvt_pk_bf16_f32 v234, v52, v53
  v_cvt_pk_bf16_f32 v235, v54, v55
  s_add_u32 s40, s45, 0
  v_cvt_pk_bf16_f32 v236, v56, v57
  v_cvt_pk_bf16_f32 v237, v58, v59
  v_cvt_pk_bf16_f32 v238, v60, v61
  v_cvt_pk_bf16_f32 v239, v62, v63
  s_add_u32 s40, s45, 1024
  s_add_u32 s45, s45, 1310720
  s_waitcnt lgkmcnt(0)
  s_xor_b32 s50, s50, 57344
  s_cmp_eq_u32 s57, 0
  s_cbranch_scc1 RM2S_B0
  s_branch RM2F_B0
RM2F_LOOP:
  s_mov_b32 s43, 0
RM2F_AGP:
  buffer_load_dwordx4 v[48:51], v23, s[4:7], s29 offen sc1
  buffer_load_dwordx4 v[52:55], v24, s[4:7], s29 offen sc1
  buffer_load_dwordx4 v[56:59], v25, s[4:7], s29 offen sc1
  s_waitcnt vmcnt(0)
  v_max3_u32 v4, v48, v49, v50
  v_max3_u32 v4, v4, v51, v52
  v_max3_u32 v4, v4, v53, v54
  v_max3_u32 v4, v4, v55, v56
  v_max3_u32 v4, v4, v57, v58
  v_max_u32 v4, v4, v59
  v_cmp_eq_u32 vcc, -1, v4
  s_nop 3
  s_cbranch_vccz RM2F_AGP_OK
  s_add_u32 s43, s43, 1
  s_cmp_lt_u32 s43, s61
  s_cbranch_scc1 RM2F_AGP
  s_mov_b32 s61, 0
RM2F_AGP_OK:
  ds_write_b128 v10, v[48:51]
  ds_write_b128 v10, v[52:55] offset:1024
  s_mov_b32 exec_hi, 0
  ds_write_b128 v10, v[56:59] offset:2048
  s_mov_b64 exec, -1
RM2F_B0:
  s_waitcnt lgkmcnt(0)
  s_barrier
  s_memtime s[98:99]
  ds_read_b128 v[48:51], v6 offset:0
  ds_read_b128 v[52:55], v6 offset:1024
  ds_read_b128 v[56:59], v6 offset:2048
  ds_read_b128 v[60:63], v6 offset:3072
  ds_read_b128 v[64:67], v6 offset:4096
  ds_read_b128 v[68:71], v6 offset:5120
  ds_read_b128 v[72:75], v6 offset:6144
  ds_read_b128 v[76:79], v6 offset:7168
  ds_read_b128 v[80:83], v6 offset:8192
  ds_read_b128 v[84:87], v6 offset:9216
  v_mov_b32 v88, 0
  v_mov_b32 v89, 0
  v_mov_b32 v90, 0
  v_mov_b32 v91, 0
  v_mov_b32 v92, 0
  v_mov_b32 v93, 0
  v_mov_b32 v94, 0
  v_mov_b32 v95, 0
  s_waitcnt lgkmcnt(9)
  v_smfmac_f32_16x16x64_bf16 v[88:91], v[48:51], a[0:7], v21
  v_smfmac_f32_16x16x64_bf16 v[92:95], v[48:51], a[80:87], v21
  s_waitcnt lgkmcnt(8)
  v_smfmac_f32_16x16x64_bf16 v[88:91], v[52:55], a[8:15], v21
  v_smfmac_f32_16x16x64_bf16 v[92:95], v[52:55], a[88:95], v21
  s_waitcnt lgkmcnt(7)
  v_smfmac_f32_16x16x64_bf16 v[88:91], v[56:59], a[16:23], v21
  v_smfmac_f32_16x16x64_bf16 v[92:95], v[56:59], a[96:103], v21
  s_waitcnt lgkmcnt(6)
  v_smfmac_f32_16x16x64_bf16 v[88:91], v[60:63], a[24:31], v21
  v_smfmac_f32_16x16x64_bf16 v[92:95], v[60:63], a[104:111], v21
  s_waitcnt lgkmcnt(5)
  v_smfmac_f32_16x16x64_bf16 v[88:91], v[64:67], a[32:39], v21
  v_smfmac_f32_16x16x64_bf16 v[92:95], v[64:67], a[112:119], v21
  s_waitcnt lgkmcnt(4)
  v_smfmac_f32_16x16x64_bf16 v[88:91], v[68:71], a[40:47], v21
  v_smfmac_f32_16x16x64_bf16 v[92:95], v[68:71], a[120:127], v21
  s_waitcnt lgkmcnt(3)
  v_smfmac_f32_16x16x64_bf16 v[88:91], v[72:75], a[48:55], v21
  v_smfmac_f32_16x16x64_bf16 v[92:95], v[72:75], a[128:135], v21
  s_waitcnt lgkmcnt(2)
  v_smfmac_f32_16x16x64_bf16 v[88:91], v[76:79], a[56:63], v21
  v_smfmac_f32_16x16x64_bf16 v[92:95], v[76:79], a[136:143], v21
  s_waitcnt lgkmcnt(1)
  v_smfmac_f32_16x16x64_bf16 v[88:91], v[80:83], a[64:71], v21
  v_smfmac_f32_16x16x64_bf16 v[92:95], v[80:83], a[144:151], v21
  s_waitcnt lgkmcnt(0)
  v_smfmac_f32_16x16x64_bf16 v[88:91], v[84:87], a[72:79], v21
  v_smfmac_f32_16x16x64_bf16 v[92:95], v[84:87], a[152:159], v21
  s_nop 7
  v_permlane32_swap_b32 v88, v92
  v_permlane32_swap_b32 v89, v93
  v_permlane32_swap_b32 v90, v94
  v_permlane32_swap_b32 v91, v95
  v_add_f32 v88, v88, v92
  v_add_f32 v89, v89, v93
  v_add_f32 v90, v90, v94
  v_add_f32 v91, v91, v95
  v_cvt_pk_bf16_f32 v252, v88, v89
  v_cvt_pk_bf16_f32 v253, v90, v91
  buffer_store_dwordx2 v[252:253], v12, s[4:7], s30 offen
  v_mov_b32 v48, 0
  v_mov_b32 v49, 0
  v_mov_b32 v50, 0
  v_mov_b32 v51, 0
  v_mov_b32 v52, 0
  v_mov_b32 v53, 0
  v_mov_b32 v54, 0
  v_mov_b32 v55, 0
  s_mov_b32 s43, 0
  s_nop 0
RM2F_AP:
  buffer_load_dwordx4 v[32:35], v16, s[4:7], s30 offen sc1
  buffer_load_dwordx4 v[36:39], v17, s[4:7], s30 offen sc1
  s_waitcnt vmcnt(0)
  v_max3_u32 v4, v32, v33, v34
  v_max3_u32 v4, v4, v35, v36
  v_max3_u32 v4, v4, v37, v38
  v_max_u32 v4, v4, v39
  v_cmp_eq_u32 vcc, -1, v4
  s_nop 3
  s_cbranch_vccz RM2F_AP_OK
  s_add_u32 s43, s43, 1
  s_cmp_lt_u32 s43, s61
  s_cbranch_scc1 RM2F_AP
  s_mov_b32 s61, 0
RM2F_AP_OK:
  ds_write_b128 v19, v[32:35]
  ds_write_b128 v19, v[36:39] offset:1024
  s_waitcnt lgkmcnt(0)
  s_barrier
  ds_read_b64_tr_b16 v[148:149], v20 offset:0
  ds_read_b64_tr_b16 v[150:151], v20 offset:256
  ds_read_b64_tr_b16 v[172:173], v20 offset:3072
  ds_read_b64_tr_b16 v[174:175], v20 offset:3328
  ds_read_b64_tr_b16 v[152:153], v20 offset:512
  ds_read_b64_tr_b16 v[154:155], v20 offset:768
  ds_read_b64_tr_b16 v[176:177], v20 offset:3584
  ds_read_b64_tr_b16 v[178:179], v20 offset:3840
  ds_read_b64_tr_b16 v[156:157], v20 offset:1024
  ds_read_b64_tr_b16 v[158:159], v20 offset:1280
  ds_read_b64_tr_b16 v[180:181], v20 offset:4096
  ds_read_b64_tr_b16 v[182:183], v20 offset:4352
  s_waitcnt lgkmcnt(8)
  v_mfma_f32_16x16x32_bf16 v[224:227], v[100:103], v[148:151], 0
  v_mfma_f32_16x16x32_bf16 v[228:231], v[124:127], v[148:151], 0
  v_mfma_f32_16x16x32_bf16 v[220:223], v[172:175], v[148:151], 0
  ds_read_b64_tr_b16 v[160:161], v20 offset:1536
  ds_read_b64_tr_b16 v[162:163], v20 offset:1792
  ds_read_b64_tr_b16 v[184:185], v20 offset:4608
  ds_read_b64_tr_b16 v[186:187], v20 offset:4864
  s_waitcnt lgkmcnt(8)
  v_mfma_f32_16x16x32_bf16 v[224:227], v[104:107], v[152:155], v[224:227]
  v_mfma_f32_16x16x32_bf16 v[228:231], v[128:131], v[152:155], v[228:231]
  v_mfma_f32_16x16x32_bf16 v[220:223], v[176:179], v[152:155], v[220:223]
  ds_read_b64_tr_b16 v[164:165], v20 offset:2048
  ds_read_b64_tr_b16 v[166:167], v20 offset:2304
  ds_read_b64_tr_b16 v[188:189], v20 offset:5120
  ds_read_b64_tr_b16 v[190:191], v20 offset:5376
  s_waitcnt lgkmcnt(8)
  v_mfma_f32_16x16x32_bf16 v[224:227], v[108:111], v[156:159], v[224:227]
  v_mfma_f32_16x16x32_bf16 v[228:231], v[132:135], v[156:159], v[228:231]
  v_mfma_f32_16x16x32_bf16 v[220:223], v[180:183], v[156:159], v[220:223]
  ds_read_b64_tr_b16 v[168:169], v20 offset:2560
  ds_read_b64_tr_b16 v[170:171], v20 offset:2816
  ds_read_b64_tr_b16 v[192:193], v20 offset:5632
  ds_read_b64_tr_b16 v[194:195], v20 offset:5888
  s_waitcnt lgkmcnt(8)
  v_mfma_f32_16x16x32_bf16 v[224:227], v[112:115], v[160:163], v[224:227]
  v_mfma_f32_16x16x32_bf16 v[228:231], v[136:139], v[160:163], v[228:231]
  v_mfma_f32_16x16x32_bf16 v[220:223], v[184:187], v[160:163], v[220:223]
  s_waitcnt lgkmcnt(4)
  v_mfma_f32_16x16x32_bf16 v[224:227], v[116:119], v[164:167], v[224:227]
  v_mfma_f32_16x16x32_bf16 v[228:231], v[140:143], v[164:167], v[228:231]
  v_mfma_f32_16x16x32_bf16 v[220:223], v[188:191], v[164:167], v[220:223]
  s_waitcnt lgkmcnt(0)
  v_mfma_f32_16x16x32_bf16 v[224:227], v[120:123], v[168:171], v[224:227]
  v_mfma_f32_16x16x32_bf16 v[228:231], v[144:147], v[168:171], v[228:231]
  v_mfma_f32_16x16x32_bf16 v[220:223], v[192:195], v[168:171], v[220:223]
  s_barrier
  s_memtime s[96:97]
  ds_read_b64_tr_b16 v[196:197], v22 offset:0
  ds_read_b64_tr_b16 v[198:199], v22 offset:64
  ds_read_b64_tr_b16 v[200:201], v22 offset:1024
  ds_read_b64_tr_b16 v[202:203], v22 offset:1088
  ds_read_b64_tr_b16 v[204:205], v22 offset:2048
  ds_read_b64_tr_b16 v[206:207], v22 offset:2112
  v_cndmask_b32 v148, v224, v228, s[38:39]
  v_cndmask_b32 v149, v225, v229, s[38:39]
  s_waitcnt lgkmcnt(4)
  v_smfmac_f32_16x16x64_bf16 v[48:51], v[196:199], a[160:167], v21
  v_cndmask_b32 v150, v226, v230, s[38:39]
  v_smfmac_f32_16x16x64_bf16 v[52:55], v[196:199], a[184:191], v21
  v_cndmask_b32 v151, v227, v231, s[38:39]
  s_waitcnt lgkmcnt(2)
  v_smfmac_f32_16x16x64_bf16 v[48:51], v[200:203], a[168:175], v21
  v_cndmask_b32 v152, v220, v222, s[38:39]
  v_smfmac_f32_16x16x64_bf16 v[52:55], v[200:203], a[192:199], v21
  v_cndmask_b32 v153, v221, v223, s[38:39]
  s_waitcnt lgkmcnt(0)
  v_smfmac_f32_16x16x64_bf16 v[48:51], v[204:207], a[176:183], v21
  v_max3_f32 v154, v148, v149, v150
  v_smfmac_f32_16x16x64_bf16 v[52:55], v[204:207], a[200:207], v21
  v_max3_f32 v155, v151, v152, v153
  v_max_f32 v154, v154, v155
  s_nop 1
  v_max_f32_dpp v154, v154, v154 row_ror:8 row_mask:0xf bank_mask:0xf
  v_mov_b32 v155, v154
  s_nop 1
  v_permlane16_swap_b32 v154, v155
  v_max_f32 v154, v154, v155
  v_mov_b32 v155, v154
  s_nop 1
  v_permlane32_swap_b32 v154, v155
  v_max_f32 v154, v154, v155
  v_mul_f32 v154, s60, v154
  v_fma_f32 v148, v148, s60, -v154
  v_fma_f32 v149, v149, s60, -v154
  v_fma_f32 v150, v150, s60, -v154
  v_fma_f32 v151, v151, s60, -v154
  v_fma_f32 v152, v152, s60, -v154
  v_fma_f32 v153, v153, s60, -v154
  v_exp_f32 v148, v148
  v_exp_f32 v149, v149
  v_exp_f32 v150, v150
  v_exp_f32 v151, v151
  v_exp_f32 v152, v152
  v_exp_f32 v153, v153
  v_cvt_pk_bf16_f32 v160, v148, v149
  v_cvt_pk_bf16_f32 v161, v150, v151
  v_cvt_pk_bf16_f32 v158, v152, v153
  v_mov_b32_dpp v162, v160 row_ror:8 row_mask:0xf bank_mask:0xf
  v_mov_b32_dpp v163, v161 row_ror:8 row_mask:0xf bank_mask:0xf
  v_mov_b32_dpp v159, v158 row_ror:8 row_mask:0xf bank_mask:0xf
  s_nop 0
  v_mfma_f32_16x16x32_bf16 v[64:67], v[232:235], v[160:163], 0
  v_cvt_pk_bf16_f32 v220, v48, v49
  v_cvt_pk_bf16_f32 v221, v50, v51
  v_mfma_f32_16x16x32_bf16 v[68:71], v[236:239], v[160:163], 0
  v_cvt_pk_bf16_f32 v222, v52, v53
  v_cvt_pk_bf16_f32 v223, v54, v55
  v_mfma_f32_16x16x16_bf16 v[64:67], v[220:221], v[158:159], v[64:67]
  v_cndmask_b32 v152, v152, v31, s[20:21]
  v_cndmask_b32 v153, v153, v31, s[20:21]
  v_add_f32 v156, v148, v149
  v_add_f32 v155, v150, v151
  v_mfma_f32_16x16x16_bf16 v[68:71], v[222:223], v[158:159], v[68:71]
  v_add_f32 v157, v152, v153
  v_add_f32 v156, v156, v155
  v_add_f32 v156, v156, v157
  s_nop 1
  v_add_f32_dpp v156, v156, v156 row_ror:8 row_mask:0xf bank_mask:0xf
  v_mov_b32 v155, v156
  s_nop 1
  v_permlane16_swap_b32 v156, v155
  v_add_f32 v156, v156, v155
  v_mov_b32 v155, v156
  s_nop 1
  v_permlane32_swap_b32 v156, v155
  v_add_f32 v156, v156, v155
  v_rcp_f32 v156, v156
  s_nop 0
  v_mov_b32 v157, v156
  v_pk_mul_f32 v[64:65], v[64:65], v[156:157]
  v_pk_mul_f32 v[66:67], v[66:67], v[156:157]
  v_pk_mul_f32 v[68:69], v[68:69], v[156:157]
  v_pk_mul_f32 v[70:71], v[70:71], v[156:157]
  v_cvt_pk_bf16_f32 v80, v64, v65
  v_cvt_pk_bf16_f32 v81, v66, v67
  v_cvt_pk_bf16_f32 v82, v68, v69
  v_cvt_pk_bf16_f32 v83, v70, v71
  s_add_u32 s40, s30, s48
  s_mov_b64 exec, s[34:35]
  buffer_store_dwordx4 v[80:83], v28, s[4:7], s40 offen sc1
  s_mov_b64 exec, -1
  s_mov_b64 exec, s[34:35]
  s_cmp_lg_u32 s26, 0
  s_cbranch_scc1 RM2F_NOKM
  buffer_store_dwordx4 v[188:191], v15, s[4:7], s47 offen offset:0 sc1
  buffer_store_dwordx4 v[192:195], v15, s[4:7], s47 offen offset:512 sc1
  s_nop 1
RM2F_NOKM:
  s_mov_b64 exec, -1
  s_add_u32 s47, s47, 98304
  v_mov_b32 v64, v48
  v_mov_b32 v65, v49
  v_mov_b32 v66, v50
  v_mov_b32 v67, v51
  v_permlane32_swap_b32 v48, v64
  v_permlane32_swap_b32 v49, v65
  v_permlane32_swap_b32 v50, v66
  v_permlane32_swap_b32 v51, v67
  v_add_f32 v48, v48, v64
  v_add_f32 v49, v49, v65
  v_add_f32 v50, v50, v66
  v_add_f32 v51, v51, v67
  v_cvt_pk_bf16_f32 v220, v48, v49
  v_cvt_pk_bf16_f32 v221, v50, v51
  v_mov_b32 v64, v52
  v_mov_b32 v65, v53
  v_mov_b32 v66, v54
  v_mov_b32 v67, v55
  v_permlane32_swap_b32 v52, v64
  v_permlane32_swap_b32 v53, v65
  v_permlane32_swap_b32 v54, v66
  v_permlane32_swap_b32 v55, v67
  v_add_f32 v52, v52, v64
  v_add_f32 v53, v53, v65
  v_add_f32 v54, v54, v66
  v_add_f32 v55, v55, v67
  v_cvt_pk_bf16_f32 v222, v52, v53
  v_cvt_pk_bf16_f32 v223, v54, v55
  s_mov_b32 exec_hi, 0
  buffer_store_dwordx2 v[220:221], v29, s[4:7], s46 offen offset:0 sc1
  buffer_store_dwordx2 v[222:223], v29, s[4:7], s46 offen offset:256 sc1
  s_mov_b64 exec, -1
  s_add_u32 s46, s46, 327680
  s_add_u32 s28, s28, 1
  s_cmp_ge_u32 s28, 64
  s_cbranch_scc1 RM2F_DONE
  v_add_u32 v4, s50, v6
  ds_read_b128 v[148:151], v4 offset:12288
  ds_read_b128 v[152:155], v4 offset:13312
  ds_read_b128 v[156:159], v4 offset:14336
  ds_read_b128 v[160:163], v4 offset:15360
  ds_read_b128 v[164:167], v4 offset:16384
  ds_read_b128 v[168:171], v4 offset:17408
  ds_read_b128 v[172:175], v4 offset:18432
  ds_read_b128 v[176:179], v4 offset:19456
  s_waitcnt lgkmcnt(4)
  ds_read_b128 v[180:183], v4 offset:20480
  ds_read_b128 v[184:187], v4 offset:21504
  ds_read_b128 v[188:191], v4 offset:22528
  ds_read_b128 v[192:195], v4 offset:23552
  s_waitcnt lgkmcnt(0)
  ds_read_b128 v[100:103], v4 offset:0
  ds_read_b128 v[104:107], v4 offset:1024
  ds_read_b128 v[108:111], v4 offset:2048
  ds_read_b128 v[112:115], v4 offset:3072
  ds_read_b128 v[116:119], v4 offset:4096
  ds_read_b128 v[120:123], v4 offset:5120
  ds_read_b128 v[124:127], v4 offset:6144
  ds_read_b128 v[128:131], v4 offset:7168
  ds_read_b128 v[132:135], v4 offset:8192
  ds_read_b128 v[136:139], v4 offset:9216
  ds_read_b128 v[140:143], v4 offset:10240
  ds_read_b128 v[144:147], v4 offset:11264
  v_mfma_f32_16x16x32_bf16 v[48:51], v[148:151], a[160:163], 0
  v_mfma_f32_16x16x32_bf16 v[52:55], v[172:175], a[160:163], 0
  v_mfma_f32_16x16x32_bf16 v[56:59], v[148:151], a[184:187], 0
  v_mfma_f32_16x16x32_bf16 v[60:63], v[172:175], a[184:187], 0
  v_mfma_f32_16x16x32_bf16 v[48:51], v[152:155], a[164:167], v[48:51]
  v_mfma_f32_16x16x32_bf16 v[52:55], v[176:179], a[164:167], v[52:55]
  v_mfma_f32_16x16x32_bf16 v[56:59], v[152:155], a[188:191], v[56:59]
  v_mfma_f32_16x16x32_bf16 v[60:63], v[176:179], a[188:191], v[60:63]
  v_mfma_f32_16x16x32_bf16 v[48:51], v[156:159], a[168:171], v[48:51]
  v_mfma_f32_16x16x32_bf16 v[52:55], v[180:183], a[168:171], v[52:55]
  v_mfma_f32_16x16x32_bf16 v[56:59], v[156:159], a[192:195], v[56:59]
  v_mfma_f32_16x16x32_bf16 v[60:63], v[180:183], a[192:195], v[60:63]
  v_mfma_f32_16x16x32_bf16 v[48:51], v[160:163], a[172:175], v[48:51]
  v_mfma_f32_16x16x32_bf16 v[52:55], v[184:187], a[172:175], v[52:55]
  v_mfma_f32_16x16x32_bf16 v[56:59], v[160:163], a[196:199], v[56:59]
  v_mfma_f32_16x16x32_bf16 v[60:63], v[184:187], a[196:199], v[60:63]
  v_mfma_f32_16x16x32_bf16 v[48:51], v[164:167], a[176:179], v[48:51]
  v_mfma_f32_16x16x32_bf16 v[52:55], v[188:191], a[176:179], v[52:55]
  v_mfma_f32_16x16x32_bf16 v[56:59], v[164:167], a[200:203], v[56:59]
  v_mfma_f32_16x16x32_bf16 v[60:63], v[188:191], a[200:203], v[60:63]
  v_mfma_f32_16x16x32_bf16 v[48:51], v[168:171], a[180:183], v[48:51]
  v_mfma_f32_16x16x32_bf16 v[52:55], v[192:195], a[180:183], v[52:55]
  v_mfma_f32_16x16x32_bf16 v[56:59], v[168:171], a[204:207], v[56:59]
  v_mfma_f32_16x16x32_bf16 v[60:63], v[192:195], a[204:207], v[60:63]
  s_nop 4
  v_cvt_pk_bf16_f32 v232, v48, v49
  v_cvt_pk_bf16_f32 v233, v50, v51
  v_cvt_pk_bf16_f32 v234, v52, v53
  v_cvt_pk_bf16_f32 v235, v54, v55
  s_add_u32 s40, s45, 0
  v_cvt_pk_bf16_f32 v236, v56, v57
  v_cvt_pk_bf16_f32 v237, v58, v59
  v_cvt_pk_bf16_f32 v238, v60, v61
  v_cvt_pk_bf16_f32 v239, v62, v63
  s_add_u32 s40, s45, 1024
  s_add_u32 s45, s45, 1310720
  s_waitcnt lgkmcnt(0)
  s_xor_b32 s50, s50, 57344
  s_cmp_eq_u32 s51, 0
  s_cbranch_scc1 RM2F_NORED
WU_17:
  s_memtime s[58:59]
  s_waitcnt lgkmcnt(0)
  s_sub_u32 s58, s58, s96
  s_cmp_ge_u32 s58, 1150
  s_cbranch_scc1 WU_17_D
  s_sub_u32 s58, 1150, s58
  s_cmp_lt_u32 s58, 96
  s_cbranch_scc1 WU_17
  s_sleep 1
  s_branch WU_17
WU_17_D:
  s_add_u32 s41, s30, s52
  s_mov_b32 s43, 0
RM2F_RP:
  buffer_load_dwordx4 v[48:51], v6, s[4:7], s41 offen offset:0 sc1
  buffer_load_dwordx4 v[52:55], v6, s[4:7], s41 offen offset:1024 sc1
  buffer_load_dwordx4 v[56:59], v6, s[4:7], s41 offen offset:2048 sc1
  buffer_load_dwordx4 v[60:63], v6, s[4:7], s41 offen offset:3072 sc1
  s_waitcnt vmcnt(0)
  v_max3_u32 v4, v48, v49, v50
  v_max3_u32 v4, v4, v51, v52
  v_max3_u32 v4, v4, v53, v54
  v_max3_u32 v4, v4, v55, v56
  v_max3_u32 v4, v4, v57, v58
  v_max3_u32 v4, v4, v59, v60
  v_max3_u32 v4, v4, v61, v62
  v_max_u32 v4, v4, v63
  v_cmp_eq_u32 vcc, -1, v4
  s_nop 3
  s_cbranch_vccz RM2F_RP_OK
  s_add_u32 s43, s43, 1
  s_cmp_lt_u32 s43, s61
  s_cbranch_scc1 RM2F_RP
  s_mov_b32 s61, 0
RM2F_RP_OK:
  v_mfma_f32_16x16x32_bf16 v[64:67], v[240:243], v[48:51], 0
  v_mfma_f32_16x16x32_bf16 v[64:67], v[240:243], v[52:55], v[64:67]
  v_mfma_f32_16x16x32_bf16 v[64:67], v[240:243], v[56:59], v[64:67]
  v_mfma_f32_16x16x32_bf16 v[64:67], v[240:243], v[60:63], v[64:67]
  s_nop 7
  v_add_f32_dpp v68, v64, v64 row_ror:8 row_mask:0xf bank_mask:0xf
  v_add_f32_dpp v69, v65, v65 row_ror:8 row_mask:0xf bank_mask:0xf
  v_add_f32_dpp v70, v66, v66 row_ror:8 row_mask:0xf bank_mask:0xf
  v_add_f32_dpp v71, v67, v67 row_ror:8 row_mask:0xf bank_mask:0xf
  v_cvt_pk_bf16_f32 v80, v68, v69
  v_cvt_pk_bf16_f32 v81, v70, v71
  v_mov_b32 v82, v80
  v_mov_b32 v83, v81
  v_mov_b32 v84, v80
  v_mov_b32 v85, v81
  s_nop 0
  v_permlane16_swap_b32 v84, v82
  v_permlane16_swap_b32 v85, v83
  buffer_store_dwordx4 v[80:83], v30, s[4:7], s30 offen
  s_nop 1
RM2F_NORED:
  s_mov_b32 s40, s29
  s_mov_b32 s29, s30
  s_mov_b32 s30, s31
  s_mov_b32 s31, s32
  s_mov_b32 s32, s40
  s_memtime s[36:37]
  s_branch RM2F_LOOP
RM2F_DONE:
  s_waitcnt vmcnt(0)
  s_barrier
  s_endpgm
RM2S_LOOP:
WU_18:
  s_memtime s[58:59]
  s_waitcnt lgkmcnt(0)
  s_sub_u32 s58, s58, s36
  s_cmp_ge_u32 s58, 650
  s_cbranch_scc1 WU_18_D
  s_sub_u32 s58, 650, s58
  s_cmp_lt_u32 s58, 96
  s_cbranch_scc1 WU_18
  s_sleep 1
  s_branch WU_18
WU_18_D:
  s_mov_b32 s43, 0
RM2S_AGP:
  buffer_load_dwordx4 v[48:51], v23, s[4:7], s29 offen sc1
  buffer_load_dwordx4 v[52:55], v24, s[4:7], s29 offen sc1
  buffer_load_dwordx4 v[56:59], v25, s[4:7], s29 offen sc1
  s_waitcnt vmcnt(0)
  v_max3_u32 v4, v48, v49, v50
  v_max3_u32 v4, v4, v51, v52
  v_max3_u32 v4, v4, v53, v54
  v_max3_u32 v4, v4, v55, v56
  v_max3_u32 v4, v4, v57, v58
  v_max_u32 v4, v4, v59
  v_cmp_eq_u32 vcc, -1, v4
  s_nop 3
  s_cbranch_vccz RM2S_AGP_OK
  s_add_u32 s43, s43, 1
  s_cmp_lt_u32 s43, s61
  s_cbranch_scc1 RM2S_AGP
  s_mov_b32 s61, 0
RM2S_AGP_OK:
  ds_write_b128 v10, v[48:51]
  ds_write_b128 v10, v[52:55] offset:1024
  s_mov_b32 exec_hi, 0
  ds_write_b128 v10, v[56:59] offset:2048
  s_mov_b64 exec, -1
RM2S_B0:
  s_waitcnt lgkmcnt(0)
  s_barrier
  s_memtime s[98:99]
  ds_read_b128 v[48:51], v6 offset:0
  ds_read_b128 v[52:55], v6 offset:1024
  ds_read_b128 v[56:59], v6 offset:2048
  ds_read_b128 v[60:63], v6 offset:3072
  ds_read_b128 v[64:67], v6 offset:4096
  ds_read_b128 v[68:71], v6 offset:5120
  ds_read_b128 v[72:75], v6 offset:6144
  ds_read_b128 v[76:79], v6 offset:7168
  ds_read_b128 v[80:83], v6 offset:8192
  ds_read_b128 v[84:87], v6 offset:9216
  v_mov_b32 v88, 0
  v_mov_b32 v89, 0
  v_mov_b32 v90, 0
  v_mov_b32 v91, 0
  v_mov_b32 v92, 0
  v_mov_b32 v93, 0
  v_mov_b32 v94, 0
  v_mov_b32 v95, 0
  s_waitcnt lgkmcnt(9)
  v_smfmac_f32_16x16x64_bf16 v[88:91], v[48:51], a[0:7], v21
  v_smfmac_f32_16x16x64_bf16 v[92:95], v[48:51], a[80:87], v21
  s_waitcnt lgkmcnt(8)
  v_smfmac_f32_16x16x64_bf16 v[88:91], v[52:55], a[8:15], v21
  v_smfmac_f32_16x16x64_bf16 v[92:95], v[52:55], a[88:95], v21
  s_waitcnt lgkmcnt(7)
  v_smfmac_f32_16x16x64_bf16 v[88:91], v[56:59], a[16:23], v21
  v_smfmac_f32_16x16x64_bf16 v[92:95], v[56:59], a[96:103], v21
  s_waitcnt lgkmcnt(6)
  v_smfmac_f32_16x16x64_bf16 v[88:91], v[60:63], a[24:31], v21
  v_smfmac_f32_16x16x64_bf16 v[92:95], v[60:63], a[104:111], v21
  s_waitcnt lgkmcnt(5)
  v_smfmac_f32_16x16x64_bf16 v[88:91], v[64:67], a[32:39], v21
  v_smfmac_f32_16x16x64_bf16 v[92:95], v[64:67], a[112:119], v21
  s_waitcnt lgkmcnt(4)
  v_smfmac_f32_16x16x64_bf16 v[88:91], v[68:71], a[40:47], v21
  v_smfmac_f32_16x16x64_bf16 v[92:95], v[68:71], a[120:127], v21
  s_waitcnt lgkmcnt(3)
  v_smfmac_f32_16x16x64_bf16 v[88:91], v[72:75], a[48:55], v21
  v_smfmac_f32_16x16x64_bf16 v[92:95], v[72:75], a[128:135], v21
  s_waitcnt lgkmcnt(2)
  v_smfmac_f32_16x16x64_bf16 v[88:91], v[76:79], a[56:63], v21
  v_smfmac_f32_16x16x64_bf16 v[92:95], v[76:79], a[136:143], v21
  s_waitcnt lgkmcnt(1)
  v_smfmac_f32_16x16x64_bf16 v[88:91], v[80:83], a[64:71], v21
  v_smfmac_f32_16x16x64_bf16 v[92:95], v[80:83], a[144:151], v21
  s_waitcnt lgkmcnt(0)
  v_smfmac_f32_16x16x64_bf16 v[88:91], v[84:87], a[72:79], v21
  v_smfmac_f32_16x16x64_bf16 v[92:95], v[84:87], a[152:159], v21
  s_nop 7
  v_permlane32_swap_b32 v88, v92
  v_permlane32_swap_b32 v89, v93
  v_permlane32_swap_b32 v90, v94
  v_permlane32_swap_b32 v91, v95
  v_add_f32 v88, v88, v92
  v_add_f32 v89, v89, v93
  v_add_f32 v90, v90, v94
  v_add_f32 v91, v91, v95
  v_cvt_pk_bf16_f32 v252, v88, v89
  v_cvt_pk_bf16_f32 v253, v90, v91
  buffer_store_dwordx2 v[252:253], v12, s[4:7], s30 offen sc1
  v_mov_b32 v48, 0
  v_mov_b32 v49, 0
  v_mov_b32 v50, 0
  v_mov_b32 v51, 0
  v_mov_b32 v52, 0
  v_mov_b32 v53, 0
  v_mov_b32 v54, 0
  v_mov_b32 v55, 0
  s_nop 1
WU_19:
  s_memtime s[58:59]
  s_waitcnt lgkmcnt(0)
  s_sub_u32 s58, s58, s98
  s_cmp_ge_u32 s58, 1150
  s_cbranch_scc1 WU_19_D
  s_sub_u32 s58, 1150, s58
  s_cmp_lt_u32 s58, 96
  s_cbranch_scc1 WU_19
  s_sleep 1
  s_branch WU_19
WU_19_D:
  s_mov_b32 s43, 0
RM2S_AP:
  buffer_load_dwordx4 v[32:35], v16, s[4:7], s30 offen sc1
  buffer_load_dwordx4 v[36:39], v17, s[4:7], s30 offen sc1
  s_waitcnt vmcnt(0)
  v_max3_u32 v4, v32, v33, v34
  v_max3_u32 v4, v4, v35, v36
  v_max3_u32 v4, v4, v37, v38
  v_max_u32 v4, v4, v39
  v_cmp_eq_u32 vcc, -1, v4
  s_nop 3
  s_cbranch_vccz RM2S_AP_OK
  s_add_u32 s43, s43, 1
  s_cmp_lt_u32 s43, s61
  s_cbranch_scc1 RM2S_AP
  s_mov_b32 s61, 0
RM2S_AP_OK:
  ds_write_b128 v19, v[32:35]
  ds_write_b128 v19, v[36:39] offset:1024
  s_waitcnt lgkmcnt(0)
  s_barrier
  ds_read_b64_tr_b16 v[148:149], v20 offset:0
  ds_read_b64_tr_b16 v[150:151], v20 offset:256
  ds_read_b64_tr_b16 v[172:173], v20 offset:3072
  ds_read_b64_tr_b16 v[174:175], v20 offset:3328
  ds_read_b64_tr_b16 v[152:153], v20 offset:512
  ds_read_b64_tr_b16 v[154:155], v20 offset:768
  ds_read_b64_tr_b16 v[176:177], v20 offset:3584
  ds_read_b64_tr_b16 v[178:179], v20 offset:3840
  ds_read_b64_tr_b16 v[156:157], v20 offset:1024
  ds_read_b64_tr_b16 v[158:159], v20 offset:1280
  ds_read_b64_tr_b16 v[180:181], v20 offset:4096
  ds_read_b64_tr_b16 v[182:183], v20 offset:4352
  s_waitcnt lgkmcnt(8)
  v_mfma_f32_16x16x32_bf16 v[224:227], v[100:103], v[148:151], 0
  v_mfma_f32_16x16x32_bf16 v[228:231], v[124:127], v[148:151], 0
  v_mfma_f32_16x16x32_bf16 v[220:223], v[172:175], v[148:151], 0
  ds_read_b64_tr_b16 v[160:161], v20 offset:1536
  ds_read_b64_tr_b16 v[162:163], v20 offset:1792
  ds_read_b64_tr_b16 v[184:185], v20 offset:4608
  ds_read_b64_tr_b16 v[186:187], v20 offset:4864
  s_waitcnt lgkmcnt(8)
  v_mfma_f32_16x16x32_bf16 v[224:227], v[104:107], v[152:155], v[224:227]
  v_mfma_f32_16x16x32_bf16 v[228:231], v[128:131], v[152:155], v[228:231]
  v_mfma_f32_16x16x32_bf16 v[220:223], v[176:179], v[152:155], v[220:223]
  ds_read_b64_tr_b16 v[164:165], v20 offset:2048
  ds_read_b64_tr_b16 v[166:167], v20 offset:2304
  ds_read_b64_tr_b16 v[188:189], v20 offset:5120
  ds_read_b64_tr_b16 v[190:191], v20 offset:5376
  s_waitcnt lgkmcnt(8)
  v_mfma_f32_16x16x32_bf16 v[224:227], v[108:111], v[156:159], v[224:227]
  v_mfma_f32_16x16x32_bf16 v[228:231], v[132:135], v[156:159], v[228:231]
  v_mfma_f32_16x16x32_bf16 v[220:223], v[180:183], v[156:159], v[220:223]
  ds_read_b64_tr_b16 v[168:169], v20 offset:2560
  ds_read_b64_tr_b16 v[170:171], v20 offset:2816
  ds_read_b64_tr_b16 v[192:193], v20 offset:5632
  ds_read_b64_tr_b16 v[194:195], v20 offset:5888
  s_waitcnt lgkmcnt(8)
  v_mfma_f32_16x16x32_bf16 v[224:227], v[112:115], v[160:163], v[224:227]
  v_mfma_f32_16x16x32_bf16 v[228:231], v[136:139], v[160:163], v[228:231]
  v_mfma_f32_16x16x32_bf16 v[220:223], v[184:187], v[160:163], v[220:223]
  s_waitcnt lgkmcnt(4)
  v_mfma_f32_16x16x32_bf16 v[224:227], v[116:119], v[164:167], v[224:227]
  v_mfma_f32_16x16x32_bf16 v[228:231], v[140:143], v[164:167], v[228:231]
  v_mfma_f32_16x16x32_bf16 v[220:223], v[188:191], v[164:167], v[220:223]
  s_waitcnt lgkmcnt(0)
  v_mfma_f32_16x16x32_bf16 v[224:227], v[120:123], v[168:171], v[224:227]
  v_mfma_f32_16x16x32_bf16 v[228:231], v[144:147], v[168:171], v[228:231]
  v_mfma_f32_16x16x32_bf16 v[220:223], v[192:195], v[168:171], v[220:223]
  s_barrier
  s_memtime s[96:97]
  ds_read_b64_tr_b16 v[196:197], v22 offset:0
  ds_read_b64_tr_b16 v[198:199], v22 offset:64
  ds_read_b64_tr_b16 v[200:201], v22 offset:1024
  ds_read_b64_tr_b16 v[202:203], v22 offset:1088
  ds_read_b64_tr_b16 v[204:205], v22 offset:2048
  ds_read_b64_tr_b16 v[206:207], v22 offset:2112
  v_cndmask_b32 v148, v224, v228, s[38:39]
  v_cndmask_b32 v149, v225, v229, s[38:39]
  s_waitcnt lgkmcnt(4)
  v_smfmac_f32_16x16x64_bf16 v[48:51], v[196:199], a[160:167], v21
  v_cndmask_b32 v150, v226, v230, s[38:39]
  v_smfmac_f32_16x16x64_bf16 v[52:55], v[196:199], a[184:191], v21
  v_cndmask_b32 v151, v227, v231, s[38:39]
  s_waitcnt lgkmcnt(2)
  v_smfmac_f32_16x16x64_bf16 v[48:51], v[200:203], a[168:175], v21
  v_cndmask_b32 v152, v220, v222, s[38:39]
  v_smfmac_f32_16x16x64_bf16 v[52:55], v[200:203], a[192:199], v21
  v_cndmask_b32 v153, v221, v223, s[38:39]
  s_waitcnt lgkmcnt(0)
  v_smfmac_f32_16x16x64_bf16 v[48:51], v[204:207], a[176:183], v21
  v_max3_f32 v154, v148, v149, v150
  v_smfmac_f32_16x16x64_bf16 v[52:55], v[204:207], a[200:207], v21
  v_max3_f32 v155, v151, v152, v153
  v_max_f32 v154, v154, v155
  s_nop 1
  v_max_f32_dpp v154, v154, v154 row_ror:8 row_mask:0xf bank_mask:0xf
  v_mov_b32 v155, v154
  s_nop 1
  v_permlane16_swap_b32 v154, v155
  v_max_f32 v154, v154, v155
  v_mov_b32 v155, v154
  s_nop 1
  v_permlane32_swap_b32 v154, v155
  v_max_f32 v154, v154, v155
  v_mul_f32 v154, s60, v154
  v_fma_f32 v148, v148, s60, -v154
  v_fma_f32 v149, v149, s60, -v154
  v_fma_f32 v150, v150, s60, -v154
  v_fma_f32 v151, v151, s60, -v154
  v_fma_f32 v152, v152, s60, -v154
  v_fma_f32 v153, v153, s60, -v154
  v_exp_f32 v148, v148
  v_exp_f32 v149, v149
  v_exp_f32 v150, v150
  v_exp_f32 v151, v151
  v_exp_f32 v152, v152
  v_exp_f32 v153, v153
  v_cvt_pk_bf16_f32 v160, v148, v149
  v_cvt_pk_bf16_f32 v161, v150, v151
  v_cvt_pk_bf16_f32 v158, v152, v153
  v_mov_b32_dpp v162, v160 row_ror:8 row_mask:0xf bank_mask:0xf
  v_mov_b32_dpp v163, v161 row_ror:8 row_mask:0xf bank_mask:0xf
  v_mov_b32_dpp v159, v158 row_ror:8 row_mask:0xf bank_mask:0xf
  s_nop 0
  v_mfma_f32_16x16x32_bf16 v[64:67], v[232:235], v[160:163], 0
  v_cvt_pk_bf16_f32 v220, v48, v49
  v_cvt_pk_bf16_f32 v221, v50, v51
  v_mfma_f32_16x16x32_bf16 v[68:71], v[236:239], v[160:163], 0
  v_cvt_pk_bf16_f32 v222, v52, v53
  v_cvt_pk_bf16_f32 v223, v54, v55
  v_mfma_f32_16x16x16_bf16 v[64:67], v[220:221], v[158:159], v[64:67]
  v_cndmask_b32 v152, v152, v31, s[20:21]
  v_cndmask_b32 v153, v153, v31, s[20:21]
  v_add_f32 v156, v148, v149
  v_add_f32 v155, v150, v151
  v_mfma_f32_16x16x16_bf16 v[68:71], v[222:223], v[158:159], v[68:71]
  v_add_f32 v157, v152, v153
  v_add_f32 v156, v156, v155
  v_add_f32 v156, v156, v157
  s_nop 1
  v_add_f32_dpp v156, v156, v156 row_ror:8 row_mask:0xf bank_mask:0xf
  v_mov_b32 v155, v156
  s_nop 1
  v_permlane16_swap_b32 v156, v155
  v_add_f32 v156, v156, v155
  v_mov_b32 v155, v156
  s_nop 1
  v_permlane32_swap_b32 v156, v155
  v_add_f32 v156, v156, v155
  v_rcp_f32 v156, v156
  s_nop 0
  v_mov_b32 v157, v156
  v_pk_mul_f32 v[64:65], v[64:65], v[156:157]
  v_pk_mul_f32 v[66:67], v[66:67], v[156:157]
  v_pk_mul_f32 v[68:69], v[68:69], v[156:157]
  v_pk_mul_f32 v[70:71], v[70:71], v[156:157]
  v_cvt_pk_bf16_f32 v80, v64, v65
  v_cvt_pk_bf16_f32 v81, v66, v67
  v_cvt_pk_bf16_f32 v82, v68, v69
  v_cvt_pk_bf16_f32 v83, v70, v71
  s_add_u32 s40, s30, s48
  s_mov_b64 exec, s[34:35]
  buffer_store_dwordx4 v[80:83], v28, s[4:7], s40 offen sc1
  s_mov_b64 exec, -1
  s_mov_b64 exec, s[34:35]
  s_cmp_lg_u32 s26, 0
  s_cbranch_scc1 RM2S_NOKM
  buffer_store_dwordx4 v[188:191], v15, s[4:7], s47 offen offset:0 sc1
  buffer_store_dwordx4 v[192:195], v15, s[4:7], s47 offen offset:512 sc1
  s_nop 1
RM2S_NOKM:
  s_mov_b64 exec, -1
  s_add_u32 s47, s47, 98304
  v_mov_b32 v64, v48
  v_mov_b32 v65, v49
  v_mov_b32 v66, v50
  v_mov_b32 v67, v51
  v_permlane32_swap_b32 v48, v64
  v_permlane32_swap_b32 v49, v65
  v_permlane32_swap_b32 v50, v66
  v_permlane32_swap_b32 v51, v67
  v_add_f32 v48, v48, v64
  v_add_f32 v49, v49, v65
  v_add_f32 v50, v50, v66
  v_add_f32 v51, v51, v67
  v_cvt_pk_bf16_f32 v220, v48, v49
  v_cvt_pk_bf16_f32 v221, v50, v51
  v_mov_b32 v64, v52
  v_mov_b32 v65, v53
  v_mov_b32 v66, v54
  v_mov_b32 v67, v55
  v_permlane32_swap_b32 v52, v64
  v_permlane32_swap_b32 v53, v65
  v_permlane32_swap_b32 v54, v66
  v_permlane32_swap_b32 v55, v67
  v_add_f32 v52, v52, v64
  v_add_f32 v53, v53, v65
  v_add_f32 v54, v54, v66
  v_add_f32 v55, v55, v67
  v_cvt_pk_bf16_f32 v222, v52, v53
  v_cvt_pk_bf16_f32 v223, v54, v55
  s_mov_b32 exec_hi, 0
  buffer_store_dwordx2 v[220:221], v29, s[4:7], s46 offen offset:0 sc1
  buffer_store_dwordx2 v[222:223], v29, s[4:7], s46 offen offset:256 sc1
  s_mov_b64 exec, -1
  s_add_u32 s46, s46, 327680
  s_add_u32 s28, s28, 1
  s_cmp_ge_u32 s28, 64
  s_cbranch_scc1 RM2S_DONE
  v_add_u32 v4, s50, v6
  ds_read_b128 v[148:151], v4 offset:12288
  ds_read_b128 v[152:155], v4 offset:13312
  ds_read_b128 v[156:159], v4 offset:14336
  ds_read_b128 v[160:163], v4 offset:15360
  ds_read_b128 v[164:167], v4 offset:16384
  ds_read_b128 v[168:171], v4 offset:17408
  ds_read_b128 v[172:175], v4 offset:18432
  ds_read_b128 v[176:179], v4 offset:19456
  s_waitcnt lgkmcnt(4)
  ds_read_b128 v[180:183], v4 offset:20480
  ds_read_b128 v[184:187], v4 offset:21504
  ds_read_b128 v[188:191], v4 offset:22528
  ds_read_b128 v[192:195], v4 offset:23552
  s_waitcnt lgkmcnt(0)
  ds_read_b128 v[100:103], v4 offset:0
  ds_read_b128 v[104:107], v4 offset:1024
  ds_read_b128 v[108:111], v4 offset:2048
  ds_read_b128 v[112:115], v4 offset:3072
  ds_read_b128 v[116:119], v4 offset:4096
  ds_read_b128 v[120:123], v4 offset:5120
  ds_read_b128 v[124:127], v4 offset:6144
  ds_read_b128 v[128:131], v4 offset:7168
  ds_read_b128 v[132:135], v4 offset:8192
  ds_read_b128 v[136:139], v4 offset:9216
  ds_read_b128 v[140:143], v4 offset:10240
  ds_read_b128 v[144:147], v4 offset:11264
  v_mfma_f32_16x16x32_bf16 v[48:51], v[148:151], a[160:163], 0
  v_mfma_f32_16x16x32_bf16 v[52:55], v[172:175], a[160:163], 0
  v_mfma_f32_16x16x32_bf16 v[56:59], v[148:151], a[184:187], 0
  v_mfma_f32_16x16x32_bf16 v[60:63], v[172:175], a[184:187], 0
  v_mfma_f32_16x16x32_bf16 v[48:51], v[152:155], a[164:167], v[48:51]
  v_mfma_f32_16x16x32_bf16 v[52:55], v[176:179], a[164:167], v[52:55]
  v_mfma_f32_16x16x32_bf16 v[56:59], v[152:155], a[188:191], v[56:59]
  v_mfma_f32_16x16x32_bf16 v[60:63], v[176:179], a[188:191], v[60:63]
  v_mfma_f32_16x16x32_bf16 v[48:51], v[156:159], a[168:171], v[48:51]
  v_mfma_f32_16x16x32_bf16 v[52:55], v[180:183], a[168:171], v[52:55]
  v_mfma_f32_16x16x32_bf16 v[56:59], v[156:159], a[192:195], v[56:59]
  v_mfma_f32_16x16x32_bf16 v[60:63], v[180:183], a[192:195], v[60:63]
  v_mfma_f32_16x16x32_bf16 v[48:51], v[160:163], a[172:175], v[48:51]
  v_mfma_f32_16x16x32_bf16 v[52:55], v[184:187], a[172:175], v[52:55]
  v_mfma_f32_16x16x32_bf16 v[56:59], v[160:163], a[196:199], v[56:59]
  v_mfma_f32_16x16x32_bf16 v[60:63], v[184:187], a[196:199], v[60:63]
  v_mfma_f32_16x16x32_bf16 v[48:51], v[164:167], a[176:179], v[48:51]
  v_mfma_f32_16x16x32_bf16 v[52:55], v[188:191], a[176:179], v[52:55]
  v_mfma_f32_16x16x32_bf16 v[56:59], v[164:167], a[200:203], v[56:59]
  v_mfma_f32_16x16x32_bf16 v[60:63], v[188:191], a[200:203], v[60:63]
  v_mfma_f32_16x16x32_bf16 v[48:51], v[168:171], a[180:183], v[48:51]
  v_mfma_f32_16x16x32_bf16 v[52:55], v[192:195], a[180:183], v[52:55]
  v_mfma_f32_16x16x32_bf16 v[56:59], v[168:171], a[204:207], v[56:59]
  v_mfma_f32_16x16x32_bf16 v[60:63], v[192:195], a[204:207], v[60:63]
  s_nop 4
  v_cvt_pk_bf16_f32 v232, v48, v49
  v_cvt_pk_bf16_f32 v233, v50, v51
  v_cvt_pk_bf16_f32 v234, v52, v53
  v_cvt_pk_bf16_f32 v235, v54, v55
  s_add_u32 s40, s45, 0
  v_cvt_pk_bf16_f32 v236, v56, v57
  v_cvt_pk_bf16_f32 v237, v58, v59
  v_cvt_pk_bf16_f32 v238, v60, v61
  v_cvt_pk_bf16_f32 v239, v62, v63
  s_add_u32 s40, s45, 1024
  s_add_u32 s45, s45, 1310720
  s_waitcnt lgkmcnt(0)
  s_xor_b32 s50, s50, 57344
  s_cmp_eq_u32 s51, 0
  s_cbranch_scc1 RM2S_NORED
WU_20:
  s_memtime s[58:59]
  s_waitcnt lgkmcnt(0)
  s_sub_u32 s58, s58, s96
  s_cmp_ge_u32 s58, 1150
  s_cbranch_scc1 WU_20_D
  s_sub_u32 s58, 1150, s58
  s_cmp_lt_u32 s58, 96
  s_cbranch_scc1 WU_20
  s_sleep 1
  s_branch WU_20
WU_20_D:
  s_add_u32 s41, s30, s52
  s_mov_b32 s43, 0
RM2S_RP:
  buffer_load_dwordx4 v[48:51], v6, s[4:7], s41 offen offset:0 sc1
  buffer_load_dwordx4 v[52:55], v6, s[4:7], s41 offen offset:1024 sc1
  buffer_load_dwordx4 v[56:59], v6, s[4:7], s41 offen offset:2048 sc1
  buffer_load_dwordx4 v[60:63], v6, s[4:7], s41 offen offset:3072 sc1
  s_waitcnt vmcnt(0)
  v_max3_u32 v4, v48, v49, v50
  v_max3_u32 v4, v4, v51, v52
  v_max3_u32 v4, v4, v53, v54
  v_max3_u32 v4, v4, v55, v56
  v_max3_u32 v4, v4, v57, v58
  v_max3_u32 v4, v4, v59, v60
  v_max3_u32 v4, v4, v61, v62
  v_max_u32 v4, v4, v63
  v_cmp_eq_u32 vcc, -1, v4
  s_nop 3
  s_cbranch_vccz RM2S_RP_OK
  s_add_u32 s43, s43, 1
  s_cmp_lt_u32 s43, s61
  s_cbranch_scc1 RM2S_RP
  s_mov_b32 s61, 0
RM2S_RP_OK:
  v_mfma_f32_16x16x32_bf16 v[64:67], v[240:243], v[48:51], 0
  v_mfma_f32_16x16x32_bf16 v[64:67], v[240:243], v[52:55], v[64:67]
  v_mfma_f32_16x16x32_bf16 v[64:67], v[240:243], v[56:59], v[64:67]
  v_mfma_f32_16x16x32_bf16 v[64:67], v[240:243], v[60:63], v[64:67]
  s_nop 7
  v_add_f32_dpp v68, v64, v64 row_ror:8 row_mask:0xf bank_mask:0xf
  v_add_f32_dpp v69, v65, v65 row_ror:8 row_mask:0xf bank_mask:0xf
  v_add_f32_dpp v70, v66, v66 row_ror:8 row_mask:0xf bank_mask:0xf
  v_add_f32_dpp v71, v67, v67 row_ror:8 row_mask:0xf bank_mask:0xf
  v_cvt_pk_bf16_f32 v80, v68, v69
  v_cvt_pk_bf16_f32 v81, v70, v71
  v_mov_b32 v82, v80
  v_mov_b32 v83, v81
  v_mov_b32 v84, v80
  v_mov_b32 v85, v81
  s_nop 0
  v_permlane16_swap_b32 v84, v82
  v_permlane16_swap_b32 v85, v83
  buffer_store_dwordx4 v[80:83], v30, s[4:7], s30 offen sc1
  s_nop 1
RM2S_NORED:
  s_mov_b32 s40, s29
  s_mov_b32 s29, s30
  s_mov_b32 s30, s31
  s_mov_b32 s31, s32
  s_mov_b32 s32, s40
  s_memtime s[36:37]
  s_branch RM2S_LOOP
RM2S_DONE:
  s_waitcnt vmcnt(0)
  s_barrier
  s_endpgm
RK_W3:
  v_add_u32 v4, 480, v1
  v_and_b32 v5, 7, v4
  v_mul_u32_u24 v5, 1280, v5
  v_lshrrev_b32 v212, 5, v4
  v_lshlrev_b32 v212, 6, v212
  v_add_u32 v5, v5, v212
  v_bfe_u32 v4, v4, 3, 2
  v_lshlrev_b32 v4, 3, v4
  v_add_u32 v4, v4, v5
  buffer_load_dwordx2 v[200:201], v4, s[88:91], 0 offen
  buffer_load_dwordx2 v[202:203], v4, s[88:91], 0 offen offset:32
  v_add_u32 v4, 544, v1
  v_and_b32 v5, 7, v4
  v_mul_u32_u24 v5, 1280, v5
  v_lshrrev_b32 v212, 5, v4
  v_lshlrev_b32 v212, 6, v212
  v_add_u32 v5, v5, v212
  v_bfe_u32 v4, v4, 3, 2
  v_lshlrev_b32 v4, 3, v4
  v_add_u32 v4, v4, v5
  buffer_load_dwordx2 v[204:205], v4, s[88:91], 0 offen
  buffer_load_dwordx2 v[206:207], v4, s[88:91], 0 offen offset:32
  v_add_u32 v4, 608, v1
  v_and_b32 v5, 7, v4
  v_mul_u32_u24 v5, 1280, v5
  v_lshrrev_b32 v212, 5, v4
  v_lshlrev_b32 v212, 6, v212
  v_add_u32 v5, v5, v212
  v_bfe_u32 v4, v4, 3, 2
  v_lshlrev_b32 v4, 3, v4
  v_add_u32 v4, v4, v5
  buffer_load_dwordx2 v[208:209], v4, s[88:91], 0 offen
  buffer_load_dwordx2 v[210:211], v4, s[88:91], 0 offen offset:32
  s_lshl_b32 s54, s24, 15
  v_lshrrev_b32 v4, 3, v1
  v_add_u32 v4, 24, v4
  s_mov_b32 s55, 12288
  v_mul_lo_u32 v32, v4, s55
  v_and_b32 v4, 7, v1
  v_lshlrev_b32 v4, 4, v4
  v_add_u32 v32, v32, v4
  v_bfe_u32 v33, v1, 4, 1
  v_lshlrev_b32 v33, 4, v33
  v_bfe_u32 v4, v1, 5, 1
  v_lshlrev_b32 v4, 3, v4
  v_add_u32 v33, v33, v4
  v_bfe_u32 v4, v1, 2, 1
  v_add_u32 v33, v33, v4
  v_bfe_u32 v4, v1, 3, 1
  v_lshlrev_b32 v4, 2, v4
  v_add_u32 v33, v33, v4
  v_lshlrev_b32 v33, 7, v33
  v_and_b32 v4, 3, v1
  v_lshlrev_b32 v4, 3, v4
  v_add_u32 v33, v33, v4
  s_mul_i32 s56, s25, 384
  s_mul_i32 s40, s26, 96
  s_add_u32 s56, s56, s40
  v_add_u32 v34, 61440, v33
  v_lshlrev_b32 v35, 4, v1
  v_add_u32 v35, 3072, v35
  v_add_u32 v36, 61440, v35
  s_add_u32 s40, s56, 0
  s_mov_b32 m0, 3072
  s_nop 0
  buffer_load_dwordx4 v32, s[8:11], s40 offen lds
  s_add_u32 s40, s56, 0
  s_mov_b32 m0, 7168
  s_nop 0
  buffer_load_dwordx4 v32, s[12:15], s40 offen lds
  s_add_u32 s40, s56, 0
  s_mov_b32 m0, 11264
  s_nop 0
  buffer_load_dwordx4 v32, s[16:19], s40 offen lds
  s_add_u32 s40, s56, 393216
  s_mov_b32 m0, 15360
  s_nop 0
  buffer_load_dwordx4 v32, s[8:11], s40 offen lds
  s_add_u32 s40, s56, 393216
  s_mov_b32 m0, 19456
  s_nop 0
  buffer_load_dwordx4 v32, s[12:15], s40 offen lds
  s_add_u32 s40, s56, 393216
  s_mov_b32 m0, 23552
  s_nop 0
  buffer_load_dwordx4 v32, s[16:19], s40 offen lds
  s_add_u32 s40, s56, 786432
  s_mov_b32 m0, 27648
  s_nop 0
  buffer_load_dwordx4 v32, s[8:11], s40 offen lds
  s_add_u32 s40, s56, 786432
  s_mov_b32 m0, 31744
  s_nop 0
  buffer_load_dwordx4 v32, s[12:15], s40 offen lds
  s_add_u32 s40, s56, 786432
  s_mov_b32 m0, 35840
  s_nop 0
  buffer_load_dwordx4 v32, s[16:19], s40 offen lds
  s_add_u32 s40, s56, 1179648
  s_mov_b32 m0, 39936
  s_nop 0
  buffer_load_dwordx4 v32, s[8:11], s40 offen lds
  s_add_u32 s40, s56, 1179648
  s_mov_b32 m0, 44032
  s_nop 0
  buffer_load_dwordx4 v32, s[12:15], s40 offen lds
  s_add_u32 s40, s56, 1179648
  s_mov_b32 m0, 48128
  s_nop 0
  buffer_load_dwordx4 v32, s[16:19], s40 offen lds
  s_add_u32 s40, s56, 1572864
  s_mov_b32 m0, 52224
  s_nop 0
  buffer_load_dwordx4 v32, s[8:11], s40 offen lds
  s_add_u32 s40, s56, 1572864
  s_mov_b32 m0, 56320
  s_nop 0
  buffer_load_dwordx4 v32, s[12:15], s40 offen lds
  s_add_u32 s40, s56, 1572864
  s_mov_b32 m0, 60416
  s_nop 0
  buffer_load_dwordx4 v32, s[16:19], s40 offen lds
  s_add_u32 s40, s56, 1966080
  s_mov_b32 m0, 64512
  s_nop 0
  buffer_load_dwordx4 v32, s[8:11], s40 offen lds
  s_add_u32 s40, s56, 1966080
  s_mov_b32 m0, 68608
  s_nop 0
  buffer_load_dwordx4 v32, s[12:15], s40 offen lds
  s_add_u32 s40, s56, 1966080
  s_mov_b32 m0, 72704
  s_nop 0
  buffer_load_dwordx4 v32, s[16:19], s40 offen lds
  s_add_u32 s40, s56, 2359296
  s_mov_b32 m0, 76800
  s_nop 0
  buffer_load_dwordx4 v32, s[8:11], s40 offen lds
  s_add_u32 s40, s56, 2359296
  s_mov_b32 m0, 80896
  s_nop 0
  buffer_load_dwordx4 v32, s[12:15], s40 offen lds
  s_add_u32 s40, s56, 2359296
  s_mov_b32 m0, 84992
  s_nop 0
  buffer_load_dwordx4 v32, s[16:19], s40 offen lds
  s_add_u32 s40, s56, 2752512
  s_mov_b32 m0, 89088
  s_nop 0
  buffer_load_dwordx4 v32, s[8:11], s40 offen lds
  s_add_u32 s40, s56, 2752512
  s_mov_b32 m0, 93184
  s_nop 0
  buffer_load_dwordx4 v32, s[12:15], s40 offen lds
  s_add_u32 s40, s56, 2752512
  s_mov_b32 m0, 97280
  s_nop 0
  buffer_load_dwordx4 v32, s[16:19], s40 offen lds
  s_add_u32 s40, s56, 3145728
  s_mov_b32 m0, 101376
  s_nop 0
  buffer_load_dwordx4 v32, s[8:11], s40 offen lds
  s_add_u32 s40, s56, 3145728
  s_mov_b32 m0, 105472
  s_nop 0
  buffer_load_dwordx4 v32, s[12:15], s40 offen lds
  s_add_u32 s40, s56, 3145728
  s_mov_b32 m0, 109568
  s_nop 0
  buffer_load_dwordx4 v32, s[16:19], s40 offen lds
  s_add_u32 s40, s56, 3538944
  s_mov_b32 m0, 113664
  s_nop 0
  buffer_load_dwordx4 v32, s[8:11], s40 offen lds
  s_add_u32 s40, s56, 3538944
  s_mov_b32 m0, 117760
  s_nop 0
  buffer_load_dwordx4 v32, s[12:15], s40 offen lds
  s_add_u32 s40, s56, 3538944
  s_mov_b32 m0, 121856
  s_nop 0
  buffer_load_dwordx4 v32, s[16:19], s40 offen lds
  s_add_u32 s40, s56, 3932160
  buffer_load_dwordx4 v[64:67], v32, s[8:11], s40 offen
  s_add_u32 s40, s56, 3932160
  buffer_load_dwordx4 v[68:71], v32, s[12:15], s40 offen
  s_add_u32 s40, s56, 3932160
  buffer_load_dwordx4 v[72:75], v32, s[16:19], s40 offen
  s_add_u32 s40, s56, 4325376
  buffer_load_dwordx4 v[76:79], v32, s[8:11], s40 offen
  s_add_u32 s40, s56, 4325376
  buffer_load_dwordx4 v[80:83], v32, s[12:15], s40 offen
  s_add_u32 s40, s56, 4325376
  buffer_load_dwordx4 v[84:87], v32, s[16:19], s40 offen
  s_add_u32 s40, s56, 4718592
  buffer_load_dwordx4 v[88:91], v32, s[8:11], s40 offen
  s_add_u32 s40, s56, 4718592
  buffer_load_dwordx4 v[92:95], v32, s[12:15], s40 offen
  s_add_u32 s40, s56, 4718592
  buffer_load_dwordx4 v[96:99], v32, s[16:19], s40 offen
  s_add_u32 s40, s56, 5111808
  buffer_load_dwordx4 v[100:103], v32, s[8:11], s40 offen
  s_add_u32 s40, s56, 5111808
  buffer_load_dwordx4 v[104:107], v32, s[12:15], s40 offen
  s_add_u32 s40, s56, 5111808
  buffer_load_dwordx4 v[108:111], v32, s[16:19], s40 offen
  s_add_u32 s40, s56, 5505024
  buffer_load_dwordx4 v[112:115], v32, s[8:11], s40 offen
  s_add_u32 s40, s56, 5505024
  buffer_load_dwordx4 v[116:119], v32, s[12:15], s40 offen
  s_add_u32 s40, s56, 5505024
  buffer_load_dwordx4 v[120:123], v32, s[16:19], s40 offen
  s_add_u32 s40, s56, 5898240
  buffer_load_dwordx4 v[124:127], v32, s[8:11], s40 offen
  s_add_u32 s40, s56, 5898240
  buffer_load_dwordx4 v[128:131], v32, s[12:15], s40 offen
  s_add_u32 s40, s56, 5898240
  buffer_load_dwordx4 v[132:135], v32, s[16:19], s40 offen
  s_add_u32 s40, s56, 6291456
  buffer_load_dwordx4 v[136:139], v32, s[8:11], s40 offen
  s_add_u32 s40, s56, 6291456
  buffer_load_dwordx4 v[140:143], v32, s[12:15], s40 offen
  s_add_u32 s40, s56, 6291456
  buffer_load_dwordx4 v[144:147], v32, s[16:19], s40 offen
  s_add_u32 s40, s56, 6684672
  buffer_load_dwordx4 v[148:151], v32, s[8:11], s40 offen
  s_add_u32 s40, s56, 6684672
  buffer_load_dwordx4 v[152:155], v32, s[12:15], s40 offen
  s_add_u32 s40, s56, 6684672
  buffer_load_dwordx4 v[156:159], v32, s[16:19], s40 offen
  s_add_u32 s40, s56, 7077888
  buffer_load_dwordx4 v[160:163], v32, s[8:11], s40 offen
  s_add_u32 s40, s56, 7077888
  buffer_load_dwordx4 v[164:167], v32, s[12:15], s40 offen
  s_add_u32 s40, s56, 7077888
  buffer_load_dwordx4 v[168:171], v32, s[16:19], s40 offen
  s_add_u32 s40, s56, 7471104
  buffer_load_dwordx4 v[172:175], v32, s[8:11], s40 offen
  s_add_u32 s40, s56, 7471104
  buffer_load_dwordx4 v[176:179], v32, s[12:15], s40 offen
  s_add_u32 s40, s56, 7471104
  buffer_load_dwordx4 v[180:183], v32, s[16:19], s40 offen
  s_waitcnt vmcnt(45)
  s_barrier
  ds_read_b64_tr_b16 a[0:1], v33 offset:8192
  ds_read_b64_tr_b16 a[2:3], v33 offset:8448
  ds_read_b64_tr_b16 a[80:81], v33 offset:8224
  ds_read_b64_tr_b16 a[82:83], v33 offset:8480
  ds_read_b64_tr_b16 a[160:161], v33 offset:8256
  ds_read_b64_tr_b16 a[162:163], v33 offset:8512
  ds_read_b64_tr_b16 a[4:5], v33 offset:20480
  ds_read_b64_tr_b16 a[6:7], v33 offset:20736
  ds_read_b64_tr_b16 a[84:85], v33 offset:20512
  ds_read_b64_tr_b16 a[86:87], v33 offset:20768
  ds_read_b64_tr_b16 a[164:165], v33 offset:20544
  ds_read_b64_tr_b16 a[166:167], v33 offset:20800
  s_waitcnt lgkmcnt(4)
  ds_read_b64_tr_b16 a[8:9], v33 offset:32768
  ds_read_b64_tr_b16 a[10:11], v33 offset:33024
  ds_read_b64_tr_b16 a[88:89], v33 offset:32800
  ds_read_b64_tr_b16 a[90:91], v33 offset:33056
  ds_read_b64_tr_b16 a[168:169], v33 offset:32832
  ds_read_b64_tr_b16 a[170:171], v33 offset:33088
  ds_read_b64_tr_b16 a[12:13], v33 offset:45056
  ds_read_b64_tr_b16 a[14:15], v33 offset:45312
  ds_read_b64_tr_b16 a[92:93], v33 offset:45088
  ds_read_b64_tr_b16 a[94:95], v33 offset:45344
  ds_read_b64_tr_b16 a[172:173], v33 offset:45120
  ds_read_b64_tr_b16 a[174:175], v33 offset:45376
  s_waitcnt lgkmcnt(4)
  ds_read_b64_tr_b16 a[16:17], v33 offset:57344
  ds_read_b64_tr_b16 a[18:19], v33 offset:57600
  ds_read_b64_tr_b16 a[96:97], v33 offset:57376
  ds_read_b64_tr_b16 a[98:99], v33 offset:57632
  ds_read_b64_tr_b16 a[176:177], v33 offset:57408
  ds_read_b64_tr_b16 a[178:179], v33 offset:57664
  s_waitcnt lgkmcnt(0)
  s_barrier
  s_waitcnt vmcnt(30)
  s_barrier
  ds_read_b64_tr_b16 a[20:21], v34 offset:8192
  ds_read_b64_tr_b16 a[22:23], v34 offset:8448
  ds_read_b64_tr_b16 a[100:101], v34 offset:8224
  ds_read_b64_tr_b16 a[102:103], v34 offset:8480
  ds_read_b64_tr_b16 a[180:181], v34 offset:8256
  ds_read_b64_tr_b16 a[182:183], v34 offset:8512
  ds_read_b64_tr_b16 a[24:25], v34 offset:20480
  ds_read_b64_tr_b16 a[26:27], v34 offset:20736
  ds_read_b64_tr_b16 a[104:105], v34 offset:20512
  ds_read_b64_tr_b16 a[106:107], v34 offset:20768
  ds_read_b64_tr_b16 a[184:185], v34 offset:20544
  ds_read_b64_tr_b16 a[186:187], v34 offset:20800
  s_waitcnt lgkmcnt(4)
  ds_read_b64_tr_b16 a[28:29], v34 offset:32768
  ds_read_b64_tr_b16 a[30:31], v34 offset:33024
  ds_read_b64_tr_b16 a[108:109], v34 offset:32800
  ds_read_b64_tr_b16 a[110:111], v34 offset:33056
  ds_read_b64_tr_b16 a[188:189], v34 offset:32832
  ds_read_b64_tr_b16 a[190:191], v34 offset:33088
  ds_read_b64_tr_b16 a[32:33], v34 offset:45056
  ds_read_b64_tr_b16 a[34:35], v34 offset:45312
  ds_read_b64_tr_b16 a[112:113], v34 offset:45088
  ds_read_b64_tr_b16 a[114:115], v34 offset:45344
  ds_read_b64_tr_b16 a[192:193], v34 offset:45120
  ds_read_b64_tr_b16 a[194:195], v34 offset:45376
  s_waitcnt lgkmcnt(4)
  ds_read_b64_tr_b16 a[36:37], v34 offset:57344
  ds_read_b64_tr_b16 a[38:39], v34 offset:57600
  ds_read_b64_tr_b16 a[116:117], v34 offset:57376
  ds_read_b64_tr_b16 a[118:119], v34 offset:57632
  ds_read_b64_tr_b16 a[196:197], v34 offset:57408
  ds_read_b64_tr_b16 a[198:199], v34 offset:57664
  s_waitcnt lgkmcnt(0)
  s_barrier
  s_waitcnt vmcnt(15)
  ds_write_b128 v35, v[64:67] offset:0
  ds_write_b128 v35, v[68:71] offset:4096
  ds_write_b128 v35, v[72:75] offset:8192
  ds_write_b128 v35, v[76:79] offset:12288
  ds_write_b128 v35, v[80:83] offset:16384
  ds_write_b128 v35, v[84:87] offset:20480
  s_waitcnt lgkmcnt(6)
  ds_write_b128 v35, v[88:91] offset:24576
  ds_write_b128 v35, v[92:95] offset:28672
  ds_write_b128 v35, v[96:99] offset:32768
  ds_write_b128 v35, v[100:103] offset:36864
  ds_write_b128 v35, v[104:107] offset:40960
  ds_write_b128 v35, v[108:111] offset:45056
  s_waitcnt lgkmcnt(6)
  ds_write_b128 v35, v[112:115] offset:49152
  ds_write_b128 v35, v[116:119] offset:53248
  ds_write_b128 v35, v[120:123] offset:57344
  s_waitcnt lgkmcnt(0)
  s_barrier
  ds_read_b64_tr_b16 a[40:41], v33 offset:8192
  ds_read_b64_tr_b16 a[42:43], v33 offset:8448
  ds_read_b64_tr_b16 a[120:121], v33 offset:8224
  ds_read_b64_tr_b16 a[122:123], v33 offset:8480
  ds_read_b64_tr_b16 a[200:201], v33 offset:8256
  ds_read_b64_tr_b16 a[202:203], v33 offset:8512
  ds_read_b64_tr_b16 a[44:45], v33 offset:20480
  ds_read_b64_tr_b16 a[46:47], v33 offset:20736
  ds_read_b64_tr_b16 a[124:125], v33 offset:20512
  ds_read_b64_tr_b16 a[126:127], v33 offset:20768
  ds_read_b64_tr_b16 a[204:205], v33 offset:20544
  ds_read_b64_tr_b16 a[206:207], v33 offset:20800
  s_waitcnt lgkmcnt(4)
  ds_read_b64_tr_b16 a[48:49], v33 offset:32768
  ds_read_b64_tr_b16 a[50:51], v33 offset:33024
  ds_read_b64_tr_b16 a[128:129], v33 offset:32800
  ds_read_b64_tr_b16 a[130:131], v33 offset:33056
  ds_read_b64_tr_b16 a[208:209], v33 offset:32832
  ds_read_b64_tr_b16 a[210:211], v33 offset:33088
  ds_read_b64_tr_b16 a[52:53], v33 offset:45056
  ds_read_b64_tr_b16 a[54:55], v33 offset:45312
  ds_read_b64_tr_b16 a[132:133], v33 offset:45088
  ds_read_b64_tr_b16 a[134:135], v33 offset:45344
  ds_read_b64_tr_b16 a[212:213], v33 offset:45120
  ds_read_b64_tr_b16 a[214:215], v33 offset:45376
  s_waitcnt lgkmcnt(4)
  ds_read_b64_tr_b16 a[56:57], v33 offset:57344
  ds_read_b64_tr_b16 a[58:59], v33 offset:57600
  ds_read_b64_tr_b16 a[136:137], v33 offset:57376
  ds_read_b64_tr_b16 a[138:139], v33 offset:57632
  ds_read_b64_tr_b16 a[216:217], v33 offset:57408
  ds_read_b64_tr_b16 a[218:219], v33 offset:57664
  s_waitcnt lgkmcnt(0)
  s_barrier
  s_waitcnt vmcnt(0)
  ds_write_b128 v36, v[124:127] offset:0
  ds_write_b128 v36, v[128:131] offset:4096
  ds_write_b128 v36, v[132:135] offset:8192
  ds_write_b128 v36, v[136:139] offset:12288
  ds_write_b128 v36, v[140:143] offset:16384
  ds_write_b128 v36, v[144:147] offset:20480
  s_waitcnt lgkmcnt(6)
  ds_write_b128 v36, v[148:151] offset:24576
  ds_write_b128 v36, v[152:155] offset:28672
  ds_write_b128 v36, v[156:159] offset:32768
  ds_write_b128 v36, v[160:163] offset:36864
  ds_write_b128 v36, v[164:167] offset:40960
  ds_write_b128 v36, v[168:171] offset:45056
  s_waitcnt lgkmcnt(6)
  ds_write_b128 v36, v[172:175] offset:49152
  ds_write_b128 v36, v[176:179] offset:53248
  ds_write_b128 v36, v[180:183] offset:57344
  s_waitcnt lgkmcnt(0)
  s_barrier
  ds_read_b64_tr_b16 a[60:61], v34 offset:8192
  ds_read_b64_tr_b16 a[62:63], v34 offset:8448
  ds_read_b64_tr_b16 a[140:141], v34 offset:8224
  ds_read_b64_tr_b16 a[142:143], v34 offset:8480
  ds_read_b64_tr_b16 a[220:221], v34 offset:8256
  ds_read_b64_tr_b16 a[222:223], v34 offset:8512
  ds_read_b64_tr_b16 a[64:65], v34 offset:20480
  ds_read_b64_tr_b16 a[66:67], v34 offset:20736
  ds_read_b64_tr_b16 a[144:145], v34 offset:20512
  ds_read_b64_tr_b16 a[146:147], v34 offset:20768
  ds_read_b64_tr_b16 a[224:225], v34 offset:20544
  ds_read_b64_tr_b16 a[226:227], v34 offset:20800
  s_waitcnt lgkmcnt(4)
  ds_read_b64_tr_b16 a[68:69], v34 offset:32768
  ds_read_b64_tr_b16 a[70:71], v34 offset:33024
  ds_read_b64_tr_b16 a[148:149], v34 offset:32800
  ds_read_b64_tr_b16 a[150:151], v34 offset:33056
  ds_read_b64_tr_b16 a[228:229], v34 offset:32832
  ds_read_b64_tr_b16 a[230:231], v34 offset:33088
  ds_read_b64_tr_b16 a[72:73], v34 offset:45056
  ds_read_b64_tr_b16 a[74:75], v34 offset:45312
  ds_read_b64_tr_b16 a[152:153], v34 offset:45088
  ds_read_b64_tr_b16 a[154:155], v34 offset:45344
  ds_read_b64_tr_b16 a[232:233], v34 offset:45120
  ds_read_b64_tr_b16 a[234:235], v34 offset:45376
  s_waitcnt lgkmcnt(4)
  ds_read_b64_tr_b16 a[76:77], v34 offset:57344
  ds_read_b64_tr_b16 a[78:79], v34 offset:57600
  ds_read_b64_tr_b16 a[156:157], v34 offset:57376
  ds_read_b64_tr_b16 a[158:159], v34 offset:57632
  ds_read_b64_tr_b16 a[236:237], v34 offset:57408
  ds_read_b64_tr_b16 a[238:239], v34 offset:57664
  s_waitcnt lgkmcnt(0)
  s_barrier
  v_lshlrev_b32 v6, 4, v1
  v_lshlrev_b32 v29, 3, v1
  v_mov_b32 v31, 0
  s_mov_b32 s34, 0x00ff00ff
  s_mov_b32 s35, 0x00ff00ff
  s_mov_b32 s38, 0xff00ff00
  s_mov_b32 s39, 0xff00ff00
  s_mov_b32 s20, 0
  s_mov_b32 s21, -1
  v_mov_b32 v248, 0xff800000
  s_mov_b32 s16, 0x0000ffff
  s_mov_b32 s17, 0x0000ffff
  v_mov_b32 v21, 0x44444444
  v_mov_b32 v4, 0xeeeeeeee
  v_cndmask_b32 v21, v21, v4, s[38:39]
  s_mov_b32 s60, 0x3dd53b95
  s_mov_b32 s61, 400000
  s_mov_b32 s28, 0
  s_mov_b32 s80, 0
  s_mov_b32 s81, 0
  s_mov_b32 s82, 0
  s_mov_b32 s83, 0
  s_mov_b32 s84, 0
  s_mov_b32 s85, 0
  s_mov_b32 s86, 0
  s_mov_b32 s87, 0
  s_mov_b32 s92, 0
  s_mov_b32 s93, 0
  s_mov_b32 s94, 0
  s_lshr_b32 s40, s27, 5
  s_mul_i32 s40, s40, 10240
  s_add_u32 s40, s40, 630272
  v_add_u32 v23, s40, v6
  v_lshrrev_b32 v5, 13, v23
  v_lshlrev_b32 v5, 14, v5
  v_and_b32 v23, 0x1fff, v23
  v_or_b32 v23, v23, v5
  v_add_u32 v24, s40, v6
  v_add_u32 v24, 1024, v24
  v_lshrrev_b32 v5, 13, v24
  v_lshlrev_b32 v5, 14, v5
  v_and_b32 v24, 0x1fff, v24
  v_or_b32 v24, v24, v5
  v_add_u32 v25, s40, v6
  v_add_u32 v25, 2048, v25
  v_lshrrev_b32 v5, 13, v25
  v_lshlrev_b32 v5, 14, v5
  v_and_b32 v25, 0x1fff, v25
  v_or_b32 v25, v25, v5
  v_mov_b32 v4, 0x80000000
  v_cmp_gt_u32 vcc, 32, v1
  s_nop 1
  v_cndmask_b32 v25, v4, v25, vcc
  v_add_u32 v10, 7680, v6
  v_lshrrev_b32 v12, 1, v2
  v_lshlrev_b32 v12, 8, v12
  v_lshlrev_b32 v4, 4, v3
  v_add_u32 v12, v12, v4
  v_and_b32 v4, 1, v2
  v_lshlrev_b32 v4, 3, v4
  v_add_u32 v12, v12, v4
  v_lshlrev_b32 v13, 4, v3
  v_add_u32 v13, v13, v4
  s_mul_i32 s41, s25, 9216
  s_mul_i32 s40, s26, 768
  s_add_u32 s40, s40, s41
  v_add_u32 v100, s40, v6
  v_add_u32 v101, 3072, v100
  v_add_u32 v102, 6144, v100
  s_add_u32 s40, s40, 6144
  v_add_u32 v12, s40, v12
  v_add_u32 v13, s40, v13
  v_add_u32 v13, 512, v13
  v_lshrrev_b32 v4, 13, v12
  v_lshlrev_b32 v4, 14, v4
  v_and_b32 v12, 0x1fff, v12
  v_or_b32 v12, v12, v4
  v_lshrrev_b32 v4, 13, v13
  v_lshlrev_b32 v4, 14, v4
  v_and_b32 v13, 0x1fff, v13
  v_or_b32 v13, v13, v4
  v_lshrrev_b32 v4, 13, v102
  v_lshlrev_b32 v4, 14, v4
  v_and_b32 v102, 0x1fff, v102
  v_or_b32 v102, v102, v4
  v_lshrrev_b32 v4, 13, v100
  v_lshlrev_b32 v4, 14, v4
  v_and_b32 v100, 0x1fff, v100
  v_or_b32 v100, v100, v4
  v_lshrrev_b32 v4, 13, v101
  v_lshlrev_b32 v4, 14, v4
  v_and_b32 v101, 0x1fff, v101
  v_or_b32 v101, v101, v4
  v_mov_b32 v4, 0x80000000
  v_cmp_gt_u32 vcc, 48, v1
  s_nop 1
  v_cndmask_b32 v102, v4, v102, vcc
  v_mov_b32 v4, 0x80000000
  v_cmp_gt_u32 vcc, 48, v1
  s_nop 1
  v_cndmask_b32 v101, v4, v101, vcc
  v_mov_b32 v4, 0x80000000
  v_cmp_gt_u32 vcc, 48, v1
  s_nop 1
  v_cndmask_b32 v100, v4, v100, vcc
  v_mov_b32 v4, 0x80000000
  v_cmp_gt_u32 vcc, 32, v1
  s_nop 1
  v_cndmask_b32 v13, v4, v13, vcc
  v_add_u32 v16, s41, v6
  v_add_u32 v16, 6144, v16
  v_lshrrev_b32 v4, 13, v16
  v_lshlrev_b32 v4, 14, v4
  v_and_b32 v16, 0x1fff, v16
  v_or_b32 v16, v16, v4
  v_add_u32 v17, s41, v6
  v_add_u32 v17, 7168, v17
  v_lshrrev_b32 v4, 13, v17
  v_lshlrev_b32 v4, 14, v4
  v_and_b32 v17, 0x1fff, v17
  v_or_b32 v17, v17, v4
  v_add_u32 v18, s41, v6
  v_add_u32 v18, 8192, v18
  v_lshrrev_b32 v4, 13, v18
  v_lshlrev_b32 v4, 14, v4
  v_and_b32 v18, 0x1fff, v18
  v_or_b32 v18, v18, v4
  v_add_u32 v19, 16384, v6
  v_lshrrev_b32 v106, 1, v2
  v_lshlrev_b32 v106, 14, v106
  v_and_b32 v4, 1, v2
  v_lshlrev_b32 v4, 12, v4
  v_add_u32 v106, v106, v4
  v_and_b32 v4, 7, v1
  v_lshlrev_b32 v4, 4, v4
  v_add_u32 v106, v106, v4
  s_lshl_b32 s40, s25, 7
  v_add_u32 v106, s40, v106
  s_mul_i32 s48, s26, 163840
  s_add_u32 s48, s48, 589824
  s_and_b32 s56, s27, 31
  s_lshr_b32 s52, s56, 1
  s_lshl_b32 s52, s52, 14
  s_and_b32 s40, s56, 1
  s_lshl_b32 s40, s40, 12
  s_add_u32 s52, s52, s40
  s_add_u32 s52, s52, 589824
  s_lshr_b32 s72, s27, 5
  s_mul_i32 s72, s72, 81920
  s_lshl_b32 s40, s56, 10
  s_add_u32 s72, s72, s40
  s_lshr_b32 s40, s72, 13
  s_lshl_b32 s40, s40, 14
  s_and_b32 s72, s72, 0x1fff
  s_or_b32 s72, s72, s40
  s_add_u32 s72, s72, 589824
  s_add_u32 s56, s56, 32
  s_lshr_b32 s51, s56, 1
  s_lshl_b32 s51, s51, 14
  s_and_b32 s40, s56, 1
  s_lshl_b32 s40, s40, 12
  s_add_u32 s51, s51, s40
  s_add_u32 s51, s51, 589824
  s_lshr_b32 s73, s27, 5
  s_mul_i32 s73, s73, 81920
  s_lshl_b32 s40, s56, 10
  s_add_u32 s73, s73, s40
  s_lshr_b32 s40, s73, 13
  s_lshl_b32 s40, s40, 14
  s_and_b32 s73, s73, 0x1fff
  s_or_b32 s73, s73, s40
  s_add_u32 s73, s73, 589824
  v_lshlrev_b32 v9, 10, v2
  v_and_b32 v4, 7, v1
  v_lshlrev_b32 v4, 4, v4
  v_add_u32 v9, v9, v4
  s_and_b32 s40, s25, 7
  s_lshl_b32 s40, s40, 7
  v_add_u32 v9, s40, v9
  s_lshr_b32 s77, s27, 5
  s_mul_i32 s77, s77, 81920
  s_mul_i32 s40, s26, 20480
  s_add_u32 s77, s77, s40
  s_lshr_b32 s40, s27, 5
  s_mul_i32 s40, s40, 10240
  s_add_u32 s40, s40, 622592
  s_and_b32 s41, s27, 31
  s_lshl_b32 s42, s41, 7
  s_add_u32 s40, s40, s42
  v_lshrrev_b32 v30, 3, v1
  v_lshlrev_b32 v30, 12, v30
  v_and_b32 v4, 7, v1
  v_lshlrev_b32 v4, 4, v4
  v_add_u32 v30, v30, v4
  v_add_u32 v30, s40, v30
  v_lshrrev_b32 v4, 13, v30
  v_lshlrev_b32 v4, 14, v4
  v_and_b32 v30, 0x1fff, v30
  v_or_b32 v30, v30, v4
  v_mov_b32 v107, v30
  v_bfe_u32 v30, v1, 3, 1
  v_lshlrev_b32 v30, 12, v30
  v_and_b32 v4, 7, v1
  v_lshlrev_b32 v4, 4, v4
  v_add_u32 v30, v30, v4
  v_lshlrev_b32 v4, 3, v2
  v_add_u32 v30, v30, v4
  s_lshr_b32 s40, s27, 5
  s_mul_i32 s40, s40, 10240
  s_add_u32 s40, s40, 622592
  s_add_u32 s40, s40, s42
  v_add_u32 v30, s40, v30
  v_lshrrev_b32 v4, 13, v30
  v_lshlrev_b32 v4, 14, v4
  v_and_b32 v30, 0x1fff, v30
  v_or_b32 v30, v30, v4
  v_mov_b32 v4, 0x80000000
  v_cmp_gt_u32 vcc, 32, v1
  s_nop 1
  v_cndmask_b32 v30, v4, v30, vcc
  v_mov_b32 v105, s52
  v_mov_b32 v4, s51
  v_cndmask_b32 v105, v105, v4, s[38:39]
  v_lshlrev_b32 v4, 7, v2
  v_add_u32 v105, v105, v4
  v_and_b32 v4, 7, v1
  v_lshlrev_b32 v4, 4, v4
  v_add_u32 v105, v105, v4
  s_cmp_lt_u32 s41, 16
  s_cselect_b32 s40, 24, 16
  v_mov_b32 v4, 0x80000000
  v_cmp_gt_u32 vcc, s40, v1
  s_nop 1
  v_cndmask_b32 v107, v4, v107, vcc
  v_mov_b32 v108, 0
  v_mov_b32 v4, 0x3f80
  v_cmp_eq_u32 vcc, 0, v3
  s_nop 1
  v_cndmask_b32 v108, v108, v4, vcc
  v_mov_b32 v4, 0x3f800000
  v_cmp_eq_u32 vcc, 1, v3
  s_nop 1
  v_cndmask_b32 v108, v108, v4, vcc
  v_mov_b32 v109, 0
  v_mov_b32 v4, 0x3f80
  v_cmp_eq_u32 vcc, 2, v3
  s_nop 1
  v_cndmask_b32 v109, v109, v4, vcc
  v_mov_b32 v4, 0x3f800000
  v_cmp_eq_u32 vcc, 3, v3
  s_nop 1
  v_cndmask_b32 v109, v109, v4, vcc
  v_mov_b32 v110, 0
  v_mov_b32 v4, 0x3f80
  v_cmp_eq_u32 vcc, 4, v3
  s_nop 1
  v_cndmask_b32 v110, v110, v4, vcc
  v_mov_b32 v4, 0x3f800000
  v_cmp_eq_u32 vcc, 5, v3
  s_nop 1
  v_cndmask_b32 v110, v110, v4, vcc
  v_mov_b32 v111, 0
  v_mov_b32 v4, 0x3f80
  v_cmp_eq_u32 vcc, 6, v3
  s_nop 1
  v_cndmask_b32 v111, v111, v4, vcc
  v_mov_b32 v4, 0x3f800000
  v_cmp_eq_u32 vcc, 7, v3
  s_nop 1
  v_cndmask_b32 v111, v111, v4, vcc
  v_mov_b32 v112, -1
  v_mov_b32 v113, -1
  v_mov_b32 v114, -1
  v_mov_b32 v115, -1
  v_mov_b32 v116, 1
  s_load_dwordx2 s[96:97], s[0:1], 96
  v_and_b32 v5, 15, v1
  v_lshlrev_b32 v5, 2, v5
  s_mov_b32 s43, 0
  s_waitcnt lgkmcnt(0)
RS3_MD:
  global_load_dword v4, v5, s[96:97] sc1
  s_waitcnt vmcnt(0)
  s_mov_b32 s40, 0
  s_mov_b32 s57, 1
  v_readlane_b32 s41, v4, 0
  s_nop 0
  s_add_u32 s40, s40, s41
  s_cmp_eq_u32 s41, 32
  s_cselect_b32 s57, s57, 0
  v_readlane_b32 s41, v4, 1
  s_nop 0
  s_add_u32 s40, s40, s41
  s_cmp_eq_u32 s41, 32
  s_cselect_b32 s57, s57, 0
  v_readlane_b32 s41, v4, 2
  s_nop 0
  s_add_u32 s40, s40, s41
  s_cmp_eq_u32 s41, 32
  s_cselect_b32 s57, s57, 0
  v_readlane_b32 s41, v4, 3
  s_nop 0
  s_add_u32 s40, s40, s41
  s_cmp_eq_u32 s41, 32
  s_cselect_b32 s57, s57, 0
  v_readlane_b32 s41, v4, 4
  s_nop 0
  s_add_u32 s40, s40, s41
  s_cmp_eq_u32 s41, 32
  s_cselect_b32 s57, s57, 0
  v_readlane_b32 s41, v4, 5
  s_nop 0
  s_add_u32 s40, s40, s41
  s_cmp_eq_u32 s41, 32
  s_cselect_b32 s57, s57, 0
  v_readlane_b32 s41, v4, 6
  s_nop 0
  s_add_u32 s40, s40, s41
  s_cmp_eq_u32 s41, 32
  s_cselect_b32 s57, s57, 0
  v_readlane_b32 s41, v4, 7
  s_nop 0
  s_add_u32 s40, s40, s41
  s_cmp_eq_u32 s41, 32
  s_cselect_b32 s57, s57, 0
  v_readlane_b32 s41, v4, 12
  v_readlane_b32 s42, v4, 13
  s_cmp_ge_u32 s40, 256
  s_nop 2
  s_cbranch_scc0 RS3_MDN
  s_cmp_ge_u32 s41, 80
  s_cbranch_scc0 RS3_MDN
  s_and_b32 s40, s42, 0xaa
  s_cmp_eq_u32 s40, 0xaa
  s_cbranch_scc1 RS3_POLOK
RS3_MDN:
  s_sleep 4
  s_add_u32 s43, s43, 1
  s_cmp_lt_u32 s43, 0x200000
  s_cbranch_scc1 RS3_MD
  s_mov_b32 s57, 0
RS3_POLOK:
  s_and_b32 s40, s42, 0x55
  s_xor_b32 s40, s40, 0x44
  s_bcnt1_i32_b32 s41, s40
  s_cmp_ge_u32 s41, 3
  s_cselect_b32 s40, 0x55, s40
  s_cmp_le_u32 s41, 1
  s_cselect_b32 s40, 0, s40
  s_xor_b32 s42, s40, 0x44
  s_bfe_u32 s40, s42, 65536
  s_lshl_b32 s40, s40, 13
  s_add_u32 s30, s40, 0
  s_bfe_u32 s40, s42, 65538
  s_lshl_b32 s40, s40, 13
  s_add_u32 s31, s40, 2097152
  s_bfe_u32 s40, s42, 65540
  s_lshl_b32 s40, s40, 13
  s_add_u32 s32, s40, 4194304
  s_bfe_u32 s40, s42, 65542
  s_lshl_b32 s40, s40, 13
  s_add_u32 s29, s40, 6291456
  s_barrier
  ds_write_b128 v10, v[200:203]
  ds_write_b128 v10, v[204:207] offset:1024
  s_mov_b32 exec_hi, 0
  ds_write_b128 v10, v[208:211] offset:2048
  s_mov_b64 exec, -1
  s_waitcnt vmcnt(0) lgkmcnt(0)
  s_barrier
  s_cmp_eq_u32 s57, 0
  s_cbranch_scc1 RS3S_B0
  s_branch RS3F_B0
RS3F_LOOP:
  s_mov_b32 s43, 0
RS3F_AGP:
  buffer_load_dwordx4 v[48:51], v23, s[4:7], s29 offen sc1
  buffer_load_dwordx4 v[52:55], v24, s[4:7], s29 offen sc1
  buffer_load_dwordx4 v[56:59], v25, s[4:7], s29 offen sc1
  s_waitcnt vmcnt(0)
  v_max3_u32 v4, v48, v49, v50
  v_max3_u32 v4, v4, v51, v52
  v_max3_u32 v4, v4, v53, v54
  v_max3_u32 v4, v4, v55, v56
  v_max3_u32 v4, v4, v57, v58
  v_max_u32 v4, v4, v59
  v_cmp_eq_u32 vcc, -1, v4
  s_nop 3
  s_cbranch_vccz RS3F_AGP_OK
  s_add_u32 s43, s43, 1
  s_cmp_lt_u32 s43, s61
  s_cbranch_scc1 RS3F_AGP
  s_mov_b32 s61, 0
RS3F_AGP_OK:
  ds_write_b128 v10, v[48:51]
  ds_write_b128 v10, v[52:55] offset:1024
  s_mov_b32 exec_hi, 0
  ds_write_b128 v10, v[56:59] offset:2048
  s_mov_b64 exec, -1
RS3F_B0:
  s_waitcnt lgkmcnt(0)
  s_barrier
  s_memtime s[98:99]
  ds_read_b128 v[48:51], v6 offset:0
  ds_read_b128 v[52:55], v6 offset:1024
  ds_read_b128 v[56:59], v6 offset:2048
  ds_read_b128 v[60:63], v6 offset:3072
  ds_read_b128 v[64:67], v6 offset:4096
  ds_read_b128 v[68:71], v6 offset:5120
  ds_read_b128 v[72:75], v6 offset:6144
  ds_read_b128 v[76:79], v6 offset:7168
  ds_read_b128 v[80:83], v6 offset:8192
  ds_read_b128 v[84:87], v6 offset:9216
  v_mov_b32 v88, 0
  v_mov_b32 v89, 0
  v_mov_b32 v90, 0
  v_mov_b32 v91, 0
  v_mov_b32 v92, 0
  v_mov_b32 v93, 0
  v_mov_b32 v94, 0
  v_mov_b32 v95, 0
  v_mov_b32 v96, 0
  v_mov_b32 v97, 0
  v_mov_b32 v98, 0
  v_mov_b32 v99, 0
  s_waitcnt lgkmcnt(9)
  v_smfmac_f32_16x16x64_bf16 v[88:91], v[48:51], a[0:7], v21
  v_smfmac_f32_16x16x64_bf16 v[92:95], v[48:51], a[80:87], v21
  s_waitcnt lgkmcnt(8)
  v_smfmac_f32_16x16x64_bf16 v[88:91], v[52:55], a[8:15], v21
  v_smfmac_f32_16x16x64_bf16 v[92:95], v[52:55], a[88:95], v21
  s_waitcnt lgkmcnt(7)
  v_smfmac_f32_16x16x64_bf16 v[88:91], v[56:59], a[16:23], v21
  v_smfmac_f32_16x16x64_bf16 v[92:95], v[56:59], a[96:103], v21
  s_waitcnt lgkmcnt(6)
  v_smfmac_f32_16x16x64_bf16 v[88:91], v[60:63], a[24:31], v21
  v_smfmac_f32_16x16x64_bf16 v[92:95], v[60:63], a[104:111], v21
  s_waitcnt lgkmcnt(5)
  v_smfmac_f32_16x16x64_bf16 v[88:91], v[64:67], a[32:39], v21
  v_smfmac_f32_16x16x64_bf16 v[92:95], v[64:67], a[112:119], v21
  s_waitcnt lgkmcnt(4)
  v_smfmac_f32_16x16x64_bf16 v[88:91], v[68:71], a[40:47], v21
  v_smfmac_f32_16x16x64_bf16 v[92:95], v[68:71], a[120:127], v21
  s_waitcnt lgkmcnt(3)
  v_smfmac_f32_16x16x64_bf16 v[88:91], v[72:75], a[48:55], v21
  v_smfmac_f32_16x16x64_bf16 v[92:95], v[72:75], a[128:135], v21
  s_waitcnt lgkmcnt(2)
  v_smfmac_f32_16x16x64_bf16 v[88:91], v[76:79], a[56:63], v21
  v_smfmac_f32_16x16x64_bf16 v[92:95], v[76:79], a[136:143], v21
  s_waitcnt lgkmcnt(1)
  v_smfmac_f32_16x16x64_bf16 v[88:91], v[80:83], a[64:71], v21
  v_smfmac_f32_16x16x64_bf16 v[92:95], v[80:83], a[144:151], v21
  s_waitcnt lgkmcnt(0)
  v_smfmac_f32_16x16x64_bf16 v[88:91], v[84:87], a[72:79], v21
  v_smfmac_f32_16x16x64_bf16 v[92:95], v[84:87], a[152:159], v21
  v_smfmac_f32_16x16x64_bf16 v[96:99], v[48:51], a[160:167], v21
  v_smfmac_f32_16x16x64_bf16 v[96:99], v[52:55], a[168:175], v21
  v_smfmac_f32_16x16x64_bf16 v[96:99], v[56:59], a[176:183], v21
  s_nop 4
  v_permlane32_swap_b32 v88, v92
  v_smfmac_f32_16x16x64_bf16 v[96:99], v[60:63], a[184:191], v21
  v_permlane32_swap_b32 v89, v93
  v_smfmac_f32_16x16x64_bf16 v[96:99], v[64:67], a[192:199], v21
  v_permlane32_swap_b32 v90, v94
  v_smfmac_f32_16x16x64_bf16 v[96:99], v[68:71], a[200:207], v21
  v_permlane32_swap_b32 v91, v95
  v_smfmac_f32_16x16x64_bf16 v[96:99], v[72:75], a[208:215], v21
  v_add_f32 v88, v88, v92
  v_add_f32 v89, v89, v93
  v_smfmac_f32_16x16x64_bf16 v[96:99], v[76:79], a[216:223], v21
  v_add_f32 v90, v90, v94
  v_add_f32 v91, v91, v95
  v_smfmac_f32_16x16x64_bf16 v[96:99], v[80:83], a[224:231], v21
  v_cvt_pk_bf16_f32 v140, v88, v89
  v_cvt_pk_bf16_f32 v141, v90, v91
  v_smfmac_f32_16x16x64_bf16 v[96:99], v[84:87], a[232:239], v21
  buffer_store_dwordx2 v[140:141], v12, s[4:7], s30 offen
  s_nop 6
  v_mov_b32 v148, v96
  v_mov_b32 v149, v97
  v_mov_b32 v150, v98
  v_mov_b32 v151, v99
  v_permlane32_swap_b32 v96, v148
  v_permlane32_swap_b32 v97, v149
  v_permlane32_swap_b32 v98, v150
  v_permlane32_swap_b32 v99, v151
  v_add_f32 v96, v96, v148
  v_add_f32 v97, v97, v149
  v_add_f32 v98, v98, v150
  v_add_f32 v99, v99, v151
  v_cvt_pk_bf16_f32 v144, v96, v97
  v_cvt_pk_bf16_f32 v145, v98, v99
  buffer_store_dwordx2 v[144:145], v13, s[4:7], s30 offen
  s_nop 0
WU_21:
  s_memtime s[58:59]
  s_waitcnt lgkmcnt(0)
  s_sub_u32 s58, s58, s98
  s_cmp_ge_u32 s58, 1300
  s_cbranch_scc1 WU_21_D
  s_sub_u32 s58, 1300, s58
  s_cmp_lt_u32 s58, 96
  s_cbranch_scc1 WU_21
  s_sleep 1
  s_branch WU_21
WU_21_D:
  buffer_load_dwordx4 v[32:35], v16, s[4:7], s30 offen sc1
  buffer_load_dwordx4 v[36:39], v17, s[4:7], s30 offen sc1
  buffer_load_dwordx4 v[40:43], v18, s[4:7], s30 offen sc1
  s_barrier
  s_mov_b32 s43, 0
  s_branch RS3F_VP_W
RS3F_VP:
  buffer_load_dwordx4 v[32:35], v16, s[4:7], s30 offen sc1
  buffer_load_dwordx4 v[36:39], v17, s[4:7], s30 offen sc1
  buffer_load_dwordx4 v[40:43], v18, s[4:7], s30 offen sc1
RS3F_VP_W:
  s_waitcnt vmcnt(0)
  v_max3_u32 v4, v32, v33, v34
  v_max3_u32 v4, v4, v35, v36
  v_max3_u32 v4, v4, v37, v38
  v_max3_u32 v4, v4, v39, v40
  v_max3_u32 v4, v4, v41, v42
  v_max_u32 v4, v4, v43
  v_cmp_eq_u32 vcc, -1, v4
  s_nop 3
  s_cbranch_vccz RS3F_VP_OK
  s_add_u32 s43, s43, 1
  s_cmp_lt_u32 s43, s61
  s_cbranch_scc1 RS3F_VP
  s_mov_b32 s61, 0
RS3F_VP_OK:
  ds_write_b128 v19, v[32:35] offset:0
  ds_write_b128 v19, v[36:39] offset:1024
  ds_write_b128 v19, v[40:43] offset:2048
  s_waitcnt lgkmcnt(0)
  s_barrier
  s_memtime s[96:97]
  s_cmp_eq_u32 s28, 63
  s_cbranch_scc1 RS3F_DONE
  buffer_store_dwordx4 v[112:115], v100, s[4:7], s32 offen
  buffer_store_dwordx4 v[112:115], v101, s[4:7], s32 offen
  buffer_store_dwordx4 v[112:115], v102, s[4:7], s32 offen
  s_add_u32 s40, s32, s48
  s_mov_b64 exec, s[34:35]
  buffer_store_dwordx4 v[112:115], v106, s[4:7], s40 offen sc1
  s_add_u32 s40, s40, 32768
  buffer_store_dwordx4 v[112:115], v106, s[4:7], s40 offen sc1
  s_add_u32 s40, s40, 32768
  buffer_store_dwordx4 v[112:115], v106, s[4:7], s40 offen sc1
  s_add_u32 s40, s40, 32768
  buffer_store_dwordx4 v[112:115], v106, s[4:7], s40 offen sc1
  s_add_u32 s40, s40, 32768
  buffer_store_dwordx4 v[112:115], v106, s[4:7], s40 offen sc1
  s_mov_b64 exec, -1
  buffer_store_dwordx4 v[112:115], v107, s[4:7], s32 offen
  s_nop 1
WU_22:
  s_memtime s[58:59]
  s_waitcnt lgkmcnt(0)
  s_sub_u32 s58, s58, s96
  s_cmp_ge_u32 s58, 1150
  s_cbranch_scc1 WU_22_D
  s_sub_u32 s58, 1150, s58
  s_cmp_lt_u32 s58, 96
  s_cbranch_scc1 WU_22
  s_sleep 1
  s_branch WU_22
WU_22_D:
  s_mov_b32 s43, 0
RS3F_RP:
  buffer_load_dwordx4 v[32:35], v105, s[4:7], s30 offen offset:0 sc1
  buffer_load_dwordx4 v[36:39], v105, s[4:7], s30 offen offset:512 sc1
  buffer_load_dwordx4 v[40:43], v105, s[4:7], s30 offen offset:1024 sc1
  buffer_load_dwordx4 v[44:47], v105, s[4:7], s30 offen offset:1536 sc1
  buffer_load_dwordx4 v[48:51], v105, s[4:7], s30 offen offset:2048 sc1
  buffer_load_dwordx4 v[52:55], v105, s[4:7], s30 offen offset:2560 sc1
  buffer_load_dwordx4 v[56:59], v105, s[4:7], s30 offen offset:3072 sc1
  buffer_load_dwordx4 v[60:63], v105, s[4:7], s30 offen offset:3584 sc1
  s_waitcnt vmcnt(0)
  v_max3_u32 v4, v32, v33, v34
  v_max3_u32 v4, v4, v35, v36
  v_max3_u32 v4, v4, v37, v38
  v_max3_u32 v4, v4, v39, v40
  v_max3_u32 v4, v4, v41, v42
  v_max3_u32 v4, v4, v43, v44
  v_max3_u32 v4, v4, v45, v46
  v_max3_u32 v4, v4, v47, v48
  v_max3_u32 v4, v4, v49, v50
  v_max3_u32 v4, v4, v51, v52
  v_max3_u32 v4, v4, v53, v54
  v_max3_u32 v4, v4, v55, v56
  v_max3_u32 v4, v4, v57, v58
  v_max3_u32 v4, v4, v59, v60
  v_max3_u32 v4, v4, v61, v62
  v_max_u32 v4, v4, v63
  v_cmp_eq_u32 vcc, -1, v4
  s_nop 3
  s_cbranch_vccz RS3F_RP_OK
  s_add_u32 s43, s43, 1
  s_cmp_lt_u32 s43, s61
  s_cbranch_scc1 RS3F_RP
  s_mov_b32 s61, 0
RS3F_RP_OK:
  v_mfma_f32_16x16x32_bf16 v[64:67], v[108:111], v[32:35], 0
  v_mfma_f32_16x16x32_bf16 v[64:67], v[108:111], v[36:39], v[64:67]
  v_mfma_f32_16x16x32_bf16 v[64:67], v[108:111], v[40:43], v[64:67]
  v_mfma_f32_16x16x32_bf16 v[64:67], v[108:111], v[44:47], v[64:67]
  v_mfma_f32_16x16x32_bf16 v[64:67], v[108:111], v[48:51], v[64:67]
  v_mfma_f32_16x16x32_bf16 v[64:67], v[108:111], v[52:55], v[64:67]
  v_mfma_f32_16x16x32_bf16 v[64:67], v[108:111], v[56:59], v[64:67]
  v_mfma_f32_16x16x32_bf16 v[64:67], v[108:111], v[60:63], v[64:67]
  s_nop 7
  v_cvt_pk_bf16_f32 v160, v64, v65
  v_cvt_pk_bf16_f32 v161, v66, v67
  buffer_store_dwordx2 v[160:161], v30, s[4:7], s30 offen
  s_add_u32 s28, s28, 1
  s_cmp_ge_u32 s28, 64
  s_cbranch_scc1 RS3F_DONE
  s_mov_b32 s40, s29
  s_mov_b32 s29, s30
  s_mov_b32 s30, s31
  s_mov_b32 s31, s32
  s_mov_b32 s32, s40
  s_memtime s[36:37]
  s_branch RS3F_LOOP
RS3F_DONE:
  s_waitcnt vmcnt(0)
  s_barrier
  s_endpgm
RS3S_LOOP:
WU_23:
  s_memtime s[58:59]
  s_waitcnt lgkmcnt(0)
  s_sub_u32 s58, s58, s36
  s_cmp_ge_u32 s58, 650
  s_cbranch_scc1 WU_23_D
  s_sub_u32 s58, 650, s58
  s_cmp_lt_u32 s58, 96
  s_cbranch_scc1 WU_23
  s_sleep 1
  s_branch WU_23
WU_23_D:
  s_mov_b32 s43, 0
RS3S_AGP:
  buffer_load_dwordx4 v[48:51], v23, s[4:7], s29 offen sc1
  buffer_load_dwordx4 v[52:55], v24, s[4:7], s29 offen sc1
  buffer_load_dwordx4 v[56:59], v25, s[4:7], s29 offen sc1
  s_waitcnt vmcnt(0)
  v_max3_u32 v4, v48, v49, v50
  v_max3_u32 v4, v4, v51, v52
  v_max3_u32 v4, v4, v53, v54
  v_max3_u32 v4, v4, v55, v56
  v_max3_u32 v4, v4, v57, v58
  v_max_u32 v4, v4, v59
  v_cmp_eq_u32 vcc, -1, v4
  s_nop 3
  s_cbranch_vccz RS3S_AGP_OK
  s_add_u32 s43, s43, 1
  s_cmp_lt_u32 s43, s61
  s_cbranch_scc1 RS3S_AGP
  s_mov_b32 s61, 0
RS3S_AGP_OK:
  ds_write_b128 v10, v[48:51]
  ds_write_b128 v10, v[52:55] offset:1024
  s_mov_b32 exec_hi, 0
  ds_write_b128 v10, v[56:59] offset:2048
  s_mov_b64 exec, -1
RS3S_B0:
  s_waitcnt lgkmcnt(0)
  s_barrier
  s_memtime s[98:99]
  ds_read_b128 v[48:51], v6 offset:0
  ds_read_b128 v[52:55], v6 offset:1024
  ds_read_b128 v[56:59], v6 offset:2048
  ds_read_b128 v[60:63], v6 offset:3072
  ds_read_b128 v[64:67], v6 offset:4096
  ds_read_b128 v[68:71], v6 offset:5120
  ds_read_b128 v[72:75], v6 offset:6144
  ds_read_b128 v[76:79], v6 offset:7168
  ds_read_b128 v[80:83], v6 offset:8192
  ds_read_b128 v[84:87], v6 offset:9216
  v_mov_b32 v88, 0
  v_mov_b32 v89, 0
  v_mov_b32 v90, 0
  v_mov_b32 v91, 0
  v_mov_b32 v92, 0
  v_mov_b32 v93, 0
  v_mov_b32 v94, 0
  v_mov_b32 v95, 0
  v_mov_b32 v96, 0
  v_mov_b32 v97, 0
  v_mov_b32 v98, 0
  v_mov_b32 v99, 0
  s_waitcnt lgkmcnt(9)
  v_smfmac_f32_16x16x64_bf16 v[88:91], v[48:51], a[0:7], v21
  v_smfmac_f32_16x16x64_bf16 v[92:95], v[48:51], a[80:87], v21
  s_waitcnt lgkmcnt(8)
  v_smfmac_f32_16x16x64_bf16 v[88:91], v[52:55], a[8:15], v21
  v_smfmac_f32_16x16x64_bf16 v[92:95], v[52:55], a[88:95], v21
  s_waitcnt lgkmcnt(7)
  v_smfmac_f32_16x16x64_bf16 v[88:91], v[56:59], a[16:23], v21
  v_smfmac_f32_16x16x64_bf16 v[92:95], v[56:59], a[96:103], v21
  s_waitcnt lgkmcnt(6)
  v_smfmac_f32_16x16x64_bf16 v[88:91], v[60:63], a[24:31], v21
  v_smfmac_f32_16x16x64_bf16 v[92:95], v[60:63], a[104:111], v21
  s_waitcnt lgkmcnt(5)
  v_smfmac_f32_16x16x64_bf16 v[88:91], v[64:67], a[32:39], v21
  v_smfmac_f32_16x16x64_bf16 v[92:95], v[64:67], a[112:119], v21
  s_waitcnt lgkmcnt(4)
  v_smfmac_f32_16x16x64_bf16 v[88:91], v[68:71], a[40:47], v21
  v_smfmac_f32_16x16x64_bf16 v[92:95], v[68:71], a[120:127], v21
  s_waitcnt lgkmcnt(3)
  v_smfmac_f32_16x16x64_bf16 v[88:91], v[72:75], a[48:55], v21
  v_smfmac_f32_16x16x64_bf16 v[92:95], v[72:75], a[128:135], v21
  s_waitcnt lgkmcnt(2)
  v_smfmac_f32_16x16x64_bf16 v[88:91], v[76:79], a[56:63], v21
  v_smfmac_f32_16x16x64_bf16 v[92:95], v[76:79], a[136:143], v21
  s_waitcnt lgkmcnt(1)
  v_smfmac_f32_16x16x64_bf16 v[88:91], v[80:83], a[64:71], v21
  v_smfmac_f32_16x16x64_bf16 v[92:95], v[80:83], a[144:151], v21
  s_waitcnt lgkmcnt(0)
  v_smfmac_f32_16x16x64_bf16 v[88:91], v[84:87], a[72:79], v21
  v_smfmac_f32_16x16x64_bf16 v[92:95], v[84:87], a[152:159], v21
  v_smfmac_f32_16x16x64_bf16 v[96:99], v[48:51], a[160:167], v21
  v_smfmac_f32_16x16x64_bf16 v[96:99], v[52:55], a[168:175], v21
  v_smfmac_f32_16x16x64_bf16 v[96:99], v[56:59], a[176:183], v21
  s_nop 4
  v_permlane32_swap_b32 v88, v92
  v_smfmac_f32_16x16x64_bf16 v[96:99], v[60:63], a[184:191], v21
  v_permlane32_swap_b32 v89, v93
  v_smfmac_f32_16x16x64_bf16 v[96:99], v[64:67], a[192:199], v21
  v_permlane32_swap_b32 v90, v94
  v_smfmac_f32_16x16x64_bf16 v[96:99], v[68:71], a[200:207], v21
  v_permlane32_swap_b32 v91, v95
  v_smfmac_f32_16x16x64_bf16 v[96:99], v[72:75], a[208:215], v21
  v_add_f32 v88, v88, v92
  v_add_f32 v89, v89, v93
  v_smfmac_f32_16x16x64_bf16 v[96:99], v[76:79], a[216:223], v21
  v_add_f32 v90, v90, v94
  v_add_f32 v91, v91, v95
  v_smfmac_f32_16x16x64_bf16 v[96:99], v[80:83], a[224:231], v21
  v_cvt_pk_bf16_f32 v140, v88, v89
  v_cvt_pk_bf16_f32 v141, v90, v91
  v_smfmac_f32_16x16x64_bf16 v[96:99], v[84:87], a[232:239], v21
  buffer_store_dwordx2 v[140:141], v12, s[4:7], s30 offen sc1
  s_nop 6
  v_mov_b32 v148, v96
  v_mov_b32 v149, v97
  v_mov_b32 v150, v98
  v_mov_b32 v151, v99
  v_permlane32_swap_b32 v96, v148
  v_permlane32_swap_b32 v97, v149
  v_permlane32_swap_b32 v98, v150
  v_permlane32_swap_b32 v99, v151
  v_add_f32 v96, v96, v148
  v_add_f32 v97, v97, v149
  v_add_f32 v98, v98, v150
  v_add_f32 v99, v99, v151
  v_cvt_pk_bf16_f32 v144, v96, v97
  v_cvt_pk_bf16_f32 v145, v98, v99
  buffer_store_dwordx2 v[144:145], v13, s[4:7], s30 offen sc1
  s_nop 0
WU_24:
  s_memtime s[58:59]
  s_waitcnt lgkmcnt(0)
  s_sub_u32 s58, s58, s98
  s_cmp_ge_u32 s58, 1500
  s_cbranch_scc1 WU_24_D
  s_sub_u32 s58, 1500, s58
  s_cmp_lt_u32 s58, 96
  s_cbranch_scc1 WU_24
  s_sleep 1
  s_branch WU_24
WU_24_D:
  buffer_load_dwordx4 v[32:35], v16, s[4:7], s30 offen sc1
  buffer_load_dwordx4 v[36:39], v17, s[4:7], s30 offen sc1
  buffer_load_dwordx4 v[40:43], v18, s[4:7], s30 offen sc1
  s_barrier
  s_mov_b32 s43, 0
  s_branch RS3S_VP_W
RS3S_VP:
  buffer_load_dwordx4 v[32:35], v16, s[4:7], s30 offen sc1
  buffer_load_dwordx4 v[36:39], v17, s[4:7], s30 offen sc1
  buffer_load_dwordx4 v[40:43], v18, s[4:7], s30 offen sc1
RS3S_VP_W:
  s_waitcnt vmcnt(0)
  v_max3_u32 v4, v32, v33, v34
  v_max3_u32 v4, v4, v35, v36
  v_max3_u32 v4, v4, v37, v38
  v_max3_u32 v4, v4, v39, v40
  v_max3_u32 v4, v4, v41, v42
  v_max_u32 v4, v4, v43
  v_cmp_eq_u32 vcc, -1, v4
  s_nop 3
  s_cbranch_vccz RS3S_VP_OK
  s_add_u32 s43, s43, 1
  s_cmp_lt_u32 s43, s61
  s_cbranch_scc1 RS3S_VP
  s_mov_b32 s61, 0
RS3S_VP_OK:
  ds_write_b128 v19, v[32:35] offset:0
  ds_write_b128 v19, v[36:39] offset:1024
  ds_write_b128 v19, v[40:43] offset:2048
  s_waitcnt lgkmcnt(0)
  s_barrier
  s_memtime s[96:97]
  s_cmp_eq_u32 s28, 63
  s_cbranch_scc1 RS3S_DONE
  buffer_store_dwordx4 v[112:115], v100, s[4:7], s32 offen sc1
  buffer_store_dwordx4 v[112:115], v101, s[4:7], s32 offen sc1
  buffer_store_dwordx4 v[112:115], v102, s[4:7], s32 offen sc1
  s_add_u32 s40, s32, s48
  s_mov_b64 exec, s[34:35]
  buffer_store_dwordx4 v[112:115], v106, s[4:7], s40 offen sc1
  s_add_u32 s40, s40, 32768
  buffer_store_dwordx4 v[112:115], v106, s[4:7], s40 offen sc1
  s_add_u32 s40, s40, 32768
  buffer_store_dwordx4 v[112:115], v106, s[4:7], s40 offen sc1
  s_add_u32 s40, s40, 32768
  buffer_store_dwordx4 v[112:115], v106, s[4:7], s40 offen sc1
  s_add_u32 s40, s40, 32768
  buffer_store_dwordx4 v[112:115], v106, s[4:7], s40 offen sc1
  s_mov_b64 exec, -1
  buffer_store_dwordx4 v[112:115], v107, s[4:7], s32 offen sc1
  s_nop 1
WU_25:
  s_memtime s[58:59]
  s_waitcnt lgkmcnt(0)
  s_sub_u32 s58, s58, s96
  s_cmp_ge_u32 s58, 1150
  s_cbranch_scc1 WU_25_D
  s_sub_u32 s58, 1150, s58
  s_cmp_lt_u32 s58, 96
  s_cbranch_scc1 WU_25
  s_sleep 1
  s_branch WU_25
WU_25_D:
  s_mov_b32 s43, 0
RS3S_RP:
  buffer_load_dwordx4 v[32:35], v105, s[4:7], s30 offen offset:0 sc1
  buffer_load_dwordx4 v[36:39], v105, s[4:7], s30 offen offset:512 sc1
  buffer_load_dwordx4 v[40:43], v105, s[4:7], s30 offen offset:1024 sc1
  buffer_load_dwordx4 v[44:47], v105, s[4:7], s30 offen offset:1536 sc1
  buffer_load_dwordx4 v[48:51], v105, s[4:7], s30 offen offset:2048 sc1
  buffer_load_dwordx4 v[52:55], v105, s[4:7], s30 offen offset:2560 sc1
  buffer_load_dwordx4 v[56:59], v105, s[4:7], s30 offen offset:3072 sc1
  buffer_load_dwordx4 v[60:63], v105, s[4:7], s30 offen offset:3584 sc1
  s_waitcnt vmcnt(0)
  v_max3_u32 v4, v32, v33, v34
  v_max3_u32 v4, v4, v35, v36
  v_max3_u32 v4, v4, v37, v38
  v_max3_u32 v4, v4, v39, v40
  v_max3_u32 v4, v4, v41, v42
  v_max3_u32 v4, v4, v43, v44
  v_max3_u32 v4, v4, v45, v46
  v_max3_u32 v4, v4, v47, v48
  v_max3_u32 v4, v4, v49, v50
  v_max3_u32 v4, v4, v51, v52
  v_max3_u32 v4, v4, v53, v54
  v_max3_u32 v4, v4, v55, v56
  v_max3_u32 v4, v4, v57, v58
  v_max3_u32 v4, v4, v59, v60
  v_max3_u32 v4, v4, v61, v62
  v_max_u32 v4, v4, v63
  v_cmp_eq_u32 vcc, -1, v4
  s_nop 3
  s_cbranch_vccz RS3S_RP_OK
  s_add_u32 s43, s43, 1
  s_cmp_lt_u32 s43, s61
  s_cbranch_scc1 RS3S_RP
  s_mov_b32 s61, 0
RS3S_RP_OK:
  v_mfma_f32_16x16x32_bf16 v[64:67], v[108:111], v[32:35], 0
  v_mfma_f32_16x16x32_bf16 v[64:67], v[108:111], v[36:39], v[64:67]
  v_mfma_f32_16x16x32_bf16 v[64:67], v[108:111], v[40:43], v[64:67]
  v_mfma_f32_16x16x32_bf16 v[64:67], v[108:111], v[44:47], v[64:67]
  v_mfma_f32_16x16x32_bf16 v[64:67], v[108:111], v[48:51], v[64:67]
  v_mfma_f32_16x16x32_bf16 v[64:67], v[108:111], v[52:55], v[64:67]
  v_mfma_f32_16x16x32_bf16 v[64:67], v[108:111], v[56:59], v[64:67]
  v_mfma_f32_16x16x32_bf16 v[64:67], v[108:111], v[60:63], v[64:67]
  s_nop 7
  v_cvt_pk_bf16_f32 v160, v64, v65
  v_cvt_pk_bf16_f32 v161, v66, v67
  buffer_store_dwordx2 v[160:161], v30, s[4:7], s30 offen sc1
  s_add_u32 s28, s28, 1
  s_cmp_ge_u32 s28, 64
  s_cbranch_scc1 RS3S_DONE
  s_mov_b32 s40, s29
  s_mov_b32 s29, s30
  s_mov_b32 s30, s31
  s_mov_b32 s31, s32
  s_mov_b32 s32, s40
  s_memtime s[36:37]
  s_branch RS3S_LOOP
RS3S_DONE:
  s_waitcnt vmcnt(0)
  s_barrier
  s_endpgm
MK_GEMM:
  s_lshl_b32 s51, s79, 2
  s_sub_u32 s80, s80, 4
  s_add_u32 s51, s51, s80
  s_mov_b32 s20, s24
  s_lshl_b32 s52, s51, 7
  s_add_u32 s52, s52, 8437760
  s_add_u32 s97, s51, 128
  s_mov_b32 s62, s51
  s_mov_b32 s79, s51
  s_cmp_lt_u32 s51, 48
  s_cbranch_scc1 MK_NOINIT
  s_load_dwordx2 s[40:41], s[0:1], 0
  s_sub_u32 s62, s62, 48
  s_mov_b32 s63, s62
  s_waitcnt lgkmcnt(0)
  s_mov_b32 s64, s40
  s_and_b32 s65, s41, 0xffff
  s_mov_b32 s66, 2621440
  s_mov_b32 s67, 0x00020000
  s_lshl_b32 s42, s63, 4
  v_add_u32 v104, s42, v3
  v_mul_u32_u24 v104, 1280, v104
  v_lshlrev_b32 v105, 4, v2
  v_add_u32 v104, v104, v105
  s_mul_i32 s42, s20, 320
  buffer_load_dwordx4 v[16:19], v104, s[64:67], s42 offen offset:0
  buffer_load_dwordx4 v[20:23], v104, s[64:67], s42 offen offset:64
  buffer_load_dwordx4 v[24:27], v104, s[64:67], s42 offen offset:128
  buffer_load_dwordx4 v[28:31], v104, s[64:67], s42 offen offset:192
  buffer_load_dwordx4 v[32:35], v104, s[64:67], s42 offen offset:256
  s_mul_i32 s43, s62, 16800
  v_lshlrev_b32 v106, 4, v0
  v_add_u32 v106, s43, v106
  v_mov_b32 v108, -1
  v_mov_b32 v109, -1
  v_mov_b32 v110, -1
  v_mov_b32 v111, -1
  v_mov_b32 v112, 0
  v_mov_b32 v113, 0
  v_mov_b32 v114, 0
  v_mov_b32 v115, 0
  s_mov_b32 s44, 0
  buffer_store_dwordx4 v[108:111], v106, s[4:7], s44 offen sc1
  s_mov_b32 s44, 4096
  buffer_store_dwordx4 v[108:111], v106, s[4:7], s44 offen sc1
  s_mov_b32 s44, 8192
  buffer_store_dwordx4 v[108:111], v106, s[4:7], s44 offen sc1
  s_mov_b32 s44, 12288
  buffer_store_dwordx4 v[108:111], v106, s[4:7], s44 offen sc1
  s_mov_b32 s44, 2097152
  buffer_store_dwordx4 v[108:111], v106, s[4:7], s44 offen sc1
  s_mov_b32 s44, 2101248
  buffer_store_dwordx4 v[108:111], v106, s[4:7], s44 offen sc1
  s_mov_b32 s44, 2105344
  buffer_store_dwordx4 v[108:111], v106, s[4:7], s44 offen sc1
  s_mov_b32 s44, 2109440
  buffer_store_dwordx4 v[108:111], v106, s[4:7], s44 offen sc1
  s_mov_b32 s44, 4194304
  buffer_store_dwordx4 v[108:111], v106, s[4:7], s44 offen sc1
  s_mov_b32 s44, 4198400
  buffer_store_dwordx4 v[108:111], v106, s[4:7], s44 offen sc1
  s_mov_b32 s44, 4202496
  buffer_store_dwordx4 v[108:111], v106, s[4:7], s44 offen sc1
  s_mov_b32 s44, 4206592
  buffer_store_dwordx4 v[108:111], v106, s[4:7], s44 offen sc1
  s_mov_b32 s44, 6291456
  buffer_store_dwordx4 v[108:111], v106, s[4:7], s44 offen sc1
  s_mov_b32 s44, 6295552
  buffer_store_dwordx4 v[108:111], v106, s[4:7], s44 offen sc1
  s_mov_b32 s44, 6299648
  buffer_store_dwordx4 v[108:111], v106, s[4:7], s44 offen sc1
  s_mov_b32 s44, 6303744
  buffer_store_dwordx4 v[108:111], v106, s[4:7], s44 offen sc1
  v_cmp_gt_u32 vcc, 26, v0
  s_nop 0
  s_and_saveexec_b64 s[46:47], vcc
  s_nop 1
  s_cbranch_execz GI_GI_NOP3
  s_mov_b32 s44, 16384
  buffer_store_dwordx4 v[108:111], v106, s[4:7], s44 offen sc1
  s_mov_b32 s44, 2113536
  buffer_store_dwordx4 v[108:111], v106, s[4:7], s44 offen sc1
  s_mov_b32 s44, 4210688
  buffer_store_dwordx4 v[108:111], v106, s[4:7], s44 offen sc1
  s_mov_b32 s44, 6307840
  buffer_store_dwordx4 v[108:111], v106, s[4:7], s44 offen sc1
  s_nop 1
GI_GI_NOP3:
  s_mov_b64 exec, s[46:47]
  s_cmp_ge_u32 s62, 64
  s_cbranch_scc1 GI_GI_NOFL
  s_cmp_lg_u32 s20, 0
  s_cbranch_scc1 GI_GI_NOFL
  s_lshl_b32 s43, s62, 10
  s_add_u32 s43, s43, 8388608
  v_lshlrev_b32 v107, 4, v1
  buffer_store_dwordx4 v[112:115], v107, s[4:7], s43 offen sc1
  s_nop 1
GI_GI_NOFL:
  s_waitcnt vmcnt(16)
GI_GI_LN:
  v_lshlrev_b32 v40, 16, v16
  v_and_b32 v41, 0xffff0000, v16
  v_lshlrev_b32 v42, 16, v17
  v_and_b32 v43, 0xffff0000, v17
  v_lshlrev_b32 v44, 16, v18
  v_and_b32 v45, 0xffff0000, v18
  v_lshlrev_b32 v46, 16, v19
  v_and_b32 v47, 0xffff0000, v19
  v_lshlrev_b32 v48, 16, v20
  v_and_b32 v49, 0xffff0000, v20
  v_lshlrev_b32 v50, 16, v21
  v_and_b32 v51, 0xffff0000, v21
  v_lshlrev_b32 v52, 16, v22
  v_and_b32 v53, 0xffff0000, v22
  v_lshlrev_b32 v54, 16, v23
  v_and_b32 v55, 0xffff0000, v23
  v_lshlrev_b32 v56, 16, v24
  v_and_b32 v57, 0xffff0000, v24
  v_lshlrev_b32 v58, 16, v25
  v_and_b32 v59, 0xffff0000, v25
  v_lshlrev_b32 v60, 16, v26
  v_and_b32 v61, 0xffff0000, v26
  v_lshlrev_b32 v62, 16, v27
  v_and_b32 v63, 0xffff0000, v27
  v_lshlrev_b32 v64, 16, v28
  v_and_b32 v65, 0xffff0000, v28
  v_lshlrev_b32 v66, 16, v29
  v_and_b32 v67, 0xffff0000, v29
  v_lshlrev_b32 v68, 16, v30
  v_and_b32 v69, 0xffff0000, v30
  v_lshlrev_b32 v70, 16, v31
  v_and_b32 v71, 0xffff0000, v31
  v_lshlrev_b32 v72, 16, v32
  v_and_b32 v73, 0xffff0000, v32
  v_lshlrev_b32 v74, 16, v33
  v_and_b32 v75, 0xffff0000, v33
  v_lshlrev_b32 v76, 16, v34
  v_and_b32 v77, 0xffff0000, v34
  v_lshlrev_b32 v78, 16, v35
  v_and_b32 v79, 0xffff0000, v35
  v_add_f32 v80, v40, v44
  v_add_f32 v81, v41, v45
  v_add_f32 v82, v42, v46
  v_add_f32 v83, v43, v47
  v_add_f32 v80, v80, v48
  v_add_f32 v81, v81, v49
  v_add_f32 v82, v82, v50
  v_add_f32 v83, v83, v51
  v_add_f32 v80, v80, v52
  v_add_f32 v81, v81, v53
  v_add_f32 v82, v82, v54
  v_add_f32 v83, v83, v55
  v_add_f32 v80, v80, v56
  v_add_f32 v81, v81, v57
  v_add_f32 v82, v82, v58
  v_add_f32 v83, v83, v59
  v_add_f32 v80, v80, v60
  v_add_f32 v81, v81, v61
  v_add_f32 v82, v82, v62
  v_add_f32 v83, v83, v63
  v_add_f32 v80, v80, v64
  v_add_f32 v81, v81, v65
  v_add_f32 v82, v82, v66
  v_add_f32 v83, v83, v67
  v_add_f32 v80, v80, v68
  v_add_f32 v81, v81, v69
  v_add_f32 v82, v82, v70
  v_add_f32 v83, v83, v71
  v_add_f32 v80, v80, v72
  v_add_f32 v81, v81, v73
  v_add_f32 v82, v82, v74
  v_add_f32 v83, v83, v75
  v_add_f32 v80, v80, v76
  v_add_f32 v81, v81, v77
  v_add_f32 v82, v82, v78
  v_add_f32 v83, v83, v79
  v_add_f32 v80, v80, v81
  v_add_f32 v82, v82, v83
  v_add_f32 v80, v80, v82
  v_mov_b32 v81, v80
  s_nop 1
  v_permlane16_swap_b32 v80, v81
  v_add_f32 v80, v80, v81
  v_mov_b32 v81, v80
  s_nop 1
  v_permlane32_swap_b32 v80, v81
  v_add_f32 v80, v80, v81
  s_lshl_b32 s43, s20, 6
  v_lshlrev_b32 v84, 2, v3
  v_add_u32 v84, 132096, v84
  v_add_u32 v85, s43, v84
  s_mov_b32 exec_hi, 0
  s_mov_b32 exec_lo, 0xffff
  ds_write_b32 v85, v80 offset:0
  s_mov_b64 exec, -1
  s_waitcnt lgkmcnt(0)
  s_barrier
  ds_read_b32 v86, v84 offset:0
  ds_read_b32 v87, v84 offset:64
  ds_read_b32 v88, v84 offset:128
  ds_read_b32 v89, v84 offset:192
  s_waitcnt lgkmcnt(0)
  v_add_f32 v86, v86, v87
  v_add_f32 v88, v88, v89
  v_add_f32 v80, v86, v88
  s_mov_b32 s45, 0x3acccccd
  v_mul_f32 v80, s45, v80
  v_sub_f32 v40, v40, v80
  v_sub_f32 v41, v41, v80
  v_sub_f32 v42, v42, v80
  v_sub_f32 v43, v43, v80
  v_sub_f32 v44, v44, v80
  v_sub_f32 v45, v45, v80
  v_sub_f32 v46, v46, v80
  v_sub_f32 v47, v47, v80
  v_sub_f32 v48, v48, v80
  v_sub_f32 v49, v49, v80
  v_sub_f32 v50, v50, v80
  v_sub_f32 v51, v51, v80
  v_sub_f32 v52, v52, v80
  v_sub_f32 v53, v53, v80
  v_sub_f32 v54, v54, v80
  v_sub_f32 v55, v55, v80
  v_sub_f32 v56, v56, v80
  v_sub_f32 v57, v57, v80
  v_sub_f32 v58, v58, v80
  v_sub_f32 v59, v59, v80
  v_sub_f32 v60, v60, v80
  v_sub_f32 v61, v61, v80
  v_sub_f32 v62, v62, v80
  v_sub_f32 v63, v63, v80
  v_sub_f32 v64, v64, v80
  v_sub_f32 v65, v65, v80
  v_sub_f32 v66, v66, v80
  v_sub_f32 v67, v67, v80
  v_sub_f32 v68, v68, v80
  v_sub_f32 v69, v69, v80
  v_sub_f32 v70, v70, v80
  v_sub_f32 v71, v71, v80
  v_sub_f32 v72, v72, v80
  v_sub_f32 v73, v73, v80
  v_sub_f32 v74, v74, v80
  v_sub_f32 v75, v75, v80
  v_sub_f32 v76, v76, v80
  v_sub_f32 v77, v77, v80
  v_sub_f32 v78, v78, v80
  v_sub_f32 v79, v79, v80
  v_mul_f32 v90, v40, v40
  v_mul_f32 v91, v41, v41
  v_mul_f32 v92, v42, v42
  v_mul_f32 v93, v43, v43
  v_fmac_f32 v90, v44, v44
  v_fmac_f32 v91, v45, v45
  v_fmac_f32 v92, v46, v46
  v_fmac_f32 v93, v47, v47
  v_fmac_f32 v90, v48, v48
  v_fmac_f32 v91, v49, v49
  v_fmac_f32 v92, v50, v50
  v_fmac_f32 v93, v51, v51
  v_fmac_f32 v90, v52, v52
  v_fmac_f32 v91, v53, v53
  v_fmac_f32 v92, v54, v54
  v_fmac_f32 v93, v55, v55
  v_fmac_f32 v90, v56, v56
  v_fmac_f32 v91, v57, v57
  v_fmac_f32 v92, v58, v58
  v_fmac_f32 v93, v59, v59
  v_fmac_f32 v90, v60, v60
  v_fmac_f32 v91, v61, v61
  v_fmac_f32 v92, v62, v62
  v_fmac_f32 v93, v63, v63
  v_fmac_f32 v90, v64, v64
  v_fmac_f32 v91, v65, v65
  v_fmac_f32 v92, v66, v66
  v_fmac_f32 v93, v67, v67
  v_fmac_f32 v90, v68, v68
  v_fmac_f32 v91, v69, v69
  v_fmac_f32 v92, v70, v70
  v_fmac_f32 v93, v71, v71
  v_fmac_f32 v90, v72, v72
  v_fmac_f32 v91, v73, v73
  v_fmac_f32 v92, v74, v74
  v_fmac_f32 v93, v75, v75
  v_fmac_f32 v90, v76, v76
  v_fmac_f32 v91, v77, v77
  v_fmac_f32 v92, v78, v78
  v_fmac_f32 v93, v79, v79
  v_add_f32 v90, v90, v91
  v_add_f32 v92, v92, v93
  v_add_f32 v90, v90, v92
  v_mov_b32 v91, v90
  s_nop 1
  v_permlane16_swap_b32 v90, v91
  v_add_f32 v90, v90, v91
  v_mov_b32 v91, v90
  s_nop 1
  v_permlane32_swap_b32 v90, v91
  v_add_f32 v90, v90, v91
  s_lshl_b32 s43, s20, 6
  v_lshlrev_b32 v84, 2, v3
  v_add_u32 v84, 132096, v84
  v_add_u32 v85, s43, v84
  s_mov_b32 exec_hi, 0
  s_mov_b32 exec_lo, 0xffff
  ds_write_b32 v85, v90 offset:256
  s_mov_b64 exec, -1
  s_waitcnt lgkmcnt(0)
  s_barrier
  ds_read_b32 v86, v84 offset:256
  ds_read_b32 v87, v84 offset:320
  ds_read_b32 v88, v84 offset:384
  ds_read_b32 v89, v84 offset:448
  s_waitcnt lgkmcnt(0)
  v_add_f32 v86, v86, v87
  v_add_f32 v88, v88, v89
  v_add_f32 v90, v86, v88
  v_mul_f32 v90, s45, v90
  v_add_f32 v90, 0x3727c5ac, v90
  v_rsq_f32 v90, v90
  s_nop 0
  v_mul_f32 v40, v40, v90
  v_mul_f32 v41, v41, v90
  v_cvt_pk_bf16_f32 v116, v40, v41
  v_mul_f32 v42, v42, v90
  v_mul_f32 v43, v43, v90
  v_cvt_pk_bf16_f32 v117, v42, v43
  v_mul_f32 v44, v44, v90
  v_mul_f32 v45, v45, v90
  v_cvt_pk_bf16_f32 v118, v44, v45
  v_mul_f32 v46, v46, v90
  v_mul_f32 v47, v47, v90
  v_cvt_pk_bf16_f32 v119, v46, v47
  v_mul_f32 v48, v48, v90
  v_mul_f32 v49, v49, v90
  v_cvt_pk_bf16_f32 v120, v48, v49
  v_mul_f32 v50, v50, v90
  v_mul_f32 v51, v51, v90
  v_cvt_pk_bf16_f32 v121, v50, v51
  v_mul_f32 v52, v52, v90
  v_mul_f32 v53, v53, v90
  v_cvt_pk_bf16_f32 v122, v52, v53
  v_mul_f32 v54, v54, v90
  v_mul_f32 v55, v55, v90
  v_cvt_pk_bf16_f32 v123, v54, v55
  v_mul_f32 v56, v56, v90
  v_mul_f32 v57, v57, v90
  v_cvt_pk_bf16_f32 v124, v56, v57
  v_mul_f32 v58, v58, v90
  v_mul_f32 v59, v59, v90
  v_cvt_pk_bf16_f32 v125, v58, v59
  v_mul_f32 v60, v60, v90
  v_mul_f32 v61, v61, v90
  v_cvt_pk_bf16_f32 v126, v60, v61
  v_mul_f32 v62, v62, v90
  v_mul_f32 v63, v63, v90
  v_cvt_pk_bf16_f32 v127, v62, v63
  v_mul_f32 v64, v64, v90
  v_mul_f32 v65, v65, v90
  v_cvt_pk_bf16_f32 v128, v64, v65
  v_mul_f32 v66, v66, v90
  v_mul_f32 v67, v67, v90
  v_cvt_pk_bf16_f32 v129, v66, v67
  v_mul_f32 v68, v68, v90
  v_mul_f32 v69, v69, v90
  v_cvt_pk_bf16_f32 v130, v68, v69
  v_mul_f32 v70, v70, v90
  v_mul_f32 v71, v71, v90
  v_cvt_pk_bf16_f32 v131, v70, v71
  v_mul_f32 v72, v72, v90
  v_mul_f32 v73, v73, v90
  v_cvt_pk_bf16_f32 v132, v72, v73
  v_mul_f32 v74, v74, v90
  v_mul_f32 v75, v75, v90
  v_cvt_pk_bf16_f32 v133, v74, v75
  v_mul_f32 v76, v76, v90
  v_mul_f32 v77, v77, v90
  v_cvt_pk_bf16_f32 v134, v76, v77
  v_mul_f32 v78, v78, v90
  v_mul_f32 v79, v79, v90
  v_cvt_pk_bf16_f32 v135, v78, v79
  s_mul_i32 s43, s63, 20480
  s_mul_i32 s44, s20, 5120
  s_add_u32 s43, s43, s44
  s_add_u32 s43, s43, 9437184
  v_lshlrev_b32 v104, 4, v1
  buffer_store_dwordx4 v[116:119], v104, s[4:7], s43 offen offset:0 sc1
  buffer_store_dwordx4 v[120:123], v104, s[4:7], s43 offen offset:1024 sc1
  buffer_store_dwordx4 v[124:127], v104, s[4:7], s43 offen offset:2048 sc1
  buffer_store_dwordx4 v[128:131], v104, s[4:7], s43 offen offset:3072 sc1
  s_add_u32 s43, s43, 4096
  buffer_store_dwordx4 v[132:135], v104, s[4:7], s43 offen offset:0 sc1
  s_add_u32 s63, s63, 80
  s_cmp_ge_u32 s63, 128
  s_cbranch_scc1 GI_GI_END
  s_lshl_b32 s42, s63, 4
  v_add_u32 v104, s42, v3
  v_mul_u32_u24 v104, 1280, v104
  v_lshlrev_b32 v105, 4, v2
  v_add_u32 v104, v104, v105
  s_mul_i32 s42, s20, 320
  buffer_load_dwordx4 v[16:19], v104, s[64:67], s42 offen offset:0
  buffer_load_dwordx4 v[20:23], v104, s[64:67], s42 offen offset:64
  buffer_load_dwordx4 v[24:27], v104, s[64:67], s42 offen offset:128
  buffer_load_dwordx4 v[28:31], v104, s[64:67], s42 offen offset:192
  buffer_load_dwordx4 v[32:35], v104, s[64:67], s42 offen offset:256
  s_waitcnt vmcnt(0)
  s_barrier
  s_branch GI_GI_LN
GI_GI_END:
  s_waitcnt vmcnt(0)
  s_barrier
  s_cmp_lg_u32 s20, 0
  s_cbranch_scc1 GI_GI_DONE
  v_mov_b32 v110, 1
  v_mov_b32 v111, 48
  s_mov_b64 exec, 1
  global_atomic_add v111, v110, s[76:77] sc1
  s_mov_b64 exec, -1
GI_GI_DONE:
MK_NOINIT:
  s_cmp_lt_u32 s51, 72
  s_cbranch_scc1 MK_QKV
  s_cmp_lt_u32 s51, 84
  s_cbranch_scc1 MK_UP
  s_cmp_lt_u32 s51, 94
  s_cbranch_scc1 MK_DN
  s_cmp_lt_u32 s51, 126
  s_cbranch_scc1 MK_U
  s_cmp_eq_u32 s51, 126
  s_cbranch_scc0 MK_TOK
  s_mov_b64 exec, 1
  v_mov_b32 v10, -1
  s_lshl_b32 s40, s24, 21
  s_add_u32 s40, s40, 1331200
  v_mov_b32 v11, s40
  v_add_u32 v13, 8192, v11
  s_mov_b32 s41, 0
  s_mov_b32 s84, -1
  s_mov_b32 s85, -1
MK_PR_R:
  buffer_store_dword v10, v11, s[4:7], 0 offen sc1
  buffer_store_dword v10, v13, s[4:7], 0 offen sc1
  s_waitcnt vmcnt(0)
  s_sleep 6
  s_memtime s[80:81]
  s_waitcnt lgkmcnt(0)
  buffer_load_dword v12, v11, s[4:7], 0 offen sc1
  s_waitcnt vmcnt(0)
  s_memtime s[82:83]
  s_waitcnt lgkmcnt(0)
  s_sub_u32 s86, s82, s80
  s_memtime s[80:81]
  s_waitcnt lgkmcnt(0)
  buffer_load_dword v12, v13, s[4:7], 0 offen sc1
  s_waitcnt vmcnt(0)
  s_memtime s[82:83]
  s_waitcnt lgkmcnt(0)
  s_sub_u32 s87, s82, s80
  s_min_u32 s84, s84, s86
  s_min_u32 s85, s85, s87
  s_add_u32 s41, s41, 1
  s_cmp_lt_u32 s41, 7
  s_cbranch_scc1 MK_PR_R
  s_cmp_lt_u32 s85, s84
  s_cselect_b32 s42, 1, 0
  s_lshr_b32 s40, s78, 2
  s_xor_b32 s42, s42, s40
  s_and_b32 s42, s42, 1
  s_or_b32 s42, s42, 2
  s_lshl_b32 s40, s24, 1
  s_lshl_b32 s42, s42, s40
  v_mov_b32 v10, s42
  v_mov_b32 v11, 52
  global_atomic_or v11, v10, s[76:77] sc1
  s_waitcnt vmcnt(0)
  s_mov_b64 exec, -1
  s_branch MK_TOK
MK_QKV:
  s_mul_i32 s40, s51, 2731
  s_lshr_b32 s40, s40, 16
  s_mul_i32 s41, s40, 24
  s_sub_u32 s41, s51, s41
  s_mov_b32 s42, 24
  s_cmp_eq_u32 s40, 1
  s_cselect_b32 s42, 32, s42
  s_cmp_eq_u32 s40, 2
  s_cselect_b32 s42, 16, s42
  s_add_u32 s44, s0, s42
  s_addc_u32 s45, s1, 0
  s_load_dwordx2 s[46:47], s[44:45], 0
  s_mov_b32 s43, 12582912
  s_cmp_eq_u32 s40, 1
  s_cselect_b32 s43, 37748736, s43
  s_cmp_eq_u32 s40, 2
  s_cselect_b32 s43, 62914560, s43
  s_waitcnt lgkmcnt(0)
  s_mov_b32 s8, s46
  s_and_b32 s9, s47, 0xffff
  s_mov_b32 s10, 7864320
  s_mov_b32 s11, 0x00020000
  s_mov_b32 s12, s46
  s_and_b32 s13, s47, 0xffff
  s_mov_b32 s14, 7864320
  s_mov_b32 s15, 0x00020000
  s_lshl_b32 s48, s41, 8
  s_lshl_b32 s49, s20, 6
  s_add_u32 s48, s48, s49
  s_lshl_b32 s48, s48, 1
  s_mov_b32 s24, s48
  s_add_u32 s25, s48, 32
  s_add_u32 s26, s48, 64
  s_add_u32 s27, s48, 96
  s_lshl_b32 s48, s41, 3
  s_lshl_b32 s49, s20, 1
  s_add_u32 s48, s48, s49
  s_add_u32 s48, s48, 0
  s_mul_i32 s49, s48, 10923
  s_lshr_b32 s49, s49, 16
  s_mul_i32 s50, s49, 6
  s_sub_u32 s50, s48, s50
  s_mul_i32 s49, s49, 12
  s_add_u32 s49, s49, s50
  s_lshl_b32 s49, s49, 10
  s_add_u32 s28, s49, s43
  s_lshl_b32 s48, s41, 3
  s_lshl_b32 s49, s20, 1
  s_add_u32 s48, s48, s49
  s_add_u32 s48, s48, 1
  s_mul_i32 s49, s48, 10923
  s_lshr_b32 s49, s49, 16
  s_mul_i32 s50, s49, 6
  s_sub_u32 s50, s48, s50
  s_mul_i32 s49, s49, 12
  s_add_u32 s49, s49, s50
  s_lshl_b32 s49, s49, 10
  s_add_u32 s29, s49, s43
  s_lshl_b32 s21, s20, 15
  v_lshrrev_b32 v6, 3, v1
  s_mov_b32 s22, 12288
  v_mul_lo_u32 v4, v6, s22
  v_and_b32 v6, 7, v1
  v_lshlrev_b32 v6, 4, v6
  v_add_u32 v4, v4, v6
  v_lshrrev_b32 v5, 4, v1
  v_lshlrev_b32 v5, 3, v5
  v_bfe_u32 v6, v1, 2, 2
  v_add_u32 v5, v5, v6
  v_mul_u32_u24 v5, 128, v5
  v_and_b32 v6, 3, v1
  v_lshlrev_b32 v6, 3, v6
  v_add_u32 v5, v5, v6
  v_add_u32 v5, s21, v5
  s_add_u32 s33, s24, 0
  s_add_u32 m0, s21, 0
  s_nop 0
  buffer_load_dwordx4 v4, s[8:11], s33 offen lds
  s_add_u32 s33, s24, 98304
  s_add_u32 m0, s21, 1024
  s_nop 0
  buffer_load_dwordx4 v4, s[8:11], s33 offen lds
  s_add_u32 s33, s24, 196608
  s_add_u32 m0, s21, 2048
  s_nop 0
  buffer_load_dwordx4 v4, s[8:11], s33 offen lds
  s_add_u32 s33, s24, 294912
  s_add_u32 m0, s21, 3072
  s_nop 0
  buffer_load_dwordx4 v4, s[8:11], s33 offen lds
  s_add_u32 s33, s24, 393216
  s_add_u32 m0, s21, 4096
  s_nop 0
  buffer_load_dwordx4 v4, s[8:11], s33 offen lds
  s_add_u32 s33, s24, 491520
  s_add_u32 m0, s21, 5120
  s_nop 0
  buffer_load_dwordx4 v4, s[8:11], s33 offen lds
  s_add_u32 s33, s24, 589824
  s_add_u32 m0, s21, 6144
  s_nop 0
  buffer_load_dwordx4 v4, s[8:11], s33 offen lds
  s_add_u32 s33, s24, 688128
  s_add_u32 m0, s21, 7168
  s_nop 0
  buffer_load_dwordx4 v4, s[8:11], s33 offen lds
  s_add_u32 s33, s24, 786432
  s_add_u32 m0, s21, 8192
  s_nop 0
  buffer_load_dwordx4 v4, s[8:11], s33 offen lds
  s_add_u32 s33, s24, 884736
  s_add_u32 m0, s21, 9216
  s_nop 0
  buffer_load_dwordx4 v4, s[8:11], s33 offen lds
  s_add_u32 s33, s24, 983040
  s_add_u32 m0, s21, 10240
  s_nop 0
  buffer_load_dwordx4 v4, s[8:11], s33 offen lds
  s_add_u32 s33, s24, 1081344
  s_add_u32 m0, s21, 11264
  s_nop 0
  buffer_load_dwordx4 v4, s[8:11], s33 offen lds
  s_add_u32 s33, s24, 1179648
  s_add_u32 m0, s21, 12288
  s_nop 0
  buffer_load_dwordx4 v4, s[8:11], s33 offen lds
  s_add_u32 s33, s24, 1277952
  s_add_u32 m0, s21, 13312
  s_nop 0
  buffer_load_dwordx4 v4, s[8:11], s33 offen lds
  s_add_u32 s33, s24, 1376256
  s_add_u32 m0, s21, 14336
  s_nop 0
  buffer_load_dwordx4 v4, s[8:11], s33 offen lds
  s_add_u32 s33, s24, 1474560
  s_add_u32 m0, s21, 15360
  s_nop 0
  buffer_load_dwordx4 v4, s[8:11], s33 offen lds
  s_add_u32 s33, s24, 1572864
  s_add_u32 m0, s21, 16384
  s_nop 0
  buffer_load_dwordx4 v4, s[8:11], s33 offen lds
  s_add_u32 s33, s24, 1671168
  s_add_u32 m0, s21, 17408
  s_nop 0
  buffer_load_dwordx4 v4, s[8:11], s33 offen lds
  s_add_u32 s33, s24, 1769472
  s_add_u32 m0, s21, 18432
  s_nop 0
  buffer_load_dwordx4 v4, s[8:11], s33 offen lds
  s_add_u32 s33, s24, 1867776
  s_add_u32 m0, s21, 19456
  s_nop 0
  buffer_load_dwordx4 v4, s[8:11], s33 offen lds
  s_add_u32 s33, s24, 1966080
  s_add_u32 m0, s21, 20480
  s_nop 0
  buffer_load_dwordx4 v4, s[8:11], s33 offen lds
  s_add_u32 s33, s24, 2064384
  s_add_u32 m0, s21, 21504
  s_nop 0
  buffer_load_dwordx4 v4, s[8:11], s33 offen lds
  s_add_u32 s33, s24, 2162688
  s_add_u32 m0, s21, 22528
  s_nop 0
  buffer_load_dwordx4 v4, s[8:11], s33 offen lds
  s_add_u32 s33, s24, 2260992
  s_add_u32 m0, s21, 23552
  s_nop 0
  buffer_load_dwordx4 v4, s[8:11], s33 offen lds
  s_add_u32 s33, s24, 2359296
  s_add_u32 m0, s21, 24576
  s_nop 0
  buffer_load_dwordx4 v4, s[8:11], s33 offen lds
  s_add_u32 s33, s24, 2457600
  s_add_u32 m0, s21, 25600
  s_nop 0
  buffer_load_dwordx4 v4, s[8:11], s33 offen lds
  s_add_u32 s33, s24, 2555904
  s_add_u32 m0, s21, 26624
  s_nop 0
  buffer_load_dwordx4 v4, s[8:11], s33 offen lds
  s_add_u32 s33, s24, 2654208
  s_add_u32 m0, s21, 27648
  s_nop 0
  buffer_load_dwordx4 v4, s[8:11], s33 offen lds
  s_add_u32 s33, s24, 2752512
  s_add_u32 m0, s21, 28672
  s_nop 0
  buffer_load_dwordx4 v4, s[8:11], s33 offen lds
  s_add_u32 s33, s24, 2850816
  s_add_u32 m0, s21, 29696
  s_nop 0
  buffer_load_dwordx4 v4, s[8:11], s33 offen lds
  s_add_u32 s33, s24, 2949120
  s_add_u32 m0, s21, 30720
  s_nop 0
  buffer_load_dwordx4 v4, s[8:11], s33 offen lds
  s_add_u32 s33, s24, 3047424
  s_add_u32 m0, s21, 31744
  s_nop 0
  buffer_load_dwordx4 v4, s[8:11], s33 offen lds
  s_waitcnt vmcnt(28)
  ds_read_b64_tr_b16 a[0:1], v5 offset:0
  ds_read_b64_tr_b16 a[2:3], v5 offset:512
  ds_read_b64_tr_b16 a[80:81], v5 offset:32
  ds_read_b64_tr_b16 a[82:83], v5 offset:544
  ds_read_b64_tr_b16 a[160:161], v5 offset:64
  ds_read_b64_tr_b16 a[162:163], v5 offset:576
  ds_read_b64_tr_b16 a[240:241], v5 offset:96
  ds_read_b64_tr_b16 a[242:243], v5 offset:608
  s_waitcnt lgkmcnt(0)
  s_add_u32 s33, s24, 3145728
  s_add_u32 m0, s21, 0
  s_nop 0
  buffer_load_dwordx4 v4, s[8:11], s33 offen lds
  s_add_u32 s33, s24, 3244032
  s_add_u32 m0, s21, 1024
  s_nop 0
  buffer_load_dwordx4 v4, s[8:11], s33 offen lds
  s_add_u32 s33, s24, 3342336
  s_add_u32 m0, s21, 2048
  s_nop 0
  buffer_load_dwordx4 v4, s[8:11], s33 offen lds
  s_add_u32 s33, s24, 3440640
  s_add_u32 m0, s21, 3072
  s_nop 0
  buffer_load_dwordx4 v4, s[8:11], s33 offen lds
  s_waitcnt vmcnt(28)
  ds_read_b64_tr_b16 a[4:5], v5 offset:4096
  ds_read_b64_tr_b16 a[6:7], v5 offset:4608
  ds_read_b64_tr_b16 a[84:85], v5 offset:4128
  ds_read_b64_tr_b16 a[86:87], v5 offset:4640
  ds_read_b64_tr_b16 a[164:165], v5 offset:4160
  ds_read_b64_tr_b16 a[166:167], v5 offset:4672
  ds_read_b64_tr_b16 a[244:245], v5 offset:4192
  ds_read_b64_tr_b16 a[246:247], v5 offset:4704
  s_waitcnt lgkmcnt(0)
  s_add_u32 s33, s24, 3538944
  s_add_u32 m0, s21, 4096
  s_nop 0
  buffer_load_dwordx4 v4, s[8:11], s33 offen lds
  s_add_u32 s33, s24, 3637248
  s_add_u32 m0, s21, 5120
  s_nop 0
  buffer_load_dwordx4 v4, s[8:11], s33 offen lds
  s_add_u32 s33, s24, 3735552
  s_add_u32 m0, s21, 6144
  s_nop 0
  buffer_load_dwordx4 v4, s[8:11], s33 offen lds
  s_add_u32 s33, s24, 3833856
  s_add_u32 m0, s21, 7168
  s_nop 0
  buffer_load_dwordx4 v4, s[8:11], s33 offen lds
  s_waitcnt vmcnt(28)
  ds_read_b64_tr_b16 a[8:9], v5 offset:8192
  ds_read_b64_tr_b16 a[10:11], v5 offset:8704
  ds_read_b64_tr_b16 a[88:89], v5 offset:8224
  ds_read_b64_tr_b16 a[90:91], v5 offset:8736
  ds_read_b64_tr_b16 a[168:169], v5 offset:8256
  ds_read_b64_tr_b16 a[170:171], v5 offset:8768
  ds_read_b64_tr_b16 a[248:249], v5 offset:8288
  ds_read_b64_tr_b16 a[250:251], v5 offset:8800
  s_waitcnt lgkmcnt(0)
  s_add_u32 s33, s24, 3932160
  s_add_u32 m0, s21, 8192
  s_nop 0
  buffer_load_dwordx4 v4, s[8:11], s33 offen lds
  s_add_u32 s33, s24, 4030464
  s_add_u32 m0, s21, 9216
  s_nop 0
  buffer_load_dwordx4 v4, s[8:11], s33 offen lds
  s_add_u32 s33, s24, 4128768
  s_add_u32 m0, s21, 10240
  s_nop 0
  buffer_load_dwordx4 v4, s[8:11], s33 offen lds
  s_add_u32 s33, s24, 4227072
  s_add_u32 m0, s21, 11264
  s_nop 0
  buffer_load_dwordx4 v4, s[8:11], s33 offen lds
  s_waitcnt vmcnt(28)
  ds_read_b64_tr_b16 a[12:13], v5 offset:12288
  ds_read_b64_tr_b16 a[14:15], v5 offset:12800
  ds_read_b64_tr_b16 a[92:93], v5 offset:12320
  ds_read_b64_tr_b16 a[94:95], v5 offset:12832
  ds_read_b64_tr_b16 a[172:173], v5 offset:12352
  ds_read_b64_tr_b16 a[174:175], v5 offset:12864
  ds_read_b64_tr_b16 a[252:253], v5 offset:12384
  ds_read_b64_tr_b16 a[254:255], v5 offset:12896
  s_waitcnt lgkmcnt(0)
  s_add_u32 s33, s24, 4325376
  s_add_u32 m0, s21, 12288
  s_nop 0
  buffer_load_dwordx4 v4, s[8:11], s33 offen lds
  s_add_u32 s33, s24, 4423680
  s_add_u32 m0, s21, 13312
  s_nop 0
  buffer_load_dwordx4 v4, s[8:11], s33 offen lds
  s_add_u32 s33, s24, 4521984
  s_add_u32 m0, s21, 14336
  s_nop 0
  buffer_load_dwordx4 v4, s[8:11], s33 offen lds
  s_add_u32 s33, s24, 4620288
  s_add_u32 m0, s21, 15360
  s_nop 0
  buffer_load_dwordx4 v4, s[8:11], s33 offen lds
  s_waitcnt vmcnt(28)
  ds_read_b64_tr_b16 a[16:17], v5 offset:16384
  ds_read_b64_tr_b16 a[18:19], v5 offset:16896
  ds_read_b64_tr_b16 a[96:97], v5 offset:16416
  ds_read_b64_tr_b16 a[98:99], v5 offset:16928
  ds_read_b64_tr_b16 a[176:177], v5 offset:16448
  ds_read_b64_tr_b16 a[178:179], v5 offset:16960
  ds_read_b64_tr_b16 v[96:97], v5 offset:16480
  ds_read_b64_tr_b16 v[98:99], v5 offset:16992
  s_waitcnt lgkmcnt(0)
  s_add_u32 s33, s24, 4718592
  s_add_u32 m0, s21, 16384
  s_nop 0
  buffer_load_dwordx4 v4, s[8:11], s33 offen lds
  s_add_u32 s33, s24, 4816896
  s_add_u32 m0, s21, 17408
  s_nop 0
  buffer_load_dwordx4 v4, s[8:11], s33 offen lds
  s_add_u32 s33, s24, 4915200
  s_add_u32 m0, s21, 18432
  s_nop 0
  buffer_load_dwordx4 v4, s[8:11], s33 offen lds
  s_add_u32 s33, s24, 5013504
  s_add_u32 m0, s21, 19456
  s_nop 0
  buffer_load_dwordx4 v4, s[8:11], s33 offen lds
  s_waitcnt vmcnt(28)
  ds_read_b64_tr_b16 a[20:21], v5 offset:20480
  ds_read_b64_tr_b16 a[22:23], v5 offset:20992
  ds_read_b64_tr_b16 a[100:101], v5 offset:20512
  ds_read_b64_tr_b16 a[102:103], v5 offset:21024
  ds_read_b64_tr_b16 a[180:181], v5 offset:20544
  ds_read_b64_tr_b16 a[182:183], v5 offset:21056
  ds_read_b64_tr_b16 v[100:101], v5 offset:20576
  ds_read_b64_tr_b16 v[102:103], v5 offset:21088
  s_waitcnt lgkmcnt(0)
  s_add_u32 s33, s24, 5111808
  s_add_u32 m0, s21, 20480
  s_nop 0
  buffer_load_dwordx4 v4, s[8:11], s33 offen lds
  s_add_u32 s33, s24, 5210112
  s_add_u32 m0, s21, 21504
  s_nop 0
  buffer_load_dwordx4 v4, s[8:11], s33 offen lds
  s_add_u32 s33, s24, 5308416
  s_add_u32 m0, s21, 22528
  s_nop 0
  buffer_load_dwordx4 v4, s[8:11], s33 offen lds
  s_add_u32 s33, s24, 5406720
  s_add_u32 m0, s21, 23552
  s_nop 0
  buffer_load_dwordx4 v4, s[8:11], s33 offen lds
  s_waitcnt vmcnt(28)
  ds_read_b64_tr_b16 a[24:25], v5 offset:24576
  ds_read_b64_tr_b16 a[26:27], v5 offset:25088
  ds_read_b64_tr_b16 a[104:105], v5 offset:24608
  ds_read_b64_tr_b16 a[106:107], v5 offset:25120
  ds_read_b64_tr_b16 a[184:185], v5 offset:24640
  ds_read_b64_tr_b16 a[186:187], v5 offset:25152
  ds_read_b64_tr_b16 v[104:105], v5 offset:24672
  ds_read_b64_tr_b16 v[106:107], v5 offset:25184
  s_waitcnt lgkmcnt(0)
  s_add_u32 s33, s24, 5505024
  s_add_u32 m0, s21, 24576
  s_nop 0
  buffer_load_dwordx4 v4, s[8:11], s33 offen lds
  s_add_u32 s33, s24, 5603328
  s_add_u32 m0, s21, 25600
  s_nop 0
  buffer_load_dwordx4 v4, s[8:11], s33 offen lds
  s_add_u32 s33, s24, 5701632
  s_add_u32 m0, s21, 26624
  s_nop 0
  buffer_load_dwordx4 v4, s[8:11], s33 offen lds
  s_add_u32 s33, s24, 5799936
  s_add_u32 m0, s21, 27648
  s_nop 0
  buffer_load_dwordx4 v4, s[8:11], s33 offen lds
  s_waitcnt vmcnt(28)
  ds_read_b64_tr_b16 a[28:29], v5 offset:28672
  ds_read_b64_tr_b16 a[30:31], v5 offset:29184
  ds_read_b64_tr_b16 a[108:109], v5 offset:28704
  ds_read_b64_tr_b16 a[110:111], v5 offset:29216
  ds_read_b64_tr_b16 a[188:189], v5 offset:28736
  ds_read_b64_tr_b16 a[190:191], v5 offset:29248
  ds_read_b64_tr_b16 v[108:109], v5 offset:28768
  ds_read_b64_tr_b16 v[110:111], v5 offset:29280
  s_waitcnt lgkmcnt(0)
  s_add_u32 s33, s24, 5898240
  s_add_u32 m0, s21, 28672
  s_nop 0
  buffer_load_dwordx4 v4, s[8:11], s33 offen lds
  s_add_u32 s33, s24, 5996544
  s_add_u32 m0, s21, 29696
  s_nop 0
  buffer_load_dwordx4 v4, s[8:11], s33 offen lds
  s_add_u32 s33, s24, 6094848
  s_add_u32 m0, s21, 30720
  s_nop 0
  buffer_load_dwordx4 v4, s[8:11], s33 offen lds
  s_add_u32 s33, s24, 6193152
  s_add_u32 m0, s21, 31744
  s_nop 0
  buffer_load_dwordx4 v4, s[8:11], s33 offen lds
  s_waitcnt vmcnt(28)
  ds_read_b64_tr_b16 a[32:33], v5 offset:0
  ds_read_b64_tr_b16 a[34:35], v5 offset:512
  ds_read_b64_tr_b16 a[112:113], v5 offset:32
  ds_read_b64_tr_b16 a[114:115], v5 offset:544
  ds_read_b64_tr_b16 a[192:193], v5 offset:64
  ds_read_b64_tr_b16 a[194:195], v5 offset:576
  ds_read_b64_tr_b16 v[112:113], v5 offset:96
  ds_read_b64_tr_b16 v[114:115], v5 offset:608
  s_waitcnt lgkmcnt(0)
  s_add_u32 s33, s24, 6291456
  s_add_u32 m0, s21, 0
  s_nop 0
  buffer_load_dwordx4 v4, s[8:11], s33 offen lds
  s_add_u32 s33, s24, 6389760
  s_add_u32 m0, s21, 1024
  s_nop 0
  buffer_load_dwordx4 v4, s[8:11], s33 offen lds
  s_add_u32 s33, s24, 6488064
  s_add_u32 m0, s21, 2048
  s_nop 0
  buffer_load_dwordx4 v4, s[8:11], s33 offen lds
  s_add_u32 s33, s24, 6586368
  s_add_u32 m0, s21, 3072
  s_nop 0
  buffer_load_dwordx4 v4, s[8:11], s33 offen lds
  s_waitcnt vmcnt(28)
  ds_read_b64_tr_b16 a[36:37], v5 offset:4096
  ds_read_b64_tr_b16 a[38:39], v5 offset:4608
  ds_read_b64_tr_b16 a[116:117], v5 offset:4128
  ds_read_b64_tr_b16 a[118:119], v5 offset:4640
  ds_read_b64_tr_b16 a[196:197], v5 offset:4160
  ds_read_b64_tr_b16 a[198:199], v5 offset:4672
  ds_read_b64_tr_b16 v[116:117], v5 offset:4192
  ds_read_b64_tr_b16 v[118:119], v5 offset:4704
  s_waitcnt lgkmcnt(0)
  s_add_u32 s33, s24, 6684672
  s_add_u32 m0, s21, 4096
  s_nop 0
  buffer_load_dwordx4 v4, s[8:11], s33 offen lds
  s_add_u32 s33, s24, 6782976
  s_add_u32 m0, s21, 5120
  s_nop 0
  buffer_load_dwordx4 v4, s[8:11], s33 offen lds
  s_add_u32 s33, s24, 6881280
  s_add_u32 m0, s21, 6144
  s_nop 0
  buffer_load_dwordx4 v4, s[8:11], s33 offen lds
  s_add_u32 s33, s24, 6979584
  s_add_u32 m0, s21, 7168
  s_nop 0
  buffer_load_dwordx4 v4, s[8:11], s33 offen lds
  s_waitcnt vmcnt(28)
  ds_read_b64_tr_b16 a[40:41], v5 offset:8192
  ds_read_b64_tr_b16 a[42:43], v5 offset:8704
  ds_read_b64_tr_b16 a[120:121], v5 offset:8224
  ds_read_b64_tr_b16 a[122:123], v5 offset:8736
  ds_read_b64_tr_b16 a[200:201], v5 offset:8256
  ds_read_b64_tr_b16 a[202:203], v5 offset:8768
  ds_read_b64_tr_b16 v[120:121], v5 offset:8288
  ds_read_b64_tr_b16 v[122:123], v5 offset:8800
  s_waitcnt lgkmcnt(0)
  s_add_u32 s33, s24, 7077888
  s_add_u32 m0, s21, 8192
  s_nop 0
  buffer_load_dwordx4 v4, s[8:11], s33 offen lds
  s_add_u32 s33, s24, 7176192
  s_add_u32 m0, s21, 9216
  s_nop 0
  buffer_load_dwordx4 v4, s[8:11], s33 offen lds
  s_add_u32 s33, s24, 7274496
  s_add_u32 m0, s21, 10240
  s_nop 0
  buffer_load_dwordx4 v4, s[8:11], s33 offen lds
  s_add_u32 s33, s24, 7372800
  s_add_u32 m0, s21, 11264
  s_nop 0
  buffer_load_dwordx4 v4, s[8:11], s33 offen lds
  s_waitcnt vmcnt(28)
  ds_read_b64_tr_b16 a[44:45], v5 offset:12288
  ds_read_b64_tr_b16 a[46:47], v5 offset:12800
  ds_read_b64_tr_b16 a[124:125], v5 offset:12320
  ds_read_b64_tr_b16 a[126:127], v5 offset:12832
  ds_read_b64_tr_b16 a[204:205], v5 offset:12352
  ds_read_b64_tr_b16 a[206:207], v5 offset:12864
  ds_read_b64_tr_b16 v[124:125], v5 offset:12384
  ds_read_b64_tr_b16 v[126:127], v5 offset:12896
  s_waitcnt lgkmcnt(0)
  s_add_u32 s33, s24, 7471104
  s_add_u32 m0, s21, 12288
  s_nop 0
  buffer_load_dwordx4 v4, s[8:11], s33 offen lds
  s_add_u32 s33, s24, 7569408
  s_add_u32 m0, s21, 13312
  s_nop 0
  buffer_load_dwordx4 v4, s[8:11], s33 offen lds
  s_add_u32 s33, s24, 7667712
  s_add_u32 m0, s21, 14336
  s_nop 0
  buffer_load_dwordx4 v4, s[8:11], s33 offen lds
  s_add_u32 s33, s24, 7766016
  s_add_u32 m0, s21, 15360
  s_nop 0
  buffer_load_dwordx4 v4, s[8:11], s33 offen lds
  s_waitcnt vmcnt(28)
  ds_read_b64_tr_b16 a[48:49], v5 offset:16384
  ds_read_b64_tr_b16 a[50:51], v5 offset:16896
  ds_read_b64_tr_b16 a[128:129], v5 offset:16416
  ds_read_b64_tr_b16 a[130:131], v5 offset:16928
  ds_read_b64_tr_b16 a[208:209], v5 offset:16448
  ds_read_b64_tr_b16 a[210:211], v5 offset:16960
  ds_read_b64_tr_b16 v[128:129], v5 offset:16480
  ds_read_b64_tr_b16 v[130:131], v5 offset:16992
  s_waitcnt vmcnt(24)
  ds_read_b64_tr_b16 a[52:53], v5 offset:20480
  ds_read_b64_tr_b16 a[54:55], v5 offset:20992
  ds_read_b64_tr_b16 a[132:133], v5 offset:20512
  ds_read_b64_tr_b16 a[134:135], v5 offset:21024
  ds_read_b64_tr_b16 a[212:213], v5 offset:20544
  ds_read_b64_tr_b16 a[214:215], v5 offset:21056
  ds_read_b64_tr_b16 v[132:133], v5 offset:20576
  ds_read_b64_tr_b16 v[134:135], v5 offset:21088
  s_waitcnt vmcnt(20)
  ds_read_b64_tr_b16 a[56:57], v5 offset:24576
  ds_read_b64_tr_b16 a[58:59], v5 offset:25088
  ds_read_b64_tr_b16 a[136:137], v5 offset:24608
  ds_read_b64_tr_b16 a[138:139], v5 offset:25120
  ds_read_b64_tr_b16 a[216:217], v5 offset:24640
  ds_read_b64_tr_b16 a[218:219], v5 offset:25152
  ds_read_b64_tr_b16 v[136:137], v5 offset:24672
  ds_read_b64_tr_b16 v[138:139], v5 offset:25184
  s_waitcnt vmcnt(16)
  ds_read_b64_tr_b16 a[60:61], v5 offset:28672
  ds_read_b64_tr_b16 a[62:63], v5 offset:29184
  ds_read_b64_tr_b16 a[140:141], v5 offset:28704
  ds_read_b64_tr_b16 a[142:143], v5 offset:29216
  ds_read_b64_tr_b16 a[220:221], v5 offset:28736
  ds_read_b64_tr_b16 a[222:223], v5 offset:29248
  ds_read_b64_tr_b16 v[140:141], v5 offset:28768
  ds_read_b64_tr_b16 v[142:143], v5 offset:29280
  s_waitcnt vmcnt(12)
  ds_read_b64_tr_b16 a[64:65], v5 offset:0
  ds_read_b64_tr_b16 a[66:67], v5 offset:512
  ds_read_b64_tr_b16 a[144:145], v5 offset:32
  ds_read_b64_tr_b16 a[146:147], v5 offset:544
  ds_read_b64_tr_b16 a[224:225], v5 offset:64
  ds_read_b64_tr_b16 a[226:227], v5 offset:576
  ds_read_b64_tr_b16 v[144:145], v5 offset:96
  ds_read_b64_tr_b16 v[146:147], v5 offset:608
  s_waitcnt vmcnt(8)
  ds_read_b64_tr_b16 a[68:69], v5 offset:4096
  ds_read_b64_tr_b16 a[70:71], v5 offset:4608
  ds_read_b64_tr_b16 a[148:149], v5 offset:4128
  ds_read_b64_tr_b16 a[150:151], v5 offset:4640
  ds_read_b64_tr_b16 a[228:229], v5 offset:4160
  ds_read_b64_tr_b16 a[230:231], v5 offset:4672
  ds_read_b64_tr_b16 v[148:149], v5 offset:4192
  ds_read_b64_tr_b16 v[150:151], v5 offset:4704
  s_waitcnt vmcnt(4)
  ds_read_b64_tr_b16 a[72:73], v5 offset:8192
  ds_read_b64_tr_b16 a[74:75], v5 offset:8704
  ds_read_b64_tr_b16 a[152:153], v5 offset:8224
  ds_read_b64_tr_b16 a[154:155], v5 offset:8736
  ds_read_b64_tr_b16 a[232:233], v5 offset:8256
  ds_read_b64_tr_b16 a[234:235], v5 offset:8768
  ds_read_b64_tr_b16 v[152:153], v5 offset:8288
  ds_read_b64_tr_b16 v[154:155], v5 offset:8800
  s_waitcnt vmcnt(0)
  ds_read_b64_tr_b16 a[76:77], v5 offset:12288
  ds_read_b64_tr_b16 a[78:79], v5 offset:12800
  ds_read_b64_tr_b16 a[156:157], v5 offset:12320
  ds_read_b64_tr_b16 a[158:159], v5 offset:12832
  ds_read_b64_tr_b16 a[236:237], v5 offset:12352
  ds_read_b64_tr_b16 a[238:239], v5 offset:12864
  ds_read_b64_tr_b16 v[156:157], v5 offset:12384
  ds_read_b64_tr_b16 v[158:159], v5 offset:12896
  s_waitcnt lgkmcnt(0)
  v_mov_b32 v250, 48
  s_mov_b32 s86, 0
  s_nop 0
WI_Q:
  global_load_dword v251, v250, s[76:77] sc1
  s_waitcnt vmcnt(0)
  v_readfirstlane_b32 s88, v251
  s_nop 0
  s_cmp_ge_u32 s88, 80
  s_nop 1
  s_cbranch_scc1 WI_Q_K
  s_sleep 4
  s_add_u32 s86, s86, 1
  s_cmp_lt_u32 s86, 0x100000
  s_cbranch_scc1 WI_Q
WI_Q_K:
  v_mov_b32 v165, 0x80000000
  s_barrier
  v_lshlrev_b32 v7, 4, v1
  s_mul_i32 s33, s20, 5120
  s_add_u32 s31, s33, 9437184
  s_mov_b32 s32, s33
  s_mov_b32 s53, 0
  v_mov_b32 v161, 0
  s_mov_b32 s54, 0
  s_mov_b32 s55, 0
  s_mov_b32 s59, 0
  s_mov_b32 s61, 0
  v_mov_b32 v164, 8390656
  s_add_u32 m0, s32, 0
  s_add_u32 s33, s31, 0
  buffer_load_dwordx4 v7, s[4:7], s33 offen offset:0 lds
  buffer_load_dwordx4 v7, s[4:7], s33 offen offset:1024 lds
  buffer_load_dwordx4 v7, s[4:7], s33 offen offset:2048 lds
  buffer_load_dwordx4 v7, s[4:7], s33 offen offset:3072 lds
  s_add_u32 m0, s32, 4096
  s_add_u32 s33, s31, 4096
  buffer_load_dwordx4 v7, s[4:7], s33 offen offset:0 lds
  s_add_u32 s31, s31, 20480
  s_add_u32 s32, s32, 20480
  s_sub_u32 s33, s32, 61440
  s_cmp_ge_u32 s32, 61440
  s_cselect_b32 s32, s33, s32
  s_add_u32 m0, s32, 0
  s_add_u32 s33, s31, 0
  buffer_load_dwordx4 v7, s[4:7], s33 offen offset:0 lds
  buffer_load_dwordx4 v7, s[4:7], s33 offen offset:1024 lds
  buffer_load_dwordx4 v7, s[4:7], s33 offen offset:2048 lds
  buffer_load_dwordx4 v7, s[4:7], s33 offen offset:3072 lds
  s_add_u32 m0, s32, 4096
  s_add_u32 s33, s31, 4096
  buffer_load_dwordx4 v7, s[4:7], s33 offen offset:0 lds
  s_add_u32 s31, s31, 20480
  s_add_u32 s32, s32, 20480
  s_sub_u32 s33, s32, 61440
  s_cmp_ge_u32 s32, 61440
  s_cselect_b32 s32, s33, s32
  s_mov_b32 s36, 20480
  v_mov_b32 v8, v7
  s_mov_b32 s34, 0
  s_mov_b32 s37, 0
  s_waitcnt vmcnt(5)
  s_barrier
  ds_read_b128 v[10:13], v8 offset:0
  ds_read_b128 v[14:17], v8 offset:1024
  ds_read_b128 v[18:21], v8 offset:2048
  ds_read_b128 v[22:25], v8 offset:3072
  s_waitcnt lgkmcnt(3)
  v_mfma_f32_16x16x32_bf16 v[26:29], a[0:3], v[10:13], 0
  v_mfma_f32_16x16x32_bf16 v[30:33], a[80:83], v[10:13], 0
  v_mfma_f32_16x16x32_bf16 v[34:37], a[160:163], v[10:13], 0
  v_mfma_f32_16x16x32_bf16 v[38:41], a[240:243], v[10:13], 0
  ds_read_b128 v[10:13], v8 offset:4096
  s_waitcnt lgkmcnt(3)
  v_mfma_f32_16x16x32_bf16 v[26:29], a[4:7], v[14:17], v[26:29]
  v_mfma_f32_16x16x32_bf16 v[30:33], a[84:87], v[14:17], v[30:33]
  v_mfma_f32_16x16x32_bf16 v[34:37], a[164:167], v[14:17], v[34:37]
  v_mfma_f32_16x16x32_bf16 v[38:41], a[244:247], v[14:17], v[38:41]
  ds_read_b128 v[14:17], v8 offset:5120
  s_waitcnt lgkmcnt(3)
  v_mfma_f32_16x16x32_bf16 v[26:29], a[8:11], v[18:21], v[26:29]
  v_mfma_f32_16x16x32_bf16 v[30:33], a[88:91], v[18:21], v[30:33]
  v_mfma_f32_16x16x32_bf16 v[34:37], a[168:171], v[18:21], v[34:37]
  v_mfma_f32_16x16x32_bf16 v[38:41], a[248:251], v[18:21], v[38:41]
  ds_read_b128 v[18:21], v8 offset:6144
  s_waitcnt lgkmcnt(3)
  v_mfma_f32_16x16x32_bf16 v[26:29], a[12:15], v[22:25], v[26:29]
  v_mfma_f32_16x16x32_bf16 v[30:33], a[92:95], v[22:25], v[30:33]
  v_mfma_f32_16x16x32_bf16 v[34:37], a[172:175], v[22:25], v[34:37]
  v_mfma_f32_16x16x32_bf16 v[38:41], a[252:255], v[22:25], v[38:41]
  ds_read_b128 v[22:25], v8 offset:7168
  s_waitcnt lgkmcnt(3)
  v_mfma_f32_16x16x32_bf16 v[26:29], a[16:19], v[10:13], v[26:29]
  v_mfma_f32_16x16x32_bf16 v[30:33], a[96:99], v[10:13], v[30:33]
  v_mfma_f32_16x16x32_bf16 v[34:37], a[176:179], v[10:13], v[34:37]
  v_mfma_f32_16x16x32_bf16 v[38:41], v[96:99], v[10:13], v[38:41]
  ds_read_b128 v[10:13], v8 offset:8192
  s_waitcnt lgkmcnt(3)
  v_mfma_f32_16x16x32_bf16 v[26:29], a[20:23], v[14:17], v[26:29]
  v_mfma_f32_16x16x32_bf16 v[30:33], a[100:103], v[14:17], v[30:33]
  v_mfma_f32_16x16x32_bf16 v[34:37], a[180:183], v[14:17], v[34:37]
  v_mfma_f32_16x16x32_bf16 v[38:41], v[100:103], v[14:17], v[38:41]
  ds_read_b128 v[14:17], v8 offset:9216
  s_waitcnt lgkmcnt(3)
  v_mfma_f32_16x16x32_bf16 v[26:29], a[24:27], v[18:21], v[26:29]
  v_mfma_f32_16x16x32_bf16 v[30:33], a[104:107], v[18:21], v[30:33]
  v_mfma_f32_16x16x32_bf16 v[34:37], a[184:187], v[18:21], v[34:37]
  v_mfma_f32_16x16x32_bf16 v[38:41], v[104:107], v[18:21], v[38:41]
  ds_read_b128 v[18:21], v8 offset:10240
  s_waitcnt lgkmcnt(3)
  v_mfma_f32_16x16x32_bf16 v[26:29], a[28:31], v[22:25], v[26:29]
  v_mfma_f32_16x16x32_bf16 v[30:33], a[108:111], v[22:25], v[30:33]
  v_mfma_f32_16x16x32_bf16 v[34:37], a[188:191], v[22:25], v[34:37]
  v_mfma_f32_16x16x32_bf16 v[38:41], v[108:111], v[22:25], v[38:41]
  ds_read_b128 v[22:25], v8 offset:11264
  s_waitcnt lgkmcnt(3)
  v_mfma_f32_16x16x32_bf16 v[26:29], a[32:35], v[10:13], v[26:29]
  v_mfma_f32_16x16x32_bf16 v[30:33], a[112:115], v[10:13], v[30:33]
  v_mfma_f32_16x16x32_bf16 v[34:37], a[192:195], v[10:13], v[34:37]
  v_mfma_f32_16x16x32_bf16 v[38:41], v[112:115], v[10:13], v[38:41]
  ds_read_b128 v[10:13], v8 offset:12288
  s_waitcnt lgkmcnt(3)
  v_mfma_f32_16x16x32_bf16 v[26:29], a[36:39], v[14:17], v[26:29]
  v_mfma_f32_16x16x32_bf16 v[30:33], a[116:119], v[14:17], v[30:33]
  v_mfma_f32_16x16x32_bf16 v[34:37], a[196:199], v[14:17], v[34:37]
  v_mfma_f32_16x16x32_bf16 v[38:41], v[116:119], v[14:17], v[38:41]
  ds_read_b128 v[14:17], v8 offset:13312
  s_waitcnt lgkmcnt(3)
  v_mfma_f32_16x16x32_bf16 v[26:29], a[40:43], v[18:21], v[26:29]
  v_mfma_f32_16x16x32_bf16 v[30:33], a[120:123], v[18:21], v[30:33]
  v_mfma_f32_16x16x32_bf16 v[34:37], a[200:203], v[18:21], v[34:37]
  v_mfma_f32_16x16x32_bf16 v[38:41], v[120:123], v[18:21], v[38:41]
  ds_read_b128 v[18:21], v8 offset:14336
  s_waitcnt lgkmcnt(3)
  v_mfma_f32_16x16x32_bf16 v[26:29], a[44:47], v[22:25], v[26:29]
  v_mfma_f32_16x16x32_bf16 v[30:33], a[124:127], v[22:25], v[30:33]
  v_mfma_f32_16x16x32_bf16 v[34:37], a[204:207], v[22:25], v[34:37]
  v_mfma_f32_16x16x32_bf16 v[38:41], v[124:127], v[22:25], v[38:41]
  ds_read_b128 v[22:25], v8 offset:15360
  s_waitcnt lgkmcnt(3)
  v_mfma_f32_16x16x32_bf16 v[26:29], a[48:51], v[10:13], v[26:29]
  v_mfma_f32_16x16x32_bf16 v[30:33], a[128:131], v[10:13], v[30:33]
  v_mfma_f32_16x16x32_bf16 v[34:37], a[208:211], v[10:13], v[34:37]
  v_mfma_f32_16x16x32_bf16 v[38:41], v[128:131], v[10:13], v[38:41]
  ds_read_b128 v[10:13], v8 offset:16384
  s_waitcnt lgkmcnt(3)
  v_mfma_f32_16x16x32_bf16 v[26:29], a[52:55], v[14:17], v[26:29]
  v_mfma_f32_16x16x32_bf16 v[30:33], a[132:135], v[14:17], v[30:33]
  v_mfma_f32_16x16x32_bf16 v[34:37], a[212:215], v[14:17], v[34:37]
  v_mfma_f32_16x16x32_bf16 v[38:41], v[132:135], v[14:17], v[38:41]
  ds_read_b128 v[14:17], v8 offset:17408
  s_waitcnt lgkmcnt(3)
  v_mfma_f32_16x16x32_bf16 v[26:29], a[56:59], v[18:21], v[26:29]
  v_mfma_f32_16x16x32_bf16 v[30:33], a[136:139], v[18:21], v[30:33]
  v_mfma_f32_16x16x32_bf16 v[34:37], a[216:219], v[18:21], v[34:37]
  v_mfma_f32_16x16x32_bf16 v[38:41], v[136:139], v[18:21], v[38:41]
  ds_read_b128 v[18:21], v8 offset:18432
  s_waitcnt lgkmcnt(3)
  v_mfma_f32_16x16x32_bf16 v[26:29], a[60:63], v[22:25], v[26:29]
  v_mfma_f32_16x16x32_bf16 v[30:33], a[140:143], v[22:25], v[30:33]
  v_mfma_f32_16x16x32_bf16 v[34:37], a[220:223], v[22:25], v[34:37]
  v_mfma_f32_16x16x32_bf16 v[38:41], v[140:143], v[22:25], v[38:41]
  ds_read_b128 v[22:25], v8 offset:19456
  s_waitcnt lgkmcnt(3)
  v_mfma_f32_16x16x32_bf16 v[26:29], a[64:67], v[10:13], v[26:29]
  v_mfma_f32_16x16x32_bf16 v[30:33], a[144:147], v[10:13], v[30:33]
  v_mfma_f32_16x16x32_bf16 v[34:37], a[224:227], v[10:13], v[34:37]
  v_mfma_f32_16x16x32_bf16 v[38:41], v[144:147], v[10:13], v[38:41]
  s_waitcnt vmcnt(0)
  s_barrier
  v_add_u32 v9, s36, v7
  s_add_u32 s36, s36, 20480
  s_cmp_ge_u32 s36, 61440
  s_cselect_b32 s36, 0, s36
  s_add_u32 m0, s32, 0
  s_add_u32 s33, s31, 0
  buffer_load_dwordx4 v7, s[4:7], s33 offen offset:0 lds
  buffer_load_dwordx4 v7, s[4:7], s33 offen offset:1024 lds
  buffer_load_dwordx4 v7, s[4:7], s33 offen offset:2048 lds
  buffer_load_dwordx4 v7, s[4:7], s33 offen offset:3072 lds
  s_add_u32 m0, s32, 4096
  s_add_u32 s33, s31, 4096
  buffer_load_dwordx4 v7, s[4:7], s33 offen offset:0 lds
  s_add_u32 s31, s31, 20480
  s_add_u32 s32, s32, 20480
  s_sub_u32 s33, s32, 61440
  s_cmp_ge_u32 s32, 61440
  s_cselect_b32 s32, s33, s32
  s_cmp_lg_u32 s20, 0
  s_cbranch_scc1 MPQ_NP26
  v_mov_b32 v160, s53
  s_mov_b64 exec, 1
  buffer_store_dword v160, v161, s[4:7], s52 offen sc1
  s_mov_b64 exec, -1
MPQ_NP26:
  ds_read_b128 v[10:13], v9 offset:0
  s_waitcnt lgkmcnt(3)
  v_mfma_f32_16x16x32_bf16 v[26:29], a[68:71], v[14:17], v[26:29]
  v_mfma_f32_16x16x32_bf16 v[30:33], a[148:151], v[14:17], v[30:33]
  v_mfma_f32_16x16x32_bf16 v[34:37], a[228:231], v[14:17], v[34:37]
  v_mfma_f32_16x16x32_bf16 v[38:41], v[148:151], v[14:17], v[38:41]
  ds_read_b128 v[14:17], v9 offset:1024
  s_waitcnt lgkmcnt(3)
  v_mfma_f32_16x16x32_bf16 v[26:29], a[72:75], v[18:21], v[26:29]
  v_mfma_f32_16x16x32_bf16 v[30:33], a[152:155], v[18:21], v[30:33]
  v_mfma_f32_16x16x32_bf16 v[34:37], a[232:235], v[18:21], v[34:37]
  v_mfma_f32_16x16x32_bf16 v[38:41], v[152:155], v[18:21], v[38:41]
  ds_read_b128 v[18:21], v9 offset:2048
  s_waitcnt lgkmcnt(3)
  v_mfma_f32_16x16x32_bf16 v[26:29], a[76:79], v[22:25], v[26:29]
  v_mfma_f32_16x16x32_bf16 v[30:33], a[156:159], v[22:25], v[30:33]
  v_mfma_f32_16x16x32_bf16 v[34:37], a[236:239], v[22:25], v[34:37]
  v_mfma_f32_16x16x32_bf16 v[38:41], v[156:159], v[22:25], v[38:41]
  ds_read_b128 v[22:25], v9 offset:3072
  s_waitcnt lgkmcnt(3)
  v_mfma_f32_16x16x32_bf16 v[42:45], a[0:3], v[10:13], 0
  v_mfma_f32_16x16x32_bf16 v[46:49], a[80:83], v[10:13], 0
  v_mfma_f32_16x16x32_bf16 v[50:53], a[160:163], v[10:13], 0
  v_mfma_f32_16x16x32_bf16 v[54:57], a[240:243], v[10:13], 0
  ds_read_b128 v[10:13], v9 offset:4096
  s_waitcnt lgkmcnt(3)
  v_mfma_f32_16x16x32_bf16 v[42:45], a[4:7], v[14:17], v[42:45]
  v_mfma_f32_16x16x32_bf16 v[46:49], a[84:87], v[14:17], v[46:49]
  v_mfma_f32_16x16x32_bf16 v[50:53], a[164:167], v[14:17], v[50:53]
  v_mfma_f32_16x16x32_bf16 v[54:57], a[244:247], v[14:17], v[54:57]
  ds_read_b128 v[14:17], v9 offset:5120
  s_waitcnt lgkmcnt(3)
  v_mfma_f32_16x16x32_bf16 v[42:45], a[8:11], v[18:21], v[42:45]
  v_mfma_f32_16x16x32_bf16 v[46:49], a[88:91], v[18:21], v[46:49]
  v_mfma_f32_16x16x32_bf16 v[50:53], a[168:171], v[18:21], v[50:53]
  v_mfma_f32_16x16x32_bf16 v[54:57], a[248:251], v[18:21], v[54:57]
  v_cvt_pk_bf16_f32 v58, v26, v27
  ds_read_b128 v[18:21], v9 offset:6144
  s_waitcnt lgkmcnt(3)
  v_mfma_f32_16x16x32_bf16 v[42:45], a[12:15], v[22:25], v[42:45]
  v_mfma_f32_16x16x32_bf16 v[46:49], a[92:95], v[22:25], v[46:49]
  v_mfma_f32_16x16x32_bf16 v[50:53], a[172:175], v[22:25], v[50:53]
  v_mfma_f32_16x16x32_bf16 v[54:57], a[252:255], v[22:25], v[54:57]
  v_cvt_pk_bf16_f32 v59, v28, v29
  ds_read_b128 v[22:25], v9 offset:7168
  s_waitcnt lgkmcnt(3)
  v_mfma_f32_16x16x32_bf16 v[42:45], a[16:19], v[10:13], v[42:45]
  v_mfma_f32_16x16x32_bf16 v[46:49], a[96:99], v[10:13], v[46:49]
  v_mfma_f32_16x16x32_bf16 v[50:53], a[176:179], v[10:13], v[50:53]
  v_mfma_f32_16x16x32_bf16 v[54:57], v[96:99], v[10:13], v[54:57]
  v_cvt_pk_bf16_f32 v60, v30, v31
  ds_read_b128 v[10:13], v9 offset:8192
  s_waitcnt lgkmcnt(3)
  v_mfma_f32_16x16x32_bf16 v[42:45], a[20:23], v[14:17], v[42:45]
  v_mfma_f32_16x16x32_bf16 v[46:49], a[100:103], v[14:17], v[46:49]
  v_mfma_f32_16x16x32_bf16 v[50:53], a[180:183], v[14:17], v[50:53]
  v_mfma_f32_16x16x32_bf16 v[54:57], v[100:103], v[14:17], v[54:57]
  v_cvt_pk_bf16_f32 v61, v32, v33
  ds_read_b128 v[14:17], v9 offset:9216
  s_waitcnt lgkmcnt(3)
  v_mfma_f32_16x16x32_bf16 v[42:45], a[24:27], v[18:21], v[42:45]
  v_mfma_f32_16x16x32_bf16 v[46:49], a[104:107], v[18:21], v[46:49]
  v_mfma_f32_16x16x32_bf16 v[50:53], a[184:187], v[18:21], v[50:53]
  v_mfma_f32_16x16x32_bf16 v[54:57], v[104:107], v[18:21], v[54:57]
  s_add_u32 s35, s34, s28
  ds_read_b128 v[18:21], v9 offset:10240
  s_waitcnt lgkmcnt(3)
  v_mfma_f32_16x16x32_bf16 v[42:45], a[28:31], v[22:25], v[42:45]
  v_mfma_f32_16x16x32_bf16 v[46:49], a[108:111], v[22:25], v[46:49]
  v_mfma_f32_16x16x32_bf16 v[50:53], a[188:191], v[22:25], v[50:53]
  v_mfma_f32_16x16x32_bf16 v[54:57], v[108:111], v[22:25], v[54:57]
  buffer_store_dwordx4 v[58:61], v7, s[4:7], s35 offen sc1
  ds_read_b128 v[22:25], v9 offset:11264
  s_waitcnt lgkmcnt(3)
  v_mfma_f32_16x16x32_bf16 v[42:45], a[32:35], v[10:13], v[42:45]
  v_mfma_f32_16x16x32_bf16 v[46:49], a[112:115], v[10:13], v[46:49]
  v_mfma_f32_16x16x32_bf16 v[50:53], a[192:195], v[10:13], v[50:53]
  v_mfma_f32_16x16x32_bf16 v[54:57], v[112:115], v[10:13], v[54:57]
  v_cvt_pk_bf16_f32 v62, v34, v35
  ds_read_b128 v[10:13], v9 offset:12288
  s_waitcnt lgkmcnt(3)
  v_mfma_f32_16x16x32_bf16 v[42:45], a[36:39], v[14:17], v[42:45]
  v_mfma_f32_16x16x32_bf16 v[46:49], a[116:119], v[14:17], v[46:49]
  v_mfma_f32_16x16x32_bf16 v[50:53], a[196:199], v[14:17], v[50:53]
  v_mfma_f32_16x16x32_bf16 v[54:57], v[116:119], v[14:17], v[54:57]
  v_cvt_pk_bf16_f32 v63, v36, v37
  ds_read_b128 v[14:17], v9 offset:13312
  s_waitcnt lgkmcnt(3)
  v_mfma_f32_16x16x32_bf16 v[42:45], a[40:43], v[18:21], v[42:45]
  v_mfma_f32_16x16x32_bf16 v[46:49], a[120:123], v[18:21], v[46:49]
  v_mfma_f32_16x16x32_bf16 v[50:53], a[200:203], v[18:21], v[50:53]
  v_mfma_f32_16x16x32_bf16 v[54:57], v[120:123], v[18:21], v[54:57]
  v_cvt_pk_bf16_f32 v64, v38, v39
  ds_read_b128 v[18:21], v9 offset:14336
  s_waitcnt lgkmcnt(3)
  v_mfma_f32_16x16x32_bf16 v[42:45], a[44:47], v[22:25], v[42:45]
  v_mfma_f32_16x16x32_bf16 v[46:49], a[124:127], v[22:25], v[46:49]
  v_mfma_f32_16x16x32_bf16 v[50:53], a[204:207], v[22:25], v[50:53]
  v_mfma_f32_16x16x32_bf16 v[54:57], v[124:127], v[22:25], v[54:57]
  v_cvt_pk_bf16_f32 v65, v40, v41
  ds_read_b128 v[22:25], v9 offset:15360
  s_waitcnt lgkmcnt(3)
  v_mfma_f32_16x16x32_bf16 v[42:45], a[48:51], v[10:13], v[42:45]
  v_mfma_f32_16x16x32_bf16 v[46:49], a[128:131], v[10:13], v[46:49]
  v_mfma_f32_16x16x32_bf16 v[50:53], a[208:211], v[10:13], v[50:53]
  v_mfma_f32_16x16x32_bf16 v[54:57], v[128:131], v[10:13], v[54:57]
  s_add_u32 s35, s34, s29
  ds_read_b128 v[10:13], v9 offset:16384
  s_waitcnt lgkmcnt(3)
  v_mfma_f32_16x16x32_bf16 v[42:45], a[52:55], v[14:17], v[42:45]
  v_mfma_f32_16x16x32_bf16 v[46:49], a[132:135], v[14:17], v[46:49]
  v_mfma_f32_16x16x32_bf16 v[50:53], a[212:215], v[14:17], v[50:53]
  v_mfma_f32_16x16x32_bf16 v[54:57], v[132:135], v[14:17], v[54:57]
  buffer_store_dwordx4 v[62:65], v7, s[4:7], s35 offen sc1
  ds_read_b128 v[14:17], v9 offset:17408
  s_waitcnt lgkmcnt(3)
  v_mfma_f32_16x16x32_bf16 v[42:45], a[56:59], v[18:21], v[42:45]
  v_mfma_f32_16x16x32_bf16 v[46:49], a[136:139], v[18:21], v[46:49]
  v_mfma_f32_16x16x32_bf16 v[50:53], a[216:219], v[18:21], v[50:53]
  v_mfma_f32_16x16x32_bf16 v[54:57], v[136:139], v[18:21], v[54:57]
  s_add_u32 s34, s34, 6144
  ds_read_b128 v[18:21], v9 offset:18432
  s_waitcnt lgkmcnt(3)
  v_mfma_f32_16x16x32_bf16 v[42:45], a[60:63], v[22:25], v[42:45]
  v_mfma_f32_16x16x32_bf16 v[46:49], a[140:143], v[22:25], v[46:49]
  v_mfma_f32_16x16x32_bf16 v[50:53], a[220:223], v[22:25], v[50:53]
  v_mfma_f32_16x16x32_bf16 v[54:57], v[140:143], v[22:25], v[54:57]
  ds_read_b128 v[22:25], v9 offset:19456
  s_waitcnt lgkmcnt(3)
  v_mfma_f32_16x16x32_bf16 v[42:45], a[64:67], v[10:13], v[42:45]
  v_mfma_f32_16x16x32_bf16 v[46:49], a[144:147], v[10:13], v[46:49]
  v_mfma_f32_16x16x32_bf16 v[50:53], a[224:227], v[10:13], v[50:53]
  v_mfma_f32_16x16x32_bf16 v[54:57], v[144:147], v[10:13], v[54:57]
  s_cmp_eq_u32 s20, 0
  s_nop 5
  s_cbranch_scc1 MPQ_SW27
  s_waitcnt vmcnt(2)
  s_branch MPQ_SX27
MPQ_SW27:
  s_waitcnt vmcnt(3)
MPQ_SX27:
  s_barrier
  v_add_u32 v8, s36, v7
  s_add_u32 s36, s36, 20480
  s_cmp_ge_u32 s36, 61440
  s_cselect_b32 s36, 0, s36
  s_add_u32 m0, s32, 0
  s_add_u32 s33, s31, 0
  buffer_load_dwordx4 v7, s[4:7], s33 offen offset:0 lds
  buffer_load_dwordx4 v7, s[4:7], s33 offen offset:1024 lds
  buffer_load_dwordx4 v7, s[4:7], s33 offen offset:2048 lds
  buffer_load_dwordx4 v7, s[4:7], s33 offen offset:3072 lds
  s_add_u32 m0, s32, 4096
  s_add_u32 s33, s31, 4096
  buffer_load_dwordx4 v7, s[4:7], s33 offen offset:0 lds
  s_add_u32 s31, s31, 20480
  s_add_u32 s32, s32, 20480
  s_sub_u32 s33, s32, 61440
  s_cmp_ge_u32 s32, 61440
  s_cselect_b32 s32, s33, s32
  s_cmp_lg_u32 s20, 0
  s_cbranch_scc1 MPQ_NP28
  v_mov_b32 v160, s53
  s_mov_b64 exec, 1
  buffer_store_dword v160, v161, s[4:7], s52 offen sc1
  s_mov_b64 exec, -1
MPQ_NP28:
  s_add_u32 s53, s53, 1
  ds_read_b128 v[10:13], v8 offset:0
  s_waitcnt lgkmcnt(3)
  v_mfma_f32_16x16x32_bf16 v[42:45], a[68:71], v[14:17], v[42:45]
  v_mfma_f32_16x16x32_bf16 v[46:49], a[148:151], v[14:17], v[46:49]
  v_mfma_f32_16x16x32_bf16 v[50:53], a[228:231], v[14:17], v[50:53]
  v_mfma_f32_16x16x32_bf16 v[54:57], v[148:151], v[14:17], v[54:57]
  ds_read_b128 v[14:17], v8 offset:1024
  s_waitcnt lgkmcnt(3)
  v_mfma_f32_16x16x32_bf16 v[42:45], a[72:75], v[18:21], v[42:45]
  v_mfma_f32_16x16x32_bf16 v[46:49], a[152:155], v[18:21], v[46:49]
  v_mfma_f32_16x16x32_bf16 v[50:53], a[232:235], v[18:21], v[50:53]
  v_mfma_f32_16x16x32_bf16 v[54:57], v[152:155], v[18:21], v[54:57]
  ds_read_b128 v[18:21], v8 offset:2048
  s_waitcnt lgkmcnt(3)
  v_mfma_f32_16x16x32_bf16 v[42:45], a[76:79], v[22:25], v[42:45]
  v_mfma_f32_16x16x32_bf16 v[46:49], a[156:159], v[22:25], v[46:49]
  v_mfma_f32_16x16x32_bf16 v[50:53], a[236:239], v[22:25], v[50:53]
  v_mfma_f32_16x16x32_bf16 v[54:57], v[156:159], v[22:25], v[54:57]
  ds_read_b128 v[22:25], v8 offset:3072
  s_waitcnt lgkmcnt(3)
  v_mfma_f32_16x16x32_bf16 v[26:29], a[0:3], v[10:13], 0
  v_mfma_f32_16x16x32_bf16 v[30:33], a[80:83], v[10:13], 0
  v_mfma_f32_16x16x32_bf16 v[34:37], a[160:163], v[10:13], 0
  v_mfma_f32_16x16x32_bf16 v[38:41], a[240:243], v[10:13], 0
  ds_read_b128 v[10:13], v8 offset:4096
  s_waitcnt lgkmcnt(3)
  v_mfma_f32_16x16x32_bf16 v[26:29], a[4:7], v[14:17], v[26:29]
  v_mfma_f32_16x16x32_bf16 v[30:33], a[84:87], v[14:17], v[30:33]
  v_mfma_f32_16x16x32_bf16 v[34:37], a[164:167], v[14:17], v[34:37]
  v_mfma_f32_16x16x32_bf16 v[38:41], a[244:247], v[14:17], v[38:41]
  ds_read_b128 v[14:17], v8 offset:5120
  s_waitcnt lgkmcnt(3)
  v_mfma_f32_16x16x32_bf16 v[26:29], a[8:11], v[18:21], v[26:29]
  v_mfma_f32_16x16x32_bf16 v[30:33], a[88:91], v[18:21], v[30:33]
  v_mfma_f32_16x16x32_bf16 v[34:37], a[168:171], v[18:21], v[34:37]
  v_mfma_f32_16x16x32_bf16 v[38:41], a[248:251], v[18:21], v[38:41]
  v_cvt_pk_bf16_f32 v58, v42, v43
  ds_read_b128 v[18:21], v8 offset:6144
  s_waitcnt lgkmcnt(3)
  v_mfma_f32_16x16x32_bf16 v[26:29], a[12:15], v[22:25], v[26:29]
  v_mfma_f32_16x16x32_bf16 v[30:33], a[92:95], v[22:25], v[30:33]
  v_mfma_f32_16x16x32_bf16 v[34:37], a[172:175], v[22:25], v[34:37]
  v_mfma_f32_16x16x32_bf16 v[38:41], a[252:255], v[22:25], v[38:41]
  v_cvt_pk_bf16_f32 v59, v44, v45
  ds_read_b128 v[22:25], v8 offset:7168
  s_waitcnt lgkmcnt(3)
  v_mfma_f32_16x16x32_bf16 v[26:29], a[16:19], v[10:13], v[26:29]
  v_mfma_f32_16x16x32_bf16 v[30:33], a[96:99], v[10:13], v[30:33]
  v_mfma_f32_16x16x32_bf16 v[34:37], a[176:179], v[10:13], v[34:37]
  v_mfma_f32_16x16x32_bf16 v[38:41], v[96:99], v[10:13], v[38:41]
  v_cvt_pk_bf16_f32 v60, v46, v47
  ds_read_b128 v[10:13], v8 offset:8192
  s_waitcnt lgkmcnt(3)
  v_mfma_f32_16x16x32_bf16 v[26:29], a[20:23], v[14:17], v[26:29]
  v_mfma_f32_16x16x32_bf16 v[30:33], a[100:103], v[14:17], v[30:33]
  v_mfma_f32_16x16x32_bf16 v[34:37], a[180:183], v[14:17], v[34:37]
  v_mfma_f32_16x16x32_bf16 v[38:41], v[100:103], v[14:17], v[38:41]
  v_cvt_pk_bf16_f32 v61, v48, v49
  ds_read_b128 v[14:17], v8 offset:9216
  s_waitcnt lgkmcnt(3)
  v_mfma_f32_16x16x32_bf16 v[26:29], a[24:27], v[18:21], v[26:29]
  v_mfma_f32_16x16x32_bf16 v[30:33], a[104:107], v[18:21], v[30:33]
  v_mfma_f32_16x16x32_bf16 v[34:37], a[184:187], v[18:21], v[34:37]
  v_mfma_f32_16x16x32_bf16 v[38:41], v[104:107], v[18:21], v[38:41]
  s_add_u32 s35, s34, s28
  ds_read_b128 v[18:21], v8 offset:10240
  s_waitcnt lgkmcnt(3)
  v_mfma_f32_16x16x32_bf16 v[26:29], a[28:31], v[22:25], v[26:29]
  v_mfma_f32_16x16x32_bf16 v[30:33], a[108:111], v[22:25], v[30:33]
  v_mfma_f32_16x16x32_bf16 v[34:37], a[188:191], v[22:25], v[34:37]
  v_mfma_f32_16x16x32_bf16 v[38:41], v[108:111], v[22:25], v[38:41]
  buffer_store_dwordx4 v[58:61], v7, s[4:7], s35 offen sc1
  ds_read_b128 v[22:25], v8 offset:11264
  s_waitcnt lgkmcnt(3)
  v_mfma_f32_16x16x32_bf16 v[26:29], a[32:35], v[10:13], v[26:29]
  v_mfma_f32_16x16x32_bf16 v[30:33], a[112:115], v[10:13], v[30:33]
  v_mfma_f32_16x16x32_bf16 v[34:37], a[192:195], v[10:13], v[34:37]
  v_mfma_f32_16x16x32_bf16 v[38:41], v[112:115], v[10:13], v[38:41]
  v_cvt_pk_bf16_f32 v62, v50, v51
  ds_read_b128 v[10:13], v8 offset:12288
  s_waitcnt lgkmcnt(3)
  v_mfma_f32_16x16x32_bf16 v[26:29], a[36:39], v[14:17], v[26:29]
  v_mfma_f32_16x16x32_bf16 v[30:33], a[116:119], v[14:17], v[30:33]
  v_mfma_f32_16x16x32_bf16 v[34:37], a[196:199], v[14:17], v[34:37]
  v_mfma_f32_16x16x32_bf16 v[38:41], v[116:119], v[14:17], v[38:41]
  v_cvt_pk_bf16_f32 v63, v52, v53
  ds_read_b128 v[14:17], v8 offset:13312
  s_waitcnt lgkmcnt(3)
  v_mfma_f32_16x16x32_bf16 v[26:29], a[40:43], v[18:21], v[26:29]
  v_mfma_f32_16x16x32_bf16 v[30:33], a[120:123], v[18:21], v[30:33]
  v_mfma_f32_16x16x32_bf16 v[34:37], a[200:203], v[18:21], v[34:37]
  v_mfma_f32_16x16x32_bf16 v[38:41], v[120:123], v[18:21], v[38:41]
  v_cvt_pk_bf16_f32 v64, v54, v55
  ds_read_b128 v[18:21], v8 offset:14336
  s_waitcnt lgkmcnt(3)
  v_mfma_f32_16x16x32_bf16 v[26:29], a[44:47], v[22:25], v[26:29]
  v_mfma_f32_16x16x32_bf16 v[30:33], a[124:127], v[22:25], v[30:33]
  v_mfma_f32_16x16x32_bf16 v[34:37], a[204:207], v[22:25], v[34:37]
  v_mfma_f32_16x16x32_bf16 v[38:41], v[124:127], v[22:25], v[38:41]
  v_cvt_pk_bf16_f32 v65, v56, v57
  ds_read_b128 v[22:25], v8 offset:15360
  s_waitcnt lgkmcnt(3)
  v_mfma_f32_16x16x32_bf16 v[26:29], a[48:51], v[10:13], v[26:29]
  v_mfma_f32_16x16x32_bf16 v[30:33], a[128:131], v[10:13], v[30:33]
  v_mfma_f32_16x16x32_bf16 v[34:37], a[208:211], v[10:13], v[34:37]
  v_mfma_f32_16x16x32_bf16 v[38:41], v[128:131], v[10:13], v[38:41]
  s_add_u32 s35, s34, s29
  ds_read_b128 v[10:13], v8 offset:16384
  s_waitcnt lgkmcnt(3)
  v_mfma_f32_16x16x32_bf16 v[26:29], a[52:55], v[14:17], v[26:29]
  v_mfma_f32_16x16x32_bf16 v[30:33], a[132:135], v[14:17], v[30:33]
  v_mfma_f32_16x16x32_bf16 v[34:37], a[212:215], v[14:17], v[34:37]
  v_mfma_f32_16x16x32_bf16 v[38:41], v[132:135], v[14:17], v[38:41]
  buffer_store_dwordx4 v[62:65], v7, s[4:7], s35 offen sc1
  ds_read_b128 v[14:17], v8 offset:17408
  s_waitcnt lgkmcnt(3)
  v_mfma_f32_16x16x32_bf16 v[26:29], a[56:59], v[18:21], v[26:29]
  v_mfma_f32_16x16x32_bf16 v[30:33], a[136:139], v[18:21], v[30:33]
  v_mfma_f32_16x16x32_bf16 v[34:37], a[216:219], v[18:21], v[34:37]
  v_mfma_f32_16x16x32_bf16 v[38:41], v[136:139], v[18:21], v[38:41]
  s_add_u32 s34, s34, 387072
  ds_read_b128 v[18:21], v8 offset:18432
  s_waitcnt lgkmcnt(3)
  v_mfma_f32_16x16x32_bf16 v[26:29], a[60:63], v[22:25], v[26:29]
  v_mfma_f32_16x16x32_bf16 v[30:33], a[140:143], v[22:25], v[30:33]
  v_mfma_f32_16x16x32_bf16 v[34:37], a[220:223], v[22:25], v[34:37]
  v_mfma_f32_16x16x32_bf16 v[38:41], v[140:143], v[22:25], v[38:41]
  ds_read_b128 v[22:25], v8 offset:19456
  s_waitcnt lgkmcnt(3)
  v_mfma_f32_16x16x32_bf16 v[26:29], a[64:67], v[10:13], v[26:29]
  v_mfma_f32_16x16x32_bf16 v[30:33], a[144:147], v[10:13], v[30:33]
  v_mfma_f32_16x16x32_bf16 v[34:37], a[224:227], v[10:13], v[34:37]
  v_mfma_f32_16x16x32_bf16 v[38:41], v[144:147], v[10:13], v[38:41]
  s_cmp_eq_u32 s20, 0
  s_nop 5
  s_cbranch_scc1 MPQ_SW29
  s_waitcnt vmcnt(2)
  s_branch MPQ_SX29
MPQ_SW29:
  s_waitcnt vmcnt(3)
MPQ_SX29:
  s_barrier
  v_add_u32 v9, s36, v7
  s_add_u32 s36, s36, 20480
  s_cmp_ge_u32 s36, 61440
  s_cselect_b32 s36, 0, s36
  s_add_u32 m0, s32, 0
  s_add_u32 s33, s31, 0
  buffer_load_dwordx4 v7, s[4:7], s33 offen offset:0 lds
  buffer_load_dwordx4 v7, s[4:7], s33 offen offset:1024 lds
  buffer_load_dwordx4 v7, s[4:7], s33 offen offset:2048 lds
  buffer_load_dwordx4 v7, s[4:7], s33 offen offset:3072 lds
  s_add_u32 m0, s32, 4096
  s_add_u32 s33, s31, 4096
  buffer_load_dwordx4 v7, s[4:7], s33 offen offset:0 lds
  s_add_u32 s31, s31, 20480
  s_add_u32 s32, s32, 20480
  s_sub_u32 s33, s32, 61440
  s_cmp_ge_u32 s32, 61440
  s_cselect_b32 s32, s33, s32
  s_cmp_lg_u32 s20, 0
  s_cbranch_scc1 MPQ_NP30
  v_mov_b32 v160, s53
  s_mov_b64 exec, 1
  buffer_store_dword v160, v161, s[4:7], s52 offen sc1
  s_mov_b64 exec, -1
MPQ_NP30:
  s_add_u32 s53, s53, 1
  ds_read_b128 v[10:13], v9 offset:0
  s_waitcnt lgkmcnt(3)
  v_mfma_f32_16x16x32_bf16 v[26:29], a[68:71], v[14:17], v[26:29]
  v_mfma_f32_16x16x32_bf16 v[30:33], a[148:151], v[14:17], v[30:33]
  v_mfma_f32_16x16x32_bf16 v[34:37], a[228:231], v[14:17], v[34:37]
  v_mfma_f32_16x16x32_bf16 v[38:41], v[148:151], v[14:17], v[38:41]
  ds_read_b128 v[14:17], v9 offset:1024
  s_waitcnt lgkmcnt(3)
  v_mfma_f32_16x16x32_bf16 v[26:29], a[72:75], v[18:21], v[26:29]
  v_mfma_f32_16x16x32_bf16 v[30:33], a[152:155], v[18:21], v[30:33]
  v_mfma_f32_16x16x32_bf16 v[34:37], a[232:235], v[18:21], v[34:37]
  v_mfma_f32_16x16x32_bf16 v[38:41], v[152:155], v[18:21], v[38:41]
  ds_read_b128 v[18:21], v9 offset:2048
  s_waitcnt lgkmcnt(3)
  v_mfma_f32_16x16x32_bf16 v[26:29], a[76:79], v[22:25], v[26:29]
  v_mfma_f32_16x16x32_bf16 v[30:33], a[156:159], v[22:25], v[30:33]
  v_mfma_f32_16x16x32_bf16 v[34:37], a[236:239], v[22:25], v[34:37]
  v_mfma_f32_16x16x32_bf16 v[38:41], v[156:159], v[22:25], v[38:41]
  s_waitcnt vmcnt(0)
  s_barrier
  s_mov_b32 s56, 2
  s_cmp_lg_u32 s20, 0
  s_nop 2
  s_cbranch_scc1 MPQ_EP31
  v_mov_b32 v160, s56
  s_mov_b64 exec, 1
  buffer_store_dword v160, v161, s[4:7], s52 offen sc1
  s_mov_b64 exec, -1
MPQ_EP31:
  ds_read_b128 v[22:25], v9 offset:3072
  s_waitcnt lgkmcnt(3)
  v_mfma_f32_16x16x32_bf16 v[42:45], a[0:3], v[10:13], 0
  v_mfma_f32_16x16x32_bf16 v[46:49], a[80:83], v[10:13], 0
  v_mfma_f32_16x16x32_bf16 v[50:53], a[160:163], v[10:13], 0
  v_mfma_f32_16x16x32_bf16 v[54:57], a[240:243], v[10:13], 0
  ds_read_b128 v[10:13], v9 offset:4096
  s_waitcnt lgkmcnt(3)
  v_mfma_f32_16x16x32_bf16 v[42:45], a[4:7], v[14:17], v[42:45]
  v_mfma_f32_16x16x32_bf16 v[46:49], a[84:87], v[14:17], v[46:49]
  v_mfma_f32_16x16x32_bf16 v[50:53], a[164:167], v[14:17], v[50:53]
  v_mfma_f32_16x16x32_bf16 v[54:57], a[244:247], v[14:17], v[54:57]
  ds_read_b128 v[14:17], v9 offset:5120
  s_waitcnt lgkmcnt(3)
  v_mfma_f32_16x16x32_bf16 v[42:45], a[8:11], v[18:21], v[42:45]
  v_mfma_f32_16x16x32_bf16 v[46:49], a[88:91], v[18:21], v[46:49]
  v_mfma_f32_16x16x32_bf16 v[50:53], a[168:171], v[18:21], v[50:53]
  v_mfma_f32_16x16x32_bf16 v[54:57], a[248:251], v[18:21], v[54:57]
  v_cvt_pk_bf16_f32 v58, v26, v27
  ds_read_b128 v[18:21], v9 offset:6144
  s_waitcnt lgkmcnt(3)
  v_mfma_f32_16x16x32_bf16 v[42:45], a[12:15], v[22:25], v[42:45]
  v_mfma_f32_16x16x32_bf16 v[46:49], a[92:95], v[22:25], v[46:49]
  v_mfma_f32_16x16x32_bf16 v[50:53], a[172:175], v[22:25], v[50:53]
  v_mfma_f32_16x16x32_bf16 v[54:57], a[252:255], v[22:25], v[54:57]
  v_cvt_pk_bf16_f32 v59, v28, v29
  ds_read_b128 v[22:25], v9 offset:7168
  s_waitcnt lgkmcnt(3)
  v_mfma_f32_16x16x32_bf16 v[42:45], a[16:19], v[10:13], v[42:45]
  v_mfma_f32_16x16x32_bf16 v[46:49], a[96:99], v[10:13], v[46:49]
  v_mfma_f32_16x16x32_bf16 v[50:53], a[176:179], v[10:13], v[50:53]
  v_mfma_f32_16x16x32_bf16 v[54:57], v[96:99], v[10:13], v[54:57]
  v_cvt_pk_bf16_f32 v60, v30, v31
  ds_read_b128 v[10:13], v9 offset:8192
  s_waitcnt lgkmcnt(3)
  v_mfma_f32_16x16x32_bf16 v[42:45], a[20:23], v[14:17], v[42:45]
  v_mfma_f32_16x16x32_bf16 v[46:49], a[100:103], v[14:17], v[46:49]
  v_mfma_f32_16x16x32_bf16 v[50:53], a[180:183], v[14:17], v[50:53]
  v_mfma_f32_16x16x32_bf16 v[54:57], v[100:103], v[14:17], v[54:57]
  v_cvt_pk_bf16_f32 v61, v32, v33
  ds_read_b128 v[14:17], v9 offset:9216
  s_waitcnt lgkmcnt(3)
  v_mfma_f32_16x16x32_bf16 v[42:45], a[24:27], v[18:21], v[42:45]
  v_mfma_f32_16x16x32_bf16 v[46:49], a[104:107], v[18:21], v[46:49]
  v_mfma_f32_16x16x32_bf16 v[50:53], a[184:187], v[18:21], v[50:53]
  v_mfma_f32_16x16x32_bf16 v[54:57], v[104:107], v[18:21], v[54:57]
  s_add_u32 s35, s34, s28
  ds_read_b128 v[18:21], v9 offset:10240
  s_waitcnt lgkmcnt(3)
  v_mfma_f32_16x16x32_bf16 v[42:45], a[28:31], v[22:25], v[42:45]
  v_mfma_f32_16x16x32_bf16 v[46:49], a[108:111], v[22:25], v[46:49]
  v_mfma_f32_16x16x32_bf16 v[50:53], a[188:191], v[22:25], v[50:53]
  v_mfma_f32_16x16x32_bf16 v[54:57], v[108:111], v[22:25], v[54:57]
  buffer_store_dwordx4 v[58:61], v7, s[4:7], s35 offen sc1
  ds_read_b128 v[22:25], v9 offset:11264
  s_waitcnt lgkmcnt(3)
  v_mfma_f32_16x16x32_bf16 v[42:45], a[32:35], v[10:13], v[42:45]
  v_mfma_f32_16x16x32_bf16 v[46:49], a[112:115], v[10:13], v[46:49]
  v_mfma_f32_16x16x32_bf16 v[50:53], a[192:195], v[10:13], v[50:53]
  v_mfma_f32_16x16x32_bf16 v[54:57], v[112:115], v[10:13], v[54:57]
  v_cvt_pk_bf16_f32 v62, v34, v35
  ds_read_b128 v[10:13], v9 offset:12288
  s_waitcnt lgkmcnt(3)
  v_mfma_f32_16x16x32_bf16 v[42:45], a[36:39], v[14:17], v[42:45]
  v_mfma_f32_16x16x32_bf16 v[46:49], a[116:119], v[14:17], v[46:49]
  v_mfma_f32_16x16x32_bf16 v[50:53], a[196:199], v[14:17], v[50:53]
  v_mfma_f32_16x16x32_bf16 v[54:57], v[116:119], v[14:17], v[54:57]
  v_cvt_pk_bf16_f32 v63, v36, v37
  ds_read_b128 v[14:17], v9 offset:13312
  s_waitcnt lgkmcnt(3)
  v_mfma_f32_16x16x32_bf16 v[42:45], a[40:43], v[18:21], v[42:45]
  v_mfma_f32_16x16x32_bf16 v[46:49], a[120:123], v[18:21], v[46:49]
  v_mfma_f32_16x16x32_bf16 v[50:53], a[200:203], v[18:21], v[50:53]
  v_mfma_f32_16x16x32_bf16 v[54:57], v[120:123], v[18:21], v[54:57]
  v_cvt_pk_bf16_f32 v64, v38, v39
  ds_read_b128 v[18:21], v9 offset:14336
  s_waitcnt lgkmcnt(3)
  v_mfma_f32_16x16x32_bf16 v[42:45], a[44:47], v[22:25], v[42:45]
  v_mfma_f32_16x16x32_bf16 v[46:49], a[124:127], v[22:25], v[46:49]
  v_mfma_f32_16x16x32_bf16 v[50:53], a[204:207], v[22:25], v[50:53]
  v_mfma_f32_16x16x32_bf16 v[54:57], v[124:127], v[22:25], v[54:57]
  v_cvt_pk_bf16_f32 v65, v40, v41
  ds_read_b128 v[22:25], v9 offset:15360
  s_waitcnt lgkmcnt(3)
  v_mfma_f32_16x16x32_bf16 v[42:45], a[48:51], v[10:13], v[42:45]
  v_mfma_f32_16x16x32_bf16 v[46:49], a[128:131], v[10:13], v[46:49]
  v_mfma_f32_16x16x32_bf16 v[50:53], a[208:211], v[10:13], v[50:53]
  v_mfma_f32_16x16x32_bf16 v[54:57], v[128:131], v[10:13], v[54:57]
  s_add_u32 s35, s34, s29
  ds_read_b128 v[10:13], v9 offset:16384
  s_waitcnt lgkmcnt(3)
  v_mfma_f32_16x16x32_bf16 v[42:45], a[52:55], v[14:17], v[42:45]
  v_mfma_f32_16x16x32_bf16 v[46:49], a[132:135], v[14:17], v[46:49]
  v_mfma_f32_16x16x32_bf16 v[50:53], a[212:215], v[14:17], v[50:53]
  v_mfma_f32_16x16x32_bf16 v[54:57], v[132:135], v[14:17], v[54:57]
  buffer_store_dwordx4 v[62:65], v7, s[4:7], s35 offen sc1
  ds_read_b128 v[14:17], v9 offset:17408
  s_waitcnt lgkmcnt(3)
  v_mfma_f32_16x16x32_bf16 v[42:45], a[56:59], v[18:21], v[42:45]
  v_mfma_f32_16x16x32_bf16 v[46:49], a[136:139], v[18:21], v[46:49]
  v_mfma_f32_16x16x32_bf16 v[50:53], a[216:219], v[18:21], v[50:53]
  v_mfma_f32_16x16x32_bf16 v[54:57], v[136:139], v[18:21], v[54:57]
  s_add_u32 s34, s34, 6144
  ds_read_b128 v[18:21], v9 offset:18432
  s_waitcnt lgkmcnt(3)
  v_mfma_f32_16x16x32_bf16 v[42:45], a[60:63], v[22:25], v[42:45]
  v_mfma_f32_16x16x32_bf16 v[46:49], a[140:143], v[22:25], v[46:49]
  v_mfma_f32_16x16x32_bf16 v[50:53], a[220:223], v[22:25], v[50:53]
  v_mfma_f32_16x16x32_bf16 v[54:57], v[140:143], v[22:25], v[54:57]
  ds_read_b128 v[22:25], v9 offset:19456
  s_waitcnt lgkmcnt(3)
  v_mfma_f32_16x16x32_bf16 v[42:45], a[64:67], v[10:13], v[42:45]
  v_mfma_f32_16x16x32_bf16 v[46:49], a[144:147], v[10:13], v[46:49]
  v_mfma_f32_16x16x32_bf16 v[50:53], a[224:227], v[10:13], v[50:53]
  v_mfma_f32_16x16x32_bf16 v[54:57], v[144:147], v[10:13], v[54:57]
  s_cmp_eq_u32 s20, 0
  s_nop 5
  s_cbranch_scc1 MPQ_SW32
  s_waitcnt vmcnt(2)
  s_branch MPQ_SX32
MPQ_SW32:
  s_waitcnt vmcnt(3)
MPQ_SX32:
  s_barrier
  v_add_u32 v8, s36, v7
  s_add_u32 s36, s36, 20480
  s_cmp_ge_u32 s36, 61440
  s_cselect_b32 s36, 0, s36
  s_add_u32 m0, s32, 0
  s_add_u32 s33, s31, 0
  buffer_load_dwordx4 v7, s[4:7], s33 offen offset:0 lds
  buffer_load_dwordx4 v7, s[4:7], s33 offen offset:1024 lds
  buffer_load_dwordx4 v7, s[4:7], s33 offen offset:2048 lds
  buffer_load_dwordx4 v7, s[4:7], s33 offen offset:3072 lds
  s_add_u32 m0, s32, 4096
  s_add_u32 s33, s31, 4096
  buffer_load_dwordx4 v7, s[4:7], s33 offen offset:0 lds
  s_add_u32 s31, s31, 20480
  s_add_u32 s32, s32, 20480
  s_sub_u32 s33, s32, 61440
  s_cmp_ge_u32 s32, 61440
  s_cselect_b32 s32, s33, s32
  s_cmp_lg_u32 s20, 0
  s_cbranch_scc1 MPQ_NP33
  v_mov_b32 v160, s53
  s_mov_b64 exec, 1
  buffer_store_dword v160, v161, s[4:7], s52 offen sc1
  s_mov_b64 exec, -1
MPQ_NP33:
  s_add_u32 s53, s53, 1
  ds_read_b128 v[10:13], v8 offset:0
  s_waitcnt lgkmcnt(3)
  v_mfma_f32_16x16x32_bf16 v[42:45], a[68:71], v[14:17], v[42:45]
  v_mfma_f32_16x16x32_bf16 v[46:49], a[148:151], v[14:17], v[46:49]
  v_mfma_f32_16x16x32_bf16 v[50:53], a[228:231], v[14:17], v[50:53]
  v_mfma_f32_16x16x32_bf16 v[54:57], v[148:151], v[14:17], v[54:57]
  ds_read_b128 v[14:17], v8 offset:1024
  s_waitcnt lgkmcnt(3)
  v_mfma_f32_16x16x32_bf16 v[42:45], a[72:75], v[18:21], v[42:45]
  v_mfma_f32_16x16x32_bf16 v[46:49], a[152:155], v[18:21], v[46:49]
  v_mfma_f32_16x16x32_bf16 v[50:53], a[232:235], v[18:21], v[50:53]
  v_mfma_f32_16x16x32_bf16 v[54:57], v[152:155], v[18:21], v[54:57]
  ds_read_b128 v[18:21], v8 offset:2048
  s_waitcnt lgkmcnt(3)
  v_mfma_f32_16x16x32_bf16 v[42:45], a[76:79], v[22:25], v[42:45]
  v_mfma_f32_16x16x32_bf16 v[46:49], a[156:159], v[22:25], v[46:49]
  v_mfma_f32_16x16x32_bf16 v[50:53], a[236:239], v[22:25], v[50:53]
  v_mfma_f32_16x16x32_bf16 v[54:57], v[156:159], v[22:25], v[54:57]
  ds_read_b128 v[22:25], v8 offset:3072
  s_waitcnt lgkmcnt(3)
  v_mfma_f32_16x16x32_bf16 v[26:29], a[0:3], v[10:13], 0
  v_mfma_f32_16x16x32_bf16 v[30:33], a[80:83], v[10:13], 0
  v_mfma_f32_16x16x32_bf16 v[34:37], a[160:163], v[10:13], 0
  v_mfma_f32_16x16x32_bf16 v[38:41], a[240:243], v[10:13], 0
  ds_read_b128 v[10:13], v8 offset:4096
  s_waitcnt lgkmcnt(3)
  v_mfma_f32_16x16x32_bf16 v[26:29], a[4:7], v[14:17], v[26:29]
  v_mfma_f32_16x16x32_bf16 v[30:33], a[84:87], v[14:17], v[30:33]
  v_mfma_f32_16x16x32_bf16 v[34:37], a[164:167], v[14:17], v[34:37]
  v_mfma_f32_16x16x32_bf16 v[38:41], a[244:247], v[14:17], v[38:41]
  ds_read_b128 v[14:17], v8 offset:5120
  s_waitcnt lgkmcnt(3)
  v_mfma_f32_16x16x32_bf16 v[26:29], a[8:11], v[18:21], v[26:29]
  v_mfma_f32_16x16x32_bf16 v[30:33], a[88:91], v[18:21], v[30:33]
  v_mfma_f32_16x16x32_bf16 v[34:37], a[168:171], v[18:21], v[34:37]
  v_mfma_f32_16x16x32_bf16 v[38:41], a[248:251], v[18:21], v[38:41]
  v_cvt_pk_bf16_f32 v58, v42, v43
  ds_read_b128 v[18:21], v8 offset:6144
  s_waitcnt lgkmcnt(3)
  v_mfma_f32_16x16x32_bf16 v[26:29], a[12:15], v[22:25], v[26:29]
  v_mfma_f32_16x16x32_bf16 v[30:33], a[92:95], v[22:25], v[30:33]
  v_mfma_f32_16x16x32_bf16 v[34:37], a[172:175], v[22:25], v[34:37]
  v_mfma_f32_16x16x32_bf16 v[38:41], a[252:255], v[22:25], v[38:41]
  v_cvt_pk_bf16_f32 v59, v44, v45
  ds_read_b128 v[22:25], v8 offset:7168
  s_waitcnt lgkmcnt(3)
  v_mfma_f32_16x16x32_bf16 v[26:29], a[16:19], v[10:13], v[26:29]
  v_mfma_f32_16x16x32_bf16 v[30:33], a[96:99], v[10:13], v[30:33]
  v_mfma_f32_16x16x32_bf16 v[34:37], a[176:179], v[10:13], v[34:37]
  v_mfma_f32_16x16x32_bf16 v[38:41], v[96:99], v[10:13], v[38:41]
  v_cvt_pk_bf16_f32 v60, v46, v47
  ds_read_b128 v[10:13], v8 offset:8192
  s_waitcnt lgkmcnt(3)
  v_mfma_f32_16x16x32_bf16 v[26:29], a[20:23], v[14:17], v[26:29]
  v_mfma_f32_16x16x32_bf16 v[30:33], a[100:103], v[14:17], v[30:33]
  v_mfma_f32_16x16x32_bf16 v[34:37], a[180:183], v[14:17], v[34:37]
  v_mfma_f32_16x16x32_bf16 v[38:41], v[100:103], v[14:17], v[38:41]
  v_cvt_pk_bf16_f32 v61, v48, v49
  ds_read_b128 v[14:17], v8 offset:9216
  s_waitcnt lgkmcnt(3)
  v_mfma_f32_16x16x32_bf16 v[26:29], a[24:27], v[18:21], v[26:29]
  v_mfma_f32_16x16x32_bf16 v[30:33], a[104:107], v[18:21], v[30:33]
  v_mfma_f32_16x16x32_bf16 v[34:37], a[184:187], v[18:21], v[34:37]
  v_mfma_f32_16x16x32_bf16 v[38:41], v[104:107], v[18:21], v[38:41]
  s_add_u32 s35, s34, s28
  ds_read_b128 v[18:21], v8 offset:10240
  s_waitcnt lgkmcnt(3)
  v_mfma_f32_16x16x32_bf16 v[26:29], a[28:31], v[22:25], v[26:29]
  v_mfma_f32_16x16x32_bf16 v[30:33], a[108:111], v[22:25], v[30:33]
  v_mfma_f32_16x16x32_bf16 v[34:37], a[188:191], v[22:25], v[34:37]
  v_mfma_f32_16x16x32_bf16 v[38:41], v[108:111], v[22:25], v[38:41]
  buffer_store_dwordx4 v[58:61], v7, s[4:7], s35 offen sc1
  ds_read_b128 v[22:25], v8 offset:11264
  s_waitcnt lgkmcnt(3)
  v_mfma_f32_16x16x32_bf16 v[26:29], a[32:35], v[10:13], v[26:29]
  v_mfma_f32_16x16x32_bf16 v[30:33], a[112:115], v[10:13], v[30:33]
  v_mfma_f32_16x16x32_bf16 v[34:37], a[192:195], v[10:13], v[34:37]
  v_mfma_f32_16x16x32_bf16 v[38:41], v[112:115], v[10:13], v[38:41]
  v_cvt_pk_bf16_f32 v62, v50, v51
  ds_read_b128 v[10:13], v8 offset:12288
  s_waitcnt lgkmcnt(3)
  v_mfma_f32_16x16x32_bf16 v[26:29], a[36:39], v[14:17], v[26:29]
  v_mfma_f32_16x16x32_bf16 v[30:33], a[116:119], v[14:17], v[30:33]
  v_mfma_f32_16x16x32_bf16 v[34:37], a[196:199], v[14:17], v[34:37]
  v_mfma_f32_16x16x32_bf16 v[38:41], v[116:119], v[14:17], v[38:41]
  v_cvt_pk_bf16_f32 v63, v52, v53
  ds_read_b128 v[14:17], v8 offset:13312
  s_waitcnt lgkmcnt(3)
  v_mfma_f32_16x16x32_bf16 v[26:29], a[40:43], v[18:21], v[26:29]
  v_mfma_f32_16x16x32_bf16 v[30:33], a[120:123], v[18:21], v[30:33]
  v_mfma_f32_16x16x32_bf16 v[34:37], a[200:203], v[18:21], v[34:37]
  v_mfma_f32_16x16x32_bf16 v[38:41], v[120:123], v[18:21], v[38:41]
  v_cvt_pk_bf16_f32 v64, v54, v55
  ds_read_b128 v[18:21], v8 offset:14336
  s_waitcnt lgkmcnt(3)
  v_mfma_f32_16x16x32_bf16 v[26:29], a[44:47], v[22:25], v[26:29]
  v_mfma_f32_16x16x32_bf16 v[30:33], a[124:127], v[22:25], v[30:33]
  v_mfma_f32_16x16x32_bf16 v[34:37], a[204:207], v[22:25], v[34:37]
  v_mfma_f32_16x16x32_bf16 v[38:41], v[124:127], v[22:25], v[38:41]
  v_cvt_pk_bf16_f32 v65, v56, v57
  ds_read_b128 v[22:25], v8 offset:15360
  s_waitcnt lgkmcnt(3)
  v_mfma_f32_16x16x32_bf16 v[26:29], a[48:51], v[10:13], v[26:29]
  v_mfma_f32_16x16x32_bf16 v[30:33], a[128:131], v[10:13], v[30:33]
  v_mfma_f32_16x16x32_bf16 v[34:37], a[208:211], v[10:13], v[34:37]
  v_mfma_f32_16x16x32_bf16 v[38:41], v[128:131], v[10:13], v[38:41]
  s_add_u32 s35, s34, s29
  ds_read_b128 v[10:13], v8 offset:16384
  s_waitcnt lgkmcnt(3)
  v_mfma_f32_16x16x32_bf16 v[26:29], a[52:55], v[14:17], v[26:29]
  v_mfma_f32_16x16x32_bf16 v[30:33], a[132:135], v[14:17], v[30:33]
  v_mfma_f32_16x16x32_bf16 v[34:37], a[212:215], v[14:17], v[34:37]
  v_mfma_f32_16x16x32_bf16 v[38:41], v[132:135], v[14:17], v[38:41]
  buffer_store_dwordx4 v[62:65], v7, s[4:7], s35 offen sc1
  ds_read_b128 v[14:17], v8 offset:17408
  s_waitcnt lgkmcnt(3)
  v_mfma_f32_16x16x32_bf16 v[26:29], a[56:59], v[18:21], v[26:29]
  v_mfma_f32_16x16x32_bf16 v[30:33], a[136:139], v[18:21], v[30:33]
  v_mfma_f32_16x16x32_bf16 v[34:37], a[216:219], v[18:21], v[34:37]
  v_mfma_f32_16x16x32_bf16 v[38:41], v[136:139], v[18:21], v[38:41]
  s_add_u32 s34, s34, 387072
  ds_read_b128 v[18:21], v8 offset:18432
  s_waitcnt lgkmcnt(3)
  v_mfma_f32_16x16x32_bf16 v[26:29], a[60:63], v[22:25], v[26:29]
  v_mfma_f32_16x16x32_bf16 v[30:33], a[140:143], v[22:25], v[30:33]
  v_mfma_f32_16x16x32_bf16 v[34:37], a[220:223], v[22:25], v[34:37]
  v_mfma_f32_16x16x32_bf16 v[38:41], v[140:143], v[22:25], v[38:41]
  ds_read_b128 v[22:25], v8 offset:19456
  s_waitcnt lgkmcnt(3)
  v_mfma_f32_16x16x32_bf16 v[26:29], a[64:67], v[10:13], v[26:29]
  v_mfma_f32_16x16x32_bf16 v[30:33], a[144:147], v[10:13], v[30:33]
  v_mfma_f32_16x16x32_bf16 v[34:37], a[224:227], v[10:13], v[34:37]
  v_mfma_f32_16x16x32_bf16 v[38:41], v[144:147], v[10:13], v[38:41]
  s_cmp_eq_u32 s20, 0
  s_nop 5
  s_cbranch_scc1 MPQ_SW34
  s_waitcnt vmcnt(2)
  s_branch MPQ_SX34
MPQ_SW34:
  s_waitcnt vmcnt(3)
MPQ_SX34:
  s_barrier
  v_add_u32 v9, s36, v7
  s_add_u32 s36, s36, 20480
  s_cmp_ge_u32 s36, 61440
  s_cselect_b32 s36, 0, s36
  s_add_u32 m0, s32, 0
  s_add_u32 s33, s31, 0
  buffer_load_dwordx4 v7, s[4:7], s33 offen offset:0 lds
  buffer_load_dwordx4 v7, s[4:7], s33 offen offset:1024 lds
  buffer_load_dwordx4 v7, s[4:7], s33 offen offset:2048 lds
  buffer_load_dwordx4 v7, s[4:7], s33 offen offset:3072 lds
  s_add_u32 m0, s32, 4096
  s_add_u32 s33, s31, 4096
  buffer_load_dwordx4 v7, s[4:7], s33 offen offset:0 lds
  s_add_u32 s31, s31, 20480
  s_add_u32 s32, s32, 20480
  s_sub_u32 s33, s32, 61440
  s_cmp_ge_u32 s32, 61440
  s_cselect_b32 s32, s33, s32
  s_cmp_lg_u32 s20, 0
  s_cbranch_scc1 MPQ_NP35
  v_mov_b32 v160, s53
  s_mov_b64 exec, 1
  buffer_store_dword v160, v161, s[4:7], s52 offen sc1
  s_mov_b64 exec, -1
MPQ_NP35:
  s_add_u32 s53, s53, 1
  ds_read_b128 v[10:13], v9 offset:0
  s_waitcnt lgkmcnt(3)
  v_mfma_f32_16x16x32_bf16 v[26:29], a[68:71], v[14:17], v[26:29]
  v_mfma_f32_16x16x32_bf16 v[30:33], a[148:151], v[14:17], v[30:33]
  v_mfma_f32_16x16x32_bf16 v[34:37], a[228:231], v[14:17], v[34:37]
  v_mfma_f32_16x16x32_bf16 v[38:41], v[148:151], v[14:17], v[38:41]
  ds_read_b128 v[14:17], v9 offset:1024
  s_waitcnt lgkmcnt(3)
  v_mfma_f32_16x16x32_bf16 v[26:29], a[72:75], v[18:21], v[26:29]
  v_mfma_f32_16x16x32_bf16 v[30:33], a[152:155], v[18:21], v[30:33]
  v_mfma_f32_16x16x32_bf16 v[34:37], a[232:235], v[18:21], v[34:37]
  v_mfma_f32_16x16x32_bf16 v[38:41], v[152:155], v[18:21], v[38:41]
  ds_read_b128 v[18:21], v9 offset:2048
  s_waitcnt lgkmcnt(3)
  v_mfma_f32_16x16x32_bf16 v[26:29], a[76:79], v[22:25], v[26:29]
  v_mfma_f32_16x16x32_bf16 v[30:33], a[156:159], v[22:25], v[30:33]
  v_mfma_f32_16x16x32_bf16 v[34:37], a[236:239], v[22:25], v[34:37]
  v_mfma_f32_16x16x32_bf16 v[38:41], v[156:159], v[22:25], v[38:41]
  s_waitcnt vmcnt(0)
  s_barrier
  s_mov_b32 s56, 4
  s_cmp_lg_u32 s20, 0
  s_nop 2
  s_cbranch_scc1 MPQ_EP36
  v_mov_b32 v160, s56
  s_mov_b64 exec, 1
  buffer_store_dword v160, v161, s[4:7], s52 offen sc1
  s_mov_b64 exec, -1
MPQ_EP36:
  s_mov_b32 s30, 61
MPQ_LOOP:
  ds_read_b128 v[22:25], v9 offset:3072
  s_waitcnt lgkmcnt(3)
  v_mfma_f32_16x16x32_bf16 v[42:45], a[0:3], v[10:13], 0
  v_mfma_f32_16x16x32_bf16 v[46:49], a[80:83], v[10:13], 0
  v_mfma_f32_16x16x32_bf16 v[50:53], a[160:163], v[10:13], 0
  v_mfma_f32_16x16x32_bf16 v[54:57], a[240:243], v[10:13], 0
  ds_read_b128 v[10:13], v9 offset:4096
  s_waitcnt lgkmcnt(3)
  v_mfma_f32_16x16x32_bf16 v[42:45], a[4:7], v[14:17], v[42:45]
  v_mfma_f32_16x16x32_bf16 v[46:49], a[84:87], v[14:17], v[46:49]
  v_mfma_f32_16x16x32_bf16 v[50:53], a[164:167], v[14:17], v[50:53]
  v_mfma_f32_16x16x32_bf16 v[54:57], a[244:247], v[14:17], v[54:57]
  ds_read_b128 v[14:17], v9 offset:5120
  s_waitcnt lgkmcnt(3)
  v_mfma_f32_16x16x32_bf16 v[42:45], a[8:11], v[18:21], v[42:45]
  v_mfma_f32_16x16x32_bf16 v[46:49], a[88:91], v[18:21], v[46:49]
  v_mfma_f32_16x16x32_bf16 v[50:53], a[168:171], v[18:21], v[50:53]
  v_mfma_f32_16x16x32_bf16 v[54:57], a[248:251], v[18:21], v[54:57]
  v_cvt_pk_bf16_f32 v58, v26, v27
  ds_read_b128 v[18:21], v9 offset:6144
  s_waitcnt lgkmcnt(3)
  v_mfma_f32_16x16x32_bf16 v[42:45], a[12:15], v[22:25], v[42:45]
  v_mfma_f32_16x16x32_bf16 v[46:49], a[92:95], v[22:25], v[46:49]
  v_mfma_f32_16x16x32_bf16 v[50:53], a[172:175], v[22:25], v[50:53]
  v_mfma_f32_16x16x32_bf16 v[54:57], a[252:255], v[22:25], v[54:57]
  v_cvt_pk_bf16_f32 v59, v28, v29
  ds_read_b128 v[22:25], v9 offset:7168
  s_waitcnt lgkmcnt(3)
  v_mfma_f32_16x16x32_bf16 v[42:45], a[16:19], v[10:13], v[42:45]
  v_mfma_f32_16x16x32_bf16 v[46:49], a[96:99], v[10:13], v[46:49]
  v_mfma_f32_16x16x32_bf16 v[50:53], a[176:179], v[10:13], v[50:53]
  v_mfma_f32_16x16x32_bf16 v[54:57], v[96:99], v[10:13], v[54:57]
  v_cvt_pk_bf16_f32 v60, v30, v31
  ds_read_b128 v[10:13], v9 offset:8192
  s_waitcnt lgkmcnt(3)
  v_mfma_f32_16x16x32_bf16 v[42:45], a[20:23], v[14:17], v[42:45]
  v_mfma_f32_16x16x32_bf16 v[46:49], a[100:103], v[14:17], v[46:49]
  v_mfma_f32_16x16x32_bf16 v[50:53], a[180:183], v[14:17], v[50:53]
  v_mfma_f32_16x16x32_bf16 v[54:57], v[100:103], v[14:17], v[54:57]
  v_cvt_pk_bf16_f32 v61, v32, v33
  ds_read_b128 v[14:17], v9 offset:9216
  s_waitcnt lgkmcnt(3)
  v_mfma_f32_16x16x32_bf16 v[42:45], a[24:27], v[18:21], v[42:45]
  v_mfma_f32_16x16x32_bf16 v[46:49], a[104:107], v[18:21], v[46:49]
  v_mfma_f32_16x16x32_bf16 v[50:53], a[184:187], v[18:21], v[50:53]
  v_mfma_f32_16x16x32_bf16 v[54:57], v[104:107], v[18:21], v[54:57]
  s_add_u32 s35, s34, s28
  ds_read_b128 v[18:21], v9 offset:10240
  s_waitcnt lgkmcnt(3)
  v_mfma_f32_16x16x32_bf16 v[42:45], a[28:31], v[22:25], v[42:45]
  v_mfma_f32_16x16x32_bf16 v[46:49], a[108:111], v[22:25], v[46:49]
  v_mfma_f32_16x16x32_bf16 v[50:53], a[188:191], v[22:25], v[50:53]
  v_mfma_f32_16x16x32_bf16 v[54:57], v[108:111], v[22:25], v[54:57]
  buffer_store_dwordx4 v[58:61], v7, s[4:7], s35 offen sc1
  ds_read_b128 v[22:25], v9 offset:11264
  s_waitcnt lgkmcnt(3)
  v_mfma_f32_16x16x32_bf16 v[42:45], a[32:35], v[10:13], v[42:45]
  v_mfma_f32_16x16x32_bf16 v[46:49], a[112:115], v[10:13], v[46:49]
  v_mfma_f32_16x16x32_bf16 v[50:53], a[192:195], v[10:13], v[50:53]
  v_mfma_f32_16x16x32_bf16 v[54:57], v[112:115], v[10:13], v[54:57]
  v_cvt_pk_bf16_f32 v62, v34, v35
  ds_read_b128 v[10:13], v9 offset:12288
  s_waitcnt lgkmcnt(3)
  v_mfma_f32_16x16x32_bf16 v[42:45], a[36:39], v[14:17], v[42:45]
  v_mfma_f32_16x16x32_bf16 v[46:49], a[116:119], v[14:17], v[46:49]
  v_mfma_f32_16x16x32_bf16 v[50:53], a[196:199], v[14:17], v[50:53]
  v_mfma_f32_16x16x32_bf16 v[54:57], v[116:119], v[14:17], v[54:57]
  v_cvt_pk_bf16_f32 v63, v36, v37
  ds_read_b128 v[14:17], v9 offset:13312
  s_waitcnt lgkmcnt(3)
  v_mfma_f32_16x16x32_bf16 v[42:45], a[40:43], v[18:21], v[42:45]
  v_mfma_f32_16x16x32_bf16 v[46:49], a[120:123], v[18:21], v[46:49]
  v_mfma_f32_16x16x32_bf16 v[50:53], a[200:203], v[18:21], v[50:53]
  v_mfma_f32_16x16x32_bf16 v[54:57], v[120:123], v[18:21], v[54:57]
  v_cvt_pk_bf16_f32 v64, v38, v39
  ds_read_b128 v[18:21], v9 offset:14336
  s_waitcnt lgkmcnt(3)
  v_mfma_f32_16x16x32_bf16 v[42:45], a[44:47], v[22:25], v[42:45]
  v_mfma_f32_16x16x32_bf16 v[46:49], a[124:127], v[22:25], v[46:49]
  v_mfma_f32_16x16x32_bf16 v[50:53], a[204:207], v[22:25], v[50:53]
  v_mfma_f32_16x16x32_bf16 v[54:57], v[124:127], v[22:25], v[54:57]
  v_cvt_pk_bf16_f32 v65, v40, v41
  ds_read_b128 v[22:25], v9 offset:15360
  s_waitcnt lgkmcnt(3)
  v_mfma_f32_16x16x32_bf16 v[42:45], a[48:51], v[10:13], v[42:45]
  v_mfma_f32_16x16x32_bf16 v[46:49], a[128:131], v[10:13], v[46:49]
  v_mfma_f32_16x16x32_bf16 v[50:53], a[208:211], v[10:13], v[50:53]
  v_mfma_f32_16x16x32_bf16 v[54:57], v[128:131], v[10:13], v[54:57]
  s_add_u32 s35, s34, s29
  ds_read_b128 v[10:13], v9 offset:16384
  s_waitcnt lgkmcnt(3)
  v_mfma_f32_16x16x32_bf16 v[42:45], a[52:55], v[14:17], v[42:45]
  v_mfma_f32_16x16x32_bf16 v[46:49], a[132:135], v[14:17], v[46:49]
  v_mfma_f32_16x16x32_bf16 v[50:53], a[212:215], v[14:17], v[50:53]
  v_mfma_f32_16x16x32_bf16 v[54:57], v[132:135], v[14:17], v[54:57]
  buffer_store_dwordx4 v[62:65], v7, s[4:7], s35 offen sc1
  ds_read_b128 v[14:17], v9 offset:17408
  s_waitcnt lgkmcnt(3)
  v_mfma_f32_16x16x32_bf16 v[42:45], a[56:59], v[18:21], v[42:45]
  v_mfma_f32_16x16x32_bf16 v[46:49], a[136:139], v[18:21], v[46:49]
  v_mfma_f32_16x16x32_bf16 v[50:53], a[216:219], v[18:21], v[50:53]
  v_mfma_f32_16x16x32_bf16 v[54:57], v[136:139], v[18:21], v[54:57]
  s_add_u32 s34, s34, 6144
  ds_read_b128 v[18:21], v9 offset:18432
  s_waitcnt lgkmcnt(3)
  v_mfma_f32_16x16x32_bf16 v[42:45], a[60:63], v[22:25], v[42:45]
  v_mfma_f32_16x16x32_bf16 v[46:49], a[140:143], v[22:25], v[46:49]
  v_mfma_f32_16x16x32_bf16 v[50:53], a[220:223], v[22:25], v[50:53]
  v_mfma_f32_16x16x32_bf16 v[54:57], v[140:143], v[22:25], v[54:57]
  ds_read_b128 v[22:25], v9 offset:19456
  s_waitcnt lgkmcnt(3)
  v_mfma_f32_16x16x32_bf16 v[42:45], a[64:67], v[10:13], v[42:45]
  v_mfma_f32_16x16x32_bf16 v[46:49], a[144:147], v[10:13], v[46:49]
  v_mfma_f32_16x16x32_bf16 v[50:53], a[224:227], v[10:13], v[50:53]
  v_mfma_f32_16x16x32_bf16 v[54:57], v[144:147], v[10:13], v[54:57]
  s_cmp_eq_u32 s20, 0
  s_nop 5
  s_cbranch_scc1 MPQ_SW37
  s_waitcnt vmcnt(2)
  s_branch MPQ_SX37
MPQ_SW37:
  s_waitcnt vmcnt(3)
MPQ_SX37:
  s_barrier
  v_add_u32 v8, s36, v7
  s_add_u32 s36, s36, 20480
  s_cmp_ge_u32 s36, 61440
  s_cselect_b32 s36, 0, s36
  s_add_u32 m0, s32, 0
  s_add_u32 s33, s31, 0
  buffer_load_dwordx4 v7, s[4:7], s33 offen offset:0 lds
  buffer_load_dwordx4 v7, s[4:7], s33 offen offset:1024 lds
  buffer_load_dwordx4 v7, s[4:7], s33 offen offset:2048 lds
  buffer_load_dwordx4 v7, s[4:7], s33 offen offset:3072 lds
  s_add_u32 m0, s32, 4096
  s_add_u32 s33, s31, 4096
  buffer_load_dwordx4 v7, s[4:7], s33 offen offset:0 lds
  s_add_u32 s31, s31, 20480
  s_add_u32 s32, s32, 20480
  s_sub_u32 s33, s32, 61440
  s_cmp_ge_u32 s32, 61440
  s_cselect_b32 s32, s33, s32
  s_cmp_lg_u32 s20, 0
  s_cbranch_scc1 MPQ_NP38
  v_mov_b32 v160, s53
  s_mov_b64 exec, 1
  buffer_store_dword v160, v161, s[4:7], s52 offen sc1
  s_mov_b64 exec, -1
MPQ_NP38:
  s_add_u32 s53, s53, 1
  ds_read_b128 v[10:13], v8 offset:0
  s_waitcnt lgkmcnt(3)
  v_mfma_f32_16x16x32_bf16 v[42:45], a[68:71], v[14:17], v[42:45]
  v_mfma_f32_16x16x32_bf16 v[46:49], a[148:151], v[14:17], v[46:49]
  v_mfma_f32_16x16x32_bf16 v[50:53], a[228:231], v[14:17], v[50:53]
  v_mfma_f32_16x16x32_bf16 v[54:57], v[148:151], v[14:17], v[54:57]
  ds_read_b128 v[14:17], v8 offset:1024
  s_waitcnt lgkmcnt(3)
  v_mfma_f32_16x16x32_bf16 v[42:45], a[72:75], v[18:21], v[42:45]
  v_mfma_f32_16x16x32_bf16 v[46:49], a[152:155], v[18:21], v[46:49]
  v_mfma_f32_16x16x32_bf16 v[50:53], a[232:235], v[18:21], v[50:53]
  v_mfma_f32_16x16x32_bf16 v[54:57], v[152:155], v[18:21], v[54:57]
  ds_read_b128 v[18:21], v8 offset:2048
  s_waitcnt lgkmcnt(3)
  v_mfma_f32_16x16x32_bf16 v[42:45], a[76:79], v[22:25], v[42:45]
  v_mfma_f32_16x16x32_bf16 v[46:49], a[156:159], v[22:25], v[46:49]
  v_mfma_f32_16x16x32_bf16 v[50:53], a[236:239], v[22:25], v[50:53]
  v_mfma_f32_16x16x32_bf16 v[54:57], v[156:159], v[22:25], v[54:57]
  ds_read_b128 v[22:25], v8 offset:3072
  s_waitcnt lgkmcnt(3)
  v_mfma_f32_16x16x32_bf16 v[26:29], a[0:3], v[10:13], 0
  v_mfma_f32_16x16x32_bf16 v[30:33], a[80:83], v[10:13], 0
  v_mfma_f32_16x16x32_bf16 v[34:37], a[160:163], v[10:13], 0
  v_mfma_f32_16x16x32_bf16 v[38:41], a[240:243], v[10:13], 0
  ds_read_b128 v[10:13], v8 offset:4096
  s_waitcnt lgkmcnt(3)
  v_mfma_f32_16x16x32_bf16 v[26:29], a[4:7], v[14:17], v[26:29]
  v_mfma_f32_16x16x32_bf16 v[30:33], a[84:87], v[14:17], v[30:33]
  v_mfma_f32_16x16x32_bf16 v[34:37], a[164:167], v[14:17], v[34:37]
  v_mfma_f32_16x16x32_bf16 v[38:41], a[244:247], v[14:17], v[38:41]
  ds_read_b128 v[14:17], v8 offset:5120
  s_waitcnt lgkmcnt(3)
  v_mfma_f32_16x16x32_bf16 v[26:29], a[8:11], v[18:21], v[26:29]
  v_mfma_f32_16x16x32_bf16 v[30:33], a[88:91], v[18:21], v[30:33]
  v_mfma_f32_16x16x32_bf16 v[34:37], a[168:171], v[18:21], v[34:37]
  v_mfma_f32_16x16x32_bf16 v[38:41], a[248:251], v[18:21], v[38:41]
  v_cvt_pk_bf16_f32 v58, v42, v43
  ds_read_b128 v[18:21], v8 offset:6144
  s_waitcnt lgkmcnt(3)
  v_mfma_f32_16x16x32_bf16 v[26:29], a[12:15], v[22:25], v[26:29]
  v_mfma_f32_16x16x32_bf16 v[30:33], a[92:95], v[22:25], v[30:33]
  v_mfma_f32_16x16x32_bf16 v[34:37], a[172:175], v[22:25], v[34:37]
  v_mfma_f32_16x16x32_bf16 v[38:41], a[252:255], v[22:25], v[38:41]
  v_cvt_pk_bf16_f32 v59, v44, v45
  ds_read_b128 v[22:25], v8 offset:7168
  s_waitcnt lgkmcnt(3)
  v_mfma_f32_16x16x32_bf16 v[26:29], a[16:19], v[10:13], v[26:29]
  v_mfma_f32_16x16x32_bf16 v[30:33], a[96:99], v[10:13], v[30:33]
  v_mfma_f32_16x16x32_bf16 v[34:37], a[176:179], v[10:13], v[34:37]
  v_mfma_f32_16x16x32_bf16 v[38:41], v[96:99], v[10:13], v[38:41]
  v_cvt_pk_bf16_f32 v60, v46, v47
  ds_read_b128 v[10:13], v8 offset:8192
  s_waitcnt lgkmcnt(3)
  v_mfma_f32_16x16x32_bf16 v[26:29], a[20:23], v[14:17], v[26:29]
  v_mfma_f32_16x16x32_bf16 v[30:33], a[100:103], v[14:17], v[30:33]
  v_mfma_f32_16x16x32_bf16 v[34:37], a[180:183], v[14:17], v[34:37]
  v_mfma_f32_16x16x32_bf16 v[38:41], v[100:103], v[14:17], v[38:41]
  v_cvt_pk_bf16_f32 v61, v48, v49
  ds_read_b128 v[14:17], v8 offset:9216
  s_waitcnt lgkmcnt(3)
  v_mfma_f32_16x16x32_bf16 v[26:29], a[24:27], v[18:21], v[26:29]
  v_mfma_f32_16x16x32_bf16 v[30:33], a[104:107], v[18:21], v[30:33]
  v_mfma_f32_16x16x32_bf16 v[34:37], a[184:187], v[18:21], v[34:37]
  v_mfma_f32_16x16x32_bf16 v[38:41], v[104:107], v[18:21], v[38:41]
  s_add_u32 s35, s34, s28
  ds_read_b128 v[18:21], v8 offset:10240
  s_waitcnt lgkmcnt(3)
  v_mfma_f32_16x16x32_bf16 v[26:29], a[28:31], v[22:25], v[26:29]
  v_mfma_f32_16x16x32_bf16 v[30:33], a[108:111], v[22:25], v[30:33]
  v_mfma_f32_16x16x32_bf16 v[34:37], a[188:191], v[22:25], v[34:37]
  v_mfma_f32_16x16x32_bf16 v[38:41], v[108:111], v[22:25], v[38:41]
  buffer_store_dwordx4 v[58:61], v7, s[4:7], s35 offen sc1
  ds_read_b128 v[22:25], v8 offset:11264
  s_waitcnt lgkmcnt(3)
  v_mfma_f32_16x16x32_bf16 v[26:29], a[32:35], v[10:13], v[26:29]
  v_mfma_f32_16x16x32_bf16 v[30:33], a[112:115], v[10:13], v[30:33]
  v_mfma_f32_16x16x32_bf16 v[34:37], a[192:195], v[10:13], v[34:37]
  v_mfma_f32_16x16x32_bf16 v[38:41], v[112:115], v[10:13], v[38:41]
  v_cvt_pk_bf16_f32 v62, v50, v51
  ds_read_b128 v[10:13], v8 offset:12288
  s_waitcnt lgkmcnt(3)
  v_mfma_f32_16x16x32_bf16 v[26:29], a[36:39], v[14:17], v[26:29]
  v_mfma_f32_16x16x32_bf16 v[30:33], a[116:119], v[14:17], v[30:33]
  v_mfma_f32_16x16x32_bf16 v[34:37], a[196:199], v[14:17], v[34:37]
  v_mfma_f32_16x16x32_bf16 v[38:41], v[116:119], v[14:17], v[38:41]
  v_cvt_pk_bf16_f32 v63, v52, v53
  ds_read_b128 v[14:17], v8 offset:13312
  s_waitcnt lgkmcnt(3)
  v_mfma_f32_16x16x32_bf16 v[26:29], a[40:43], v[18:21], v[26:29]
  v_mfma_f32_16x16x32_bf16 v[30:33], a[120:123], v[18:21], v[30:33]
  v_mfma_f32_16x16x32_bf16 v[34:37], a[200:203], v[18:21], v[34:37]
  v_mfma_f32_16x16x32_bf16 v[38:41], v[120:123], v[18:21], v[38:41]
  v_cvt_pk_bf16_f32 v64, v54, v55
  ds_read_b128 v[18:21], v8 offset:14336
  s_waitcnt lgkmcnt(3)
  v_mfma_f32_16x16x32_bf16 v[26:29], a[44:47], v[22:25], v[26:29]
  v_mfma_f32_16x16x32_bf16 v[30:33], a[124:127], v[22:25], v[30:33]
  v_mfma_f32_16x16x32_bf16 v[34:37], a[204:207], v[22:25], v[34:37]
  v_mfma_f32_16x16x32_bf16 v[38:41], v[124:127], v[22:25], v[38:41]
  v_cvt_pk_bf16_f32 v65, v56, v57
  ds_read_b128 v[22:25], v8 offset:15360
  s_waitcnt lgkmcnt(3)
  v_mfma_f32_16x16x32_bf16 v[26:29], a[48:51], v[10:13], v[26:29]
  v_mfma_f32_16x16x32_bf16 v[30:33], a[128:131], v[10:13], v[30:33]
  v_mfma_f32_16x16x32_bf16 v[34:37], a[208:211], v[10:13], v[34:37]
  v_mfma_f32_16x16x32_bf16 v[38:41], v[128:131], v[10:13], v[38:41]
  s_add_u32 s35, s34, s29
  ds_read_b128 v[10:13], v8 offset:16384
  s_waitcnt lgkmcnt(3)
  v_mfma_f32_16x16x32_bf16 v[26:29], a[52:55], v[14:17], v[26:29]
  v_mfma_f32_16x16x32_bf16 v[30:33], a[132:135], v[14:17], v[30:33]
  v_mfma_f32_16x16x32_bf16 v[34:37], a[212:215], v[14:17], v[34:37]
  v_mfma_f32_16x16x32_bf16 v[38:41], v[132:135], v[14:17], v[38:41]
  buffer_store_dwordx4 v[62:65], v7, s[4:7], s35 offen sc1
  ds_read_b128 v[14:17], v8 offset:17408
  s_waitcnt lgkmcnt(3)
  v_mfma_f32_16x16x32_bf16 v[26:29], a[56:59], v[18:21], v[26:29]
  v_mfma_f32_16x16x32_bf16 v[30:33], a[136:139], v[18:21], v[30:33]
  v_mfma_f32_16x16x32_bf16 v[34:37], a[216:219], v[18:21], v[34:37]
  v_mfma_f32_16x16x32_bf16 v[38:41], v[136:139], v[18:21], v[38:41]
  s_add_u32 s34, s34, 387072
  ds_read_b128 v[18:21], v8 offset:18432
  s_waitcnt lgkmcnt(3)
  v_mfma_f32_16x16x32_bf16 v[26:29], a[60:63], v[22:25], v[26:29]
  v_mfma_f32_16x16x32_bf16 v[30:33], a[140:143], v[22:25], v[30:33]
  v_mfma_f32_16x16x32_bf16 v[34:37], a[220:223], v[22:25], v[34:37]
  v_mfma_f32_16x16x32_bf16 v[38:41], v[140:143], v[22:25], v[38:41]
  ds_read_b128 v[22:25], v8 offset:19456
  s_waitcnt lgkmcnt(3)
  v_mfma_f32_16x16x32_bf16 v[26:29], a[64:67], v[10:13], v[26:29]
  v_mfma_f32_16x16x32_bf16 v[30:33], a[144:147], v[10:13], v[30:33]
  v_mfma_f32_16x16x32_bf16 v[34:37], a[224:227], v[10:13], v[34:37]
  v_mfma_f32_16x16x32_bf16 v[38:41], v[144:147], v[10:13], v[38:41]
  s_cmp_eq_u32 s20, 0
  s_nop 5
  s_cbranch_scc1 MPQ_SW39
  s_waitcnt vmcnt(2)
  s_branch MPQ_SX39
MPQ_SW39:
  s_waitcnt vmcnt(3)
MPQ_SX39:
  s_barrier
  v_add_u32 v9, s36, v7
  s_add_u32 s36, s36, 20480
  s_cmp_ge_u32 s36, 61440
  s_cselect_b32 s36, 0, s36
  s_add_u32 m0, s32, 0
  s_add_u32 s33, s31, 0
  buffer_load_dwordx4 v7, s[4:7], s33 offen offset:0 lds
  buffer_load_dwordx4 v7, s[4:7], s33 offen offset:1024 lds
  buffer_load_dwordx4 v7, s[4:7], s33 offen offset:2048 lds
  buffer_load_dwordx4 v7, s[4:7], s33 offen offset:3072 lds
  s_add_u32 m0, s32, 4096
  s_add_u32 s33, s31, 4096
  buffer_load_dwordx4 v7, s[4:7], s33 offen offset:0 lds
  s_add_u32 s31, s31, 20480
  s_add_u32 s32, s32, 20480
  s_sub_u32 s33, s32, 61440
  s_cmp_ge_u32 s32, 61440
  s_cselect_b32 s32, s33, s32
  s_cmp_lg_u32 s20, 0
  s_cbranch_scc1 MPQ_NP40
  v_mov_b32 v160, s53
  s_mov_b64 exec, 1
  buffer_store_dword v160, v161, s[4:7], s52 offen sc1
  s_mov_b64 exec, -1
MPQ_NP40:
  s_add_u32 s53, s53, 1
  ds_read_b128 v[10:13], v9 offset:0
  s_waitcnt lgkmcnt(3)
  v_mfma_f32_16x16x32_bf16 v[26:29], a[68:71], v[14:17], v[26:29]
  v_mfma_f32_16x16x32_bf16 v[30:33], a[148:151], v[14:17], v[30:33]
  v_mfma_f32_16x16x32_bf16 v[34:37], a[228:231], v[14:17], v[34:37]
  v_mfma_f32_16x16x32_bf16 v[38:41], v[148:151], v[14:17], v[38:41]
  ds_read_b128 v[14:17], v9 offset:1024
  s_waitcnt lgkmcnt(3)
  v_mfma_f32_16x16x32_bf16 v[26:29], a[72:75], v[18:21], v[26:29]
  v_mfma_f32_16x16x32_bf16 v[30:33], a[152:155], v[18:21], v[30:33]
  v_mfma_f32_16x16x32_bf16 v[34:37], a[232:235], v[18:21], v[34:37]
  v_mfma_f32_16x16x32_bf16 v[38:41], v[152:155], v[18:21], v[38:41]
  ds_read_b128 v[18:21], v9 offset:2048
  s_waitcnt lgkmcnt(3)
  v_mfma_f32_16x16x32_bf16 v[26:29], a[76:79], v[22:25], v[26:29]
  v_mfma_f32_16x16x32_bf16 v[30:33], a[156:159], v[22:25], v[30:33]
  v_mfma_f32_16x16x32_bf16 v[34:37], a[236:239], v[22:25], v[34:37]
  v_mfma_f32_16x16x32_bf16 v[38:41], v[156:159], v[22:25], v[38:41]
  s_sub_u32 s30, s30, 1
  s_cmp_lg_u32 s30, 0
  s_nop 4
  s_cbranch_scc1 MPQ_LOOP
  ds_read_b128 v[22:25], v9 offset:3072
  s_waitcnt lgkmcnt(3)
  v_mfma_f32_16x16x32_bf16 v[42:45], a[0:3], v[10:13], 0
  v_mfma_f32_16x16x32_bf16 v[46:49], a[80:83], v[10:13], 0
  v_mfma_f32_16x16x32_bf16 v[50:53], a[160:163], v[10:13], 0
  v_mfma_f32_16x16x32_bf16 v[54:57], a[240:243], v[10:13], 0
  ds_read_b128 v[10:13], v9 offset:4096
  s_waitcnt lgkmcnt(3)
  v_mfma_f32_16x16x32_bf16 v[42:45], a[4:7], v[14:17], v[42:45]
  v_mfma_f32_16x16x32_bf16 v[46:49], a[84:87], v[14:17], v[46:49]
  v_mfma_f32_16x16x32_bf16 v[50:53], a[164:167], v[14:17], v[50:53]
  v_mfma_f32_16x16x32_bf16 v[54:57], a[244:247], v[14:17], v[54:57]
  ds_read_b128 v[14:17], v9 offset:5120
  s_waitcnt lgkmcnt(3)
  v_mfma_f32_16x16x32_bf16 v[42:45], a[8:11], v[18:21], v[42:45]
  v_mfma_f32_16x16x32_bf16 v[46:49], a[88:91], v[18:21], v[46:49]
  v_mfma_f32_16x16x32_bf16 v[50:53], a[168:171], v[18:21], v[50:53]
  v_mfma_f32_16x16x32_bf16 v[54:57], a[248:251], v[18:21], v[54:57]
  v_cvt_pk_bf16_f32 v58, v26, v27
  ds_read_b128 v[18:21], v9 offset:6144
  s_waitcnt lgkmcnt(3)
  v_mfma_f32_16x16x32_bf16 v[42:45], a[12:15], v[22:25], v[42:45]
  v_mfma_f32_16x16x32_bf16 v[46:49], a[92:95], v[22:25], v[46:49]
  v_mfma_f32_16x16x32_bf16 v[50:53], a[172:175], v[22:25], v[50:53]
  v_mfma_f32_16x16x32_bf16 v[54:57], a[252:255], v[22:25], v[54:57]
  v_cvt_pk_bf16_f32 v59, v28, v29
  ds_read_b128 v[22:25], v9 offset:7168
  s_waitcnt lgkmcnt(3)
  v_mfma_f32_16x16x32_bf16 v[42:45], a[16:19], v[10:13], v[42:45]
  v_mfma_f32_16x16x32_bf16 v[46:49], a[96:99], v[10:13], v[46:49]
  v_mfma_f32_16x16x32_bf16 v[50:53], a[176:179], v[10:13], v[50:53]
  v_mfma_f32_16x16x32_bf16 v[54:57], v[96:99], v[10:13], v[54:57]
  v_cvt_pk_bf16_f32 v60, v30, v31
  ds_read_b128 v[10:13], v9 offset:8192
  s_waitcnt lgkmcnt(3)
  v_mfma_f32_16x16x32_bf16 v[42:45], a[20:23], v[14:17], v[42:45]
  v_mfma_f32_16x16x32_bf16 v[46:49], a[100:103], v[14:17], v[46:49]
  v_mfma_f32_16x16x32_bf16 v[50:53], a[180:183], v[14:17], v[50:53]
  v_mfma_f32_16x16x32_bf16 v[54:57], v[100:103], v[14:17], v[54:57]
  v_cvt_pk_bf16_f32 v61, v32, v33
  ds_read_b128 v[14:17], v9 offset:9216
  s_waitcnt lgkmcnt(3)
  v_mfma_f32_16x16x32_bf16 v[42:45], a[24:27], v[18:21], v[42:45]
  v_mfma_f32_16x16x32_bf16 v[46:49], a[104:107], v[18:21], v[46:49]
  v_mfma_f32_16x16x32_bf16 v[50:53], a[184:187], v[18:21], v[50:53]
  v_mfma_f32_16x16x32_bf16 v[54:57], v[104:107], v[18:21], v[54:57]
  s_add_u32 s35, s34, s28
  ds_read_b128 v[18:21], v9 offset:10240
  s_waitcnt lgkmcnt(3)
  v_mfma_f32_16x16x32_bf16 v[42:45], a[28:31], v[22:25], v[42:45]
  v_mfma_f32_16x16x32_bf16 v[46:49], a[108:111], v[22:25], v[46:49]
  v_mfma_f32_16x16x32_bf16 v[50:53], a[188:191], v[22:25], v[50:53]
  v_mfma_f32_16x16x32_bf16 v[54:57], v[108:111], v[22:25], v[54:57]
  buffer_store_dwordx4 v[58:61], v7, s[4:7], s35 offen sc1
  ds_read_b128 v[22:25], v9 offset:11264
  s_waitcnt lgkmcnt(3)
  v_mfma_f32_16x16x32_bf16 v[42:45], a[32:35], v[10:13], v[42:45]
  v_mfma_f32_16x16x32_bf16 v[46:49], a[112:115], v[10:13], v[46:49]
  v_mfma_f32_16x16x32_bf16 v[50:53], a[192:195], v[10:13], v[50:53]
  v_mfma_f32_16x16x32_bf16 v[54:57], v[112:115], v[10:13], v[54:57]
  v_cvt_pk_bf16_f32 v62, v34, v35
  ds_read_b128 v[10:13], v9 offset:12288
  s_waitcnt lgkmcnt(3)
  v_mfma_f32_16x16x32_bf16 v[42:45], a[36:39], v[14:17], v[42:45]
  v_mfma_f32_16x16x32_bf16 v[46:49], a[116:119], v[14:17], v[46:49]
  v_mfma_f32_16x16x32_bf16 v[50:53], a[196:199], v[14:17], v[50:53]
  v_mfma_f32_16x16x32_bf16 v[54:57], v[116:119], v[14:17], v[54:57]
  v_cvt_pk_bf16_f32 v63, v36, v37
  ds_read_b128 v[14:17], v9 offset:13312
  s_waitcnt lgkmcnt(3)
  v_mfma_f32_16x16x32_bf16 v[42:45], a[40:43], v[18:21], v[42:45]
  v_mfma_f32_16x16x32_bf16 v[46:49], a[120:123], v[18:21], v[46:49]
  v_mfma_f32_16x16x32_bf16 v[50:53], a[200:203], v[18:21], v[50:53]
  v_mfma_f32_16x16x32_bf16 v[54:57], v[120:123], v[18:21], v[54:57]
  v_cvt_pk_bf16_f32 v64, v38, v39
  ds_read_b128 v[18:21], v9 offset:14336
  s_waitcnt lgkmcnt(3)
  v_mfma_f32_16x16x32_bf16 v[42:45], a[44:47], v[22:25], v[42:45]
  v_mfma_f32_16x16x32_bf16 v[46:49], a[124:127], v[22:25], v[46:49]
  v_mfma_f32_16x16x32_bf16 v[50:53], a[204:207], v[22:25], v[50:53]
  v_mfma_f32_16x16x32_bf16 v[54:57], v[124:127], v[22:25], v[54:57]
  v_cvt_pk_bf16_f32 v65, v40, v41
  ds_read_b128 v[22:25], v9 offset:15360
  s_waitcnt lgkmcnt(3)
  v_mfma_f32_16x16x32_bf16 v[42:45], a[48:51], v[10:13], v[42:45]
  v_mfma_f32_16x16x32_bf16 v[46:49], a[128:131], v[10:13], v[46:49]
  v_mfma_f32_16x16x32_bf16 v[50:53], a[208:211], v[10:13], v[50:53]
  v_mfma_f32_16x16x32_bf16 v[54:57], v[128:131], v[10:13], v[54:57]
  s_add_u32 s35, s34, s29
  ds_read_b128 v[10:13], v9 offset:16384
  s_waitcnt lgkmcnt(3)
  v_mfma_f32_16x16x32_bf16 v[42:45], a[52:55], v[14:17], v[42:45]
  v_mfma_f32_16x16x32_bf16 v[46:49], a[132:135], v[14:17], v[46:49]
  v_mfma_f32_16x16x32_bf16 v[50:53], a[212:215], v[14:17], v[50:53]
  v_mfma_f32_16x16x32_bf16 v[54:57], v[132:135], v[14:17], v[54:57]
  buffer_store_dwordx4 v[62:65], v7, s[4:7], s35 offen sc1
  ds_read_b128 v[14:17], v9 offset:17408
  s_waitcnt lgkmcnt(3)
  v_mfma_f32_16x16x32_bf16 v[42:45], a[56:59], v[18:21], v[42:45]
  v_mfma_f32_16x16x32_bf16 v[46:49], a[136:139], v[18:21], v[46:49]
  v_mfma_f32_16x16x32_bf16 v[50:53], a[216:219], v[18:21], v[50:53]
  v_mfma_f32_16x16x32_bf16 v[54:57], v[136:139], v[18:21], v[54:57]
  s_add_u32 s34, s34, 6144
  ds_read_b128 v[18:21], v9 offset:18432
  s_waitcnt lgkmcnt(3)
  v_mfma_f32_16x16x32_bf16 v[42:45], a[60:63], v[22:25], v[42:45]
  v_mfma_f32_16x16x32_bf16 v[46:49], a[140:143], v[22:25], v[46:49]
  v_mfma_f32_16x16x32_bf16 v[50:53], a[220:223], v[22:25], v[50:53]
  v_mfma_f32_16x16x32_bf16 v[54:57], v[140:143], v[22:25], v[54:57]
  ds_read_b128 v[22:25], v9 offset:19456
  s_waitcnt lgkmcnt(3)
  v_mfma_f32_16x16x32_bf16 v[42:45], a[64:67], v[10:13], v[42:45]
  v_mfma_f32_16x16x32_bf16 v[46:49], a[144:147], v[10:13], v[46:49]
  v_mfma_f32_16x16x32_bf16 v[50:53], a[224:227], v[10:13], v[50:53]
  v_mfma_f32_16x16x32_bf16 v[54:57], v[144:147], v[10:13], v[54:57]
  s_cmp_eq_u32 s20, 0
  s_nop 5
  s_cbranch_scc1 MPQ_SW41
  s_waitcnt vmcnt(2)
  s_branch MPQ_SX41
MPQ_SW41:
  s_waitcnt vmcnt(3)
MPQ_SX41:
  s_barrier
  v_add_u32 v8, s36, v7
  s_add_u32 s36, s36, 20480
  s_cmp_ge_u32 s36, 61440
  s_cselect_b32 s36, 0, s36
  s_add_u32 m0, s32, 0
  s_add_u32 s33, s31, 0
  buffer_load_dwordx4 v7, s[4:7], s33 offen offset:0 lds
  buffer_load_dwordx4 v7, s[4:7], s33 offen offset:1024 lds
  buffer_load_dwordx4 v7, s[4:7], s33 offen offset:2048 lds
  buffer_load_dwordx4 v7, s[4:7], s33 offen offset:3072 lds
  s_add_u32 m0, s32, 4096
  s_add_u32 s33, s31, 4096
  buffer_load_dwordx4 v7, s[4:7], s33 offen offset:0 lds
  s_add_u32 s31, s31, 20480
  s_add_u32 s32, s32, 20480
  s_sub_u32 s33, s32, 61440
  s_cmp_ge_u32 s32, 61440
  s_cselect_b32 s32, s33, s32
  s_cmp_lg_u32 s20, 0
  s_cbranch_scc1 MPQ_NP42
  v_mov_b32 v160, s53
  s_mov_b64 exec, 1
  buffer_store_dword v160, v161, s[4:7], s52 offen sc1
  s_mov_b64 exec, -1
MPQ_NP42:
  s_add_u32 s53, s53, 1
  ds_read_b128 v[10:13], v8 offset:0
  s_waitcnt lgkmcnt(3)
  v_mfma_f32_16x16x32_bf16 v[42:45], a[68:71], v[14:17], v[42:45]
  v_mfma_f32_16x16x32_bf16 v[46:49], a[148:151], v[14:17], v[46:49]
  v_mfma_f32_16x16x32_bf16 v[50:53], a[228:231], v[14:17], v[50:53]
  v_mfma_f32_16x16x32_bf16 v[54:57], v[148:151], v[14:17], v[54:57]
  ds_read_b128 v[14:17], v8 offset:1024
  s_waitcnt lgkmcnt(3)
  v_mfma_f32_16x16x32_bf16 v[42:45], a[72:75], v[18:21], v[42:45]
  v_mfma_f32_16x16x32_bf16 v[46:49], a[152:155], v[18:21], v[46:49]
  v_mfma_f32_16x16x32_bf16 v[50:53], a[232:235], v[18:21], v[50:53]
  v_mfma_f32_16x16x32_bf16 v[54:57], v[152:155], v[18:21], v[54:57]
  ds_read_b128 v[18:21], v8 offset:2048
  s_waitcnt lgkmcnt(3)
  v_mfma_f32_16x16x32_bf16 v[42:45], a[76:79], v[22:25], v[42:45]
  v_mfma_f32_16x16x32_bf16 v[46:49], a[156:159], v[22:25], v[46:49]
  v_mfma_f32_16x16x32_bf16 v[50:53], a[236:239], v[22:25], v[50:53]
  v_mfma_f32_16x16x32_bf16 v[54:57], v[156:159], v[22:25], v[54:57]
  s_nop 7
  v_cvt_pk_bf16_f32 v58, v42, v43
  v_cvt_pk_bf16_f32 v59, v44, v45
  v_cvt_pk_bf16_f32 v60, v46, v47
  v_cvt_pk_bf16_f32 v61, v48, v49
  s_add_u32 s35, s34, s28
  buffer_store_dwordx4 v[58:61], v7, s[4:7], s35 offen sc1
  v_cvt_pk_bf16_f32 v62, v50, v51
  v_cvt_pk_bf16_f32 v63, v52, v53
  v_cvt_pk_bf16_f32 v64, v54, v55
  v_cvt_pk_bf16_f32 v65, v56, v57
  s_add_u32 s35, s34, s29
  buffer_store_dwordx4 v[62:65], v7, s[4:7], s35 offen sc1
  s_add_u32 s34, s34, 387072
  s_waitcnt vmcnt(0) lgkmcnt(0)
  s_barrier
  s_mov_b32 s53, 128
  v_mov_b32 v160, s53
  s_mov_b64 exec, 1
  buffer_store_dword v160, v161, s[4:7], s52 offen sc1
  s_mov_b64 exec, -1
  s_waitcnt vmcnt(0)
  s_branch MK_TOK
MK_UP:
  s_sub_u32 s51, s51, 72
  s_load_dwordx2 s[46:47], s[0:1], 64
  s_load_dwordx2 s[48:49], s[0:1], 72
  s_waitcnt lgkmcnt(0)
  s_mov_b32 s8, s46
  s_and_b32 s9, s47, 0xffff
  s_mov_b32 s10, 1966080
  s_mov_b32 s11, 0x00020000
  s_mov_b32 s12, s48
  s_and_b32 s13, s49, 0xffff
  s_mov_b32 s14, 1966080
  s_mov_b32 s15, 0x00020000
  s_lshl_b32 s48, s51, 2
  s_add_u32 s48, s48, s20
  s_lshl_b32 s49, s48, 6
  s_mov_b32 s24, s49
  s_add_u32 s25, s49, 32
  s_mov_b32 s26, s49
  s_add_u32 s27, s49, 32
  s_lshl_b32 s49, s48, 10
  s_add_u32 s28, s49, 88080384
  s_lshl_b32 s21, s20, 15
  v_lshrrev_b32 v6, 2, v1
  s_mov_b32 s22, 3072
  v_mul_lo_u32 v4, v6, s22
  v_and_b32 v6, 3, v1
  v_lshlrev_b32 v6, 4, v6
  v_add_u32 v4, v4, v6
  v_lshrrev_b32 v5, 4, v1
  v_lshlrev_b32 v5, 3, v5
  v_bfe_u32 v6, v1, 2, 2
  v_add_u32 v5, v5, v6
  v_mul_u32_u24 v5, 64, v5
  v_and_b32 v6, 3, v1
  v_lshlrev_b32 v6, 3, v6
  v_add_u32 v5, v5, v6
  v_add_u32 v5, s21, v5
  s_add_u32 s33, s24, 0
  s_add_u32 m0, s21, 0
  s_nop 0
  buffer_load_dwordx4 v4, s[8:11], s33 offen lds
  s_add_u32 s33, s24, 49152
  s_add_u32 m0, s21, 1024
  s_nop 0
  buffer_load_dwordx4 v4, s[8:11], s33 offen lds
  s_add_u32 s33, s26, 0
  s_add_u32 m0, s21, 2048
  s_nop 0
  buffer_load_dwordx4 v4, s[12:15], s33 offen lds
  s_add_u32 s33, s26, 49152
  s_add_u32 m0, s21, 3072
  s_nop 0
  buffer_load_dwordx4 v4, s[12:15], s33 offen lds
  s_add_u32 s33, s24, 98304
  s_add_u32 m0, s21, 4096
  s_nop 0
  buffer_load_dwordx4 v4, s[8:11], s33 offen lds
  s_add_u32 s33, s24, 147456
  s_add_u32 m0, s21, 5120
  s_nop 0
  buffer_load_dwordx4 v4, s[8:11], s33 offen lds
  s_add_u32 s33, s26, 98304
  s_add_u32 m0, s21, 6144
  s_nop 0
  buffer_load_dwordx4 v4, s[12:15], s33 offen lds
  s_add_u32 s33, s26, 147456
  s_add_u32 m0, s21, 7168
  s_nop 0
  buffer_load_dwordx4 v4, s[12:15], s33 offen lds
  s_add_u32 s33, s24, 196608
  s_add_u32 m0, s21, 8192
  s_nop 0
  buffer_load_dwordx4 v4, s[8:11], s33 offen lds
  s_add_u32 s33, s24, 245760
  s_add_u32 m0, s21, 9216
  s_nop 0
  buffer_load_dwordx4 v4, s[8:11], s33 offen lds
  s_add_u32 s33, s26, 196608
  s_add_u32 m0, s21, 10240
  s_nop 0
  buffer_load_dwordx4 v4, s[12:15], s33 offen lds
  s_add_u32 s33, s26, 245760
  s_add_u32 m0, s21, 11264
  s_nop 0
  buffer_load_dwordx4 v4, s[12:15], s33 offen lds
  s_add_u32 s33, s24, 294912
  s_add_u32 m0, s21, 12288
  s_nop 0
  buffer_load_dwordx4 v4, s[8:11], s33 offen lds
  s_add_u32 s33, s24, 344064
  s_add_u32 m0, s21, 13312
  s_nop 0
  buffer_load_dwordx4 v4, s[8:11], s33 offen lds
  s_add_u32 s33, s26, 294912
  s_add_u32 m0, s21, 14336
  s_nop 0
  buffer_load_dwordx4 v4, s[12:15], s33 offen lds
  s_add_u32 s33, s26, 344064
  s_add_u32 m0, s21, 15360
  s_nop 0
  buffer_load_dwordx4 v4, s[12:15], s33 offen lds
  s_add_u32 s33, s24, 393216
  s_add_u32 m0, s21, 16384
  s_nop 0
  buffer_load_dwordx4 v4, s[8:11], s33 offen lds
  s_add_u32 s33, s24, 442368
  s_add_u32 m0, s21, 17408
  s_nop 0
  buffer_load_dwordx4 v4, s[8:11], s33 offen lds
  s_add_u32 s33, s26, 393216
  s_add_u32 m0, s21, 18432
  s_nop 0
  buffer_load_dwordx4 v4, s[12:15], s33 offen lds
  s_add_u32 s33, s26, 442368
  s_add_u32 m0, s21, 19456
  s_nop 0
  buffer_load_dwordx4 v4, s[12:15], s33 offen lds
  s_add_u32 s33, s24, 491520
  s_add_u32 m0, s21, 20480
  s_nop 0
  buffer_load_dwordx4 v4, s[8:11], s33 offen lds
  s_add_u32 s33, s24, 540672
  s_add_u32 m0, s21, 21504
  s_nop 0
  buffer_load_dwordx4 v4, s[8:11], s33 offen lds
  s_add_u32 s33, s26, 491520
  s_add_u32 m0, s21, 22528
  s_nop 0
  buffer_load_dwordx4 v4, s[12:15], s33 offen lds
  s_add_u32 s33, s26, 540672
  s_add_u32 m0, s21, 23552
  s_nop 0
  buffer_load_dwordx4 v4, s[12:15], s33 offen lds
  s_add_u32 s33, s24, 589824
  s_add_u32 m0, s21, 24576
  s_nop 0
  buffer_load_dwordx4 v4, s[8:11], s33 offen lds
  s_add_u32 s33, s24, 638976
  s_add_u32 m0, s21, 25600
  s_nop 0
  buffer_load_dwordx4 v4, s[8:11], s33 offen lds
  s_add_u32 s33, s26, 589824
  s_add_u32 m0, s21, 26624
  s_nop 0
  buffer_load_dwordx4 v4, s[12:15], s33 offen lds
  s_add_u32 s33, s26, 638976
  s_add_u32 m0, s21, 27648
  s_nop 0
  buffer_load_dwordx4 v4, s[12:15], s33 offen lds
  s_add_u32 s33, s24, 688128
  s_add_u32 m0, s21, 28672
  s_nop 0
  buffer_load_dwordx4 v4, s[8:11], s33 offen lds
  s_add_u32 s33, s24, 737280
  s_add_u32 m0, s21, 29696
  s_nop 0
  buffer_load_dwordx4 v4, s[8:11], s33 offen lds
  s_add_u32 s33, s26, 688128
  s_add_u32 m0, s21, 30720
  s_nop 0
  buffer_load_dwordx4 v4, s[12:15], s33 offen lds
  s_add_u32 s33, s26, 737280
  s_add_u32 m0, s21, 31744
  s_nop 0
  buffer_load_dwordx4 v4, s[12:15], s33 offen lds
  s_waitcnt vmcnt(28)
  ds_read_b64_tr_b16 a[0:1], v5 offset:0
  ds_read_b64_tr_b16 a[2:3], v5 offset:256
  ds_read_b64_tr_b16 a[80:81], v5 offset:32
  ds_read_b64_tr_b16 a[82:83], v5 offset:288
  ds_read_b64_tr_b16 a[160:161], v5 offset:2048
  ds_read_b64_tr_b16 a[162:163], v5 offset:2304
  ds_read_b64_tr_b16 a[240:241], v5 offset:2080
  ds_read_b64_tr_b16 a[242:243], v5 offset:2336
  s_waitcnt lgkmcnt(0)
  s_add_u32 s33, s24, 786432
  s_add_u32 m0, s21, 0
  s_nop 0
  buffer_load_dwordx4 v4, s[8:11], s33 offen lds
  s_add_u32 s33, s24, 835584
  s_add_u32 m0, s21, 1024
  s_nop 0
  buffer_load_dwordx4 v4, s[8:11], s33 offen lds
  s_add_u32 s33, s26, 786432
  s_add_u32 m0, s21, 2048
  s_nop 0
  buffer_load_dwordx4 v4, s[12:15], s33 offen lds
  s_add_u32 s33, s26, 835584
  s_add_u32 m0, s21, 3072
  s_nop 0
  buffer_load_dwordx4 v4, s[12:15], s33 offen lds
  s_waitcnt vmcnt(28)
  ds_read_b64_tr_b16 a[4:5], v5 offset:4096
  ds_read_b64_tr_b16 a[6:7], v5 offset:4352
  ds_read_b64_tr_b16 a[84:85], v5 offset:4128
  ds_read_b64_tr_b16 a[86:87], v5 offset:4384
  ds_read_b64_tr_b16 a[164:165], v5 offset:6144
  ds_read_b64_tr_b16 a[166:167], v5 offset:6400
  ds_read_b64_tr_b16 a[244:245], v5 offset:6176
  ds_read_b64_tr_b16 a[246:247], v5 offset:6432
  s_waitcnt lgkmcnt(0)
  s_add_u32 s33, s24, 884736
  s_add_u32 m0, s21, 4096
  s_nop 0
  buffer_load_dwordx4 v4, s[8:11], s33 offen lds
  s_add_u32 s33, s24, 933888
  s_add_u32 m0, s21, 5120
  s_nop 0
  buffer_load_dwordx4 v4, s[8:11], s33 offen lds
  s_add_u32 s33, s26, 884736
  s_add_u32 m0, s21, 6144
  s_nop 0
  buffer_load_dwordx4 v4, s[12:15], s33 offen lds
  s_add_u32 s33, s26, 933888
  s_add_u32 m0, s21, 7168
  s_nop 0
  buffer_load_dwordx4 v4, s[12:15], s33 offen lds
  s_waitcnt vmcnt(28)
  ds_read_b64_tr_b16 a[8:9], v5 offset:8192
  ds_read_b64_tr_b16 a[10:11], v5 offset:8448
  ds_read_b64_tr_b16 a[88:89], v5 offset:8224
  ds_read_b64_tr_b16 a[90:91], v5 offset:8480
  ds_read_b64_tr_b16 a[168:169], v5 offset:10240
  ds_read_b64_tr_b16 a[170:171], v5 offset:10496
  ds_read_b64_tr_b16 a[248:249], v5 offset:10272
  ds_read_b64_tr_b16 a[250:251], v5 offset:10528
  s_waitcnt lgkmcnt(0)
  s_add_u32 s33, s24, 983040
  s_add_u32 m0, s21, 8192
  s_nop 0
  buffer_load_dwordx4 v4, s[8:11], s33 offen lds
  s_add_u32 s33, s24, 1032192
  s_add_u32 m0, s21, 9216
  s_nop 0
  buffer_load_dwordx4 v4, s[8:11], s33 offen lds
  s_add_u32 s33, s26, 983040
  s_add_u32 m0, s21, 10240
  s_nop 0
  buffer_load_dwordx4 v4, s[12:15], s33 offen lds
  s_add_u32 s33, s26, 1032192
  s_add_u32 m0, s21, 11264
  s_nop 0
  buffer_load_dwordx4 v4, s[12:15], s33 offen lds
  s_waitcnt vmcnt(28)
  ds_read_b64_tr_b16 a[12:13], v5 offset:12288
  ds_read_b64_tr_b16 a[14:15], v5 offset:12544
  ds_read_b64_tr_b16 a[92:93], v5 offset:12320
  ds_read_b64_tr_b16 a[94:95], v5 offset:12576
  ds_read_b64_tr_b16 a[172:173], v5 offset:14336
  ds_read_b64_tr_b16 a[174:175], v5 offset:14592
  ds_read_b64_tr_b16 a[252:253], v5 offset:14368
  ds_read_b64_tr_b16 a[254:255], v5 offset:14624
  s_waitcnt lgkmcnt(0)
  s_add_u32 s33, s24, 1081344
  s_add_u32 m0, s21, 12288
  s_nop 0
  buffer_load_dwordx4 v4, s[8:11], s33 offen lds
  s_add_u32 s33, s24, 1130496
  s_add_u32 m0, s21, 13312
  s_nop 0
  buffer_load_dwordx4 v4, s[8:11], s33 offen lds
  s_add_u32 s33, s26, 1081344
  s_add_u32 m0, s21, 14336
  s_nop 0
  buffer_load_dwordx4 v4, s[12:15], s33 offen lds
  s_add_u32 s33, s26, 1130496
  s_add_u32 m0, s21, 15360
  s_nop 0
  buffer_load_dwordx4 v4, s[12:15], s33 offen lds
  s_waitcnt vmcnt(28)
  ds_read_b64_tr_b16 a[16:17], v5 offset:16384
  ds_read_b64_tr_b16 a[18:19], v5 offset:16640
  ds_read_b64_tr_b16 a[96:97], v5 offset:16416
  ds_read_b64_tr_b16 a[98:99], v5 offset:16672
  ds_read_b64_tr_b16 a[176:177], v5 offset:18432
  ds_read_b64_tr_b16 a[178:179], v5 offset:18688
  ds_read_b64_tr_b16 v[96:97], v5 offset:18464
  ds_read_b64_tr_b16 v[98:99], v5 offset:18720
  s_waitcnt lgkmcnt(0)
  s_add_u32 s33, s24, 1179648
  s_add_u32 m0, s21, 16384
  s_nop 0
  buffer_load_dwordx4 v4, s[8:11], s33 offen lds
  s_add_u32 s33, s24, 1228800
  s_add_u32 m0, s21, 17408
  s_nop 0
  buffer_load_dwordx4 v4, s[8:11], s33 offen lds
  s_add_u32 s33, s26, 1179648
  s_add_u32 m0, s21, 18432
  s_nop 0
  buffer_load_dwordx4 v4, s[12:15], s33 offen lds
  s_add_u32 s33, s26, 1228800
  s_add_u32 m0, s21, 19456
  s_nop 0
  buffer_load_dwordx4 v4, s[12:15], s33 offen lds
  s_waitcnt vmcnt(28)
  ds_read_b64_tr_b16 a[20:21], v5 offset:20480
  ds_read_b64_tr_b16 a[22:23], v5 offset:20736
  ds_read_b64_tr_b16 a[100:101], v5 offset:20512
  ds_read_b64_tr_b16 a[102:103], v5 offset:20768
  ds_read_b64_tr_b16 a[180:181], v5 offset:22528
  ds_read_b64_tr_b16 a[182:183], v5 offset:22784
  ds_read_b64_tr_b16 v[100:101], v5 offset:22560
  ds_read_b64_tr_b16 v[102:103], v5 offset:22816
  s_waitcnt lgkmcnt(0)
  s_add_u32 s33, s24, 1277952
  s_add_u32 m0, s21, 20480
  s_nop 0
  buffer_load_dwordx4 v4, s[8:11], s33 offen lds
  s_add_u32 s33, s24, 1327104
  s_add_u32 m0, s21, 21504
  s_nop 0
  buffer_load_dwordx4 v4, s[8:11], s33 offen lds
  s_add_u32 s33, s26, 1277952
  s_add_u32 m0, s21, 22528
  s_nop 0
  buffer_load_dwordx4 v4, s[12:15], s33 offen lds
  s_add_u32 s33, s26, 1327104
  s_add_u32 m0, s21, 23552
  s_nop 0
  buffer_load_dwordx4 v4, s[12:15], s33 offen lds
  s_waitcnt vmcnt(28)
  ds_read_b64_tr_b16 a[24:25], v5 offset:24576
  ds_read_b64_tr_b16 a[26:27], v5 offset:24832
  ds_read_b64_tr_b16 a[104:105], v5 offset:24608
  ds_read_b64_tr_b16 a[106:107], v5 offset:24864
  ds_read_b64_tr_b16 a[184:185], v5 offset:26624
  ds_read_b64_tr_b16 a[186:187], v5 offset:26880
  ds_read_b64_tr_b16 v[104:105], v5 offset:26656
  ds_read_b64_tr_b16 v[106:107], v5 offset:26912
  s_waitcnt lgkmcnt(0)
  s_add_u32 s33, s24, 1376256
  s_add_u32 m0, s21, 24576
  s_nop 0
  buffer_load_dwordx4 v4, s[8:11], s33 offen lds
  s_add_u32 s33, s24, 1425408
  s_add_u32 m0, s21, 25600
  s_nop 0
  buffer_load_dwordx4 v4, s[8:11], s33 offen lds
  s_add_u32 s33, s26, 1376256
  s_add_u32 m0, s21, 26624
  s_nop 0
  buffer_load_dwordx4 v4, s[12:15], s33 offen lds
  s_add_u32 s33, s26, 1425408
  s_add_u32 m0, s21, 27648
  s_nop 0
  buffer_load_dwordx4 v4, s[12:15], s33 offen lds
  s_waitcnt vmcnt(28)
  ds_read_b64_tr_b16 a[28:29], v5 offset:28672
  ds_read_b64_tr_b16 a[30:31], v5 offset:28928
  ds_read_b64_tr_b16 a[108:109], v5 offset:28704
  ds_read_b64_tr_b16 a[110:111], v5 offset:28960
  ds_read_b64_tr_b16 a[188:189], v5 offset:30720
  ds_read_b64_tr_b16 a[190:191], v5 offset:30976
  ds_read_b64_tr_b16 v[108:109], v5 offset:30752
  ds_read_b64_tr_b16 v[110:111], v5 offset:31008
  s_waitcnt lgkmcnt(0)
  s_add_u32 s33, s24, 1474560
  s_add_u32 m0, s21, 28672
  s_nop 0
  buffer_load_dwordx4 v4, s[8:11], s33 offen lds
  s_add_u32 s33, s24, 1523712
  s_add_u32 m0, s21, 29696
  s_nop 0
  buffer_load_dwordx4 v4, s[8:11], s33 offen lds
  s_add_u32 s33, s26, 1474560
  s_add_u32 m0, s21, 30720
  s_nop 0
  buffer_load_dwordx4 v4, s[12:15], s33 offen lds
  s_add_u32 s33, s26, 1523712
  s_add_u32 m0, s21, 31744
  s_nop 0
  buffer_load_dwordx4 v4, s[12:15], s33 offen lds
  s_waitcnt vmcnt(28)
  ds_read_b64_tr_b16 a[32:33], v5 offset:0
  ds_read_b64_tr_b16 a[34:35], v5 offset:256
  ds_read_b64_tr_b16 a[112:113], v5 offset:32
  ds_read_b64_tr_b16 a[114:115], v5 offset:288
  ds_read_b64_tr_b16 a[192:193], v5 offset:2048
  ds_read_b64_tr_b16 a[194:195], v5 offset:2304
  ds_read_b64_tr_b16 v[112:113], v5 offset:2080
  ds_read_b64_tr_b16 v[114:115], v5 offset:2336
  s_waitcnt lgkmcnt(0)
  s_add_u32 s33, s24, 1572864
  s_add_u32 m0, s21, 0
  s_nop 0
  buffer_load_dwordx4 v4, s[8:11], s33 offen lds
  s_add_u32 s33, s24, 1622016
  s_add_u32 m0, s21, 1024
  s_nop 0
  buffer_load_dwordx4 v4, s[8:11], s33 offen lds
  s_add_u32 s33, s26, 1572864
  s_add_u32 m0, s21, 2048
  s_nop 0
  buffer_load_dwordx4 v4, s[12:15], s33 offen lds
  s_add_u32 s33, s26, 1622016
  s_add_u32 m0, s21, 3072
  s_nop 0
  buffer_load_dwordx4 v4, s[12:15], s33 offen lds
  s_waitcnt vmcnt(28)
  ds_read_b64_tr_b16 a[36:37], v5 offset:4096
  ds_read_b64_tr_b16 a[38:39], v5 offset:4352
  ds_read_b64_tr_b16 a[116:117], v5 offset:4128
  ds_read_b64_tr_b16 a[118:119], v5 offset:4384
  ds_read_b64_tr_b16 a[196:197], v5 offset:6144
  ds_read_b64_tr_b16 a[198:199], v5 offset:6400
  ds_read_b64_tr_b16 v[116:117], v5 offset:6176
  ds_read_b64_tr_b16 v[118:119], v5 offset:6432
  s_waitcnt lgkmcnt(0)
  s_add_u32 s33, s24, 1671168
  s_add_u32 m0, s21, 4096
  s_nop 0
  buffer_load_dwordx4 v4, s[8:11], s33 offen lds
  s_add_u32 s33, s24, 1720320
  s_add_u32 m0, s21, 5120
  s_nop 0
  buffer_load_dwordx4 v4, s[8:11], s33 offen lds
  s_add_u32 s33, s26, 1671168
  s_add_u32 m0, s21, 6144
  s_nop 0
  buffer_load_dwordx4 v4, s[12:15], s33 offen lds
  s_add_u32 s33, s26, 1720320
  s_add_u32 m0, s21, 7168
  s_nop 0
  buffer_load_dwordx4 v4, s[12:15], s33 offen lds
  s_waitcnt vmcnt(28)
  ds_read_b64_tr_b16 a[40:41], v5 offset:8192
  ds_read_b64_tr_b16 a[42:43], v5 offset:8448
  ds_read_b64_tr_b16 a[120:121], v5 offset:8224
  ds_read_b64_tr_b16 a[122:123], v5 offset:8480
  ds_read_b64_tr_b16 a[200:201], v5 offset:10240
  ds_read_b64_tr_b16 a[202:203], v5 offset:10496
  ds_read_b64_tr_b16 v[120:121], v5 offset:10272
  ds_read_b64_tr_b16 v[122:123], v5 offset:10528
  s_waitcnt lgkmcnt(0)
  s_add_u32 s33, s24, 1769472
  s_add_u32 m0, s21, 8192
  s_nop 0
  buffer_load_dwordx4 v4, s[8:11], s33 offen lds
  s_add_u32 s33, s24, 1818624
  s_add_u32 m0, s21, 9216
  s_nop 0
  buffer_load_dwordx4 v4, s[8:11], s33 offen lds
  s_add_u32 s33, s26, 1769472
  s_add_u32 m0, s21, 10240
  s_nop 0
  buffer_load_dwordx4 v4, s[12:15], s33 offen lds
  s_add_u32 s33, s26, 1818624
  s_add_u32 m0, s21, 11264
  s_nop 0
  buffer_load_dwordx4 v4, s[12:15], s33 offen lds
  s_waitcnt vmcnt(28)
  ds_read_b64_tr_b16 a[44:45], v5 offset:12288
  ds_read_b64_tr_b16 a[46:47], v5 offset:12544
  ds_read_b64_tr_b16 a[124:125], v5 offset:12320
  ds_read_b64_tr_b16 a[126:127], v5 offset:12576
  ds_read_b64_tr_b16 a[204:205], v5 offset:14336
  ds_read_b64_tr_b16 a[206:207], v5 offset:14592
  ds_read_b64_tr_b16 v[124:125], v5 offset:14368
  ds_read_b64_tr_b16 v[126:127], v5 offset:14624
  s_waitcnt lgkmcnt(0)
  s_add_u32 s33, s24, 1867776
  s_add_u32 m0, s21, 12288
  s_nop 0
  buffer_load_dwordx4 v4, s[8:11], s33 offen lds
  s_add_u32 s33, s24, 1916928
  s_add_u32 m0, s21, 13312
  s_nop 0
  buffer_load_dwordx4 v4, s[8:11], s33 offen lds
  s_add_u32 s33, s26, 1867776
  s_add_u32 m0, s21, 14336
  s_nop 0
  buffer_load_dwordx4 v4, s[12:15], s33 offen lds
  s_add_u32 s33, s26, 1916928
  s_add_u32 m0, s21, 15360
  s_nop 0
  buffer_load_dwordx4 v4, s[12:15], s33 offen lds
  s_waitcnt vmcnt(28)
  ds_read_b64_tr_b16 a[48:49], v5 offset:16384
  ds_read_b64_tr_b16 a[50:51], v5 offset:16640
  ds_read_b64_tr_b16 a[128:129], v5 offset:16416
  ds_read_b64_tr_b16 a[130:131], v5 offset:16672
  ds_read_b64_tr_b16 a[208:209], v5 offset:18432
  ds_read_b64_tr_b16 a[210:211], v5 offset:18688
  ds_read_b64_tr_b16 v[128:129], v5 offset:18464
  ds_read_b64_tr_b16 v[130:131], v5 offset:18720
  s_waitcnt vmcnt(24)
  ds_read_b64_tr_b16 a[52:53], v5 offset:20480
  ds_read_b64_tr_b16 a[54:55], v5 offset:20736
  ds_read_b64_tr_b16 a[132:133], v5 offset:20512
  ds_read_b64_tr_b16 a[134:135], v5 offset:20768
  ds_read_b64_tr_b16 a[212:213], v5 offset:22528
  ds_read_b64_tr_b16 a[214:215], v5 offset:22784
  ds_read_b64_tr_b16 v[132:133], v5 offset:22560
  ds_read_b64_tr_b16 v[134:135], v5 offset:22816
  s_waitcnt vmcnt(20)
  ds_read_b64_tr_b16 a[56:57], v5 offset:24576
  ds_read_b64_tr_b16 a[58:59], v5 offset:24832
  ds_read_b64_tr_b16 a[136:137], v5 offset:24608
  ds_read_b64_tr_b16 a[138:139], v5 offset:24864
  ds_read_b64_tr_b16 a[216:217], v5 offset:26624
  ds_read_b64_tr_b16 a[218:219], v5 offset:26880
  ds_read_b64_tr_b16 v[136:137], v5 offset:26656
  ds_read_b64_tr_b16 v[138:139], v5 offset:26912
  s_waitcnt vmcnt(16)
  ds_read_b64_tr_b16 a[60:61], v5 offset:28672
  ds_read_b64_tr_b16 a[62:63], v5 offset:28928
  ds_read_b64_tr_b16 a[140:141], v5 offset:28704
  ds_read_b64_tr_b16 a[142:143], v5 offset:28960
  ds_read_b64_tr_b16 a[220:221], v5 offset:30720
  ds_read_b64_tr_b16 a[222:223], v5 offset:30976
  ds_read_b64_tr_b16 v[140:141], v5 offset:30752
  ds_read_b64_tr_b16 v[142:143], v5 offset:31008
  s_waitcnt vmcnt(12)
  ds_read_b64_tr_b16 a[64:65], v5 offset:0
  ds_read_b64_tr_b16 a[66:67], v5 offset:256
  ds_read_b64_tr_b16 a[144:145], v5 offset:32
  ds_read_b64_tr_b16 a[146:147], v5 offset:288
  ds_read_b64_tr_b16 a[224:225], v5 offset:2048
  ds_read_b64_tr_b16 a[226:227], v5 offset:2304
  ds_read_b64_tr_b16 v[144:145], v5 offset:2080
  ds_read_b64_tr_b16 v[146:147], v5 offset:2336
  s_waitcnt vmcnt(8)
  ds_read_b64_tr_b16 a[68:69], v5 offset:4096
  ds_read_b64_tr_b16 a[70:71], v5 offset:4352
  ds_read_b64_tr_b16 a[148:149], v5 offset:4128
  ds_read_b64_tr_b16 a[150:151], v5 offset:4384
  ds_read_b64_tr_b16 a[228:229], v5 offset:6144
  ds_read_b64_tr_b16 a[230:231], v5 offset:6400
  ds_read_b64_tr_b16 v[148:149], v5 offset:6176
  ds_read_b64_tr_b16 v[150:151], v5 offset:6432
  s_waitcnt vmcnt(4)
  ds_read_b64_tr_b16 a[72:73], v5 offset:8192
  ds_read_b64_tr_b16 a[74:75], v5 offset:8448
  ds_read_b64_tr_b16 a[152:153], v5 offset:8224
  ds_read_b64_tr_b16 a[154:155], v5 offset:8480
  ds_read_b64_tr_b16 a[232:233], v5 offset:10240
  ds_read_b64_tr_b16 a[234:235], v5 offset:10496
  ds_read_b64_tr_b16 v[152:153], v5 offset:10272
  ds_read_b64_tr_b16 v[154:155], v5 offset:10528
  s_waitcnt vmcnt(0)
  ds_read_b64_tr_b16 a[76:77], v5 offset:12288
  ds_read_b64_tr_b16 a[78:79], v5 offset:12544
  ds_read_b64_tr_b16 a[156:157], v5 offset:12320
  ds_read_b64_tr_b16 a[158:159], v5 offset:12576
  ds_read_b64_tr_b16 a[236:237], v5 offset:14336
  ds_read_b64_tr_b16 a[238:239], v5 offset:14592
  ds_read_b64_tr_b16 v[156:157], v5 offset:14368
  ds_read_b64_tr_b16 v[158:159], v5 offset:14624
  s_waitcnt lgkmcnt(0)
  v_mov_b32 v250, 48
  s_mov_b32 s86, 0
  s_nop 0
WI_U:
  global_load_dword v251, v250, s[76:77] sc1
  s_waitcnt vmcnt(0)
  v_readfirstlane_b32 s88, v251
  s_nop 0
  s_cmp_ge_u32 s88, 80
  s_nop 1
  s_cbranch_scc1 WI_U_K
  s_sleep 4
  s_add_u32 s86, s86, 1
  s_cmp_lt_u32 s86, 0x100000
  s_cbranch_scc1 WI_U
WI_U_K:
  v_mov_b32 v165, 0x80000000
  s_barrier
  v_lshlrev_b32 v7, 4, v1
  s_mul_i32 s33, s20, 5120
  s_add_u32 s31, s33, 9437184
  s_mov_b32 s32, s33
  s_mov_b32 s53, 0
  v_mov_b32 v161, 0
  s_mov_b32 s54, 0
  s_mov_b32 s55, 0
  s_mov_b32 s59, 0
  s_mov_b32 s61, 0
  v_mov_b32 v164, 8390656
  s_add_u32 m0, s32, 0
  s_add_u32 s33, s31, 0
  buffer_load_dwordx4 v7, s[4:7], s33 offen offset:0 lds
  buffer_load_dwordx4 v7, s[4:7], s33 offen offset:1024 lds
  buffer_load_dwordx4 v7, s[4:7], s33 offen offset:2048 lds
  buffer_load_dwordx4 v7, s[4:7], s33 offen offset:3072 lds
  s_add_u32 m0, s32, 4096
  s_add_u32 s33, s31, 4096
  buffer_load_dwordx4 v7, s[4:7], s33 offen offset:0 lds
  s_add_u32 s31, s31, 20480
  s_add_u32 s32, s32, 20480
  s_sub_u32 s33, s32, 61440
  s_cmp_ge_u32 s32, 61440
  s_cselect_b32 s32, s33, s32
  s_add_u32 m0, s32, 0
  s_add_u32 s33, s31, 0
  buffer_load_dwordx4 v7, s[4:7], s33 offen offset:0 lds
  buffer_load_dwordx4 v7, s[4:7], s33 offen offset:1024 lds
  buffer_load_dwordx4 v7, s[4:7], s33 offen offset:2048 lds
  buffer_load_dwordx4 v7, s[4:7], s33 offen offset:3072 lds
  s_add_u32 m0, s32, 4096
  s_add_u32 s33, s31, 4096
  buffer_load_dwordx4 v7, s[4:7], s33 offen offset:0 lds
  s_add_u32 s31, s31, 20480
  s_add_u32 s32, s32, 20480
  s_sub_u32 s33, s32, 61440
  s_cmp_ge_u32 s32, 61440
  s_cselect_b32 s32, s33, s32
  s_mov_b32 s36, 20480
  v_mov_b32 v8, v7
  s_mov_b32 s34, 0
  s_mov_b32 s37, 0
  v_mov_b32 v82, 0xbdd2d3e8
  v_mov_b32 v83, 0xc0135761
  s_waitcnt vmcnt(5)
  s_barrier
  ds_read_b128 v[10:13], v8 offset:0
  ds_read_b128 v[14:17], v8 offset:1024
  ds_read_b128 v[18:21], v8 offset:2048
  ds_read_b128 v[22:25], v8 offset:3072
  s_waitcnt lgkmcnt(3)
  v_mfma_f32_16x16x32_bf16 v[26:29], a[0:3], v[10:13], 0
  v_mfma_f32_16x16x32_bf16 v[30:33], a[80:83], v[10:13], 0
  v_mfma_f32_16x16x32_bf16 v[34:37], a[160:163], v[10:13], 0
  v_mfma_f32_16x16x32_bf16 v[38:41], a[240:243], v[10:13], 0
  ds_read_b128 v[10:13], v8 offset:4096
  s_waitcnt lgkmcnt(3)
  v_mfma_f32_16x16x32_bf16 v[26:29], a[4:7], v[14:17], v[26:29]
  v_mfma_f32_16x16x32_bf16 v[30:33], a[84:87], v[14:17], v[30:33]
  v_mfma_f32_16x16x32_bf16 v[34:37], a[164:167], v[14:17], v[34:37]
  v_mfma_f32_16x16x32_bf16 v[38:41], a[244:247], v[14:17], v[38:41]
  ds_read_b128 v[14:17], v8 offset:5120
  s_waitcnt lgkmcnt(3)
  v_mfma_f32_16x16x32_bf16 v[26:29], a[8:11], v[18:21], v[26:29]
  v_mfma_f32_16x16x32_bf16 v[30:33], a[88:91], v[18:21], v[30:33]
  v_mfma_f32_16x16x32_bf16 v[34:37], a[168:171], v[18:21], v[34:37]
  v_mfma_f32_16x16x32_bf16 v[38:41], a[248:251], v[18:21], v[38:41]
  ds_read_b128 v[18:21], v8 offset:6144
  s_waitcnt lgkmcnt(3)
  v_mfma_f32_16x16x32_bf16 v[26:29], a[12:15], v[22:25], v[26:29]
  v_mfma_f32_16x16x32_bf16 v[30:33], a[92:95], v[22:25], v[30:33]
  v_mfma_f32_16x16x32_bf16 v[34:37], a[172:175], v[22:25], v[34:37]
  v_mfma_f32_16x16x32_bf16 v[38:41], a[252:255], v[22:25], v[38:41]
  ds_read_b128 v[22:25], v8 offset:7168
  s_waitcnt lgkmcnt(3)
  v_mfma_f32_16x16x32_bf16 v[26:29], a[16:19], v[10:13], v[26:29]
  v_mfma_f32_16x16x32_bf16 v[30:33], a[96:99], v[10:13], v[30:33]
  v_mfma_f32_16x16x32_bf16 v[34:37], a[176:179], v[10:13], v[34:37]
  v_mfma_f32_16x16x32_bf16 v[38:41], v[96:99], v[10:13], v[38:41]
  ds_read_b128 v[10:13], v8 offset:8192
  s_waitcnt lgkmcnt(3)
  v_mfma_f32_16x16x32_bf16 v[26:29], a[20:23], v[14:17], v[26:29]
  v_mfma_f32_16x16x32_bf16 v[30:33], a[100:103], v[14:17], v[30:33]
  v_mfma_f32_16x16x32_bf16 v[34:37], a[180:183], v[14:17], v[34:37]
  v_mfma_f32_16x16x32_bf16 v[38:41], v[100:103], v[14:17], v[38:41]
  ds_read_b128 v[14:17], v8 offset:9216
  s_waitcnt lgkmcnt(3)
  v_mfma_f32_16x16x32_bf16 v[26:29], a[24:27], v[18:21], v[26:29]
  v_mfma_f32_16x16x32_bf16 v[30:33], a[104:107], v[18:21], v[30:33]
  v_mfma_f32_16x16x32_bf16 v[34:37], a[184:187], v[18:21], v[34:37]
  v_mfma_f32_16x16x32_bf16 v[38:41], v[104:107], v[18:21], v[38:41]
  ds_read_b128 v[18:21], v8 offset:10240
  s_waitcnt lgkmcnt(3)
  v_mfma_f32_16x16x32_bf16 v[26:29], a[28:31], v[22:25], v[26:29]
  v_mfma_f32_16x16x32_bf16 v[30:33], a[108:111], v[22:25], v[30:33]
  v_mfma_f32_16x16x32_bf16 v[34:37], a[188:191], v[22:25], v[34:37]
  v_mfma_f32_16x16x32_bf16 v[38:41], v[108:111], v[22:25], v[38:41]
  ds_read_b128 v[22:25], v8 offset:11264
  s_waitcnt lgkmcnt(3)
  v_mfma_f32_16x16x32_bf16 v[26:29], a[32:35], v[10:13], v[26:29]
  v_mfma_f32_16x16x32_bf16 v[30:33], a[112:115], v[10:13], v[30:33]
  v_mfma_f32_16x16x32_bf16 v[34:37], a[192:195], v[10:13], v[34:37]
  v_mfma_f32_16x16x32_bf16 v[38:41], v[112:115], v[10:13], v[38:41]
  ds_read_b128 v[10:13], v8 offset:12288
  s_waitcnt lgkmcnt(3)
  v_mfma_f32_16x16x32_bf16 v[26:29], a[36:39], v[14:17], v[26:29]
  v_mfma_f32_16x16x32_bf16 v[30:33], a[116:119], v[14:17], v[30:33]
  v_mfma_f32_16x16x32_bf16 v[34:37], a[196:199], v[14:17], v[34:37]
  v_mfma_f32_16x16x32_bf16 v[38:41], v[116:119], v[14:17], v[38:41]
  ds_read_b128 v[14:17], v8 offset:13312
  s_waitcnt lgkmcnt(3)
  v_mfma_f32_16x16x32_bf16 v[26:29], a[40:43], v[18:21], v[26:29]
  v_mfma_f32_16x16x32_bf16 v[30:33], a[120:123], v[18:21], v[30:33]
  v_mfma_f32_16x16x32_bf16 v[34:37], a[200:203], v[18:21], v[34:37]
  v_mfma_f32_16x16x32_bf16 v[38:41], v[120:123], v[18:21], v[38:41]
  ds_read_b128 v[18:21], v8 offset:14336
  s_waitcnt lgkmcnt(3)
  v_mfma_f32_16x16x32_bf16 v[26:29], a[44:47], v[22:25], v[26:29]
  v_mfma_f32_16x16x32_bf16 v[30:33], a[124:127], v[22:25], v[30:33]
  v_mfma_f32_16x16x32_bf16 v[34:37], a[204:207], v[22:25], v[34:37]
  v_mfma_f32_16x16x32_bf16 v[38:41], v[124:127], v[22:25], v[38:41]
  ds_read_b128 v[22:25], v8 offset:15360
  s_waitcnt lgkmcnt(3)
  v_mfma_f32_16x16x32_bf16 v[26:29], a[48:51], v[10:13], v[26:29]
  v_mfma_f32_16x16x32_bf16 v[30:33], a[128:131], v[10:13], v[30:33]
  v_mfma_f32_16x16x32_bf16 v[34:37], a[208:211], v[10:13], v[34:37]
  v_mfma_f32_16x16x32_bf16 v[38:41], v[128:131], v[10:13], v[38:41]
  ds_read_b128 v[10:13], v8 offset:16384
  s_waitcnt lgkmcnt(3)
  v_mfma_f32_16x16x32_bf16 v[26:29], a[52:55], v[14:17], v[26:29]
  v_mfma_f32_16x16x32_bf16 v[30:33], a[132:135], v[14:17], v[30:33]
  v_mfma_f32_16x16x32_bf16 v[34:37], a[212:215], v[14:17], v[34:37]
  v_mfma_f32_16x16x32_bf16 v[38:41], v[132:135], v[14:17], v[38:41]
  ds_read_b128 v[14:17], v8 offset:17408
  s_waitcnt lgkmcnt(3)
  v_mfma_f32_16x16x32_bf16 v[26:29], a[56:59], v[18:21], v[26:29]
  v_mfma_f32_16x16x32_bf16 v[30:33], a[136:139], v[18:21], v[30:33]
  v_mfma_f32_16x16x32_bf16 v[34:37], a[216:219], v[18:21], v[34:37]
  v_mfma_f32_16x16x32_bf16 v[38:41], v[136:139], v[18:21], v[38:41]
  ds_read_b128 v[18:21], v8 offset:18432
  s_waitcnt lgkmcnt(3)
  v_mfma_f32_16x16x32_bf16 v[26:29], a[60:63], v[22:25], v[26:29]
  v_mfma_f32_16x16x32_bf16 v[30:33], a[140:143], v[22:25], v[30:33]
  v_mfma_f32_16x16x32_bf16 v[34:37], a[220:223], v[22:25], v[34:37]
  v_mfma_f32_16x16x32_bf16 v[38:41], v[140:143], v[22:25], v[38:41]
  ds_read_b128 v[22:25], v8 offset:19456
  s_waitcnt lgkmcnt(3)
  v_mfma_f32_16x16x32_bf16 v[26:29], a[64:67], v[10:13], v[26:29]
  v_mfma_f32_16x16x32_bf16 v[30:33], a[144:147], v[10:13], v[30:33]
  v_mfma_f32_16x16x32_bf16 v[34:37], a[224:227], v[10:13], v[34:37]
  v_mfma_f32_16x16x32_bf16 v[38:41], v[144:147], v[10:13], v[38:41]
  s_waitcnt vmcnt(0)
  s_barrier
  v_add_u32 v9, s36, v7
  s_add_u32 s36, s36, 20480
  s_cmp_ge_u32 s36, 61440
  s_cselect_b32 s36, 0, s36
  s_add_u32 m0, s32, 0
  s_add_u32 s33, s31, 0
  buffer_load_dwordx4 v7, s[4:7], s33 offen offset:0 lds
  buffer_load_dwordx4 v7, s[4:7], s33 offen offset:1024 lds
  buffer_load_dwordx4 v7, s[4:7], s33 offen offset:2048 lds
  buffer_load_dwordx4 v7, s[4:7], s33 offen offset:3072 lds
  s_add_u32 m0, s32, 4096
  s_add_u32 s33, s31, 4096
  buffer_load_dwordx4 v7, s[4:7], s33 offen offset:0 lds
  s_add_u32 s31, s31, 20480
  s_add_u32 s32, s32, 20480
  s_sub_u32 s33, s32, 61440
  s_cmp_ge_u32 s32, 61440
  s_cselect_b32 s32, s33, s32
  s_cmp_lg_u32 s20, 0
  s_cbranch_scc1 MPU2_NP43
  v_mov_b32 v160, s53
  s_mov_b64 exec, 1
  buffer_store_dword v160, v161, s[4:7], s52 offen sc1
  s_mov_b64 exec, -1
MPU2_NP43:
  ds_read_b128 v[10:13], v9 offset:0
  s_waitcnt lgkmcnt(3)
  v_mfma_f32_16x16x32_bf16 v[26:29], a[68:71], v[14:17], v[26:29]
  v_mfma_f32_16x16x32_bf16 v[30:33], a[148:151], v[14:17], v[30:33]
  v_mfma_f32_16x16x32_bf16 v[34:37], a[228:231], v[14:17], v[34:37]
  v_mfma_f32_16x16x32_bf16 v[38:41], v[148:151], v[14:17], v[38:41]
  ds_read_b128 v[14:17], v9 offset:1024
  s_waitcnt lgkmcnt(3)
  v_mfma_f32_16x16x32_bf16 v[26:29], a[72:75], v[18:21], v[26:29]
  v_mfma_f32_16x16x32_bf16 v[30:33], a[152:155], v[18:21], v[30:33]
  v_mfma_f32_16x16x32_bf16 v[34:37], a[232:235], v[18:21], v[34:37]
  v_mfma_f32_16x16x32_bf16 v[38:41], v[152:155], v[18:21], v[38:41]
  ds_read_b128 v[18:21], v9 offset:2048
  s_waitcnt lgkmcnt(3)
  v_mfma_f32_16x16x32_bf16 v[26:29], a[76:79], v[22:25], v[26:29]
  v_mfma_f32_16x16x32_bf16 v[30:33], a[156:159], v[22:25], v[30:33]
  v_mfma_f32_16x16x32_bf16 v[34:37], a[236:239], v[22:25], v[34:37]
  v_mfma_f32_16x16x32_bf16 v[38:41], v[156:159], v[22:25], v[38:41]
  ds_read_b128 v[22:25], v9 offset:3072
  s_waitcnt lgkmcnt(3)
  v_mfma_f32_16x16x32_bf16 v[42:45], a[0:3], v[10:13], 0
  v_mfma_f32_16x16x32_bf16 v[46:49], a[80:83], v[10:13], 0
  v_mfma_f32_16x16x32_bf16 v[50:53], a[160:163], v[10:13], 0
  v_mfma_f32_16x16x32_bf16 v[54:57], a[240:243], v[10:13], 0
  ds_read_b128 v[10:13], v9 offset:4096
  s_waitcnt lgkmcnt(3)
  v_mfma_f32_16x16x32_bf16 v[42:45], a[4:7], v[14:17], v[42:45]
  v_mfma_f32_16x16x32_bf16 v[46:49], a[84:87], v[14:17], v[46:49]
  v_mfma_f32_16x16x32_bf16 v[50:53], a[164:167], v[14:17], v[50:53]
  v_mfma_f32_16x16x32_bf16 v[54:57], a[244:247], v[14:17], v[54:57]
  ds_read_b128 v[14:17], v9 offset:5120
  s_waitcnt lgkmcnt(3)
  v_mfma_f32_16x16x32_bf16 v[42:45], a[8:11], v[18:21], v[42:45]
  v_mfma_f32_16x16x32_bf16 v[46:49], a[88:91], v[18:21], v[46:49]
  v_mfma_f32_16x16x32_bf16 v[50:53], a[168:171], v[18:21], v[50:53]
  v_mfma_f32_16x16x32_bf16 v[54:57], a[248:251], v[18:21], v[54:57]
  v_mul_f32 v66, v26, v26
  v_fma_f32 v66, v66, v82, v83
  v_mul_f32 v66, v66, v26
  v_exp_f32 v66, v66
  s_nop 0
  v_add_f32 v66, 1.0, v66
  v_rcp_f32 v66, v66
  ds_read_b128 v[18:21], v9 offset:6144
  s_waitcnt lgkmcnt(3)
  v_mfma_f32_16x16x32_bf16 v[42:45], a[12:15], v[22:25], v[42:45]
  v_mfma_f32_16x16x32_bf16 v[46:49], a[92:95], v[22:25], v[46:49]
  v_mfma_f32_16x16x32_bf16 v[50:53], a[172:175], v[22:25], v[50:53]
  v_mfma_f32_16x16x32_bf16 v[54:57], a[252:255], v[22:25], v[54:57]
  v_mul_f32 v74, v26, v34
  v_mul_f32 v67, v27, v27
  v_fma_f32 v67, v67, v82, v83
  v_mul_f32 v67, v67, v27
  v_exp_f32 v67, v67
  s_nop 0
  v_add_f32 v67, 1.0, v67
  ds_read_b128 v[22:25], v9 offset:7168
  s_waitcnt lgkmcnt(3)
  v_mfma_f32_16x16x32_bf16 v[42:45], a[16:19], v[10:13], v[42:45]
  v_mfma_f32_16x16x32_bf16 v[46:49], a[96:99], v[10:13], v[46:49]
  v_mfma_f32_16x16x32_bf16 v[50:53], a[176:179], v[10:13], v[50:53]
  v_mfma_f32_16x16x32_bf16 v[54:57], v[96:99], v[10:13], v[54:57]
  v_rcp_f32 v67, v67
  v_mul_f32 v75, v27, v35
  v_mul_f32 v68, v28, v28
  v_fma_f32 v68, v68, v82, v83
  v_mul_f32 v68, v68, v28
  v_exp_f32 v68, v68
  ds_read_b128 v[10:13], v9 offset:8192
  s_waitcnt lgkmcnt(3)
  v_mfma_f32_16x16x32_bf16 v[42:45], a[20:23], v[14:17], v[42:45]
  v_mfma_f32_16x16x32_bf16 v[46:49], a[100:103], v[14:17], v[46:49]
  v_mfma_f32_16x16x32_bf16 v[50:53], a[180:183], v[14:17], v[50:53]
  v_mfma_f32_16x16x32_bf16 v[54:57], v[100:103], v[14:17], v[54:57]
  v_add_f32 v68, 1.0, v68
  v_rcp_f32 v68, v68
  v_mul_f32 v76, v28, v36
  v_mul_f32 v69, v29, v29
  v_fma_f32 v69, v69, v82, v83
  v_mul_f32 v69, v69, v29
  ds_read_b128 v[14:17], v9 offset:9216
  s_waitcnt lgkmcnt(3)
  v_mfma_f32_16x16x32_bf16 v[42:45], a[24:27], v[18:21], v[42:45]
  v_mfma_f32_16x16x32_bf16 v[46:49], a[104:107], v[18:21], v[46:49]
  v_mfma_f32_16x16x32_bf16 v[50:53], a[184:187], v[18:21], v[50:53]
  v_mfma_f32_16x16x32_bf16 v[54:57], v[104:107], v[18:21], v[54:57]
  v_exp_f32 v69, v69
  s_nop 0
  v_add_f32 v69, 1.0, v69
  v_rcp_f32 v69, v69
  v_mul_f32 v77, v29, v37
  v_mul_f32 v70, v30, v30
  v_fma_f32 v70, v70, v82, v83
  ds_read_b128 v[18:21], v9 offset:10240
  s_waitcnt lgkmcnt(3)
  v_mfma_f32_16x16x32_bf16 v[42:45], a[28:31], v[22:25], v[42:45]
  v_mfma_f32_16x16x32_bf16 v[46:49], a[108:111], v[22:25], v[46:49]
  v_mfma_f32_16x16x32_bf16 v[50:53], a[188:191], v[22:25], v[50:53]
  v_mfma_f32_16x16x32_bf16 v[54:57], v[108:111], v[22:25], v[54:57]
  v_mul_f32 v70, v70, v30
  v_exp_f32 v70, v70
  s_nop 0
  v_add_f32 v70, 1.0, v70
  v_rcp_f32 v70, v70
  v_mul_f32 v78, v30, v38
  v_mul_f32 v71, v31, v31
  ds_read_b128 v[22:25], v9 offset:11264
  s_waitcnt lgkmcnt(3)
  v_mfma_f32_16x16x32_bf16 v[42:45], a[32:35], v[10:13], v[42:45]
  v_mfma_f32_16x16x32_bf16 v[46:49], a[112:115], v[10:13], v[46:49]
  v_mfma_f32_16x16x32_bf16 v[50:53], a[192:195], v[10:13], v[50:53]
  v_mfma_f32_16x16x32_bf16 v[54:57], v[112:115], v[10:13], v[54:57]
  v_fma_f32 v71, v71, v82, v83
  v_mul_f32 v71, v71, v31
  v_exp_f32 v71, v71
  s_nop 0
  v_add_f32 v71, 1.0, v71
  v_rcp_f32 v71, v71
  v_mul_f32 v79, v31, v39
  ds_read_b128 v[10:13], v9 offset:12288
  s_waitcnt lgkmcnt(3)
  v_mfma_f32_16x16x32_bf16 v[42:45], a[36:39], v[14:17], v[42:45]
  v_mfma_f32_16x16x32_bf16 v[46:49], a[116:119], v[14:17], v[46:49]
  v_mfma_f32_16x16x32_bf16 v[50:53], a[196:199], v[14:17], v[50:53]
  v_mfma_f32_16x16x32_bf16 v[54:57], v[116:119], v[14:17], v[54:57]
  v_mul_f32 v72, v32, v32
  v_fma_f32 v72, v72, v82, v83
  v_mul_f32 v72, v72, v32
  v_exp_f32 v72, v72
  s_nop 0
  v_add_f32 v72, 1.0, v72
  v_rcp_f32 v72, v72
  ds_read_b128 v[14:17], v9 offset:13312
  s_waitcnt lgkmcnt(3)
  v_mfma_f32_16x16x32_bf16 v[42:45], a[40:43], v[18:21], v[42:45]
  v_mfma_f32_16x16x32_bf16 v[46:49], a[120:123], v[18:21], v[46:49]
  v_mfma_f32_16x16x32_bf16 v[50:53], a[200:203], v[18:21], v[50:53]
  v_mfma_f32_16x16x32_bf16 v[54:57], v[120:123], v[18:21], v[54:57]
  v_mul_f32 v80, v32, v40
  v_mul_f32 v73, v33, v33
  v_fma_f32 v73, v73, v82, v83
  v_mul_f32 v73, v73, v33
  v_exp_f32 v73, v73
  s_nop 0
  v_add_f32 v73, 1.0, v73
  ds_read_b128 v[18:21], v9 offset:14336
  s_waitcnt lgkmcnt(3)
  v_mfma_f32_16x16x32_bf16 v[42:45], a[44:47], v[22:25], v[42:45]
  v_mfma_f32_16x16x32_bf16 v[46:49], a[124:127], v[22:25], v[46:49]
  v_mfma_f32_16x16x32_bf16 v[50:53], a[204:207], v[22:25], v[50:53]
  v_mfma_f32_16x16x32_bf16 v[54:57], v[124:127], v[22:25], v[54:57]
  v_rcp_f32 v73, v73
  v_mul_f32 v81, v33, v41
  v_mul_f32 v66, v66, v74
  v_mul_f32 v67, v67, v75
  v_mul_f32 v68, v68, v76
  v_mul_f32 v69, v69, v77
  ds_read_b128 v[22:25], v9 offset:15360
  s_waitcnt lgkmcnt(3)
  v_mfma_f32_16x16x32_bf16 v[42:45], a[48:51], v[10:13], v[42:45]
  v_mfma_f32_16x16x32_bf16 v[46:49], a[128:131], v[10:13], v[46:49]
  v_mfma_f32_16x16x32_bf16 v[50:53], a[208:211], v[10:13], v[50:53]
  v_mfma_f32_16x16x32_bf16 v[54:57], v[128:131], v[10:13], v[54:57]
  v_mul_f32 v70, v70, v78
  v_mul_f32 v71, v71, v79
  v_mul_f32 v72, v72, v80
  v_mul_f32 v73, v73, v81
  v_cvt_pk_bf16_f32 v58, v66, v67
  v_cvt_pk_bf16_f32 v59, v68, v69
  ds_read_b128 v[10:13], v9 offset:16384
  s_waitcnt lgkmcnt(3)
  v_mfma_f32_16x16x32_bf16 v[42:45], a[52:55], v[14:17], v[42:45]
  v_mfma_f32_16x16x32_bf16 v[46:49], a[132:135], v[14:17], v[46:49]
  v_mfma_f32_16x16x32_bf16 v[50:53], a[212:215], v[14:17], v[50:53]
  v_mfma_f32_16x16x32_bf16 v[54:57], v[132:135], v[14:17], v[54:57]
  v_cvt_pk_bf16_f32 v60, v70, v71
  v_cvt_pk_bf16_f32 v61, v72, v73
  s_add_u32 s35, s34, s28
  buffer_store_dwordx4 v[58:61], v7, s[4:7], s35 offen sc1
  s_add_u32 s34, s34, 49152
  ds_read_b128 v[14:17], v9 offset:17408
  s_waitcnt lgkmcnt(3)
  v_mfma_f32_16x16x32_bf16 v[42:45], a[56:59], v[18:21], v[42:45]
  v_mfma_f32_16x16x32_bf16 v[46:49], a[136:139], v[18:21], v[46:49]
  v_mfma_f32_16x16x32_bf16 v[50:53], a[216:219], v[18:21], v[50:53]
  v_mfma_f32_16x16x32_bf16 v[54:57], v[136:139], v[18:21], v[54:57]
  ds_read_b128 v[18:21], v9 offset:18432
  s_waitcnt lgkmcnt(3)
  v_mfma_f32_16x16x32_bf16 v[42:45], a[60:63], v[22:25], v[42:45]
  v_mfma_f32_16x16x32_bf16 v[46:49], a[140:143], v[22:25], v[46:49]
  v_mfma_f32_16x16x32_bf16 v[50:53], a[220:223], v[22:25], v[50:53]
  v_mfma_f32_16x16x32_bf16 v[54:57], v[140:143], v[22:25], v[54:57]
  ds_read_b128 v[22:25], v9 offset:19456
  s_waitcnt lgkmcnt(3)
  v_mfma_f32_16x16x32_bf16 v[42:45], a[64:67], v[10:13], v[42:45]
  v_mfma_f32_16x16x32_bf16 v[46:49], a[144:147], v[10:13], v[46:49]
  v_mfma_f32_16x16x32_bf16 v[50:53], a[224:227], v[10:13], v[50:53]
  v_mfma_f32_16x16x32_bf16 v[54:57], v[144:147], v[10:13], v[54:57]
  s_cmp_eq_u32 s20, 0
  s_nop 5
  s_cbranch_scc1 MPU2_SW44
  s_waitcnt vmcnt(1)
  s_branch MPU2_SX44
MPU2_SW44:
  s_waitcnt vmcnt(2)
MPU2_SX44:
  s_barrier
  v_add_u32 v8, s36, v7
  s_add_u32 s36, s36, 20480
  s_cmp_ge_u32 s36, 61440
  s_cselect_b32 s36, 0, s36
  s_add_u32 m0, s32, 0
  s_add_u32 s33, s31, 0
  buffer_load_dwordx4 v7, s[4:7], s33 offen offset:0 lds
  buffer_load_dwordx4 v7, s[4:7], s33 offen offset:1024 lds
  buffer_load_dwordx4 v7, s[4:7], s33 offen offset:2048 lds
  buffer_load_dwordx4 v7, s[4:7], s33 offen offset:3072 lds
  s_add_u32 m0, s32, 4096
  s_add_u32 s33, s31, 4096
  buffer_load_dwordx4 v7, s[4:7], s33 offen offset:0 lds
  s_add_u32 s31, s31, 20480
  s_add_u32 s32, s32, 20480
  s_sub_u32 s33, s32, 61440
  s_cmp_ge_u32 s32, 61440
  s_cselect_b32 s32, s33, s32
  s_cmp_lg_u32 s20, 0
  s_cbranch_scc1 MPU2_NP45
  v_mov_b32 v160, s53
  s_mov_b64 exec, 1
  buffer_store_dword v160, v161, s[4:7], s52 offen sc1
  s_mov_b64 exec, -1
MPU2_NP45:
  s_add_u32 s53, s53, 1
  ds_read_b128 v[10:13], v8 offset:0
  s_waitcnt lgkmcnt(3)
  v_mfma_f32_16x16x32_bf16 v[42:45], a[68:71], v[14:17], v[42:45]
  v_mfma_f32_16x16x32_bf16 v[46:49], a[148:151], v[14:17], v[46:49]
  v_mfma_f32_16x16x32_bf16 v[50:53], a[228:231], v[14:17], v[50:53]
  v_mfma_f32_16x16x32_bf16 v[54:57], v[148:151], v[14:17], v[54:57]
  ds_read_b128 v[14:17], v8 offset:1024
  s_waitcnt lgkmcnt(3)
  v_mfma_f32_16x16x32_bf16 v[42:45], a[72:75], v[18:21], v[42:45]
  v_mfma_f32_16x16x32_bf16 v[46:49], a[152:155], v[18:21], v[46:49]
  v_mfma_f32_16x16x32_bf16 v[50:53], a[232:235], v[18:21], v[50:53]
  v_mfma_f32_16x16x32_bf16 v[54:57], v[152:155], v[18:21], v[54:57]
  ds_read_b128 v[18:21], v8 offset:2048
  s_waitcnt lgkmcnt(3)
  v_mfma_f32_16x16x32_bf16 v[42:45], a[76:79], v[22:25], v[42:45]
  v_mfma_f32_16x16x32_bf16 v[46:49], a[156:159], v[22:25], v[46:49]
  v_mfma_f32_16x16x32_bf16 v[50:53], a[236:239], v[22:25], v[50:53]
  v_mfma_f32_16x16x32_bf16 v[54:57], v[156:159], v[22:25], v[54:57]
  ds_read_b128 v[22:25], v8 offset:3072
  s_waitcnt lgkmcnt(3)
  v_mfma_f32_16x16x32_bf16 v[26:29], a[0:3], v[10:13], 0
  v_mfma_f32_16x16x32_bf16 v[30:33], a[80:83], v[10:13], 0
  v_mfma_f32_16x16x32_bf16 v[34:37], a[160:163], v[10:13], 0
  v_mfma_f32_16x16x32_bf16 v[38:41], a[240:243], v[10:13], 0
  ds_read_b128 v[10:13], v8 offset:4096
  s_waitcnt lgkmcnt(3)
  v_mfma_f32_16x16x32_bf16 v[26:29], a[4:7], v[14:17], v[26:29]
  v_mfma_f32_16x16x32_bf16 v[30:33], a[84:87], v[14:17], v[30:33]
  v_mfma_f32_16x16x32_bf16 v[34:37], a[164:167], v[14:17], v[34:37]
  v_mfma_f32_16x16x32_bf16 v[38:41], a[244:247], v[14:17], v[38:41]
  ds_read_b128 v[14:17], v8 offset:5120
  s_waitcnt lgkmcnt(3)
  v_mfma_f32_16x16x32_bf16 v[26:29], a[8:11], v[18:21], v[26:29]
  v_mfma_f32_16x16x32_bf16 v[30:33], a[88:91], v[18:21], v[30:33]
  v_mfma_f32_16x16x32_bf16 v[34:37], a[168:171], v[18:21], v[34:37]
  v_mfma_f32_16x16x32_bf16 v[38:41], a[248:251], v[18:21], v[38:41]
  v_mul_f32 v66, v42, v42
  v_fma_f32 v66, v66, v82, v83
  v_mul_f32 v66, v66, v42
  v_exp_f32 v66, v66
  s_nop 0
  v_add_f32 v66, 1.0, v66
  v_rcp_f32 v66, v66
  ds_read_b128 v[18:21], v8 offset:6144
  s_waitcnt lgkmcnt(3)
  v_mfma_f32_16x16x32_bf16 v[26:29], a[12:15], v[22:25], v[26:29]
  v_mfma_f32_16x16x32_bf16 v[30:33], a[92:95], v[22:25], v[30:33]
  v_mfma_f32_16x16x32_bf16 v[34:37], a[172:175], v[22:25], v[34:37]
  v_mfma_f32_16x16x32_bf16 v[38:41], a[252:255], v[22:25], v[38:41]
  v_mul_f32 v74, v42, v50
  v_mul_f32 v67, v43, v43
  v_fma_f32 v67, v67, v82, v83
  v_mul_f32 v67, v67, v43
  v_exp_f32 v67, v67
  s_nop 0
  v_add_f32 v67, 1.0, v67
  ds_read_b128 v[22:25], v8 offset:7168
  s_waitcnt lgkmcnt(3)
  v_mfma_f32_16x16x32_bf16 v[26:29], a[16:19], v[10:13], v[26:29]
  v_mfma_f32_16x16x32_bf16 v[30:33], a[96:99], v[10:13], v[30:33]
  v_mfma_f32_16x16x32_bf16 v[34:37], a[176:179], v[10:13], v[34:37]
  v_mfma_f32_16x16x32_bf16 v[38:41], v[96:99], v[10:13], v[38:41]
  v_rcp_f32 v67, v67
  v_mul_f32 v75, v43, v51
  v_mul_f32 v68, v44, v44
  v_fma_f32 v68, v68, v82, v83
  v_mul_f32 v68, v68, v44
  v_exp_f32 v68, v68
  ds_read_b128 v[10:13], v8 offset:8192
  s_waitcnt lgkmcnt(3)
  v_mfma_f32_16x16x32_bf16 v[26:29], a[20:23], v[14:17], v[26:29]
  v_mfma_f32_16x16x32_bf16 v[30:33], a[100:103], v[14:17], v[30:33]
  v_mfma_f32_16x16x32_bf16 v[34:37], a[180:183], v[14:17], v[34:37]
  v_mfma_f32_16x16x32_bf16 v[38:41], v[100:103], v[14:17], v[38:41]
  v_add_f32 v68, 1.0, v68
  v_rcp_f32 v68, v68
  v_mul_f32 v76, v44, v52
  v_mul_f32 v69, v45, v45
  v_fma_f32 v69, v69, v82, v83
  v_mul_f32 v69, v69, v45
  ds_read_b128 v[14:17], v8 offset:9216
  s_waitcnt lgkmcnt(3)
  v_mfma_f32_16x16x32_bf16 v[26:29], a[24:27], v[18:21], v[26:29]
  v_mfma_f32_16x16x32_bf16 v[30:33], a[104:107], v[18:21], v[30:33]
  v_mfma_f32_16x16x32_bf16 v[34:37], a[184:187], v[18:21], v[34:37]
  v_mfma_f32_16x16x32_bf16 v[38:41], v[104:107], v[18:21], v[38:41]
  v_exp_f32 v69, v69
  s_nop 0
  v_add_f32 v69, 1.0, v69
  v_rcp_f32 v69, v69
  v_mul_f32 v77, v45, v53
  v_mul_f32 v70, v46, v46
  v_fma_f32 v70, v70, v82, v83
  ds_read_b128 v[18:21], v8 offset:10240
  s_waitcnt lgkmcnt(3)
  v_mfma_f32_16x16x32_bf16 v[26:29], a[28:31], v[22:25], v[26:29]
  v_mfma_f32_16x16x32_bf16 v[30:33], a[108:111], v[22:25], v[30:33]
  v_mfma_f32_16x16x32_bf16 v[34:37], a[188:191], v[22:25], v[34:37]
  v_mfma_f32_16x16x32_bf16 v[38:41], v[108:111], v[22:25], v[38:41]
  v_mul_f32 v70, v70, v46
  v_exp_f32 v70, v70
  s_nop 0
  v_add_f32 v70, 1.0, v70
  v_rcp_f32 v70, v70
  v_mul_f32 v78, v46, v54
  v_mul_f32 v71, v47, v47
  ds_read_b128 v[22:25], v8 offset:11264
  s_waitcnt lgkmcnt(3)
  v_mfma_f32_16x16x32_bf16 v[26:29], a[32:35], v[10:13], v[26:29]
  v_mfma_f32_16x16x32_bf16 v[30:33], a[112:115], v[10:13], v[30:33]
  v_mfma_f32_16x16x32_bf16 v[34:37], a[192:195], v[10:13], v[34:37]
  v_mfma_f32_16x16x32_bf16 v[38:41], v[112:115], v[10:13], v[38:41]
  v_fma_f32 v71, v71, v82, v83
  v_mul_f32 v71, v71, v47
  v_exp_f32 v71, v71
  s_nop 0
  v_add_f32 v71, 1.0, v71
  v_rcp_f32 v71, v71
  v_mul_f32 v79, v47, v55
  ds_read_b128 v[10:13], v8 offset:12288
  s_waitcnt lgkmcnt(3)
  v_mfma_f32_16x16x32_bf16 v[26:29], a[36:39], v[14:17], v[26:29]
  v_mfma_f32_16x16x32_bf16 v[30:33], a[116:119], v[14:17], v[30:33]
  v_mfma_f32_16x16x32_bf16 v[34:37], a[196:199], v[14:17], v[34:37]
  v_mfma_f32_16x16x32_bf16 v[38:41], v[116:119], v[14:17], v[38:41]
  v_mul_f32 v72, v48, v48
  v_fma_f32 v72, v72, v82, v83
  v_mul_f32 v72, v72, v48
  v_exp_f32 v72, v72
  s_nop 0
  v_add_f32 v72, 1.0, v72
  v_rcp_f32 v72, v72
  ds_read_b128 v[14:17], v8 offset:13312
  s_waitcnt lgkmcnt(3)
  v_mfma_f32_16x16x32_bf16 v[26:29], a[40:43], v[18:21], v[26:29]
  v_mfma_f32_16x16x32_bf16 v[30:33], a[120:123], v[18:21], v[30:33]
  v_mfma_f32_16x16x32_bf16 v[34:37], a[200:203], v[18:21], v[34:37]
  v_mfma_f32_16x16x32_bf16 v[38:41], v[120:123], v[18:21], v[38:41]
  v_mul_f32 v80, v48, v56
  v_mul_f32 v73, v49, v49
  v_fma_f32 v73, v73, v82, v83
  v_mul_f32 v73, v73, v49
  v_exp_f32 v73, v73
  s_nop 0
  v_add_f32 v73, 1.0, v73
  ds_read_b128 v[18:21], v8 offset:14336
  s_waitcnt lgkmcnt(3)
  v_mfma_f32_16x16x32_bf16 v[26:29], a[44:47], v[22:25], v[26:29]
  v_mfma_f32_16x16x32_bf16 v[30:33], a[124:127], v[22:25], v[30:33]
  v_mfma_f32_16x16x32_bf16 v[34:37], a[204:207], v[22:25], v[34:37]
  v_mfma_f32_16x16x32_bf16 v[38:41], v[124:127], v[22:25], v[38:41]
  v_rcp_f32 v73, v73
  v_mul_f32 v81, v49, v57
  v_mul_f32 v66, v66, v74
  v_mul_f32 v67, v67, v75
  v_mul_f32 v68, v68, v76
  v_mul_f32 v69, v69, v77
  ds_read_b128 v[22:25], v8 offset:15360
  s_waitcnt lgkmcnt(3)
  v_mfma_f32_16x16x32_bf16 v[26:29], a[48:51], v[10:13], v[26:29]
  v_mfma_f32_16x16x32_bf16 v[30:33], a[128:131], v[10:13], v[30:33]
  v_mfma_f32_16x16x32_bf16 v[34:37], a[208:211], v[10:13], v[34:37]
  v_mfma_f32_16x16x32_bf16 v[38:41], v[128:131], v[10:13], v[38:41]
  v_mul_f32 v70, v70, v78
  v_mul_f32 v71, v71, v79
  v_mul_f32 v72, v72, v80
  v_mul_f32 v73, v73, v81
  v_cvt_pk_bf16_f32 v58, v66, v67
  v_cvt_pk_bf16_f32 v59, v68, v69
  ds_read_b128 v[10:13], v8 offset:16384
  s_waitcnt lgkmcnt(3)
  v_mfma_f32_16x16x32_bf16 v[26:29], a[52:55], v[14:17], v[26:29]
  v_mfma_f32_16x16x32_bf16 v[30:33], a[132:135], v[14:17], v[30:33]
  v_mfma_f32_16x16x32_bf16 v[34:37], a[212:215], v[14:17], v[34:37]
  v_mfma_f32_16x16x32_bf16 v[38:41], v[132:135], v[14:17], v[38:41]
  v_cvt_pk_bf16_f32 v60, v70, v71
  v_cvt_pk_bf16_f32 v61, v72, v73
  s_add_u32 s35, s34, s28
  buffer_store_dwordx4 v[58:61], v7, s[4:7], s35 offen sc1
  s_add_u32 s34, s34, 49152
  ds_read_b128 v[14:17], v8 offset:17408
  s_waitcnt lgkmcnt(3)
  v_mfma_f32_16x16x32_bf16 v[26:29], a[56:59], v[18:21], v[26:29]
  v_mfma_f32_16x16x32_bf16 v[30:33], a[136:139], v[18:21], v[30:33]
  v_mfma_f32_16x16x32_bf16 v[34:37], a[216:219], v[18:21], v[34:37]
  v_mfma_f32_16x16x32_bf16 v[38:41], v[136:139], v[18:21], v[38:41]
  ds_read_b128 v[18:21], v8 offset:18432
  s_waitcnt lgkmcnt(3)
  v_mfma_f32_16x16x32_bf16 v[26:29], a[60:63], v[22:25], v[26:29]
  v_mfma_f32_16x16x32_bf16 v[30:33], a[140:143], v[22:25], v[30:33]
  v_mfma_f32_16x16x32_bf16 v[34:37], a[220:223], v[22:25], v[34:37]
  v_mfma_f32_16x16x32_bf16 v[38:41], v[140:143], v[22:25], v[38:41]
  ds_read_b128 v[22:25], v8 offset:19456
  s_waitcnt lgkmcnt(3)
  v_mfma_f32_16x16x32_bf16 v[26:29], a[64:67], v[10:13], v[26:29]
  v_mfma_f32_16x16x32_bf16 v[30:33], a[144:147], v[10:13], v[30:33]
  v_mfma_f32_16x16x32_bf16 v[34:37], a[224:227], v[10:13], v[34:37]
  v_mfma_f32_16x16x32_bf16 v[38:41], v[144:147], v[10:13], v[38:41]
  s_cmp_eq_u32 s20, 0
  s_nop 5
  s_cbranch_scc1 MPU2_SW46
  s_waitcnt vmcnt(1)
  s_branch MPU2_SX46
MPU2_SW46:
  s_waitcnt vmcnt(2)
MPU2_SX46:
  s_barrier
  v_add_u32 v9, s36, v7
  s_add_u32 s36, s36, 20480
  s_cmp_ge_u32 s36, 61440
  s_cselect_b32 s36, 0, s36
  s_add_u32 m0, s32, 0
  s_add_u32 s33, s31, 0
  buffer_load_dwordx4 v7, s[4:7], s33 offen offset:0 lds
  buffer_load_dwordx4 v7, s[4:7], s33 offen offset:1024 lds
  buffer_load_dwordx4 v7, s[4:7], s33 offen offset:2048 lds
  buffer_load_dwordx4 v7, s[4:7], s33 offen offset:3072 lds
  s_add_u32 m0, s32, 4096
  s_add_u32 s33, s31, 4096
  buffer_load_dwordx4 v7, s[4:7], s33 offen offset:0 lds
  s_add_u32 s31, s31, 20480
  s_add_u32 s32, s32, 20480
  s_sub_u32 s33, s32, 61440
  s_cmp_ge_u32 s32, 61440
  s_cselect_b32 s32, s33, s32
  s_cmp_lg_u32 s20, 0
  s_cbranch_scc1 MPU2_NP47
  v_mov_b32 v160, s53
  s_mov_b64 exec, 1
  buffer_store_dword v160, v161, s[4:7], s52 offen sc1
  s_mov_b64 exec, -1
MPU2_NP47:
  s_add_u32 s53, s53, 1
  ds_read_b128 v[10:13], v9 offset:0
  s_waitcnt lgkmcnt(3)
  v_mfma_f32_16x16x32_bf16 v[26:29], a[68:71], v[14:17], v[26:29]
  v_mfma_f32_16x16x32_bf16 v[30:33], a[148:151], v[14:17], v[30:33]
  v_mfma_f32_16x16x32_bf16 v[34:37], a[228:231], v[14:17], v[34:37]
  v_mfma_f32_16x16x32_bf16 v[38:41], v[148:151], v[14:17], v[38:41]
  ds_read_b128 v[14:17], v9 offset:1024
  s_waitcnt lgkmcnt(3)
  v_mfma_f32_16x16x32_bf16 v[26:29], a[72:75], v[18:21], v[26:29]
  v_mfma_f32_16x16x32_bf16 v[30:33], a[152:155], v[18:21], v[30:33]
  v_mfma_f32_16x16x32_bf16 v[34:37], a[232:235], v[18:21], v[34:37]
  v_mfma_f32_16x16x32_bf16 v[38:41], v[152:155], v[18:21], v[38:41]
  ds_read_b128 v[18:21], v9 offset:2048
  s_waitcnt lgkmcnt(3)
  v_mfma_f32_16x16x32_bf16 v[26:29], a[76:79], v[22:25], v[26:29]
  v_mfma_f32_16x16x32_bf16 v[30:33], a[156:159], v[22:25], v[30:33]
  v_mfma_f32_16x16x32_bf16 v[34:37], a[236:239], v[22:25], v[34:37]
  v_mfma_f32_16x16x32_bf16 v[38:41], v[156:159], v[22:25], v[38:41]
  s_mov_b32 s30, 62
  s_nop 6
MPU2_LOOP:
  ds_read_b128 v[22:25], v9 offset:3072
  s_waitcnt lgkmcnt(3)
  v_mfma_f32_16x16x32_bf16 v[42:45], a[0:3], v[10:13], 0
  v_mfma_f32_16x16x32_bf16 v[46:49], a[80:83], v[10:13], 0
  v_mfma_f32_16x16x32_bf16 v[50:53], a[160:163], v[10:13], 0
  v_mfma_f32_16x16x32_bf16 v[54:57], a[240:243], v[10:13], 0
  ds_read_b128 v[10:13], v9 offset:4096
  s_waitcnt lgkmcnt(3)
  v_mfma_f32_16x16x32_bf16 v[42:45], a[4:7], v[14:17], v[42:45]
  v_mfma_f32_16x16x32_bf16 v[46:49], a[84:87], v[14:17], v[46:49]
  v_mfma_f32_16x16x32_bf16 v[50:53], a[164:167], v[14:17], v[50:53]
  v_mfma_f32_16x16x32_bf16 v[54:57], a[244:247], v[14:17], v[54:57]
  ds_read_b128 v[14:17], v9 offset:5120
  s_waitcnt lgkmcnt(3)
  v_mfma_f32_16x16x32_bf16 v[42:45], a[8:11], v[18:21], v[42:45]
  v_mfma_f32_16x16x32_bf16 v[46:49], a[88:91], v[18:21], v[46:49]
  v_mfma_f32_16x16x32_bf16 v[50:53], a[168:171], v[18:21], v[50:53]
  v_mfma_f32_16x16x32_bf16 v[54:57], a[248:251], v[18:21], v[54:57]
  v_mul_f32 v66, v26, v26
  v_fma_f32 v66, v66, v82, v83
  v_mul_f32 v66, v66, v26
  v_exp_f32 v66, v66
  s_nop 0
  v_add_f32 v66, 1.0, v66
  v_rcp_f32 v66, v66
  ds_read_b128 v[18:21], v9 offset:6144
  s_waitcnt lgkmcnt(3)
  v_mfma_f32_16x16x32_bf16 v[42:45], a[12:15], v[22:25], v[42:45]
  v_mfma_f32_16x16x32_bf16 v[46:49], a[92:95], v[22:25], v[46:49]
  v_mfma_f32_16x16x32_bf16 v[50:53], a[172:175], v[22:25], v[50:53]
  v_mfma_f32_16x16x32_bf16 v[54:57], a[252:255], v[22:25], v[54:57]
  v_mul_f32 v74, v26, v34
  v_mul_f32 v67, v27, v27
  v_fma_f32 v67, v67, v82, v83
  v_mul_f32 v67, v67, v27
  v_exp_f32 v67, v67
  s_nop 0
  v_add_f32 v67, 1.0, v67
  ds_read_b128 v[22:25], v9 offset:7168
  s_waitcnt lgkmcnt(3)
  v_mfma_f32_16x16x32_bf16 v[42:45], a[16:19], v[10:13], v[42:45]
  v_mfma_f32_16x16x32_bf16 v[46:49], a[96:99], v[10:13], v[46:49]
  v_mfma_f32_16x16x32_bf16 v[50:53], a[176:179], v[10:13], v[50:53]
  v_mfma_f32_16x16x32_bf16 v[54:57], v[96:99], v[10:13], v[54:57]
  v_rcp_f32 v67, v67
  v_mul_f32 v75, v27, v35
  v_mul_f32 v68, v28, v28
  v_fma_f32 v68, v68, v82, v83
  v_mul_f32 v68, v68, v28
  v_exp_f32 v68, v68
  ds_read_b128 v[10:13], v9 offset:8192
  s_waitcnt lgkmcnt(3)
  v_mfma_f32_16x16x32_bf16 v[42:45], a[20:23], v[14:17], v[42:45]
  v_mfma_f32_16x16x32_bf16 v[46:49], a[100:103], v[14:17], v[46:49]
  v_mfma_f32_16x16x32_bf16 v[50:53], a[180:183], v[14:17], v[50:53]
  v_mfma_f32_16x16x32_bf16 v[54:57], v[100:103], v[14:17], v[54:57]
  v_add_f32 v68, 1.0, v68
  v_rcp_f32 v68, v68
  v_mul_f32 v76, v28, v36
  v_mul_f32 v69, v29, v29
  v_fma_f32 v69, v69, v82, v83
  v_mul_f32 v69, v69, v29
  ds_read_b128 v[14:17], v9 offset:9216
  s_waitcnt lgkmcnt(3)
  v_mfma_f32_16x16x32_bf16 v[42:45], a[24:27], v[18:21], v[42:45]
  v_mfma_f32_16x16x32_bf16 v[46:49], a[104:107], v[18:21], v[46:49]
  v_mfma_f32_16x16x32_bf16 v[50:53], a[184:187], v[18:21], v[50:53]
  v_mfma_f32_16x16x32_bf16 v[54:57], v[104:107], v[18:21], v[54:57]
  v_exp_f32 v69, v69
  s_nop 0
  v_add_f32 v69, 1.0, v69
  v_rcp_f32 v69, v69
  v_mul_f32 v77, v29, v37
  v_mul_f32 v70, v30, v30
  v_fma_f32 v70, v70, v82, v83
  ds_read_b128 v[18:21], v9 offset:10240
  s_waitcnt lgkmcnt(3)
  v_mfma_f32_16x16x32_bf16 v[42:45], a[28:31], v[22:25], v[42:45]
  v_mfma_f32_16x16x32_bf16 v[46:49], a[108:111], v[22:25], v[46:49]
  v_mfma_f32_16x16x32_bf16 v[50:53], a[188:191], v[22:25], v[50:53]
  v_mfma_f32_16x16x32_bf16 v[54:57], v[108:111], v[22:25], v[54:57]
  v_mul_f32 v70, v70, v30
  v_exp_f32 v70, v70
  s_nop 0
  v_add_f32 v70, 1.0, v70
  v_rcp_f32 v70, v70
  v_mul_f32 v78, v30, v38
  v_mul_f32 v71, v31, v31
  ds_read_b128 v[22:25], v9 offset:11264
  s_waitcnt lgkmcnt(3)
  v_mfma_f32_16x16x32_bf16 v[42:45], a[32:35], v[10:13], v[42:45]
  v_mfma_f32_16x16x32_bf16 v[46:49], a[112:115], v[10:13], v[46:49]
  v_mfma_f32_16x16x32_bf16 v[50:53], a[192:195], v[10:13], v[50:53]
  v_mfma_f32_16x16x32_bf16 v[54:57], v[112:115], v[10:13], v[54:57]
  v_fma_f32 v71, v71, v82, v83
  v_mul_f32 v71, v71, v31
  v_exp_f32 v71, v71
  s_nop 0
  v_add_f32 v71, 1.0, v71
  v_rcp_f32 v71, v71
  v_mul_f32 v79, v31, v39
  ds_read_b128 v[10:13], v9 offset:12288
  s_waitcnt lgkmcnt(3)
  v_mfma_f32_16x16x32_bf16 v[42:45], a[36:39], v[14:17], v[42:45]
  v_mfma_f32_16x16x32_bf16 v[46:49], a[116:119], v[14:17], v[46:49]
  v_mfma_f32_16x16x32_bf16 v[50:53], a[196:199], v[14:17], v[50:53]
  v_mfma_f32_16x16x32_bf16 v[54:57], v[116:119], v[14:17], v[54:57]
  v_mul_f32 v72, v32, v32
  v_fma_f32 v72, v72, v82, v83
  v_mul_f32 v72, v72, v32
  v_exp_f32 v72, v72
  s_nop 0
  v_add_f32 v72, 1.0, v72
  v_rcp_f32 v72, v72
  ds_read_b128 v[14:17], v9 offset:13312
  s_waitcnt lgkmcnt(3)
  v_mfma_f32_16x16x32_bf16 v[42:45], a[40:43], v[18:21], v[42:45]
  v_mfma_f32_16x16x32_bf16 v[46:49], a[120:123], v[18:21], v[46:49]
  v_mfma_f32_16x16x32_bf16 v[50:53], a[200:203], v[18:21], v[50:53]
  v_mfma_f32_16x16x32_bf16 v[54:57], v[120:123], v[18:21], v[54:57]
  v_mul_f32 v80, v32, v40
  v_mul_f32 v73, v33, v33
  v_fma_f32 v73, v73, v82, v83
  v_mul_f32 v73, v73, v33
  v_exp_f32 v73, v73
  s_nop 0
  v_add_f32 v73, 1.0, v73
  ds_read_b128 v[18:21], v9 offset:14336
  s_waitcnt lgkmcnt(3)
  v_mfma_f32_16x16x32_bf16 v[42:45], a[44:47], v[22:25], v[42:45]
  v_mfma_f32_16x16x32_bf16 v[46:49], a[124:127], v[22:25], v[46:49]
  v_mfma_f32_16x16x32_bf16 v[50:53], a[204:207], v[22:25], v[50:53]
  v_mfma_f32_16x16x32_bf16 v[54:57], v[124:127], v[22:25], v[54:57]
  v_rcp_f32 v73, v73
  v_mul_f32 v81, v33, v41
  v_mul_f32 v66, v66, v74
  v_mul_f32 v67, v67, v75
  v_mul_f32 v68, v68, v76
  v_mul_f32 v69, v69, v77
  ds_read_b128 v[22:25], v9 offset:15360
  s_waitcnt lgkmcnt(3)
  v_mfma_f32_16x16x32_bf16 v[42:45], a[48:51], v[10:13], v[42:45]
  v_mfma_f32_16x16x32_bf16 v[46:49], a[128:131], v[10:13], v[46:49]
  v_mfma_f32_16x16x32_bf16 v[50:53], a[208:211], v[10:13], v[50:53]
  v_mfma_f32_16x16x32_bf16 v[54:57], v[128:131], v[10:13], v[54:57]
  v_mul_f32 v70, v70, v78
  v_mul_f32 v71, v71, v79
  v_mul_f32 v72, v72, v80
  v_mul_f32 v73, v73, v81
  v_cvt_pk_bf16_f32 v58, v66, v67
  v_cvt_pk_bf16_f32 v59, v68, v69
  ds_read_b128 v[10:13], v9 offset:16384
  s_waitcnt lgkmcnt(3)
  v_mfma_f32_16x16x32_bf16 v[42:45], a[52:55], v[14:17], v[42:45]
  v_mfma_f32_16x16x32_bf16 v[46:49], a[132:135], v[14:17], v[46:49]
  v_mfma_f32_16x16x32_bf16 v[50:53], a[212:215], v[14:17], v[50:53]
  v_mfma_f32_16x16x32_bf16 v[54:57], v[132:135], v[14:17], v[54:57]
  v_cvt_pk_bf16_f32 v60, v70, v71
  v_cvt_pk_bf16_f32 v61, v72, v73
  s_add_u32 s35, s34, s28
  buffer_store_dwordx4 v[58:61], v7, s[4:7], s35 offen sc1
  s_add_u32 s34, s34, 49152
  ds_read_b128 v[14:17], v9 offset:17408
  s_waitcnt lgkmcnt(3)
  v_mfma_f32_16x16x32_bf16 v[42:45], a[56:59], v[18:21], v[42:45]
  v_mfma_f32_16x16x32_bf16 v[46:49], a[136:139], v[18:21], v[46:49]
  v_mfma_f32_16x16x32_bf16 v[50:53], a[216:219], v[18:21], v[50:53]
  v_mfma_f32_16x16x32_bf16 v[54:57], v[136:139], v[18:21], v[54:57]
  ds_read_b128 v[18:21], v9 offset:18432
  s_waitcnt lgkmcnt(3)
  v_mfma_f32_16x16x32_bf16 v[42:45], a[60:63], v[22:25], v[42:45]
  v_mfma_f32_16x16x32_bf16 v[46:49], a[140:143], v[22:25], v[46:49]
  v_mfma_f32_16x16x32_bf16 v[50:53], a[220:223], v[22:25], v[50:53]
  v_mfma_f32_16x16x32_bf16 v[54:57], v[140:143], v[22:25], v[54:57]
  ds_read_b128 v[22:25], v9 offset:19456
  s_waitcnt lgkmcnt(3)
  v_mfma_f32_16x16x32_bf16 v[42:45], a[64:67], v[10:13], v[42:45]
  v_mfma_f32_16x16x32_bf16 v[46:49], a[144:147], v[10:13], v[46:49]
  v_mfma_f32_16x16x32_bf16 v[50:53], a[224:227], v[10:13], v[50:53]
  v_mfma_f32_16x16x32_bf16 v[54:57], v[144:147], v[10:13], v[54:57]
  s_cmp_eq_u32 s20, 0
  s_nop 5
  s_cbranch_scc1 MPU2_SW48
  s_waitcnt vmcnt(1)
  s_branch MPU2_SX48
MPU2_SW48:
  s_waitcnt vmcnt(2)
MPU2_SX48:
  s_barrier
  v_add_u32 v8, s36, v7
  s_add_u32 s36, s36, 20480
  s_cmp_ge_u32 s36, 61440
  s_cselect_b32 s36, 0, s36
  s_add_u32 m0, s32, 0
  s_add_u32 s33, s31, 0
  buffer_load_dwordx4 v7, s[4:7], s33 offen offset:0 lds
  buffer_load_dwordx4 v7, s[4:7], s33 offen offset:1024 lds
  buffer_load_dwordx4 v7, s[4:7], s33 offen offset:2048 lds
  buffer_load_dwordx4 v7, s[4:7], s33 offen offset:3072 lds
  s_add_u32 m0, s32, 4096
  s_add_u32 s33, s31, 4096
  buffer_load_dwordx4 v7, s[4:7], s33 offen offset:0 lds
  s_add_u32 s31, s31, 20480
  s_add_u32 s32, s32, 20480
  s_sub_u32 s33, s32, 61440
  s_cmp_ge_u32 s32, 61440
  s_cselect_b32 s32, s33, s32
  s_cmp_lg_u32 s20, 0
  s_cbranch_scc1 MPU2_NP49
  v_mov_b32 v160, s53
  s_mov_b64 exec, 1
  buffer_store_dword v160, v161, s[4:7], s52 offen sc1
  s_mov_b64 exec, -1
MPU2_NP49:
  s_add_u32 s53, s53, 1
  ds_read_b128 v[10:13], v8 offset:0
  s_waitcnt lgkmcnt(3)
  v_mfma_f32_16x16x32_bf16 v[42:45], a[68:71], v[14:17], v[42:45]
  v_mfma_f32_16x16x32_bf16 v[46:49], a[148:151], v[14:17], v[46:49]
  v_mfma_f32_16x16x32_bf16 v[50:53], a[228:231], v[14:17], v[50:53]
  v_mfma_f32_16x16x32_bf16 v[54:57], v[148:151], v[14:17], v[54:57]
  ds_read_b128 v[14:17], v8 offset:1024
  s_waitcnt lgkmcnt(3)
  v_mfma_f32_16x16x32_bf16 v[42:45], a[72:75], v[18:21], v[42:45]
  v_mfma_f32_16x16x32_bf16 v[46:49], a[152:155], v[18:21], v[46:49]
  v_mfma_f32_16x16x32_bf16 v[50:53], a[232:235], v[18:21], v[50:53]
  v_mfma_f32_16x16x32_bf16 v[54:57], v[152:155], v[18:21], v[54:57]
  ds_read_b128 v[18:21], v8 offset:2048
  s_waitcnt lgkmcnt(3)
  v_mfma_f32_16x16x32_bf16 v[42:45], a[76:79], v[22:25], v[42:45]
  v_mfma_f32_16x16x32_bf16 v[46:49], a[156:159], v[22:25], v[46:49]
  v_mfma_f32_16x16x32_bf16 v[50:53], a[236:239], v[22:25], v[50:53]
  v_mfma_f32_16x16x32_bf16 v[54:57], v[156:159], v[22:25], v[54:57]
  ds_read_b128 v[22:25], v8 offset:3072
  s_waitcnt lgkmcnt(3)
  v_mfma_f32_16x16x32_bf16 v[26:29], a[0:3], v[10:13], 0
  v_mfma_f32_16x16x32_bf16 v[30:33], a[80:83], v[10:13], 0
  v_mfma_f32_16x16x32_bf16 v[34:37], a[160:163], v[10:13], 0
  v_mfma_f32_16x16x32_bf16 v[38:41], a[240:243], v[10:13], 0
  ds_read_b128 v[10:13], v8 offset:4096
  s_waitcnt lgkmcnt(3)
  v_mfma_f32_16x16x32_bf16 v[26:29], a[4:7], v[14:17], v[26:29]
  v_mfma_f32_16x16x32_bf16 v[30:33], a[84:87], v[14:17], v[30:33]
  v_mfma_f32_16x16x32_bf16 v[34:37], a[164:167], v[14:17], v[34:37]
  v_mfma_f32_16x16x32_bf16 v[38:41], a[244:247], v[14:17], v[38:41]
  ds_read_b128 v[14:17], v8 offset:5120
  s_waitcnt lgkmcnt(3)
  v_mfma_f32_16x16x32_bf16 v[26:29], a[8:11], v[18:21], v[26:29]
  v_mfma_f32_16x16x32_bf16 v[30:33], a[88:91], v[18:21], v[30:33]
  v_mfma_f32_16x16x32_bf16 v[34:37], a[168:171], v[18:21], v[34:37]
  v_mfma_f32_16x16x32_bf16 v[38:41], a[248:251], v[18:21], v[38:41]
  v_mul_f32 v66, v42, v42
  v_fma_f32 v66, v66, v82, v83
  v_mul_f32 v66, v66, v42
  v_exp_f32 v66, v66
  s_nop 0
  v_add_f32 v66, 1.0, v66
  v_rcp_f32 v66, v66
  ds_read_b128 v[18:21], v8 offset:6144
  s_waitcnt lgkmcnt(3)
  v_mfma_f32_16x16x32_bf16 v[26:29], a[12:15], v[22:25], v[26:29]
  v_mfma_f32_16x16x32_bf16 v[30:33], a[92:95], v[22:25], v[30:33]
  v_mfma_f32_16x16x32_bf16 v[34:37], a[172:175], v[22:25], v[34:37]
  v_mfma_f32_16x16x32_bf16 v[38:41], a[252:255], v[22:25], v[38:41]
  v_mul_f32 v74, v42, v50
  v_mul_f32 v67, v43, v43
  v_fma_f32 v67, v67, v82, v83
  v_mul_f32 v67, v67, v43
  v_exp_f32 v67, v67
  s_nop 0
  v_add_f32 v67, 1.0, v67
  ds_read_b128 v[22:25], v8 offset:7168
  s_waitcnt lgkmcnt(3)
  v_mfma_f32_16x16x32_bf16 v[26:29], a[16:19], v[10:13], v[26:29]
  v_mfma_f32_16x16x32_bf16 v[30:33], a[96:99], v[10:13], v[30:33]
  v_mfma_f32_16x16x32_bf16 v[34:37], a[176:179], v[10:13], v[34:37]
  v_mfma_f32_16x16x32_bf16 v[38:41], v[96:99], v[10:13], v[38:41]
  v_rcp_f32 v67, v67
  v_mul_f32 v75, v43, v51
  v_mul_f32 v68, v44, v44
  v_fma_f32 v68, v68, v82, v83
  v_mul_f32 v68, v68, v44
  v_exp_f32 v68, v68
  ds_read_b128 v[10:13], v8 offset:8192
  s_waitcnt lgkmcnt(3)
  v_mfma_f32_16x16x32_bf16 v[26:29], a[20:23], v[14:17], v[26:29]
  v_mfma_f32_16x16x32_bf16 v[30:33], a[100:103], v[14:17], v[30:33]
  v_mfma_f32_16x16x32_bf16 v[34:37], a[180:183], v[14:17], v[34:37]
  v_mfma_f32_16x16x32_bf16 v[38:41], v[100:103], v[14:17], v[38:41]
  v_add_f32 v68, 1.0, v68
  v_rcp_f32 v68, v68
  v_mul_f32 v76, v44, v52
  v_mul_f32 v69, v45, v45
  v_fma_f32 v69, v69, v82, v83
  v_mul_f32 v69, v69, v45
  ds_read_b128 v[14:17], v8 offset:9216
  s_waitcnt lgkmcnt(3)
  v_mfma_f32_16x16x32_bf16 v[26:29], a[24:27], v[18:21], v[26:29]
  v_mfma_f32_16x16x32_bf16 v[30:33], a[104:107], v[18:21], v[30:33]
  v_mfma_f32_16x16x32_bf16 v[34:37], a[184:187], v[18:21], v[34:37]
  v_mfma_f32_16x16x32_bf16 v[38:41], v[104:107], v[18:21], v[38:41]
  v_exp_f32 v69, v69
  s_nop 0
  v_add_f32 v69, 1.0, v69
  v_rcp_f32 v69, v69
  v_mul_f32 v77, v45, v53
  v_mul_f32 v70, v46, v46
  v_fma_f32 v70, v70, v82, v83
  ds_read_b128 v[18:21], v8 offset:10240
  s_waitcnt lgkmcnt(3)
  v_mfma_f32_16x16x32_bf16 v[26:29], a[28:31], v[22:25], v[26:29]
  v_mfma_f32_16x16x32_bf16 v[30:33], a[108:111], v[22:25], v[30:33]
  v_mfma_f32_16x16x32_bf16 v[34:37], a[188:191], v[22:25], v[34:37]
  v_mfma_f32_16x16x32_bf16 v[38:41], v[108:111], v[22:25], v[38:41]
  v_mul_f32 v70, v70, v46
  v_exp_f32 v70, v70
  s_nop 0
  v_add_f32 v70, 1.0, v70
  v_rcp_f32 v70, v70
  v_mul_f32 v78, v46, v54
  v_mul_f32 v71, v47, v47
  ds_read_b128 v[22:25], v8 offset:11264
  s_waitcnt lgkmcnt(3)
  v_mfma_f32_16x16x32_bf16 v[26:29], a[32:35], v[10:13], v[26:29]
  v_mfma_f32_16x16x32_bf16 v[30:33], a[112:115], v[10:13], v[30:33]
  v_mfma_f32_16x16x32_bf16 v[34:37], a[192:195], v[10:13], v[34:37]
  v_mfma_f32_16x16x32_bf16 v[38:41], v[112:115], v[10:13], v[38:41]
  v_fma_f32 v71, v71, v82, v83
  v_mul_f32 v71, v71, v47
  v_exp_f32 v71, v71
  s_nop 0
  v_add_f32 v71, 1.0, v71
  v_rcp_f32 v71, v71
  v_mul_f32 v79, v47, v55
  ds_read_b128 v[10:13], v8 offset:12288
  s_waitcnt lgkmcnt(3)
  v_mfma_f32_16x16x32_bf16 v[26:29], a[36:39], v[14:17], v[26:29]
  v_mfma_f32_16x16x32_bf16 v[30:33], a[116:119], v[14:17], v[30:33]
  v_mfma_f32_16x16x32_bf16 v[34:37], a[196:199], v[14:17], v[34:37]
  v_mfma_f32_16x16x32_bf16 v[38:41], v[116:119], v[14:17], v[38:41]
  v_mul_f32 v72, v48, v48
  v_fma_f32 v72, v72, v82, v83
  v_mul_f32 v72, v72, v48
  v_exp_f32 v72, v72
  s_nop 0
  v_add_f32 v72, 1.0, v72
  v_rcp_f32 v72, v72
  ds_read_b128 v[14:17], v8 offset:13312
  s_waitcnt lgkmcnt(3)
  v_mfma_f32_16x16x32_bf16 v[26:29], a[40:43], v[18:21], v[26:29]
  v_mfma_f32_16x16x32_bf16 v[30:33], a[120:123], v[18:21], v[30:33]
  v_mfma_f32_16x16x32_bf16 v[34:37], a[200:203], v[18:21], v[34:37]
  v_mfma_f32_16x16x32_bf16 v[38:41], v[120:123], v[18:21], v[38:41]
  v_mul_f32 v80, v48, v56
  v_mul_f32 v73, v49, v49
  v_fma_f32 v73, v73, v82, v83
  v_mul_f32 v73, v73, v49
  v_exp_f32 v73, v73
  s_nop 0
  v_add_f32 v73, 1.0, v73
  ds_read_b128 v[18:21], v8 offset:14336
  s_waitcnt lgkmcnt(3)
  v_mfma_f32_16x16x32_bf16 v[26:29], a[44:47], v[22:25], v[26:29]
  v_mfma_f32_16x16x32_bf16 v[30:33], a[124:127], v[22:25], v[30:33]
  v_mfma_f32_16x16x32_bf16 v[34:37], a[204:207], v[22:25], v[34:37]
  v_mfma_f32_16x16x32_bf16 v[38:41], v[124:127], v[22:25], v[38:41]
  v_rcp_f32 v73, v73
  v_mul_f32 v81, v49, v57
  v_mul_f32 v66, v66, v74
  v_mul_f32 v67, v67, v75
  v_mul_f32 v68, v68, v76
  v_mul_f32 v69, v69, v77
  ds_read_b128 v[22:25], v8 offset:15360
  s_waitcnt lgkmcnt(3)
  v_mfma_f32_16x16x32_bf16 v[26:29], a[48:51], v[10:13], v[26:29]
  v_mfma_f32_16x16x32_bf16 v[30:33], a[128:131], v[10:13], v[30:33]
  v_mfma_f32_16x16x32_bf16 v[34:37], a[208:211], v[10:13], v[34:37]
  v_mfma_f32_16x16x32_bf16 v[38:41], v[128:131], v[10:13], v[38:41]
  v_mul_f32 v70, v70, v78
  v_mul_f32 v71, v71, v79
  v_mul_f32 v72, v72, v80
  v_mul_f32 v73, v73, v81
  v_cvt_pk_bf16_f32 v58, v66, v67
  v_cvt_pk_bf16_f32 v59, v68, v69
  ds_read_b128 v[10:13], v8 offset:16384
  s_waitcnt lgkmcnt(3)
  v_mfma_f32_16x16x32_bf16 v[26:29], a[52:55], v[14:17], v[26:29]
  v_mfma_f32_16x16x32_bf16 v[30:33], a[132:135], v[14:17], v[30:33]
  v_mfma_f32_16x16x32_bf16 v[34:37], a[212:215], v[14:17], v[34:37]
  v_mfma_f32_16x16x32_bf16 v[38:41], v[132:135], v[14:17], v[38:41]
  v_cvt_pk_bf16_f32 v60, v70, v71
  v_cvt_pk_bf16_f32 v61, v72, v73
  s_add_u32 s35, s34, s28
  buffer_store_dwordx4 v[58:61], v7, s[4:7], s35 offen sc1
  s_add_u32 s34, s34, 49152
  ds_read_b128 v[14:17], v8 offset:17408
  s_waitcnt lgkmcnt(3)
  v_mfma_f32_16x16x32_bf16 v[26:29], a[56:59], v[18:21], v[26:29]
  v_mfma_f32_16x16x32_bf16 v[30:33], a[136:139], v[18:21], v[30:33]
  v_mfma_f32_16x16x32_bf16 v[34:37], a[216:219], v[18:21], v[34:37]
  v_mfma_f32_16x16x32_bf16 v[38:41], v[136:139], v[18:21], v[38:41]
  ds_read_b128 v[18:21], v8 offset:18432
  s_waitcnt lgkmcnt(3)
  v_mfma_f32_16x16x32_bf16 v[26:29], a[60:63], v[22:25], v[26:29]
  v_mfma_f32_16x16x32_bf16 v[30:33], a[140:143], v[22:25], v[30:33]
  v_mfma_f32_16x16x32_bf16 v[34:37], a[220:223], v[22:25], v[34:37]
  v_mfma_f32_16x16x32_bf16 v[38:41], v[140:143], v[22:25], v[38:41]
  ds_read_b128 v[22:25], v8 offset:19456
  s_waitcnt lgkmcnt(3)
  v_mfma_f32_16x16x32_bf16 v[26:29], a[64:67], v[10:13], v[26:29]
  v_mfma_f32_16x16x32_bf16 v[30:33], a[144:147], v[10:13], v[30:33]
  v_mfma_f32_16x16x32_bf16 v[34:37], a[224:227], v[10:13], v[34:37]
  v_mfma_f32_16x16x32_bf16 v[38:41], v[144:147], v[10:13], v[38:41]
  s_cmp_eq_u32 s20, 0
  s_nop 5
  s_cbranch_scc1 MPU2_SW50
  s_waitcnt vmcnt(1)
  s_branch MPU2_SX50
MPU2_SW50:
  s_waitcnt vmcnt(2)
MPU2_SX50:
  s_barrier
  v_add_u32 v9, s36, v7
  s_add_u32 s36, s36, 20480
  s_cmp_ge_u32 s36, 61440
  s_cselect_b32 s36, 0, s36
  s_add_u32 m0, s32, 0
  s_add_u32 s33, s31, 0
  buffer_load_dwordx4 v7, s[4:7], s33 offen offset:0 lds
  buffer_load_dwordx4 v7, s[4:7], s33 offen offset:1024 lds
  buffer_load_dwordx4 v7, s[4:7], s33 offen offset:2048 lds
  buffer_load_dwordx4 v7, s[4:7], s33 offen offset:3072 lds
  s_add_u32 m0, s32, 4096
  s_add_u32 s33, s31, 4096
  buffer_load_dwordx4 v7, s[4:7], s33 offen offset:0 lds
  s_add_u32 s31, s31, 20480
  s_add_u32 s32, s32, 20480
  s_sub_u32 s33, s32, 61440
  s_cmp_ge_u32 s32, 61440
  s_cselect_b32 s32, s33, s32
  s_cmp_lg_u32 s20, 0
  s_cbranch_scc1 MPU2_NP51
  v_mov_b32 v160, s53
  s_mov_b64 exec, 1
  buffer_store_dword v160, v161, s[4:7], s52 offen sc1
  s_mov_b64 exec, -1
MPU2_NP51:
  s_add_u32 s53, s53, 1
  ds_read_b128 v[10:13], v9 offset:0
  s_waitcnt lgkmcnt(3)
  v_mfma_f32_16x16x32_bf16 v[26:29], a[68:71], v[14:17], v[26:29]
  v_mfma_f32_16x16x32_bf16 v[30:33], a[148:151], v[14:17], v[30:33]
  v_mfma_f32_16x16x32_bf16 v[34:37], a[228:231], v[14:17], v[34:37]
  v_mfma_f32_16x16x32_bf16 v[38:41], v[148:151], v[14:17], v[38:41]
  ds_read_b128 v[14:17], v9 offset:1024
  s_waitcnt lgkmcnt(3)
  v_mfma_f32_16x16x32_bf16 v[26:29], a[72:75], v[18:21], v[26:29]
  v_mfma_f32_16x16x32_bf16 v[30:33], a[152:155], v[18:21], v[30:33]
  v_mfma_f32_16x16x32_bf16 v[34:37], a[232:235], v[18:21], v[34:37]
  v_mfma_f32_16x16x32_bf16 v[38:41], v[152:155], v[18:21], v[38:41]
  ds_read_b128 v[18:21], v9 offset:2048
  s_waitcnt lgkmcnt(3)
  v_mfma_f32_16x16x32_bf16 v[26:29], a[76:79], v[22:25], v[26:29]
  v_mfma_f32_16x16x32_bf16 v[30:33], a[156:159], v[22:25], v[30:33]
  v_mfma_f32_16x16x32_bf16 v[34:37], a[236:239], v[22:25], v[34:37]
  v_mfma_f32_16x16x32_bf16 v[38:41], v[156:159], v[22:25], v[38:41]
  s_sub_u32 s30, s30, 1
  s_cmp_lg_u32 s30, 0
  s_nop 4
  s_cbranch_scc1 MPU2_LOOP
  ds_read_b128 v[22:25], v9 offset:3072
  s_waitcnt lgkmcnt(3)
  v_mfma_f32_16x16x32_bf16 v[42:45], a[0:3], v[10:13], 0
  v_mfma_f32_16x16x32_bf16 v[46:49], a[80:83], v[10:13], 0
  v_mfma_f32_16x16x32_bf16 v[50:53], a[160:163], v[10:13], 0
  v_mfma_f32_16x16x32_bf16 v[54:57], a[240:243], v[10:13], 0
  ds_read_b128 v[10:13], v9 offset:4096
  s_waitcnt lgkmcnt(3)
  v_mfma_f32_16x16x32_bf16 v[42:45], a[4:7], v[14:17], v[42:45]
  v_mfma_f32_16x16x32_bf16 v[46:49], a[84:87], v[14:17], v[46:49]
  v_mfma_f32_16x16x32_bf16 v[50:53], a[164:167], v[14:17], v[50:53]
  v_mfma_f32_16x16x32_bf16 v[54:57], a[244:247], v[14:17], v[54:57]
  ds_read_b128 v[14:17], v9 offset:5120
  s_waitcnt lgkmcnt(3)
  v_mfma_f32_16x16x32_bf16 v[42:45], a[8:11], v[18:21], v[42:45]
  v_mfma_f32_16x16x32_bf16 v[46:49], a[88:91], v[18:21], v[46:49]
  v_mfma_f32_16x16x32_bf16 v[50:53], a[168:171], v[18:21], v[50:53]
  v_mfma_f32_16x16x32_bf16 v[54:57], a[248:251], v[18:21], v[54:57]
  v_mul_f32 v66, v26, v26
  v_fma_f32 v66, v66, v82, v83
  v_mul_f32 v66, v66, v26
  v_exp_f32 v66, v66
  s_nop 0
  v_add_f32 v66, 1.0, v66
  v_rcp_f32 v66, v66
  ds_read_b128 v[18:21], v9 offset:6144
  s_waitcnt lgkmcnt(3)
  v_mfma_f32_16x16x32_bf16 v[42:45], a[12:15], v[22:25], v[42:45]
  v_mfma_f32_16x16x32_bf16 v[46:49], a[92:95], v[22:25], v[46:49]
  v_mfma_f32_16x16x32_bf16 v[50:53], a[172:175], v[22:25], v[50:53]
  v_mfma_f32_16x16x32_bf16 v[54:57], a[252:255], v[22:25], v[54:57]
  v_mul_f32 v74, v26, v34
  v_mul_f32 v67, v27, v27
  v_fma_f32 v67, v67, v82, v83
  v_mul_f32 v67, v67, v27
  v_exp_f32 v67, v67
  s_nop 0
  v_add_f32 v67, 1.0, v67
  ds_read_b128 v[22:25], v9 offset:7168
  s_waitcnt lgkmcnt(3)
  v_mfma_f32_16x16x32_bf16 v[42:45], a[16:19], v[10:13], v[42:45]
  v_mfma_f32_16x16x32_bf16 v[46:49], a[96:99], v[10:13], v[46:49]
  v_mfma_f32_16x16x32_bf16 v[50:53], a[176:179], v[10:13], v[50:53]
  v_mfma_f32_16x16x32_bf16 v[54:57], v[96:99], v[10:13], v[54:57]
  v_rcp_f32 v67, v67
  v_mul_f32 v75, v27, v35
  v_mul_f32 v68, v28, v28
  v_fma_f32 v68, v68, v82, v83
  v_mul_f32 v68, v68, v28
  v_exp_f32 v68, v68
  ds_read_b128 v[10:13], v9 offset:8192
  s_waitcnt lgkmcnt(3)
  v_mfma_f32_16x16x32_bf16 v[42:45], a[20:23], v[14:17], v[42:45]
  v_mfma_f32_16x16x32_bf16 v[46:49], a[100:103], v[14:17], v[46:49]
  v_mfma_f32_16x16x32_bf16 v[50:53], a[180:183], v[14:17], v[50:53]
  v_mfma_f32_16x16x32_bf16 v[54:57], v[100:103], v[14:17], v[54:57]
  v_add_f32 v68, 1.0, v68
  v_rcp_f32 v68, v68
  v_mul_f32 v76, v28, v36
  v_mul_f32 v69, v29, v29
  v_fma_f32 v69, v69, v82, v83
  v_mul_f32 v69, v69, v29
  ds_read_b128 v[14:17], v9 offset:9216
  s_waitcnt lgkmcnt(3)
  v_mfma_f32_16x16x32_bf16 v[42:45], a[24:27], v[18:21], v[42:45]
  v_mfma_f32_16x16x32_bf16 v[46:49], a[104:107], v[18:21], v[46:49]
  v_mfma_f32_16x16x32_bf16 v[50:53], a[184:187], v[18:21], v[50:53]
  v_mfma_f32_16x16x32_bf16 v[54:57], v[104:107], v[18:21], v[54:57]
  v_exp_f32 v69, v69
  s_nop 0
  v_add_f32 v69, 1.0, v69
  v_rcp_f32 v69, v69
  v_mul_f32 v77, v29, v37
  v_mul_f32 v70, v30, v30
  v_fma_f32 v70, v70, v82, v83
  ds_read_b128 v[18:21], v9 offset:10240
  s_waitcnt lgkmcnt(3)
  v_mfma_f32_16x16x32_bf16 v[42:45], a[28:31], v[22:25], v[42:45]
  v_mfma_f32_16x16x32_bf16 v[46:49], a[108:111], v[22:25], v[46:49]
  v_mfma_f32_16x16x32_bf16 v[50:53], a[188:191], v[22:25], v[50:53]
  v_mfma_f32_16x16x32_bf16 v[54:57], v[108:111], v[22:25], v[54:57]
  v_mul_f32 v70, v70, v30
  v_exp_f32 v70, v70
  s_nop 0
  v_add_f32 v70, 1.0, v70
  v_rcp_f32 v70, v70
  v_mul_f32 v78, v30, v38
  v_mul_f32 v71, v31, v31
  ds_read_b128 v[22:25], v9 offset:11264
  s_waitcnt lgkmcnt(3)
  v_mfma_f32_16x16x32_bf16 v[42:45], a[32:35], v[10:13], v[42:45]
  v_mfma_f32_16x16x32_bf16 v[46:49], a[112:115], v[10:13], v[46:49]
  v_mfma_f32_16x16x32_bf16 v[50:53], a[192:195], v[10:13], v[50:53]
  v_mfma_f32_16x16x32_bf16 v[54:57], v[112:115], v[10:13], v[54:57]
  v_fma_f32 v71, v71, v82, v83
  v_mul_f32 v71, v71, v31
  v_exp_f32 v71, v71
  s_nop 0
  v_add_f32 v71, 1.0, v71
  v_rcp_f32 v71, v71
  v_mul_f32 v79, v31, v39
  ds_read_b128 v[10:13], v9 offset:12288
  s_waitcnt lgkmcnt(3)
  v_mfma_f32_16x16x32_bf16 v[42:45], a[36:39], v[14:17], v[42:45]
  v_mfma_f32_16x16x32_bf16 v[46:49], a[116:119], v[14:17], v[46:49]
  v_mfma_f32_16x16x32_bf16 v[50:53], a[196:199], v[14:17], v[50:53]
  v_mfma_f32_16x16x32_bf16 v[54:57], v[116:119], v[14:17], v[54:57]
  v_mul_f32 v72, v32, v32
  v_fma_f32 v72, v72, v82, v83
  v_mul_f32 v72, v72, v32
  v_exp_f32 v72, v72
  s_nop 0
  v_add_f32 v72, 1.0, v72
  v_rcp_f32 v72, v72
  ds_read_b128 v[14:17], v9 offset:13312
  s_waitcnt lgkmcnt(3)
  v_mfma_f32_16x16x32_bf16 v[42:45], a[40:43], v[18:21], v[42:45]
  v_mfma_f32_16x16x32_bf16 v[46:49], a[120:123], v[18:21], v[46:49]
  v_mfma_f32_16x16x32_bf16 v[50:53], a[200:203], v[18:21], v[50:53]
  v_mfma_f32_16x16x32_bf16 v[54:57], v[120:123], v[18:21], v[54:57]
  v_mul_f32 v80, v32, v40
  v_mul_f32 v73, v33, v33
  v_fma_f32 v73, v73, v82, v83
  v_mul_f32 v73, v73, v33
  v_exp_f32 v73, v73
  s_nop 0
  v_add_f32 v73, 1.0, v73
  ds_read_b128 v[18:21], v9 offset:14336
  s_waitcnt lgkmcnt(3)
  v_mfma_f32_16x16x32_bf16 v[42:45], a[44:47], v[22:25], v[42:45]
  v_mfma_f32_16x16x32_bf16 v[46:49], a[124:127], v[22:25], v[46:49]
  v_mfma_f32_16x16x32_bf16 v[50:53], a[204:207], v[22:25], v[50:53]
  v_mfma_f32_16x16x32_bf16 v[54:57], v[124:127], v[22:25], v[54:57]
  v_rcp_f32 v73, v73
  v_mul_f32 v81, v33, v41
  v_mul_f32 v66, v66, v74
  v_mul_f32 v67, v67, v75
  v_mul_f32 v68, v68, v76
  v_mul_f32 v69, v69, v77
  ds_read_b128 v[22:25], v9 offset:15360
  s_waitcnt lgkmcnt(3)
  v_mfma_f32_16x16x32_bf16 v[42:45], a[48:51], v[10:13], v[42:45]
  v_mfma_f32_16x16x32_bf16 v[46:49], a[128:131], v[10:13], v[46:49]
  v_mfma_f32_16x16x32_bf16 v[50:53], a[208:211], v[10:13], v[50:53]
  v_mfma_f32_16x16x32_bf16 v[54:57], v[128:131], v[10:13], v[54:57]
  v_mul_f32 v70, v70, v78
  v_mul_f32 v71, v71, v79
  v_mul_f32 v72, v72, v80
  v_mul_f32 v73, v73, v81
  v_cvt_pk_bf16_f32 v58, v66, v67
  v_cvt_pk_bf16_f32 v59, v68, v69
  ds_read_b128 v[10:13], v9 offset:16384
  s_waitcnt lgkmcnt(3)
  v_mfma_f32_16x16x32_bf16 v[42:45], a[52:55], v[14:17], v[42:45]
  v_mfma_f32_16x16x32_bf16 v[46:49], a[132:135], v[14:17], v[46:49]
  v_mfma_f32_16x16x32_bf16 v[50:53], a[212:215], v[14:17], v[50:53]
  v_mfma_f32_16x16x32_bf16 v[54:57], v[132:135], v[14:17], v[54:57]
  v_cvt_pk_bf16_f32 v60, v70, v71
  v_cvt_pk_bf16_f32 v61, v72, v73
  s_add_u32 s35, s34, s28
  buffer_store_dwordx4 v[58:61], v7, s[4:7], s35 offen sc1
  s_add_u32 s34, s34, 49152
  ds_read_b128 v[14:17], v9 offset:17408
  s_waitcnt lgkmcnt(3)
  v_mfma_f32_16x16x32_bf16 v[42:45], a[56:59], v[18:21], v[42:45]
  v_mfma_f32_16x16x32_bf16 v[46:49], a[136:139], v[18:21], v[46:49]
  v_mfma_f32_16x16x32_bf16 v[50:53], a[216:219], v[18:21], v[50:53]
  v_mfma_f32_16x16x32_bf16 v[54:57], v[136:139], v[18:21], v[54:57]
  ds_read_b128 v[18:21], v9 offset:18432
  s_waitcnt lgkmcnt(3)
  v_mfma_f32_16x16x32_bf16 v[42:45], a[60:63], v[22:25], v[42:45]
  v_mfma_f32_16x16x32_bf16 v[46:49], a[140:143], v[22:25], v[46:49]
  v_mfma_f32_16x16x32_bf16 v[50:53], a[220:223], v[22:25], v[50:53]
  v_mfma_f32_16x16x32_bf16 v[54:57], v[140:143], v[22:25], v[54:57]
  ds_read_b128 v[22:25], v9 offset:19456
  s_waitcnt lgkmcnt(3)
  v_mfma_f32_16x16x32_bf16 v[42:45], a[64:67], v[10:13], v[42:45]
  v_mfma_f32_16x16x32_bf16 v[46:49], a[144:147], v[10:13], v[46:49]
  v_mfma_f32_16x16x32_bf16 v[50:53], a[224:227], v[10:13], v[50:53]
  v_mfma_f32_16x16x32_bf16 v[54:57], v[144:147], v[10:13], v[54:57]
  s_cmp_eq_u32 s20, 0
  s_nop 5
  s_cbranch_scc1 MPU2_SW52
  s_waitcnt vmcnt(1)
  s_branch MPU2_SX52
MPU2_SW52:
  s_waitcnt vmcnt(2)
MPU2_SX52:
  s_barrier
  v_add_u32 v8, s36, v7
  s_add_u32 s36, s36, 20480
  s_cmp_ge_u32 s36, 61440
  s_cselect_b32 s36, 0, s36
  s_add_u32 m0, s32, 0
  s_add_u32 s33, s31, 0
  buffer_load_dwordx4 v7, s[4:7], s33 offen offset:0 lds
  buffer_load_dwordx4 v7, s[4:7], s33 offen offset:1024 lds
  buffer_load_dwordx4 v7, s[4:7], s33 offen offset:2048 lds
  buffer_load_dwordx4 v7, s[4:7], s33 offen offset:3072 lds
  s_add_u32 m0, s32, 4096
  s_add_u32 s33, s31, 4096
  buffer_load_dwordx4 v7, s[4:7], s33 offen offset:0 lds
  s_add_u32 s31, s31, 20480
  s_add_u32 s32, s32, 20480
  s_sub_u32 s33, s32, 61440
  s_cmp_ge_u32 s32, 61440
  s_cselect_b32 s32, s33, s32
  s_cmp_lg_u32 s20, 0
  s_cbranch_scc1 MPU2_NP53
  v_mov_b32 v160, s53
  s_mov_b64 exec, 1
  buffer_store_dword v160, v161, s[4:7], s52 offen sc1
  s_mov_b64 exec, -1
MPU2_NP53:
  s_add_u32 s53, s53, 1
  ds_read_b128 v[10:13], v8 offset:0
  s_waitcnt lgkmcnt(3)
  v_mfma_f32_16x16x32_bf16 v[42:45], a[68:71], v[14:17], v[42:45]
  v_mfma_f32_16x16x32_bf16 v[46:49], a[148:151], v[14:17], v[46:49]
  v_mfma_f32_16x16x32_bf16 v[50:53], a[228:231], v[14:17], v[50:53]
  v_mfma_f32_16x16x32_bf16 v[54:57], v[148:151], v[14:17], v[54:57]
  ds_read_b128 v[14:17], v8 offset:1024
  s_waitcnt lgkmcnt(3)
  v_mfma_f32_16x16x32_bf16 v[42:45], a[72:75], v[18:21], v[42:45]
  v_mfma_f32_16x16x32_bf16 v[46:49], a[152:155], v[18:21], v[46:49]
  v_mfma_f32_16x16x32_bf16 v[50:53], a[232:235], v[18:21], v[50:53]
  v_mfma_f32_16x16x32_bf16 v[54:57], v[152:155], v[18:21], v[54:57]
  ds_read_b128 v[18:21], v8 offset:2048
  s_waitcnt lgkmcnt(3)
  v_mfma_f32_16x16x32_bf16 v[42:45], a[76:79], v[22:25], v[42:45]
  v_mfma_f32_16x16x32_bf16 v[46:49], a[156:159], v[22:25], v[46:49]
  v_mfma_f32_16x16x32_bf16 v[50:53], a[236:239], v[22:25], v[50:53]
  v_mfma_f32_16x16x32_bf16 v[54:57], v[156:159], v[22:25], v[54:57]
  s_nop 7
  v_mul_f32 v66, v42, v42
  v_fma_f32 v66, v66, v82, v83
  v_mul_f32 v66, v66, v42
  v_exp_f32 v66, v66
  s_nop 0
  v_add_f32 v66, 1.0, v66
  v_rcp_f32 v66, v66
  v_mul_f32 v74, v42, v50
  v_mul_f32 v67, v43, v43
  v_fma_f32 v67, v67, v82, v83
  v_mul_f32 v67, v67, v43
  v_exp_f32 v67, v67
  s_nop 0
  v_add_f32 v67, 1.0, v67
  v_rcp_f32 v67, v67
  v_mul_f32 v75, v43, v51
  v_mul_f32 v68, v44, v44
  v_fma_f32 v68, v68, v82, v83
  v_mul_f32 v68, v68, v44
  v_exp_f32 v68, v68
  s_nop 0
  v_add_f32 v68, 1.0, v68
  v_rcp_f32 v68, v68
  v_mul_f32 v76, v44, v52
  v_mul_f32 v69, v45, v45
  v_fma_f32 v69, v69, v82, v83
  v_mul_f32 v69, v69, v45
  v_exp_f32 v69, v69
  s_nop 0
  v_add_f32 v69, 1.0, v69
  v_rcp_f32 v69, v69
  v_mul_f32 v77, v45, v53
  v_mul_f32 v70, v46, v46
  v_fma_f32 v70, v70, v82, v83
  v_mul_f32 v70, v70, v46
  v_exp_f32 v70, v70
  s_nop 0
  v_add_f32 v70, 1.0, v70
  v_rcp_f32 v70, v70
  v_mul_f32 v78, v46, v54
  v_mul_f32 v71, v47, v47
  v_fma_f32 v71, v71, v82, v83
  v_mul_f32 v71, v71, v47
  v_exp_f32 v71, v71
  s_nop 0
  v_add_f32 v71, 1.0, v71
  v_rcp_f32 v71, v71
  v_mul_f32 v79, v47, v55
  v_mul_f32 v72, v48, v48
  v_fma_f32 v72, v72, v82, v83
  v_mul_f32 v72, v72, v48
  v_exp_f32 v72, v72
  s_nop 0
  v_add_f32 v72, 1.0, v72
  v_rcp_f32 v72, v72
  v_mul_f32 v80, v48, v56
  v_mul_f32 v73, v49, v49
  v_fma_f32 v73, v73, v82, v83
  v_mul_f32 v73, v73, v49
  v_exp_f32 v73, v73
  s_nop 0
  v_add_f32 v73, 1.0, v73
  v_rcp_f32 v73, v73
  v_mul_f32 v81, v49, v57
  v_mul_f32 v66, v66, v74
  v_mul_f32 v67, v67, v75
  v_mul_f32 v68, v68, v76
  v_mul_f32 v69, v69, v77
  v_mul_f32 v70, v70, v78
  v_mul_f32 v71, v71, v79
  v_mul_f32 v72, v72, v80
  v_mul_f32 v73, v73, v81
  v_cvt_pk_bf16_f32 v58, v66, v67
  v_cvt_pk_bf16_f32 v59, v68, v69
  v_cvt_pk_bf16_f32 v60, v70, v71
  v_cvt_pk_bf16_f32 v61, v72, v73
  s_add_u32 s35, s34, s28
  buffer_store_dwordx4 v[58:61], v7, s[4:7], s35 offen sc1
  s_add_u32 s34, s34, 49152
  s_waitcnt vmcnt(0) lgkmcnt(0)
  s_barrier
  s_mov_b32 s53, 128
  v_mov_b32 v160, s53
  s_mov_b64 exec, 1
  buffer_store_dword v160, v161, s[4:7], s52 offen sc1
  s_mov_b64 exec, -1
  s_waitcnt vmcnt(0)
  s_branch MK_TOK
MK_DN:
  s_sub_u32 s51, s51, 84
  s_load_dwordx2 s[46:47], s[0:1], 80
  s_load_dwordx2 s[48:49], s[0:1], 0
  s_waitcnt lgkmcnt(0)
  s_mov_b32 s8, s46
  s_and_b32 s9, s47, 0xffff
  s_mov_b32 s10, 1966080
  s_mov_b32 s11, 0x00020000
  s_mov_b32 s16, s48
  s_and_b32 s17, s49, 0xffff
  s_mov_b32 s18, 2621440
  s_mov_b32 s19, 0x00020000
  s_lshl_b32 s48, s51, 2
  s_add_u32 s48, s48, s20
  s_lshl_b32 s24, s48, 5
  s_mov_b32 s29, s24
  s_lshl_b32 s49, s48, 11
  s_add_u32 s28, s49, 94371840
  s_lshl_b32 s21, s20, 15
  v_lshrrev_b32 v6, 1, v1
  s_mov_b32 s22, 1280
  v_mul_lo_u32 v4, v6, s22
  v_and_b32 v6, 1, v1
  v_lshlrev_b32 v6, 4, v6
  v_add_u32 v4, v4, v6
  v_lshrrev_b32 v5, 4, v1
  v_lshlrev_b32 v5, 2, v5
  v_bfe_u32 v6, v1, 2, 2
  v_add_u32 v5, v5, v6
  v_mul_u32_u24 v5, 32, v5
  v_and_b32 v6, 3, v1
  v_lshlrev_b32 v6, 3, v6
  v_add_u32 v5, v5, v6
  v_add_u32 v5, s21, v5
  s_add_u32 s33, s24, 0
  s_add_u32 m0, s21, 0
  s_nop 0
  buffer_load_dwordx4 v4, s[8:11], s33 offen lds
  s_add_u32 s33, s24, 40960
  s_add_u32 m0, s21, 1024
  s_nop 0
  buffer_load_dwordx4 v4, s[8:11], s33 offen lds
  s_add_u32 s33, s24, 81920
  s_add_u32 m0, s21, 2048
  s_nop 0
  buffer_load_dwordx4 v4, s[8:11], s33 offen lds
  s_add_u32 s33, s24, 122880
  s_add_u32 m0, s21, 3072
  s_nop 0
  buffer_load_dwordx4 v4, s[8:11], s33 offen lds
  s_add_u32 s33, s24, 163840
  s_add_u32 m0, s21, 4096
  s_nop 0
  buffer_load_dwordx4 v4, s[8:11], s33 offen lds
  s_add_u32 s33, s24, 204800
  s_add_u32 m0, s21, 5120
  s_nop 0
  buffer_load_dwordx4 v4, s[8:11], s33 offen lds
  s_add_u32 s33, s24, 245760
  s_add_u32 m0, s21, 6144
  s_nop 0
  buffer_load_dwordx4 v4, s[8:11], s33 offen lds
  s_add_u32 s33, s24, 286720
  s_add_u32 m0, s21, 7168
  s_nop 0
  buffer_load_dwordx4 v4, s[8:11], s33 offen lds
  s_add_u32 s33, s24, 327680
  s_add_u32 m0, s21, 8192
  s_nop 0
  buffer_load_dwordx4 v4, s[8:11], s33 offen lds
  s_add_u32 s33, s24, 368640
  s_add_u32 m0, s21, 9216
  s_nop 0
  buffer_load_dwordx4 v4, s[8:11], s33 offen lds
  s_add_u32 s33, s24, 409600
  s_add_u32 m0, s21, 10240
  s_nop 0
  buffer_load_dwordx4 v4, s[8:11], s33 offen lds
  s_add_u32 s33, s24, 450560
  s_add_u32 m0, s21, 11264
  s_nop 0
  buffer_load_dwordx4 v4, s[8:11], s33 offen lds
  s_add_u32 s33, s24, 491520
  s_add_u32 m0, s21, 12288
  s_nop 0
  buffer_load_dwordx4 v4, s[8:11], s33 offen lds
  s_add_u32 s33, s24, 532480
  s_add_u32 m0, s21, 13312
  s_nop 0
  buffer_load_dwordx4 v4, s[8:11], s33 offen lds
  s_add_u32 s33, s24, 573440
  s_add_u32 m0, s21, 14336
  s_nop 0
  buffer_load_dwordx4 v4, s[8:11], s33 offen lds
  s_add_u32 s33, s24, 614400
  s_add_u32 m0, s21, 15360
  s_nop 0
  buffer_load_dwordx4 v4, s[8:11], s33 offen lds
  s_add_u32 s33, s24, 655360
  s_add_u32 m0, s21, 16384
  s_nop 0
  buffer_load_dwordx4 v4, s[8:11], s33 offen lds
  s_add_u32 s33, s24, 696320
  s_add_u32 m0, s21, 17408
  s_nop 0
  buffer_load_dwordx4 v4, s[8:11], s33 offen lds
  s_add_u32 s33, s24, 737280
  s_add_u32 m0, s21, 18432
  s_nop 0
  buffer_load_dwordx4 v4, s[8:11], s33 offen lds
  s_add_u32 s33, s24, 778240
  s_add_u32 m0, s21, 19456
  s_nop 0
  buffer_load_dwordx4 v4, s[8:11], s33 offen lds
  s_add_u32 s33, s24, 819200
  s_add_u32 m0, s21, 20480
  s_nop 0
  buffer_load_dwordx4 v4, s[8:11], s33 offen lds
  s_add_u32 s33, s24, 860160
  s_add_u32 m0, s21, 21504
  s_nop 0
  buffer_load_dwordx4 v4, s[8:11], s33 offen lds
  s_add_u32 s33, s24, 901120
  s_add_u32 m0, s21, 22528
  s_nop 0
  buffer_load_dwordx4 v4, s[8:11], s33 offen lds
  s_add_u32 s33, s24, 942080
  s_add_u32 m0, s21, 23552
  s_nop 0
  buffer_load_dwordx4 v4, s[8:11], s33 offen lds
  s_add_u32 s33, s24, 983040
  s_add_u32 m0, s21, 24576
  s_nop 0
  buffer_load_dwordx4 v4, s[8:11], s33 offen lds
  s_add_u32 s33, s24, 1024000
  s_add_u32 m0, s21, 25600
  s_nop 0
  buffer_load_dwordx4 v4, s[8:11], s33 offen lds
  s_add_u32 s33, s24, 1064960
  s_add_u32 m0, s21, 26624
  s_nop 0
  buffer_load_dwordx4 v4, s[8:11], s33 offen lds
  s_add_u32 s33, s24, 1105920
  s_add_u32 m0, s21, 27648
  s_nop 0
  buffer_load_dwordx4 v4, s[8:11], s33 offen lds
  s_add_u32 s33, s24, 1146880
  s_add_u32 m0, s21, 28672
  s_nop 0
  buffer_load_dwordx4 v4, s[8:11], s33 offen lds
  s_add_u32 s33, s24, 1187840
  s_add_u32 m0, s21, 29696
  s_nop 0
  buffer_load_dwordx4 v4, s[8:11], s33 offen lds
  s_add_u32 s33, s24, 1228800
  s_add_u32 m0, s21, 30720
  s_nop 0
  buffer_load_dwordx4 v4, s[8:11], s33 offen lds
  s_add_u32 s33, s24, 1269760
  s_add_u32 m0, s21, 31744
  s_nop 0
  buffer_load_dwordx4 v4, s[8:11], s33 offen lds
  s_waitcnt vmcnt(28)
  ds_read_b64_tr_b16 a[0:1], v5 offset:0
  ds_read_b64_tr_b16 a[2:3], v5 offset:512
  ds_read_b64_tr_b16 a[4:5], v5 offset:1024
  ds_read_b64_tr_b16 a[6:7], v5 offset:1536
  ds_read_b64_tr_b16 a[8:9], v5 offset:2048
  ds_read_b64_tr_b16 a[10:11], v5 offset:2560
  ds_read_b64_tr_b16 a[12:13], v5 offset:3072
  ds_read_b64_tr_b16 a[14:15], v5 offset:3584
  s_waitcnt lgkmcnt(0)
  s_add_u32 s33, s24, 1310720
  s_add_u32 m0, s21, 0
  s_nop 0
  buffer_load_dwordx4 v4, s[8:11], s33 offen lds
  s_add_u32 s33, s24, 1351680
  s_add_u32 m0, s21, 1024
  s_nop 0
  buffer_load_dwordx4 v4, s[8:11], s33 offen lds
  s_add_u32 s33, s24, 1392640
  s_add_u32 m0, s21, 2048
  s_nop 0
  buffer_load_dwordx4 v4, s[8:11], s33 offen lds
  s_add_u32 s33, s24, 1433600
  s_add_u32 m0, s21, 3072
  s_nop 0
  buffer_load_dwordx4 v4, s[8:11], s33 offen lds
  s_waitcnt vmcnt(28)
  ds_read_b64_tr_b16 a[16:17], v5 offset:4096
  ds_read_b64_tr_b16 a[18:19], v5 offset:4608
  ds_read_b64_tr_b16 a[20:21], v5 offset:5120
  ds_read_b64_tr_b16 a[22:23], v5 offset:5632
  ds_read_b64_tr_b16 a[24:25], v5 offset:6144
  ds_read_b64_tr_b16 a[26:27], v5 offset:6656
  ds_read_b64_tr_b16 a[28:29], v5 offset:7168
  ds_read_b64_tr_b16 a[30:31], v5 offset:7680
  s_waitcnt lgkmcnt(0)
  s_add_u32 s33, s24, 1474560
  s_add_u32 m0, s21, 4096
  s_nop 0
  buffer_load_dwordx4 v4, s[8:11], s33 offen lds
  s_add_u32 s33, s24, 1515520
  s_add_u32 m0, s21, 5120
  s_nop 0
  buffer_load_dwordx4 v4, s[8:11], s33 offen lds
  s_add_u32 s33, s24, 1556480
  s_add_u32 m0, s21, 6144
  s_nop 0
  buffer_load_dwordx4 v4, s[8:11], s33 offen lds
  s_add_u32 s33, s24, 1597440
  s_add_u32 m0, s21, 7168
  s_nop 0
  buffer_load_dwordx4 v4, s[8:11], s33 offen lds
  s_waitcnt vmcnt(28)
  ds_read_b64_tr_b16 a[32:33], v5 offset:8192
  ds_read_b64_tr_b16 a[34:35], v5 offset:8704
  ds_read_b64_tr_b16 a[36:37], v5 offset:9216
  ds_read_b64_tr_b16 a[38:39], v5 offset:9728
  ds_read_b64_tr_b16 a[40:41], v5 offset:10240
  ds_read_b64_tr_b16 a[42:43], v5 offset:10752
  ds_read_b64_tr_b16 a[44:45], v5 offset:11264
  ds_read_b64_tr_b16 a[46:47], v5 offset:11776
  s_waitcnt lgkmcnt(0)
  s_add_u32 s33, s24, 1638400
  s_add_u32 m0, s21, 8192
  s_nop 0
  buffer_load_dwordx4 v4, s[8:11], s33 offen lds
  s_add_u32 s33, s24, 1679360
  s_add_u32 m0, s21, 9216
  s_nop 0
  buffer_load_dwordx4 v4, s[8:11], s33 offen lds
  s_add_u32 s33, s24, 1720320
  s_add_u32 m0, s21, 10240
  s_nop 0
  buffer_load_dwordx4 v4, s[8:11], s33 offen lds
  s_add_u32 s33, s24, 1761280
  s_add_u32 m0, s21, 11264
  s_nop 0
  buffer_load_dwordx4 v4, s[8:11], s33 offen lds
  s_waitcnt vmcnt(28)
  ds_read_b64_tr_b16 a[48:49], v5 offset:12288
  ds_read_b64_tr_b16 a[50:51], v5 offset:12800
  ds_read_b64_tr_b16 a[52:53], v5 offset:13312
  ds_read_b64_tr_b16 a[54:55], v5 offset:13824
  ds_read_b64_tr_b16 a[56:57], v5 offset:14336
  ds_read_b64_tr_b16 a[58:59], v5 offset:14848
  ds_read_b64_tr_b16 a[60:61], v5 offset:15360
  ds_read_b64_tr_b16 a[62:63], v5 offset:15872
  s_waitcnt lgkmcnt(0)
  s_add_u32 s33, s24, 1802240
  s_add_u32 m0, s21, 12288
  s_nop 0
  buffer_load_dwordx4 v4, s[8:11], s33 offen lds
  s_add_u32 s33, s24, 1843200
  s_add_u32 m0, s21, 13312
  s_nop 0
  buffer_load_dwordx4 v4, s[8:11], s33 offen lds
  s_add_u32 s33, s24, 1884160
  s_add_u32 m0, s21, 14336
  s_nop 0
  buffer_load_dwordx4 v4, s[8:11], s33 offen lds
  s_add_u32 s33, s24, 1925120
  s_add_u32 m0, s21, 15360
  s_nop 0
  buffer_load_dwordx4 v4, s[8:11], s33 offen lds
  s_waitcnt vmcnt(28)
  ds_read_b64_tr_b16 a[64:65], v5 offset:16384
  ds_read_b64_tr_b16 a[66:67], v5 offset:16896
  ds_read_b64_tr_b16 a[68:69], v5 offset:17408
  ds_read_b64_tr_b16 a[70:71], v5 offset:17920
  ds_read_b64_tr_b16 a[72:73], v5 offset:18432
  ds_read_b64_tr_b16 a[74:75], v5 offset:18944
  ds_read_b64_tr_b16 a[76:77], v5 offset:19456
  ds_read_b64_tr_b16 a[78:79], v5 offset:19968
  s_waitcnt vmcnt(24)
  ds_read_b64_tr_b16 a[80:81], v5 offset:20480
  ds_read_b64_tr_b16 a[82:83], v5 offset:20992
  ds_read_b64_tr_b16 a[84:85], v5 offset:21504
  ds_read_b64_tr_b16 a[86:87], v5 offset:22016
  ds_read_b64_tr_b16 a[88:89], v5 offset:22528
  ds_read_b64_tr_b16 a[90:91], v5 offset:23040
  ds_read_b64_tr_b16 a[92:93], v5 offset:23552
  ds_read_b64_tr_b16 a[94:95], v5 offset:24064
  s_waitcnt vmcnt(20)
  ds_read_b64_tr_b16 a[96:97], v5 offset:24576
  ds_read_b64_tr_b16 a[98:99], v5 offset:25088
  ds_read_b64_tr_b16 a[100:101], v5 offset:25600
  ds_read_b64_tr_b16 a[102:103], v5 offset:26112
  ds_read_b64_tr_b16 a[104:105], v5 offset:26624
  ds_read_b64_tr_b16 a[106:107], v5 offset:27136
  ds_read_b64_tr_b16 a[108:109], v5 offset:27648
  ds_read_b64_tr_b16 a[110:111], v5 offset:28160
  s_waitcnt vmcnt(16)
  ds_read_b64_tr_b16 a[112:113], v5 offset:28672
  ds_read_b64_tr_b16 a[114:115], v5 offset:29184
  ds_read_b64_tr_b16 a[116:117], v5 offset:29696
  ds_read_b64_tr_b16 a[118:119], v5 offset:30208
  ds_read_b64_tr_b16 a[120:121], v5 offset:30720
  ds_read_b64_tr_b16 a[122:123], v5 offset:31232
  ds_read_b64_tr_b16 a[124:125], v5 offset:31744
  ds_read_b64_tr_b16 a[126:127], v5 offset:32256
  s_waitcnt vmcnt(12)
  ds_read_b64_tr_b16 a[128:129], v5 offset:0
  ds_read_b64_tr_b16 a[130:131], v5 offset:512
  ds_read_b64_tr_b16 a[132:133], v5 offset:1024
  ds_read_b64_tr_b16 a[134:135], v5 offset:1536
  ds_read_b64_tr_b16 a[136:137], v5 offset:2048
  ds_read_b64_tr_b16 a[138:139], v5 offset:2560
  ds_read_b64_tr_b16 a[140:141], v5 offset:3072
  ds_read_b64_tr_b16 a[142:143], v5 offset:3584
  s_waitcnt vmcnt(8)
  ds_read_b64_tr_b16 a[144:145], v5 offset:4096
  ds_read_b64_tr_b16 a[146:147], v5 offset:4608
  ds_read_b64_tr_b16 a[148:149], v5 offset:5120
  ds_read_b64_tr_b16 a[150:151], v5 offset:5632
  ds_read_b64_tr_b16 a[152:153], v5 offset:6144
  ds_read_b64_tr_b16 a[154:155], v5 offset:6656
  ds_read_b64_tr_b16 a[156:157], v5 offset:7168
  ds_read_b64_tr_b16 a[158:159], v5 offset:7680
  s_waitcnt vmcnt(4)
  ds_read_b64_tr_b16 a[160:161], v5 offset:8192
  ds_read_b64_tr_b16 a[162:163], v5 offset:8704
  ds_read_b64_tr_b16 a[164:165], v5 offset:9216
  ds_read_b64_tr_b16 a[166:167], v5 offset:9728
  ds_read_b64_tr_b16 a[168:169], v5 offset:10240
  ds_read_b64_tr_b16 a[170:171], v5 offset:10752
  ds_read_b64_tr_b16 a[172:173], v5 offset:11264
  ds_read_b64_tr_b16 a[174:175], v5 offset:11776
  s_waitcnt vmcnt(0)
  ds_read_b64_tr_b16 a[176:177], v5 offset:12288
  ds_read_b64_tr_b16 a[178:179], v5 offset:12800
  ds_read_b64_tr_b16 a[180:181], v5 offset:13312
  ds_read_b64_tr_b16 a[182:183], v5 offset:13824
  ds_read_b64_tr_b16 a[184:185], v5 offset:14336
  ds_read_b64_tr_b16 a[186:187], v5 offset:14848
  ds_read_b64_tr_b16 a[188:189], v5 offset:15360
  ds_read_b64_tr_b16 a[190:191], v5 offset:15872
  s_waitcnt lgkmcnt(0)
  v_mov_b32 v250, 48
  s_mov_b32 s86, 0
  s_nop 0
WI_D:
  global_load_dword v251, v250, s[76:77] sc1
  s_waitcnt vmcnt(0)
  v_readfirstlane_b32 s88, v251
  s_nop 0
  s_cmp_ge_u32 s88, 80
  s_nop 1
  s_cbranch_scc1 WI_D_K
  s_sleep 4
  s_add_u32 s86, s86, 1
  s_cmp_lt_u32 s86, 0x100000
  s_cbranch_scc1 WI_D
WI_D_K:
  v_mov_b32 v165, 0x80000000
  s_barrier
  v_lshlrev_b32 v7, 4, v1
  s_mul_i32 s33, s20, 12288
  s_add_u32 s31, s33, 88080384
  s_mov_b32 s32, s33
  s_mov_b32 s53, 0
  v_mov_b32 v161, 0
  s_mov_b32 s54, 0
  s_mov_b32 s55, 0
  s_mov_b32 s59, 0
  s_mov_b32 s61, 0
  v_mov_b32 v164, 8390656
  v_min_u32 v162, 11, v1
  v_lshlrev_b32 v162, 7, v162
  v_add_u32 v162, 8446976, v162
  s_add_u32 s55, s55, 1
  s_min_u32 s57, s55, 128
  s_cmp_ge_u32 s54, s57
  s_cbranch_scc1 MPD_WH54_D
  s_mov_b32 s58, 0
MPD_WH54:
  buffer_load_dword v163, v162, s[4:7], 0 offen sc1
  s_waitcnt vmcnt(0)
  v_cmp_gt_u32 vcc, s57, v163
  s_nop 3
  s_cbranch_vccz MPD_WH54_K
  s_sleep 4
  s_add_u32 s58, s58, 1
  s_cmp_lt_u32 s58, 0x100000
  s_cbranch_scc1 MPD_WH54
MPD_WH54_K:
  v_readlane_b32 s54, v163, 0
  v_readlane_b32 s56, v163, 1
  s_nop 0
  s_min_u32 s54, s54, s56
  v_readlane_b32 s56, v163, 2
  s_nop 0
  s_min_u32 s54, s54, s56
  v_readlane_b32 s56, v163, 3
  s_nop 0
  s_min_u32 s54, s54, s56
  v_readlane_b32 s56, v163, 4
  s_nop 0
  s_min_u32 s54, s54, s56
  v_readlane_b32 s56, v163, 5
  s_nop 0
  s_min_u32 s54, s54, s56
  v_readlane_b32 s56, v163, 6
  s_nop 0
  s_min_u32 s54, s54, s56
  v_readlane_b32 s56, v163, 7
  s_nop 0
  s_min_u32 s54, s54, s56
  v_readlane_b32 s56, v163, 8
  s_nop 0
  s_min_u32 s54, s54, s56
  v_readlane_b32 s56, v163, 9
  s_nop 0
  s_min_u32 s54, s54, s56
  v_readlane_b32 s56, v163, 10
  s_nop 0
  s_min_u32 s54, s54, s56
  v_readlane_b32 s56, v163, 11
  s_nop 0
  s_min_u32 s54, s54, s56
  s_nop 2
MPD_WH54_D:
  s_add_u32 m0, s32, 0
  s_add_u32 s33, s31, 0
  buffer_load_dwordx4 v7, s[4:7], s33 offen offset:0 lds
  buffer_load_dwordx4 v7, s[4:7], s33 offen offset:1024 lds
  buffer_load_dwordx4 v7, s[4:7], s33 offen offset:2048 lds
  buffer_load_dwordx4 v7, s[4:7], s33 offen offset:3072 lds
  s_add_u32 m0, s32, 4096
  s_add_u32 s33, s31, 4096
  buffer_load_dwordx4 v7, s[4:7], s33 offen offset:0 lds
  buffer_load_dwordx4 v7, s[4:7], s33 offen offset:1024 lds
  buffer_load_dwordx4 v7, s[4:7], s33 offen offset:2048 lds
  buffer_load_dwordx4 v7, s[4:7], s33 offen offset:3072 lds
  s_add_u32 m0, s32, 8192
  s_add_u32 s33, s31, 8192
  buffer_load_dwordx4 v7, s[4:7], s33 offen offset:0 lds
  buffer_load_dwordx4 v7, s[4:7], s33 offen offset:1024 lds
  buffer_load_dwordx4 v7, s[4:7], s33 offen offset:2048 lds
  buffer_load_dwordx4 v7, s[4:7], s33 offen offset:3072 lds
  s_add_u32 s31, s31, 49152
  s_add_u32 s32, s32, 49152
  s_sub_u32 s33, s32, 147456
  s_cmp_ge_u32 s32, 147456
  s_cselect_b32 s32, s33, s32
  s_add_u32 s55, s55, 1
  s_min_u32 s57, s55, 128
  s_cmp_ge_u32 s54, s57
  s_cbranch_scc1 MPD_WH55_D
  s_mov_b32 s58, 0
MPD_WH55:
  buffer_load_dword v163, v162, s[4:7], 0 offen sc1
  s_waitcnt vmcnt(0)
  v_cmp_gt_u32 vcc, s57, v163
  s_nop 3
  s_cbranch_vccz MPD_WH55_K
  s_sleep 4
  s_add_u32 s58, s58, 1
  s_cmp_lt_u32 s58, 0x100000
  s_cbranch_scc1 MPD_WH55
MPD_WH55_K:
  v_readlane_b32 s54, v163, 0
  v_readlane_b32 s56, v163, 1
  s_nop 0
  s_min_u32 s54, s54, s56
  v_readlane_b32 s56, v163, 2
  s_nop 0
  s_min_u32 s54, s54, s56
  v_readlane_b32 s56, v163, 3
  s_nop 0
  s_min_u32 s54, s54, s56
  v_readlane_b32 s56, v163, 4
  s_nop 0
  s_min_u32 s54, s54, s56
  v_readlane_b32 s56, v163, 5
  s_nop 0
  s_min_u32 s54, s54, s56
  v_readlane_b32 s56, v163, 6
  s_nop 0
  s_min_u32 s54, s54, s56
  v_readlane_b32 s56, v163, 7
  s_nop 0
  s_min_u32 s54, s54, s56
  v_readlane_b32 s56, v163, 8
  s_nop 0
  s_min_u32 s54, s54, s56
  v_readlane_b32 s56, v163, 9
  s_nop 0
  s_min_u32 s54, s54, s56
  v_readlane_b32 s56, v163, 10
  s_nop 0
  s_min_u32 s54, s54, s56
  v_readlane_b32 s56, v163, 11
  s_nop 0
  s_min_u32 s54, s54, s56
  s_nop 2
MPD_WH55_D:
  s_add_u32 m0, s32, 0
  s_add_u32 s33, s31, 0
  buffer_load_dwordx4 v7, s[4:7], s33 offen offset:0 lds
  buffer_load_dwordx4 v7, s[4:7], s33 offen offset:1024 lds
  buffer_load_dwordx4 v7, s[4:7], s33 offen offset:2048 lds
  buffer_load_dwordx4 v7, s[4:7], s33 offen offset:3072 lds
  s_add_u32 m0, s32, 4096
  s_add_u32 s33, s31, 4096
  buffer_load_dwordx4 v7, s[4:7], s33 offen offset:0 lds
  buffer_load_dwordx4 v7, s[4:7], s33 offen offset:1024 lds
  buffer_load_dwordx4 v7, s[4:7], s33 offen offset:2048 lds
  buffer_load_dwordx4 v7, s[4:7], s33 offen offset:3072 lds
  s_add_u32 m0, s32, 8192
  s_add_u32 s33, s31, 8192
  buffer_load_dwordx4 v7, s[4:7], s33 offen offset:0 lds
  buffer_load_dwordx4 v7, s[4:7], s33 offen offset:1024 lds
  buffer_load_dwordx4 v7, s[4:7], s33 offen offset:2048 lds
  buffer_load_dwordx4 v7, s[4:7], s33 offen offset:3072 lds
  s_add_u32 s31, s31, 49152
  s_add_u32 s32, s32, 49152
  s_sub_u32 s33, s32, 147456
  s_cmp_ge_u32 s32, 147456
  s_cselect_b32 s32, s33, s32
  s_mov_b32 s36, 49152
  v_mov_b32 v8, v7
  s_mov_b32 s34, 0
  s_mov_b32 s37, 0
  v_mul_u32_u24 v90, 1280, v3
  v_lshlrev_b32 v6, 3, v2
  v_add_u32 v90, v90, v6
  s_waitcnt vmcnt(12)
  s_barrier
  ds_read_b128 v[10:13], v8 offset:0
  ds_read_b128 v[14:17], v8 offset:1024
  ds_read_b128 v[18:21], v8 offset:2048
  s_add_u32 s35, s37, s29
  buffer_load_dwordx2 v[92:93], v90, s[16:19], s35 offen
  s_add_u32 s37, s37, 20480
  ds_read_b128 v[22:25], v8 offset:3072
  s_waitcnt lgkmcnt(3)
  v_mfma_f32_16x16x32_bf16 v[26:29], a[0:3], v[10:13], 0
  ds_read_b128 v[10:13], v8 offset:4096
  s_waitcnt lgkmcnt(3)
  v_mfma_f32_16x16x32_bf16 v[26:29], a[4:7], v[14:17], v[26:29]
  ds_read_b128 v[14:17], v8 offset:5120
  s_waitcnt lgkmcnt(3)
  v_mfma_f32_16x16x32_bf16 v[26:29], a[8:11], v[18:21], v[26:29]
  ds_read_b128 v[18:21], v8 offset:6144
  s_waitcnt lgkmcnt(3)
  v_mfma_f32_16x16x32_bf16 v[26:29], a[12:15], v[22:25], v[26:29]
  ds_read_b128 v[22:25], v8 offset:7168
  s_waitcnt lgkmcnt(3)
  v_mfma_f32_16x16x32_bf16 v[26:29], a[16:19], v[10:13], v[26:29]
  ds_read_b128 v[10:13], v8 offset:8192
  s_waitcnt lgkmcnt(3)
  v_mfma_f32_16x16x32_bf16 v[26:29], a[20:23], v[14:17], v[26:29]
  ds_read_b128 v[14:17], v8 offset:9216
  s_waitcnt lgkmcnt(3)
  v_mfma_f32_16x16x32_bf16 v[26:29], a[24:27], v[18:21], v[26:29]
  ds_read_b128 v[18:21], v8 offset:10240
  s_waitcnt lgkmcnt(3)
  v_mfma_f32_16x16x32_bf16 v[26:29], a[28:31], v[22:25], v[26:29]
  ds_read_b128 v[22:25], v8 offset:11264
  s_waitcnt lgkmcnt(3)
  v_mfma_f32_16x16x32_bf16 v[26:29], a[32:35], v[10:13], v[26:29]
  ds_read_b128 v[10:13], v8 offset:12288
  s_waitcnt lgkmcnt(3)
  v_mfma_f32_16x16x32_bf16 v[26:29], a[36:39], v[14:17], v[26:29]
  ds_read_b128 v[14:17], v8 offset:13312
  s_waitcnt lgkmcnt(3)
  v_mfma_f32_16x16x32_bf16 v[26:29], a[40:43], v[18:21], v[26:29]
  ds_read_b128 v[18:21], v8 offset:14336
  s_waitcnt lgkmcnt(3)
  v_mfma_f32_16x16x32_bf16 v[26:29], a[44:47], v[22:25], v[26:29]
  ds_read_b128 v[22:25], v8 offset:15360
  s_waitcnt lgkmcnt(3)
  v_mfma_f32_16x16x32_bf16 v[26:29], a[48:51], v[10:13], v[26:29]
  ds_read_b128 v[10:13], v8 offset:16384
  s_waitcnt lgkmcnt(3)
  v_mfma_f32_16x16x32_bf16 v[26:29], a[52:55], v[14:17], v[26:29]
  ds_read_b128 v[14:17], v8 offset:17408
  s_waitcnt lgkmcnt(3)
  v_mfma_f32_16x16x32_bf16 v[26:29], a[56:59], v[18:21], v[26:29]
  ds_read_b128 v[18:21], v8 offset:18432
  s_waitcnt lgkmcnt(3)
  v_mfma_f32_16x16x32_bf16 v[26:29], a[60:63], v[22:25], v[26:29]
  ds_read_b128 v[22:25], v8 offset:19456
  s_waitcnt lgkmcnt(3)
  v_mfma_f32_16x16x32_bf16 v[26:29], a[64:67], v[10:13], v[26:29]
  ds_read_b128 v[10:13], v8 offset:20480
  s_waitcnt lgkmcnt(3)
  v_mfma_f32_16x16x32_bf16 v[26:29], a[68:71], v[14:17], v[26:29]
  ds_read_b128 v[14:17], v8 offset:21504
  s_waitcnt lgkmcnt(3)
  v_mfma_f32_16x16x32_bf16 v[26:29], a[72:75], v[18:21], v[26:29]
  ds_read_b128 v[18:21], v8 offset:22528
  s_waitcnt lgkmcnt(3)
  v_mfma_f32_16x16x32_bf16 v[26:29], a[76:79], v[22:25], v[26:29]
  ds_read_b128 v[22:25], v8 offset:23552
  s_waitcnt lgkmcnt(3)
  v_mfma_f32_16x16x32_bf16 v[26:29], a[80:83], v[10:13], v[26:29]
  ds_read_b128 v[10:13], v8 offset:24576
  s_waitcnt lgkmcnt(3)
  v_mfma_f32_16x16x32_bf16 v[26:29], a[84:87], v[14:17], v[26:29]
  ds_read_b128 v[14:17], v8 offset:25600
  s_waitcnt lgkmcnt(3)
  v_mfma_f32_16x16x32_bf16 v[26:29], a[88:91], v[18:21], v[26:29]
  ds_read_b128 v[18:21], v8 offset:26624
  s_waitcnt lgkmcnt(3)
  v_mfma_f32_16x16x32_bf16 v[26:29], a[92:95], v[22:25], v[26:29]
  ds_read_b128 v[22:25], v8 offset:27648
  s_waitcnt lgkmcnt(3)
  v_mfma_f32_16x16x32_bf16 v[26:29], a[96:99], v[10:13], v[26:29]
  ds_read_b128 v[10:13], v8 offset:28672
  s_waitcnt lgkmcnt(3)
  v_mfma_f32_16x16x32_bf16 v[26:29], a[100:103], v[14:17], v[26:29]
  ds_read_b128 v[14:17], v8 offset:29696
  s_waitcnt lgkmcnt(3)
  v_mfma_f32_16x16x32_bf16 v[26:29], a[104:107], v[18:21], v[26:29]
  ds_read_b128 v[18:21], v8 offset:30720
  s_waitcnt lgkmcnt(3)
  v_mfma_f32_16x16x32_bf16 v[26:29], a[108:111], v[22:25], v[26:29]
  ds_read_b128 v[22:25], v8 offset:31744
  s_waitcnt lgkmcnt(3)
  v_mfma_f32_16x16x32_bf16 v[26:29], a[112:115], v[10:13], v[26:29]
  ds_read_b128 v[10:13], v8 offset:32768
  s_waitcnt lgkmcnt(3)
  v_mfma_f32_16x16x32_bf16 v[26:29], a[116:119], v[14:17], v[26:29]
  ds_read_b128 v[14:17], v8 offset:33792
  s_waitcnt lgkmcnt(3)
  v_mfma_f32_16x16x32_bf16 v[26:29], a[120:123], v[18:21], v[26:29]
  ds_read_b128 v[18:21], v8 offset:34816
  s_waitcnt lgkmcnt(3)
  v_mfma_f32_16x16x32_bf16 v[26:29], a[124:127], v[22:25], v[26:29]
  ds_read_b128 v[22:25], v8 offset:35840
  s_waitcnt lgkmcnt(3)
  v_mfma_f32_16x16x32_bf16 v[26:29], a[128:131], v[10:13], v[26:29]
  ds_read_b128 v[10:13], v8 offset:36864
  s_waitcnt lgkmcnt(3)
  v_mfma_f32_16x16x32_bf16 v[26:29], a[132:135], v[14:17], v[26:29]
  ds_read_b128 v[14:17], v8 offset:37888
  s_waitcnt lgkmcnt(3)
  v_mfma_f32_16x16x32_bf16 v[26:29], a[136:139], v[18:21], v[26:29]
  ds_read_b128 v[18:21], v8 offset:38912
  s_waitcnt lgkmcnt(3)
  v_mfma_f32_16x16x32_bf16 v[26:29], a[140:143], v[22:25], v[26:29]
  ds_read_b128 v[22:25], v8 offset:39936
  s_waitcnt lgkmcnt(3)
  v_mfma_f32_16x16x32_bf16 v[26:29], a[144:147], v[10:13], v[26:29]
  ds_read_b128 v[10:13], v8 offset:40960
  s_waitcnt lgkmcnt(3)
  v_mfma_f32_16x16x32_bf16 v[26:29], a[148:151], v[14:17], v[26:29]
  ds_read_b128 v[14:17], v8 offset:41984
  s_waitcnt lgkmcnt(3)
  v_mfma_f32_16x16x32_bf16 v[26:29], a[152:155], v[18:21], v[26:29]
  ds_read_b128 v[18:21], v8 offset:43008
  s_waitcnt lgkmcnt(3)
  v_mfma_f32_16x16x32_bf16 v[26:29], a[156:159], v[22:25], v[26:29]
  ds_read_b128 v[22:25], v8 offset:44032
  s_waitcnt lgkmcnt(3)
  v_mfma_f32_16x16x32_bf16 v[26:29], a[160:163], v[10:13], v[26:29]
  ds_read_b128 v[10:13], v8 offset:45056
  s_waitcnt lgkmcnt(3)
  v_mfma_f32_16x16x32_bf16 v[26:29], a[164:167], v[14:17], v[26:29]
  ds_read_b128 v[14:17], v8 offset:46080
  s_waitcnt lgkmcnt(3)
  v_mfma_f32_16x16x32_bf16 v[26:29], a[168:171], v[18:21], v[26:29]
  ds_read_b128 v[18:21], v8 offset:47104
  s_waitcnt lgkmcnt(3)
  v_mfma_f32_16x16x32_bf16 v[26:29], a[172:175], v[22:25], v[26:29]
  ds_read_b128 v[22:25], v8 offset:48128
  s_waitcnt lgkmcnt(3)
  v_mfma_f32_16x16x32_bf16 v[26:29], a[176:179], v[10:13], v[26:29]
  s_waitcnt vmcnt(1)
  s_barrier
  v_add_u32 v9, s36, v7
  s_add_u32 s36, s36, 49152
  s_cmp_ge_u32 s36, 147456
  s_cselect_b32 s36, 0, s36
  s_add_u32 s55, s55, 1
  s_min_u32 s57, s55, 128
  s_cmp_ge_u32 s54, s57
  s_cbranch_scc1 MPD_WH56_D
  s_mov_b32 s58, 0
MPD_WH56:
  buffer_load_dword v163, v162, s[4:7], 0 offen sc1
  s_waitcnt vmcnt(0)
  v_cmp_gt_u32 vcc, s57, v163
  s_nop 3
  s_cbranch_vccz MPD_WH56_K
  s_sleep 4
  s_add_u32 s58, s58, 1
  s_cmp_lt_u32 s58, 0x100000
  s_cbranch_scc1 MPD_WH56
MPD_WH56_K:
  v_readlane_b32 s54, v163, 0
  v_readlane_b32 s56, v163, 1
  s_nop 0
  s_min_u32 s54, s54, s56
  v_readlane_b32 s56, v163, 2
  s_nop 0
  s_min_u32 s54, s54, s56
  v_readlane_b32 s56, v163, 3
  s_nop 0
  s_min_u32 s54, s54, s56
  v_readlane_b32 s56, v163, 4
  s_nop 0
  s_min_u32 s54, s54, s56
  v_readlane_b32 s56, v163, 5
  s_nop 0
  s_min_u32 s54, s54, s56
  v_readlane_b32 s56, v163, 6
  s_nop 0
  s_min_u32 s54, s54, s56
  v_readlane_b32 s56, v163, 7
  s_nop 0
  s_min_u32 s54, s54, s56
  v_readlane_b32 s56, v163, 8
  s_nop 0
  s_min_u32 s54, s54, s56
  v_readlane_b32 s56, v163, 9
  s_nop 0
  s_min_u32 s54, s54, s56
  v_readlane_b32 s56, v163, 10
  s_nop 0
  s_min_u32 s54, s54, s56
  v_readlane_b32 s56, v163, 11
  s_nop 0
  s_min_u32 s54, s54, s56
  s_nop 2
MPD_WH56_D:
  s_add_u32 m0, s32, 0
  s_add_u32 s33, s31, 0
  buffer_load_dwordx4 v7, s[4:7], s33 offen offset:0 lds
  buffer_load_dwordx4 v7, s[4:7], s33 offen offset:1024 lds
  buffer_load_dwordx4 v7, s[4:7], s33 offen offset:2048 lds
  buffer_load_dwordx4 v7, s[4:7], s33 offen offset:3072 lds
  s_add_u32 m0, s32, 4096
  s_add_u32 s33, s31, 4096
  buffer_load_dwordx4 v7, s[4:7], s33 offen offset:0 lds
  buffer_load_dwordx4 v7, s[4:7], s33 offen offset:1024 lds
  buffer_load_dwordx4 v7, s[4:7], s33 offen offset:2048 lds
  buffer_load_dwordx4 v7, s[4:7], s33 offen offset:3072 lds
  s_add_u32 m0, s32, 8192
  s_add_u32 s33, s31, 8192
  buffer_load_dwordx4 v7, s[4:7], s33 offen offset:0 lds
  buffer_load_dwordx4 v7, s[4:7], s33 offen offset:1024 lds
  buffer_load_dwordx4 v7, s[4:7], s33 offen offset:2048 lds
  buffer_load_dwordx4 v7, s[4:7], s33 offen offset:3072 lds
  s_add_u32 s31, s31, 49152
  s_add_u32 s32, s32, 49152
  s_sub_u32 s33, s32, 147456
  s_cmp_ge_u32 s32, 147456
  s_cselect_b32 s32, s33, s32
  s_cmp_lg_u32 s20, 0
  s_cbranch_scc1 MPD_NP57
  v_mov_b32 v160, s53
  s_mov_b64 exec, 1
  buffer_store_dword v160, v161, s[4:7], s52 offen sc1
  s_mov_b64 exec, -1
MPD_NP57:
  ds_read_b128 v[10:13], v9 offset:0
  s_waitcnt lgkmcnt(3)
  v_mfma_f32_16x16x32_bf16 v[26:29], a[180:183], v[14:17], v[26:29]
  ds_read_b128 v[14:17], v9 offset:1024
  s_waitcnt lgkmcnt(3)
  v_mfma_f32_16x16x32_bf16 v[26:29], a[184:187], v[18:21], v[26:29]
  ds_read_b128 v[18:21], v9 offset:2048
  s_waitcnt lgkmcnt(3)
  v_mfma_f32_16x16x32_bf16 v[26:29], a[188:191], v[22:25], v[26:29]
  s_add_u32 s35, s37, s29
  buffer_load_dwordx2 v[94:95], v90, s[16:19], s35 offen
  s_add_u32 s37, s37, 20480
  ds_read_b128 v[22:25], v9 offset:3072
  s_waitcnt lgkmcnt(3)
  v_mfma_f32_16x16x32_bf16 v[42:45], a[0:3], v[10:13], 0
  ds_read_b128 v[10:13], v9 offset:4096
  s_waitcnt lgkmcnt(3)
  v_mfma_f32_16x16x32_bf16 v[42:45], a[4:7], v[14:17], v[42:45]
  ds_read_b128 v[14:17], v9 offset:5120
  s_waitcnt lgkmcnt(3)
  v_mfma_f32_16x16x32_bf16 v[42:45], a[8:11], v[18:21], v[42:45]
  s_waitcnt vmcnt(13)
  ds_read_b128 v[18:21], v9 offset:6144
  s_waitcnt lgkmcnt(3)
  v_mfma_f32_16x16x32_bf16 v[42:45], a[12:15], v[22:25], v[42:45]
  v_lshlrev_b32 v58, 16, v92
  ds_read_b128 v[22:25], v9 offset:7168
  s_waitcnt lgkmcnt(3)
  v_mfma_f32_16x16x32_bf16 v[42:45], a[16:19], v[10:13], v[42:45]
  v_and_b32 v59, 0xffff0000, v92
  ds_read_b128 v[10:13], v9 offset:8192
  s_waitcnt lgkmcnt(3)
  v_mfma_f32_16x16x32_bf16 v[42:45], a[20:23], v[14:17], v[42:45]
  v_lshlrev_b32 v60, 16, v93
  ds_read_b128 v[14:17], v9 offset:9216
  s_waitcnt lgkmcnt(3)
  v_mfma_f32_16x16x32_bf16 v[42:45], a[24:27], v[18:21], v[42:45]
  v_and_b32 v61, 0xffff0000, v93
  ds_read_b128 v[18:21], v9 offset:10240
  s_waitcnt lgkmcnt(3)
  v_mfma_f32_16x16x32_bf16 v[42:45], a[28:31], v[22:25], v[42:45]
  v_add_f32 v58, v58, v26
  ds_read_b128 v[22:25], v9 offset:11264
  s_waitcnt lgkmcnt(3)
  v_mfma_f32_16x16x32_bf16 v[42:45], a[32:35], v[10:13], v[42:45]
  v_add_f32 v59, v59, v27
  ds_read_b128 v[10:13], v9 offset:12288
  s_waitcnt lgkmcnt(3)
  v_mfma_f32_16x16x32_bf16 v[42:45], a[36:39], v[14:17], v[42:45]
  v_add_f32 v60, v60, v28
  ds_read_b128 v[14:17], v9 offset:13312
  s_waitcnt lgkmcnt(3)
  v_mfma_f32_16x16x32_bf16 v[42:45], a[40:43], v[18:21], v[42:45]
  v_add_f32 v61, v61, v29
  ds_read_b128 v[18:21], v9 offset:14336
  s_waitcnt lgkmcnt(3)
  v_mfma_f32_16x16x32_bf16 v[42:45], a[44:47], v[22:25], v[42:45]
  s_add_u32 s35, s34, s28
  ds_read_b128 v[22:25], v9 offset:15360
  s_waitcnt lgkmcnt(3)
  v_mfma_f32_16x16x32_bf16 v[42:45], a[48:51], v[10:13], v[42:45]
  buffer_store_dwordx4 v[58:61], v7, s[4:7], s35 offen sc1
  ds_read_b128 v[10:13], v9 offset:16384
  s_waitcnt lgkmcnt(3)
  v_mfma_f32_16x16x32_bf16 v[42:45], a[52:55], v[14:17], v[42:45]
  s_add_u32 s34, s34, 1024
  ds_read_b128 v[14:17], v9 offset:17408
  s_waitcnt lgkmcnt(3)
  v_mfma_f32_16x16x32_bf16 v[42:45], a[56:59], v[18:21], v[42:45]
  ds_read_b128 v[18:21], v9 offset:18432
  s_waitcnt lgkmcnt(3)
  v_mfma_f32_16x16x32_bf16 v[42:45], a[60:63], v[22:25], v[42:45]
  ds_read_b128 v[22:25], v9 offset:19456
  s_waitcnt lgkmcnt(3)
  v_mfma_f32_16x16x32_bf16 v[42:45], a[64:67], v[10:13], v[42:45]
  ds_read_b128 v[10:13], v9 offset:20480
  s_waitcnt lgkmcnt(3)
  v_mfma_f32_16x16x32_bf16 v[42:45], a[68:71], v[14:17], v[42:45]
  ds_read_b128 v[14:17], v9 offset:21504
  s_waitcnt lgkmcnt(3)
  v_mfma_f32_16x16x32_bf16 v[42:45], a[72:75], v[18:21], v[42:45]
  ds_read_b128 v[18:21], v9 offset:22528
  s_waitcnt lgkmcnt(3)
  v_mfma_f32_16x16x32_bf16 v[42:45], a[76:79], v[22:25], v[42:45]
  ds_read_b128 v[22:25], v9 offset:23552
  s_waitcnt lgkmcnt(3)
  v_mfma_f32_16x16x32_bf16 v[42:45], a[80:83], v[10:13], v[42:45]
  ds_read_b128 v[10:13], v9 offset:24576
  s_waitcnt lgkmcnt(3)
  v_mfma_f32_16x16x32_bf16 v[42:45], a[84:87], v[14:17], v[42:45]
  ds_read_b128 v[14:17], v9 offset:25600
  s_waitcnt lgkmcnt(3)
  v_mfma_f32_16x16x32_bf16 v[42:45], a[88:91], v[18:21], v[42:45]
  ds_read_b128 v[18:21], v9 offset:26624
  s_waitcnt lgkmcnt(3)
  v_mfma_f32_16x16x32_bf16 v[42:45], a[92:95], v[22:25], v[42:45]
  ds_read_b128 v[22:25], v9 offset:27648
  s_waitcnt lgkmcnt(3)
  v_mfma_f32_16x16x32_bf16 v[42:45], a[96:99], v[10:13], v[42:45]
  ds_read_b128 v[10:13], v9 offset:28672
  s_waitcnt lgkmcnt(3)
  v_mfma_f32_16x16x32_bf16 v[42:45], a[100:103], v[14:17], v[42:45]
  ds_read_b128 v[14:17], v9 offset:29696
  s_waitcnt lgkmcnt(3)
  v_mfma_f32_16x16x32_bf16 v[42:45], a[104:107], v[18:21], v[42:45]
  ds_read_b128 v[18:21], v9 offset:30720
  s_waitcnt lgkmcnt(3)
  v_mfma_f32_16x16x32_bf16 v[42:45], a[108:111], v[22:25], v[42:45]
  ds_read_b128 v[22:25], v9 offset:31744
  s_waitcnt lgkmcnt(3)
  v_mfma_f32_16x16x32_bf16 v[42:45], a[112:115], v[10:13], v[42:45]
  ds_read_b128 v[10:13], v9 offset:32768
  s_waitcnt lgkmcnt(3)
  v_mfma_f32_16x16x32_bf16 v[42:45], a[116:119], v[14:17], v[42:45]
  ds_read_b128 v[14:17], v9 offset:33792
  s_waitcnt lgkmcnt(3)
  v_mfma_f32_16x16x32_bf16 v[42:45], a[120:123], v[18:21], v[42:45]
  ds_read_b128 v[18:21], v9 offset:34816
  s_waitcnt lgkmcnt(3)
  v_mfma_f32_16x16x32_bf16 v[42:45], a[124:127], v[22:25], v[42:45]
  ds_read_b128 v[22:25], v9 offset:35840
  s_waitcnt lgkmcnt(3)
  v_mfma_f32_16x16x32_bf16 v[42:45], a[128:131], v[10:13], v[42:45]
  ds_read_b128 v[10:13], v9 offset:36864
  s_waitcnt lgkmcnt(3)
  v_mfma_f32_16x16x32_bf16 v[42:45], a[132:135], v[14:17], v[42:45]
  ds_read_b128 v[14:17], v9 offset:37888
  s_waitcnt lgkmcnt(3)
  v_mfma_f32_16x16x32_bf16 v[42:45], a[136:139], v[18:21], v[42:45]
  ds_read_b128 v[18:21], v9 offset:38912
  s_waitcnt lgkmcnt(3)
  v_mfma_f32_16x16x32_bf16 v[42:45], a[140:143], v[22:25], v[42:45]
  ds_read_b128 v[22:25], v9 offset:39936
  s_waitcnt lgkmcnt(3)
  v_mfma_f32_16x16x32_bf16 v[42:45], a[144:147], v[10:13], v[42:45]
  ds_read_b128 v[10:13], v9 offset:40960
  s_waitcnt lgkmcnt(3)
  v_mfma_f32_16x16x32_bf16 v[42:45], a[148:151], v[14:17], v[42:45]
  ds_read_b128 v[14:17], v9 offset:41984
  s_waitcnt lgkmcnt(3)
  v_mfma_f32_16x16x32_bf16 v[42:45], a[152:155], v[18:21], v[42:45]
  ds_read_b128 v[18:21], v9 offset:43008
  s_waitcnt lgkmcnt(3)
  v_mfma_f32_16x16x32_bf16 v[42:45], a[156:159], v[22:25], v[42:45]
  ds_read_b128 v[22:25], v9 offset:44032
  s_waitcnt lgkmcnt(3)
  v_mfma_f32_16x16x32_bf16 v[42:45], a[160:163], v[10:13], v[42:45]
  ds_read_b128 v[10:13], v9 offset:45056
  s_waitcnt lgkmcnt(3)
  v_mfma_f32_16x16x32_bf16 v[42:45], a[164:167], v[14:17], v[42:45]
  ds_read_b128 v[14:17], v9 offset:46080
  s_waitcnt lgkmcnt(3)
  v_mfma_f32_16x16x32_bf16 v[42:45], a[168:171], v[18:21], v[42:45]
  ds_read_b128 v[18:21], v9 offset:47104
  s_waitcnt lgkmcnt(3)
  v_mfma_f32_16x16x32_bf16 v[42:45], a[172:175], v[22:25], v[42:45]
  ds_read_b128 v[22:25], v9 offset:48128
  s_waitcnt lgkmcnt(3)
  v_mfma_f32_16x16x32_bf16 v[42:45], a[176:179], v[10:13], v[42:45]
  s_cmp_eq_u32 s20, 0
  s_nop 5
  s_cbranch_scc1 MPD_SW58
  s_waitcnt vmcnt(2)
  s_branch MPD_SX58
MPD_SW58:
  s_waitcnt vmcnt(3)
MPD_SX58:
  s_barrier
  v_add_u32 v8, s36, v7
  s_add_u32 s36, s36, 49152
  s_cmp_ge_u32 s36, 147456
  s_cselect_b32 s36, 0, s36
  s_add_u32 s55, s55, 1
  s_min_u32 s57, s55, 128
  s_cmp_ge_u32 s54, s57
  s_cbranch_scc1 MPD_WH59_D
  s_mov_b32 s58, 0
MPD_WH59:
  buffer_load_dword v163, v162, s[4:7], 0 offen sc1
  s_waitcnt vmcnt(0)
  v_cmp_gt_u32 vcc, s57, v163
  s_nop 3
  s_cbranch_vccz MPD_WH59_K
  s_sleep 4
  s_add_u32 s58, s58, 1
  s_cmp_lt_u32 s58, 0x100000
  s_cbranch_scc1 MPD_WH59
MPD_WH59_K:
  v_readlane_b32 s54, v163, 0
  v_readlane_b32 s56, v163, 1
  s_nop 0
  s_min_u32 s54, s54, s56
  v_readlane_b32 s56, v163, 2
  s_nop 0
  s_min_u32 s54, s54, s56
  v_readlane_b32 s56, v163, 3
  s_nop 0
  s_min_u32 s54, s54, s56
  v_readlane_b32 s56, v163, 4
  s_nop 0
  s_min_u32 s54, s54, s56
  v_readlane_b32 s56, v163, 5
  s_nop 0
  s_min_u32 s54, s54, s56
  v_readlane_b32 s56, v163, 6
  s_nop 0
  s_min_u32 s54, s54, s56
  v_readlane_b32 s56, v163, 7
  s_nop 0
  s_min_u32 s54, s54, s56
  v_readlane_b32 s56, v163, 8
  s_nop 0
  s_min_u32 s54, s54, s56
  v_readlane_b32 s56, v163, 9
  s_nop 0
  s_min_u32 s54, s54, s56
  v_readlane_b32 s56, v163, 10
  s_nop 0
  s_min_u32 s54, s54, s56
  v_readlane_b32 s56, v163, 11
  s_nop 0
  s_min_u32 s54, s54, s56
  s_nop 2
MPD_WH59_D:
  s_add_u32 m0, s32, 0
  s_add_u32 s33, s31, 0
  buffer_load_dwordx4 v7, s[4:7], s33 offen offset:0 lds
  buffer_load_dwordx4 v7, s[4:7], s33 offen offset:1024 lds
  buffer_load_dwordx4 v7, s[4:7], s33 offen offset:2048 lds
  buffer_load_dwordx4 v7, s[4:7], s33 offen offset:3072 lds
  s_add_u32 m0, s32, 4096
  s_add_u32 s33, s31, 4096
  buffer_load_dwordx4 v7, s[4:7], s33 offen offset:0 lds
  buffer_load_dwordx4 v7, s[4:7], s33 offen offset:1024 lds
  buffer_load_dwordx4 v7, s[4:7], s33 offen offset:2048 lds
  buffer_load_dwordx4 v7, s[4:7], s33 offen offset:3072 lds
  s_add_u32 m0, s32, 8192
  s_add_u32 s33, s31, 8192
  buffer_load_dwordx4 v7, s[4:7], s33 offen offset:0 lds
  buffer_load_dwordx4 v7, s[4:7], s33 offen offset:1024 lds
  buffer_load_dwordx4 v7, s[4:7], s33 offen offset:2048 lds
  buffer_load_dwordx4 v7, s[4:7], s33 offen offset:3072 lds
  s_add_u32 s31, s31, 49152
  s_add_u32 s32, s32, 49152
  s_sub_u32 s33, s32, 147456
  s_cmp_ge_u32 s32, 147456
  s_cselect_b32 s32, s33, s32
  s_cmp_lg_u32 s20, 0
  s_cbranch_scc1 MPD_NP60
  v_mov_b32 v160, s53
  s_mov_b64 exec, 1
  buffer_store_dword v160, v161, s[4:7], s52 offen sc1
  s_mov_b64 exec, -1
MPD_NP60:
  s_add_u32 s53, s53, 1
  ds_read_b128 v[10:13], v8 offset:0
  s_waitcnt lgkmcnt(3)
  v_mfma_f32_16x16x32_bf16 v[42:45], a[180:183], v[14:17], v[42:45]
  ds_read_b128 v[14:17], v8 offset:1024
  s_waitcnt lgkmcnt(3)
  v_mfma_f32_16x16x32_bf16 v[42:45], a[184:187], v[18:21], v[42:45]
  ds_read_b128 v[18:21], v8 offset:2048
  s_waitcnt lgkmcnt(3)
  v_mfma_f32_16x16x32_bf16 v[42:45], a[188:191], v[22:25], v[42:45]
  s_add_u32 s35, s37, s29
  buffer_load_dwordx2 v[92:93], v90, s[16:19], s35 offen
  s_add_u32 s37, s37, 20480
  ds_read_b128 v[22:25], v8 offset:3072
  s_waitcnt lgkmcnt(3)
  v_mfma_f32_16x16x32_bf16 v[26:29], a[0:3], v[10:13], 0
  ds_read_b128 v[10:13], v8 offset:4096
  s_waitcnt lgkmcnt(3)
  v_mfma_f32_16x16x32_bf16 v[26:29], a[4:7], v[14:17], v[26:29]
  ds_read_b128 v[14:17], v8 offset:5120
  s_waitcnt lgkmcnt(3)
  v_mfma_f32_16x16x32_bf16 v[26:29], a[8:11], v[18:21], v[26:29]
  s_waitcnt vmcnt(13)
  ds_read_b128 v[18:21], v8 offset:6144
  s_waitcnt lgkmcnt(3)
  v_mfma_f32_16x16x32_bf16 v[26:29], a[12:15], v[22:25], v[26:29]
  v_lshlrev_b32 v58, 16, v94
  ds_read_b128 v[22:25], v8 offset:7168
  s_waitcnt lgkmcnt(3)
  v_mfma_f32_16x16x32_bf16 v[26:29], a[16:19], v[10:13], v[26:29]
  v_and_b32 v59, 0xffff0000, v94
  ds_read_b128 v[10:13], v8 offset:8192
  s_waitcnt lgkmcnt(3)
  v_mfma_f32_16x16x32_bf16 v[26:29], a[20:23], v[14:17], v[26:29]
  v_lshlrev_b32 v60, 16, v95
  ds_read_b128 v[14:17], v8 offset:9216
  s_waitcnt lgkmcnt(3)
  v_mfma_f32_16x16x32_bf16 v[26:29], a[24:27], v[18:21], v[26:29]
  v_and_b32 v61, 0xffff0000, v95
  ds_read_b128 v[18:21], v8 offset:10240
  s_waitcnt lgkmcnt(3)
  v_mfma_f32_16x16x32_bf16 v[26:29], a[28:31], v[22:25], v[26:29]
  v_add_f32 v58, v58, v42
  ds_read_b128 v[22:25], v8 offset:11264
  s_waitcnt lgkmcnt(3)
  v_mfma_f32_16x16x32_bf16 v[26:29], a[32:35], v[10:13], v[26:29]
  v_add_f32 v59, v59, v43
  ds_read_b128 v[10:13], v8 offset:12288
  s_waitcnt lgkmcnt(3)
  v_mfma_f32_16x16x32_bf16 v[26:29], a[36:39], v[14:17], v[26:29]
  v_add_f32 v60, v60, v44
  ds_read_b128 v[14:17], v8 offset:13312
  s_waitcnt lgkmcnt(3)
  v_mfma_f32_16x16x32_bf16 v[26:29], a[40:43], v[18:21], v[26:29]
  v_add_f32 v61, v61, v45
  ds_read_b128 v[18:21], v8 offset:14336
  s_waitcnt lgkmcnt(3)
  v_mfma_f32_16x16x32_bf16 v[26:29], a[44:47], v[22:25], v[26:29]
  s_add_u32 s35, s34, s28
  ds_read_b128 v[22:25], v8 offset:15360
  s_waitcnt lgkmcnt(3)
  v_mfma_f32_16x16x32_bf16 v[26:29], a[48:51], v[10:13], v[26:29]
  buffer_store_dwordx4 v[58:61], v7, s[4:7], s35 offen sc1
  ds_read_b128 v[10:13], v8 offset:16384
  s_waitcnt lgkmcnt(3)
  v_mfma_f32_16x16x32_bf16 v[26:29], a[52:55], v[14:17], v[26:29]
  s_add_u32 s34, s34, 80896
  ds_read_b128 v[14:17], v8 offset:17408
  s_waitcnt lgkmcnt(3)
  v_mfma_f32_16x16x32_bf16 v[26:29], a[56:59], v[18:21], v[26:29]
  ds_read_b128 v[18:21], v8 offset:18432
  s_waitcnt lgkmcnt(3)
  v_mfma_f32_16x16x32_bf16 v[26:29], a[60:63], v[22:25], v[26:29]
  ds_read_b128 v[22:25], v8 offset:19456
  s_waitcnt lgkmcnt(3)
  v_mfma_f32_16x16x32_bf16 v[26:29], a[64:67], v[10:13], v[26:29]
  ds_read_b128 v[10:13], v8 offset:20480
  s_waitcnt lgkmcnt(3)
  v_mfma_f32_16x16x32_bf16 v[26:29], a[68:71], v[14:17], v[26:29]
  ds_read_b128 v[14:17], v8 offset:21504
  s_waitcnt lgkmcnt(3)
  v_mfma_f32_16x16x32_bf16 v[26:29], a[72:75], v[18:21], v[26:29]
  ds_read_b128 v[18:21], v8 offset:22528
  s_waitcnt lgkmcnt(3)
  v_mfma_f32_16x16x32_bf16 v[26:29], a[76:79], v[22:25], v[26:29]
  ds_read_b128 v[22:25], v8 offset:23552
  s_waitcnt lgkmcnt(3)
  v_mfma_f32_16x16x32_bf16 v[26:29], a[80:83], v[10:13], v[26:29]
  ds_read_b128 v[10:13], v8 offset:24576
  s_waitcnt lgkmcnt(3)
  v_mfma_f32_16x16x32_bf16 v[26:29], a[84:87], v[14:17], v[26:29]
  ds_read_b128 v[14:17], v8 offset:25600
  s_waitcnt lgkmcnt(3)
  v_mfma_f32_16x16x32_bf16 v[26:29], a[88:91], v[18:21], v[26:29]
  ds_read_b128 v[18:21], v8 offset:26624
  s_waitcnt lgkmcnt(3)
  v_mfma_f32_16x16x32_bf16 v[26:29], a[92:95], v[22:25], v[26:29]
  ds_read_b128 v[22:25], v8 offset:27648
  s_waitcnt lgkmcnt(3)
  v_mfma_f32_16x16x32_bf16 v[26:29], a[96:99], v[10:13], v[26:29]
  ds_read_b128 v[10:13], v8 offset:28672
  s_waitcnt lgkmcnt(3)
  v_mfma_f32_16x16x32_bf16 v[26:29], a[100:103], v[14:17], v[26:29]
  ds_read_b128 v[14:17], v8 offset:29696
  s_waitcnt lgkmcnt(3)
  v_mfma_f32_16x16x32_bf16 v[26:29], a[104:107], v[18:21], v[26:29]
  ds_read_b128 v[18:21], v8 offset:30720
  s_waitcnt lgkmcnt(3)
  v_mfma_f32_16x16x32_bf16 v[26:29], a[108:111], v[22:25], v[26:29]
  ds_read_b128 v[22:25], v8 offset:31744
  s_waitcnt lgkmcnt(3)
  v_mfma_f32_16x16x32_bf16 v[26:29], a[112:115], v[10:13], v[26:29]
  ds_read_b128 v[10:13], v8 offset:32768
  s_waitcnt lgkmcnt(3)
  v_mfma_f32_16x16x32_bf16 v[26:29], a[116:119], v[14:17], v[26:29]
  ds_read_b128 v[14:17], v8 offset:33792
  s_waitcnt lgkmcnt(3)
  v_mfma_f32_16x16x32_bf16 v[26:29], a[120:123], v[18:21], v[26:29]
  ds_read_b128 v[18:21], v8 offset:34816
  s_waitcnt lgkmcnt(3)
  v_mfma_f32_16x16x32_bf16 v[26:29], a[124:127], v[22:25], v[26:29]
  ds_read_b128 v[22:25], v8 offset:35840
  s_waitcnt lgkmcnt(3)
  v_mfma_f32_16x16x32_bf16 v[26:29], a[128:131], v[10:13], v[26:29]
  ds_read_b128 v[10:13], v8 offset:36864
  s_waitcnt lgkmcnt(3)
  v_mfma_f32_16x16x32_bf16 v[26:29], a[132:135], v[14:17], v[26:29]
  ds_read_b128 v[14:17], v8 offset:37888
  s_waitcnt lgkmcnt(3)
  v_mfma_f32_16x16x32_bf16 v[26:29], a[136:139], v[18:21], v[26:29]
  ds_read_b128 v[18:21], v8 offset:38912
  s_waitcnt lgkmcnt(3)
  v_mfma_f32_16x16x32_bf16 v[26:29], a[140:143], v[22:25], v[26:29]
  ds_read_b128 v[22:25], v8 offset:39936
  s_waitcnt lgkmcnt(3)
  v_mfma_f32_16x16x32_bf16 v[26:29], a[144:147], v[10:13], v[26:29]
  ds_read_b128 v[10:13], v8 offset:40960
  s_waitcnt lgkmcnt(3)
  v_mfma_f32_16x16x32_bf16 v[26:29], a[148:151], v[14:17], v[26:29]
  ds_read_b128 v[14:17], v8 offset:41984
  s_waitcnt lgkmcnt(3)
  v_mfma_f32_16x16x32_bf16 v[26:29], a[152:155], v[18:21], v[26:29]
  ds_read_b128 v[18:21], v8 offset:43008
  s_waitcnt lgkmcnt(3)
  v_mfma_f32_16x16x32_bf16 v[26:29], a[156:159], v[22:25], v[26:29]
  ds_read_b128 v[22:25], v8 offset:44032
  s_waitcnt lgkmcnt(3)
  v_mfma_f32_16x16x32_bf16 v[26:29], a[160:163], v[10:13], v[26:29]
  ds_read_b128 v[10:13], v8 offset:45056
  s_waitcnt lgkmcnt(3)
  v_mfma_f32_16x16x32_bf16 v[26:29], a[164:167], v[14:17], v[26:29]
  ds_read_b128 v[14:17], v8 offset:46080
  s_waitcnt lgkmcnt(3)
  v_mfma_f32_16x16x32_bf16 v[26:29], a[168:171], v[18:21], v[26:29]
  ds_read_b128 v[18:21], v8 offset:47104
  s_waitcnt lgkmcnt(3)
  v_mfma_f32_16x16x32_bf16 v[26:29], a[172:175], v[22:25], v[26:29]
  ds_read_b128 v[22:25], v8 offset:48128
  s_waitcnt lgkmcnt(3)
  v_mfma_f32_16x16x32_bf16 v[26:29], a[176:179], v[10:13], v[26:29]
  s_cmp_eq_u32 s20, 0
  s_nop 5
  s_cbranch_scc1 MPD_SW61
  s_waitcnt vmcnt(2)
  s_branch MPD_SX61
MPD_SW61:
  s_waitcnt vmcnt(3)
MPD_SX61:
  s_barrier
  v_add_u32 v9, s36, v7
  s_add_u32 s36, s36, 49152
  s_cmp_ge_u32 s36, 147456
  s_cselect_b32 s36, 0, s36
  s_add_u32 s55, s55, 1
  s_min_u32 s57, s55, 128
  s_cmp_ge_u32 s54, s57
  s_cbranch_scc1 MPD_WH62_D
  s_mov_b32 s58, 0
MPD_WH62:
  buffer_load_dword v163, v162, s[4:7], 0 offen sc1
  s_waitcnt vmcnt(0)
  v_cmp_gt_u32 vcc, s57, v163
  s_nop 3
  s_cbranch_vccz MPD_WH62_K
  s_sleep 4
  s_add_u32 s58, s58, 1
  s_cmp_lt_u32 s58, 0x100000
  s_cbranch_scc1 MPD_WH62
MPD_WH62_K:
  v_readlane_b32 s54, v163, 0
  v_readlane_b32 s56, v163, 1
  s_nop 0
  s_min_u32 s54, s54, s56
  v_readlane_b32 s56, v163, 2
  s_nop 0
  s_min_u32 s54, s54, s56
  v_readlane_b32 s56, v163, 3
  s_nop 0
  s_min_u32 s54, s54, s56
  v_readlane_b32 s56, v163, 4
  s_nop 0
  s_min_u32 s54, s54, s56
  v_readlane_b32 s56, v163, 5
  s_nop 0
  s_min_u32 s54, s54, s56
  v_readlane_b32 s56, v163, 6
  s_nop 0
  s_min_u32 s54, s54, s56
  v_readlane_b32 s56, v163, 7
  s_nop 0
  s_min_u32 s54, s54, s56
  v_readlane_b32 s56, v163, 8
  s_nop 0
  s_min_u32 s54, s54, s56
  v_readlane_b32 s56, v163, 9
  s_nop 0
  s_min_u32 s54, s54, s56
  v_readlane_b32 s56, v163, 10
  s_nop 0
  s_min_u32 s54, s54, s56
  v_readlane_b32 s56, v163, 11
  s_nop 0
  s_min_u32 s54, s54, s56
  s_nop 2
MPD_WH62_D:
  s_add_u32 m0, s32, 0
  s_add_u32 s33, s31, 0
  buffer_load_dwordx4 v7, s[4:7], s33 offen offset:0 lds
  buffer_load_dwordx4 v7, s[4:7], s33 offen offset:1024 lds
  buffer_load_dwordx4 v7, s[4:7], s33 offen offset:2048 lds
  buffer_load_dwordx4 v7, s[4:7], s33 offen offset:3072 lds
  s_add_u32 m0, s32, 4096
  s_add_u32 s33, s31, 4096
  buffer_load_dwordx4 v7, s[4:7], s33 offen offset:0 lds
  buffer_load_dwordx4 v7, s[4:7], s33 offen offset:1024 lds
  buffer_load_dwordx4 v7, s[4:7], s33 offen offset:2048 lds
  buffer_load_dwordx4 v7, s[4:7], s33 offen offset:3072 lds
  s_add_u32 m0, s32, 8192
  s_add_u32 s33, s31, 8192
  buffer_load_dwordx4 v7, s[4:7], s33 offen offset:0 lds
  buffer_load_dwordx4 v7, s[4:7], s33 offen offset:1024 lds
  buffer_load_dwordx4 v7, s[4:7], s33 offen offset:2048 lds
  buffer_load_dwordx4 v7, s[4:7], s33 offen offset:3072 lds
  s_add_u32 s31, s31, 49152
  s_add_u32 s32, s32, 49152
  s_sub_u32 s33, s32, 147456
  s_cmp_ge_u32 s32, 147456
  s_cselect_b32 s32, s33, s32
  s_cmp_lg_u32 s20, 0
  s_cbranch_scc1 MPD_NP63
  v_mov_b32 v160, s53
  s_mov_b64 exec, 1
  buffer_store_dword v160, v161, s[4:7], s52 offen sc1
  s_mov_b64 exec, -1
MPD_NP63:
  s_add_u32 s53, s53, 1
  ds_read_b128 v[10:13], v9 offset:0
  s_waitcnt lgkmcnt(3)
  v_mfma_f32_16x16x32_bf16 v[26:29], a[180:183], v[14:17], v[26:29]
  ds_read_b128 v[14:17], v9 offset:1024
  s_waitcnt lgkmcnt(3)
  v_mfma_f32_16x16x32_bf16 v[26:29], a[184:187], v[18:21], v[26:29]
  ds_read_b128 v[18:21], v9 offset:2048
  s_waitcnt lgkmcnt(3)
  v_mfma_f32_16x16x32_bf16 v[26:29], a[188:191], v[22:25], v[26:29]
  s_mov_b32 s30, 62
  s_nop 6
MPD_LOOP:
  s_add_u32 s35, s37, s29
  buffer_load_dwordx2 v[94:95], v90, s[16:19], s35 offen
  s_add_u32 s37, s37, 20480
  ds_read_b128 v[22:25], v9 offset:3072
  s_waitcnt lgkmcnt(3)
  v_mfma_f32_16x16x32_bf16 v[42:45], a[0:3], v[10:13], 0
  ds_read_b128 v[10:13], v9 offset:4096
  s_waitcnt lgkmcnt(3)
  v_mfma_f32_16x16x32_bf16 v[42:45], a[4:7], v[14:17], v[42:45]
  ds_read_b128 v[14:17], v9 offset:5120
  s_waitcnt lgkmcnt(3)
  v_mfma_f32_16x16x32_bf16 v[42:45], a[8:11], v[18:21], v[42:45]
  s_waitcnt vmcnt(13)
  ds_read_b128 v[18:21], v9 offset:6144
  s_waitcnt lgkmcnt(3)
  v_mfma_f32_16x16x32_bf16 v[42:45], a[12:15], v[22:25], v[42:45]
  v_lshlrev_b32 v58, 16, v92
  ds_read_b128 v[22:25], v9 offset:7168
  s_waitcnt lgkmcnt(3)
  v_mfma_f32_16x16x32_bf16 v[42:45], a[16:19], v[10:13], v[42:45]
  v_and_b32 v59, 0xffff0000, v92
  ds_read_b128 v[10:13], v9 offset:8192
  s_waitcnt lgkmcnt(3)
  v_mfma_f32_16x16x32_bf16 v[42:45], a[20:23], v[14:17], v[42:45]
  v_lshlrev_b32 v60, 16, v93
  ds_read_b128 v[14:17], v9 offset:9216
  s_waitcnt lgkmcnt(3)
  v_mfma_f32_16x16x32_bf16 v[42:45], a[24:27], v[18:21], v[42:45]
  v_and_b32 v61, 0xffff0000, v93
  ds_read_b128 v[18:21], v9 offset:10240
  s_waitcnt lgkmcnt(3)
  v_mfma_f32_16x16x32_bf16 v[42:45], a[28:31], v[22:25], v[42:45]
  v_add_f32 v58, v58, v26
  ds_read_b128 v[22:25], v9 offset:11264
  s_waitcnt lgkmcnt(3)
  v_mfma_f32_16x16x32_bf16 v[42:45], a[32:35], v[10:13], v[42:45]
  v_add_f32 v59, v59, v27
  ds_read_b128 v[10:13], v9 offset:12288
  s_waitcnt lgkmcnt(3)
  v_mfma_f32_16x16x32_bf16 v[42:45], a[36:39], v[14:17], v[42:45]
  v_add_f32 v60, v60, v28
  ds_read_b128 v[14:17], v9 offset:13312
  s_waitcnt lgkmcnt(3)
  v_mfma_f32_16x16x32_bf16 v[42:45], a[40:43], v[18:21], v[42:45]
  v_add_f32 v61, v61, v29
  ds_read_b128 v[18:21], v9 offset:14336
  s_waitcnt lgkmcnt(3)
  v_mfma_f32_16x16x32_bf16 v[42:45], a[44:47], v[22:25], v[42:45]
  s_add_u32 s35, s34, s28
  ds_read_b128 v[22:25], v9 offset:15360
  s_waitcnt lgkmcnt(3)
  v_mfma_f32_16x16x32_bf16 v[42:45], a[48:51], v[10:13], v[42:45]
  buffer_store_dwordx4 v[58:61], v7, s[4:7], s35 offen sc1
  ds_read_b128 v[10:13], v9 offset:16384
  s_waitcnt lgkmcnt(3)
  v_mfma_f32_16x16x32_bf16 v[42:45], a[52:55], v[14:17], v[42:45]
  s_add_u32 s34, s34, 1024
  ds_read_b128 v[14:17], v9 offset:17408
  s_waitcnt lgkmcnt(3)
  v_mfma_f32_16x16x32_bf16 v[42:45], a[56:59], v[18:21], v[42:45]
  ds_read_b128 v[18:21], v9 offset:18432
  s_waitcnt lgkmcnt(3)
  v_mfma_f32_16x16x32_bf16 v[42:45], a[60:63], v[22:25], v[42:45]
  ds_read_b128 v[22:25], v9 offset:19456
  s_waitcnt lgkmcnt(3)
  v_mfma_f32_16x16x32_bf16 v[42:45], a[64:67], v[10:13], v[42:45]
  ds_read_b128 v[10:13], v9 offset:20480
  s_waitcnt lgkmcnt(3)
  v_mfma_f32_16x16x32_bf16 v[42:45], a[68:71], v[14:17], v[42:45]
  ds_read_b128 v[14:17], v9 offset:21504
  s_waitcnt lgkmcnt(3)
  v_mfma_f32_16x16x32_bf16 v[42:45], a[72:75], v[18:21], v[42:45]
  ds_read_b128 v[18:21], v9 offset:22528
  s_waitcnt lgkmcnt(3)
  v_mfma_f32_16x16x32_bf16 v[42:45], a[76:79], v[22:25], v[42:45]
  ds_read_b128 v[22:25], v9 offset:23552
  s_waitcnt lgkmcnt(3)
  v_mfma_f32_16x16x32_bf16 v[42:45], a[80:83], v[10:13], v[42:45]
  ds_read_b128 v[10:13], v9 offset:24576
  s_waitcnt lgkmcnt(3)
  v_mfma_f32_16x16x32_bf16 v[42:45], a[84:87], v[14:17], v[42:45]
  ds_read_b128 v[14:17], v9 offset:25600
  s_waitcnt lgkmcnt(3)
  v_mfma_f32_16x16x32_bf16 v[42:45], a[88:91], v[18:21], v[42:45]
  ds_read_b128 v[18:21], v9 offset:26624
  s_waitcnt lgkmcnt(3)
  v_mfma_f32_16x16x32_bf16 v[42:45], a[92:95], v[22:25], v[42:45]
  ds_read_b128 v[22:25], v9 offset:27648
  s_waitcnt lgkmcnt(3)
  v_mfma_f32_16x16x32_bf16 v[42:45], a[96:99], v[10:13], v[42:45]
  ds_read_b128 v[10:13], v9 offset:28672
  s_waitcnt lgkmcnt(3)
  v_mfma_f32_16x16x32_bf16 v[42:45], a[100:103], v[14:17], v[42:45]
  ds_read_b128 v[14:17], v9 offset:29696
  s_waitcnt lgkmcnt(3)
  v_mfma_f32_16x16x32_bf16 v[42:45], a[104:107], v[18:21], v[42:45]
  ds_read_b128 v[18:21], v9 offset:30720
  s_waitcnt lgkmcnt(3)
  v_mfma_f32_16x16x32_bf16 v[42:45], a[108:111], v[22:25], v[42:45]
  ds_read_b128 v[22:25], v9 offset:31744
  s_waitcnt lgkmcnt(3)
  v_mfma_f32_16x16x32_bf16 v[42:45], a[112:115], v[10:13], v[42:45]
  ds_read_b128 v[10:13], v9 offset:32768
  s_waitcnt lgkmcnt(3)
  v_mfma_f32_16x16x32_bf16 v[42:45], a[116:119], v[14:17], v[42:45]
  ds_read_b128 v[14:17], v9 offset:33792
  s_waitcnt lgkmcnt(3)
  v_mfma_f32_16x16x32_bf16 v[42:45], a[120:123], v[18:21], v[42:45]
  ds_read_b128 v[18:21], v9 offset:34816
  s_waitcnt lgkmcnt(3)
  v_mfma_f32_16x16x32_bf16 v[42:45], a[124:127], v[22:25], v[42:45]
  ds_read_b128 v[22:25], v9 offset:35840
  s_waitcnt lgkmcnt(3)
  v_mfma_f32_16x16x32_bf16 v[42:45], a[128:131], v[10:13], v[42:45]
  ds_read_b128 v[10:13], v9 offset:36864
  s_waitcnt lgkmcnt(3)
  v_mfma_f32_16x16x32_bf16 v[42:45], a[132:135], v[14:17], v[42:45]
  ds_read_b128 v[14:17], v9 offset:37888
  s_waitcnt lgkmcnt(3)
  v_mfma_f32_16x16x32_bf16 v[42:45], a[136:139], v[18:21], v[42:45]
  ds_read_b128 v[18:21], v9 offset:38912
  s_waitcnt lgkmcnt(3)
  v_mfma_f32_16x16x32_bf16 v[42:45], a[140:143], v[22:25], v[42:45]
  ds_read_b128 v[22:25], v9 offset:39936
  s_waitcnt lgkmcnt(3)
  v_mfma_f32_16x16x32_bf16 v[42:45], a[144:147], v[10:13], v[42:45]
  ds_read_b128 v[10:13], v9 offset:40960
  s_waitcnt lgkmcnt(3)
  v_mfma_f32_16x16x32_bf16 v[42:45], a[148:151], v[14:17], v[42:45]
  ds_read_b128 v[14:17], v9 offset:41984
  s_waitcnt lgkmcnt(3)
  v_mfma_f32_16x16x32_bf16 v[42:45], a[152:155], v[18:21], v[42:45]
  ds_read_b128 v[18:21], v9 offset:43008
  s_waitcnt lgkmcnt(3)
  v_mfma_f32_16x16x32_bf16 v[42:45], a[156:159], v[22:25], v[42:45]
  ds_read_b128 v[22:25], v9 offset:44032
  s_waitcnt lgkmcnt(3)
  v_mfma_f32_16x16x32_bf16 v[42:45], a[160:163], v[10:13], v[42:45]
  ds_read_b128 v[10:13], v9 offset:45056
  s_waitcnt lgkmcnt(3)
  v_mfma_f32_16x16x32_bf16 v[42:45], a[164:167], v[14:17], v[42:45]
  ds_read_b128 v[14:17], v9 offset:46080
  s_waitcnt lgkmcnt(3)
  v_mfma_f32_16x16x32_bf16 v[42:45], a[168:171], v[18:21], v[42:45]
  ds_read_b128 v[18:21], v9 offset:47104
  s_waitcnt lgkmcnt(3)
  v_mfma_f32_16x16x32_bf16 v[42:45], a[172:175], v[22:25], v[42:45]
  ds_read_b128 v[22:25], v9 offset:48128
  s_waitcnt lgkmcnt(3)
  v_mfma_f32_16x16x32_bf16 v[42:45], a[176:179], v[10:13], v[42:45]
  s_cmp_eq_u32 s20, 0
  s_nop 5
  s_cbranch_scc1 MPD_SW64
  s_waitcnt vmcnt(2)
  s_branch MPD_SX64
MPD_SW64:
  s_waitcnt vmcnt(3)
MPD_SX64:
  s_barrier
  v_add_u32 v8, s36, v7
  s_add_u32 s36, s36, 49152
  s_cmp_ge_u32 s36, 147456
  s_cselect_b32 s36, 0, s36
  s_add_u32 s55, s55, 1
  s_min_u32 s57, s55, 128
  s_cmp_ge_u32 s54, s57
  s_cbranch_scc1 MPD_WH65_D
  s_mov_b32 s58, 0
MPD_WH65:
  buffer_load_dword v163, v162, s[4:7], 0 offen sc1
  s_waitcnt vmcnt(0)
  v_cmp_gt_u32 vcc, s57, v163
  s_nop 3
  s_cbranch_vccz MPD_WH65_K
  s_sleep 4
  s_add_u32 s58, s58, 1
  s_cmp_lt_u32 s58, 0x100000
  s_cbranch_scc1 MPD_WH65
MPD_WH65_K:
  v_readlane_b32 s54, v163, 0
  v_readlane_b32 s56, v163, 1
  s_nop 0
  s_min_u32 s54, s54, s56
  v_readlane_b32 s56, v163, 2
  s_nop 0
  s_min_u32 s54, s54, s56
  v_readlane_b32 s56, v163, 3
  s_nop 0
  s_min_u32 s54, s54, s56
  v_readlane_b32 s56, v163, 4
  s_nop 0
  s_min_u32 s54, s54, s56
  v_readlane_b32 s56, v163, 5
  s_nop 0
  s_min_u32 s54, s54, s56
  v_readlane_b32 s56, v163, 6
  s_nop 0
  s_min_u32 s54, s54, s56
  v_readlane_b32 s56, v163, 7
  s_nop 0
  s_min_u32 s54, s54, s56
  v_readlane_b32 s56, v163, 8
  s_nop 0
  s_min_u32 s54, s54, s56
  v_readlane_b32 s56, v163, 9
  s_nop 0
  s_min_u32 s54, s54, s56
  v_readlane_b32 s56, v163, 10
  s_nop 0
  s_min_u32 s54, s54, s56
  v_readlane_b32 s56, v163, 11
  s_nop 0
  s_min_u32 s54, s54, s56
  s_nop 2
MPD_WH65_D:
  s_add_u32 m0, s32, 0
  s_add_u32 s33, s31, 0
  buffer_load_dwordx4 v7, s[4:7], s33 offen offset:0 lds
  buffer_load_dwordx4 v7, s[4:7], s33 offen offset:1024 lds
  buffer_load_dwordx4 v7, s[4:7], s33 offen offset:2048 lds
  buffer_load_dwordx4 v7, s[4:7], s33 offen offset:3072 lds
  s_add_u32 m0, s32, 4096
  s_add_u32 s33, s31, 4096
  buffer_load_dwordx4 v7, s[4:7], s33 offen offset:0 lds
  buffer_load_dwordx4 v7, s[4:7], s33 offen offset:1024 lds
  buffer_load_dwordx4 v7, s[4:7], s33 offen offset:2048 lds
  buffer_load_dwordx4 v7, s[4:7], s33 offen offset:3072 lds
  s_add_u32 m0, s32, 8192
  s_add_u32 s33, s31, 8192
  buffer_load_dwordx4 v7, s[4:7], s33 offen offset:0 lds
  buffer_load_dwordx4 v7, s[4:7], s33 offen offset:1024 lds
  buffer_load_dwordx4 v7, s[4:7], s33 offen offset:2048 lds
  buffer_load_dwordx4 v7, s[4:7], s33 offen offset:3072 lds
  s_add_u32 s31, s31, 49152
  s_add_u32 s32, s32, 49152
  s_sub_u32 s33, s32, 147456
  s_cmp_ge_u32 s32, 147456
  s_cselect_b32 s32, s33, s32
  s_cmp_lg_u32 s20, 0
  s_cbranch_scc1 MPD_NP66
  v_mov_b32 v160, s53
  s_mov_b64 exec, 1
  buffer_store_dword v160, v161, s[4:7], s52 offen sc1
  s_mov_b64 exec, -1
MPD_NP66:
  s_add_u32 s53, s53, 1
  ds_read_b128 v[10:13], v8 offset:0
  s_waitcnt lgkmcnt(3)
  v_mfma_f32_16x16x32_bf16 v[42:45], a[180:183], v[14:17], v[42:45]
  ds_read_b128 v[14:17], v8 offset:1024
  s_waitcnt lgkmcnt(3)
  v_mfma_f32_16x16x32_bf16 v[42:45], a[184:187], v[18:21], v[42:45]
  ds_read_b128 v[18:21], v8 offset:2048
  s_waitcnt lgkmcnt(3)
  v_mfma_f32_16x16x32_bf16 v[42:45], a[188:191], v[22:25], v[42:45]
  s_add_u32 s35, s37, s29
  buffer_load_dwordx2 v[92:93], v90, s[16:19], s35 offen
  s_add_u32 s37, s37, 20480
  ds_read_b128 v[22:25], v8 offset:3072
  s_waitcnt lgkmcnt(3)
  v_mfma_f32_16x16x32_bf16 v[26:29], a[0:3], v[10:13], 0
  ds_read_b128 v[10:13], v8 offset:4096
  s_waitcnt lgkmcnt(3)
  v_mfma_f32_16x16x32_bf16 v[26:29], a[4:7], v[14:17], v[26:29]
  ds_read_b128 v[14:17], v8 offset:5120
  s_waitcnt lgkmcnt(3)
  v_mfma_f32_16x16x32_bf16 v[26:29], a[8:11], v[18:21], v[26:29]
  s_waitcnt vmcnt(13)
  ds_read_b128 v[18:21], v8 offset:6144
  s_waitcnt lgkmcnt(3)
  v_mfma_f32_16x16x32_bf16 v[26:29], a[12:15], v[22:25], v[26:29]
  v_lshlrev_b32 v58, 16, v94
  ds_read_b128 v[22:25], v8 offset:7168
  s_waitcnt lgkmcnt(3)
  v_mfma_f32_16x16x32_bf16 v[26:29], a[16:19], v[10:13], v[26:29]
  v_and_b32 v59, 0xffff0000, v94
  ds_read_b128 v[10:13], v8 offset:8192
  s_waitcnt lgkmcnt(3)
  v_mfma_f32_16x16x32_bf16 v[26:29], a[20:23], v[14:17], v[26:29]
  v_lshlrev_b32 v60, 16, v95
  ds_read_b128 v[14:17], v8 offset:9216
  s_waitcnt lgkmcnt(3)
  v_mfma_f32_16x16x32_bf16 v[26:29], a[24:27], v[18:21], v[26:29]
  v_and_b32 v61, 0xffff0000, v95
  ds_read_b128 v[18:21], v8 offset:10240
  s_waitcnt lgkmcnt(3)
  v_mfma_f32_16x16x32_bf16 v[26:29], a[28:31], v[22:25], v[26:29]
  v_add_f32 v58, v58, v42
  ds_read_b128 v[22:25], v8 offset:11264
  s_waitcnt lgkmcnt(3)
  v_mfma_f32_16x16x32_bf16 v[26:29], a[32:35], v[10:13], v[26:29]
  v_add_f32 v59, v59, v43
  ds_read_b128 v[10:13], v8 offset:12288
  s_waitcnt lgkmcnt(3)
  v_mfma_f32_16x16x32_bf16 v[26:29], a[36:39], v[14:17], v[26:29]
  v_add_f32 v60, v60, v44
  ds_read_b128 v[14:17], v8 offset:13312
  s_waitcnt lgkmcnt(3)
  v_mfma_f32_16x16x32_bf16 v[26:29], a[40:43], v[18:21], v[26:29]
  v_add_f32 v61, v61, v45
  ds_read_b128 v[18:21], v8 offset:14336
  s_waitcnt lgkmcnt(3)
  v_mfma_f32_16x16x32_bf16 v[26:29], a[44:47], v[22:25], v[26:29]
  s_add_u32 s35, s34, s28
  ds_read_b128 v[22:25], v8 offset:15360
  s_waitcnt lgkmcnt(3)
  v_mfma_f32_16x16x32_bf16 v[26:29], a[48:51], v[10:13], v[26:29]
  buffer_store_dwordx4 v[58:61], v7, s[4:7], s35 offen sc1
  ds_read_b128 v[10:13], v8 offset:16384
  s_waitcnt lgkmcnt(3)
  v_mfma_f32_16x16x32_bf16 v[26:29], a[52:55], v[14:17], v[26:29]
  s_add_u32 s34, s34, 80896
  ds_read_b128 v[14:17], v8 offset:17408
  s_waitcnt lgkmcnt(3)
  v_mfma_f32_16x16x32_bf16 v[26:29], a[56:59], v[18:21], v[26:29]
  ds_read_b128 v[18:21], v8 offset:18432
  s_waitcnt lgkmcnt(3)
  v_mfma_f32_16x16x32_bf16 v[26:29], a[60:63], v[22:25], v[26:29]
  ds_read_b128 v[22:25], v8 offset:19456
  s_waitcnt lgkmcnt(3)
  v_mfma_f32_16x16x32_bf16 v[26:29], a[64:67], v[10:13], v[26:29]
  ds_read_b128 v[10:13], v8 offset:20480
  s_waitcnt lgkmcnt(3)
  v_mfma_f32_16x16x32_bf16 v[26:29], a[68:71], v[14:17], v[26:29]
  ds_read_b128 v[14:17], v8 offset:21504
  s_waitcnt lgkmcnt(3)
  v_mfma_f32_16x16x32_bf16 v[26:29], a[72:75], v[18:21], v[26:29]
  ds_read_b128 v[18:21], v8 offset:22528
  s_waitcnt lgkmcnt(3)
  v_mfma_f32_16x16x32_bf16 v[26:29], a[76:79], v[22:25], v[26:29]
  ds_read_b128 v[22:25], v8 offset:23552
  s_waitcnt lgkmcnt(3)
  v_mfma_f32_16x16x32_bf16 v[26:29], a[80:83], v[10:13], v[26:29]
  ds_read_b128 v[10:13], v8 offset:24576
  s_waitcnt lgkmcnt(3)
  v_mfma_f32_16x16x32_bf16 v[26:29], a[84:87], v[14:17], v[26:29]
  ds_read_b128 v[14:17], v8 offset:25600
  s_waitcnt lgkmcnt(3)
  v_mfma_f32_16x16x32_bf16 v[26:29], a[88:91], v[18:21], v[26:29]
  ds_read_b128 v[18:21], v8 offset:26624
  s_waitcnt lgkmcnt(3)
  v_mfma_f32_16x16x32_bf16 v[26:29], a[92:95], v[22:25], v[26:29]
  ds_read_b128 v[22:25], v8 offset:27648
  s_waitcnt lgkmcnt(3)
  v_mfma_f32_16x16x32_bf16 v[26:29], a[96:99], v[10:13], v[26:29]
  ds_read_b128 v[10:13], v8 offset:28672
  s_waitcnt lgkmcnt(3)
  v_mfma_f32_16x16x32_bf16 v[26:29], a[100:103], v[14:17], v[26:29]
  ds_read_b128 v[14:17], v8 offset:29696
  s_waitcnt lgkmcnt(3)
  v_mfma_f32_16x16x32_bf16 v[26:29], a[104:107], v[18:21], v[26:29]
  ds_read_b128 v[18:21], v8 offset:30720
  s_waitcnt lgkmcnt(3)
  v_mfma_f32_16x16x32_bf16 v[26:29], a[108:111], v[22:25], v[26:29]
  ds_read_b128 v[22:25], v8 offset:31744
  s_waitcnt lgkmcnt(3)
  v_mfma_f32_16x16x32_bf16 v[26:29], a[112:115], v[10:13], v[26:29]
  ds_read_b128 v[10:13], v8 offset:32768
  s_waitcnt lgkmcnt(3)
  v_mfma_f32_16x16x32_bf16 v[26:29], a[116:119], v[14:17], v[26:29]
  ds_read_b128 v[14:17], v8 offset:33792
  s_waitcnt lgkmcnt(3)
  v_mfma_f32_16x16x32_bf16 v[26:29], a[120:123], v[18:21], v[26:29]
  ds_read_b128 v[18:21], v8 offset:34816
  s_waitcnt lgkmcnt(3)
  v_mfma_f32_16x16x32_bf16 v[26:29], a[124:127], v[22:25], v[26:29]
  ds_read_b128 v[22:25], v8 offset:35840
  s_waitcnt lgkmcnt(3)
  v_mfma_f32_16x16x32_bf16 v[26:29], a[128:131], v[10:13], v[26:29]
  ds_read_b128 v[10:13], v8 offset:36864
  s_waitcnt lgkmcnt(3)
  v_mfma_f32_16x16x32_bf16 v[26:29], a[132:135], v[14:17], v[26:29]
  ds_read_b128 v[14:17], v8 offset:37888
  s_waitcnt lgkmcnt(3)
  v_mfma_f32_16x16x32_bf16 v[26:29], a[136:139], v[18:21], v[26:29]
  ds_read_b128 v[18:21], v8 offset:38912
  s_waitcnt lgkmcnt(3)
  v_mfma_f32_16x16x32_bf16 v[26:29], a[140:143], v[22:25], v[26:29]
  ds_read_b128 v[22:25], v8 offset:39936
  s_waitcnt lgkmcnt(3)
  v_mfma_f32_16x16x32_bf16 v[26:29], a[144:147], v[10:13], v[26:29]
  ds_read_b128 v[10:13], v8 offset:40960
  s_waitcnt lgkmcnt(3)
  v_mfma_f32_16x16x32_bf16 v[26:29], a[148:151], v[14:17], v[26:29]
  ds_read_b128 v[14:17], v8 offset:41984
  s_waitcnt lgkmcnt(3)
  v_mfma_f32_16x16x32_bf16 v[26:29], a[152:155], v[18:21], v[26:29]
  ds_read_b128 v[18:21], v8 offset:43008
  s_waitcnt lgkmcnt(3)
  v_mfma_f32_16x16x32_bf16 v[26:29], a[156:159], v[22:25], v[26:29]
  ds_read_b128 v[22:25], v8 offset:44032
  s_waitcnt lgkmcnt(3)
  v_mfma_f32_16x16x32_bf16 v[26:29], a[160:163], v[10:13], v[26:29]
  ds_read_b128 v[10:13], v8 offset:45056
  s_waitcnt lgkmcnt(3)
  v_mfma_f32_16x16x32_bf16 v[26:29], a[164:167], v[14:17], v[26:29]
  ds_read_b128 v[14:17], v8 offset:46080
  s_waitcnt lgkmcnt(3)
  v_mfma_f32_16x16x32_bf16 v[26:29], a[168:171], v[18:21], v[26:29]
  ds_read_b128 v[18:21], v8 offset:47104
  s_waitcnt lgkmcnt(3)
  v_mfma_f32_16x16x32_bf16 v[26:29], a[172:175], v[22:25], v[26:29]
  ds_read_b128 v[22:25], v8 offset:48128
  s_waitcnt lgkmcnt(3)
  v_mfma_f32_16x16x32_bf16 v[26:29], a[176:179], v[10:13], v[26:29]
  s_cmp_eq_u32 s20, 0
  s_nop 5
  s_cbranch_scc1 MPD_SW67
  s_waitcnt vmcnt(2)
  s_branch MPD_SX67
MPD_SW67:
  s_waitcnt vmcnt(3)
MPD_SX67:
  s_barrier
  v_add_u32 v9, s36, v7
  s_add_u32 s36, s36, 49152
  s_cmp_ge_u32 s36, 147456
  s_cselect_b32 s36, 0, s36
  s_add_u32 s55, s55, 1
  s_min_u32 s57, s55, 128
  s_cmp_ge_u32 s54, s57
  s_cbranch_scc1 MPD_WH68_D
  s_mov_b32 s58, 0
MPD_WH68:
  buffer_load_dword v163, v162, s[4:7], 0 offen sc1
  s_waitcnt vmcnt(0)
  v_cmp_gt_u32 vcc, s57, v163
  s_nop 3
  s_cbranch_vccz MPD_WH68_K
  s_sleep 4
  s_add_u32 s58, s58, 1
  s_cmp_lt_u32 s58, 0x100000
  s_cbranch_scc1 MPD_WH68
MPD_WH68_K:
  v_readlane_b32 s54, v163, 0
  v_readlane_b32 s56, v163, 1
  s_nop 0
  s_min_u32 s54, s54, s56
  v_readlane_b32 s56, v163, 2
  s_nop 0
  s_min_u32 s54, s54, s56
  v_readlane_b32 s56, v163, 3
  s_nop 0
  s_min_u32 s54, s54, s56
  v_readlane_b32 s56, v163, 4
  s_nop 0
  s_min_u32 s54, s54, s56
  v_readlane_b32 s56, v163, 5
  s_nop 0
  s_min_u32 s54, s54, s56
  v_readlane_b32 s56, v163, 6
  s_nop 0
  s_min_u32 s54, s54, s56
  v_readlane_b32 s56, v163, 7
  s_nop 0
  s_min_u32 s54, s54, s56
  v_readlane_b32 s56, v163, 8
  s_nop 0
  s_min_u32 s54, s54, s56
  v_readlane_b32 s56, v163, 9
  s_nop 0
  s_min_u32 s54, s54, s56
  v_readlane_b32 s56, v163, 10
  s_nop 0
  s_min_u32 s54, s54, s56
  v_readlane_b32 s56, v163, 11
  s_nop 0
  s_min_u32 s54, s54, s56
  s_nop 2
MPD_WH68_D:
  s_add_u32 m0, s32, 0
  s_add_u32 s33, s31, 0
  buffer_load_dwordx4 v7, s[4:7], s33 offen offset:0 lds
  buffer_load_dwordx4 v7, s[4:7], s33 offen offset:1024 lds
  buffer_load_dwordx4 v7, s[4:7], s33 offen offset:2048 lds
  buffer_load_dwordx4 v7, s[4:7], s33 offen offset:3072 lds
  s_add_u32 m0, s32, 4096
  s_add_u32 s33, s31, 4096
  buffer_load_dwordx4 v7, s[4:7], s33 offen offset:0 lds
  buffer_load_dwordx4 v7, s[4:7], s33 offen offset:1024 lds
  buffer_load_dwordx4 v7, s[4:7], s33 offen offset:2048 lds
  buffer_load_dwordx4 v7, s[4:7], s33 offen offset:3072 lds
  s_add_u32 m0, s32, 8192
  s_add_u32 s33, s31, 8192
  buffer_load_dwordx4 v7, s[4:7], s33 offen offset:0 lds
  buffer_load_dwordx4 v7, s[4:7], s33 offen offset:1024 lds
  buffer_load_dwordx4 v7, s[4:7], s33 offen offset:2048 lds
  buffer_load_dwordx4 v7, s[4:7], s33 offen offset:3072 lds
  s_add_u32 s31, s31, 49152
  s_add_u32 s32, s32, 49152
  s_sub_u32 s33, s32, 147456
  s_cmp_ge_u32 s32, 147456
  s_cselect_b32 s32, s33, s32
  s_cmp_lg_u32 s20, 0
  s_cbranch_scc1 MPD_NP69
  v_mov_b32 v160, s53
  s_mov_b64 exec, 1
  buffer_store_dword v160, v161, s[4:7], s52 offen sc1
  s_mov_b64 exec, -1
MPD_NP69:
  s_add_u32 s53, s53, 1
  ds_read_b128 v[10:13], v9 offset:0
  s_waitcnt lgkmcnt(3)
  v_mfma_f32_16x16x32_bf16 v[26:29], a[180:183], v[14:17], v[26:29]
  ds_read_b128 v[14:17], v9 offset:1024
  s_waitcnt lgkmcnt(3)
  v_mfma_f32_16x16x32_bf16 v[26:29], a[184:187], v[18:21], v[26:29]
  ds_read_b128 v[18:21], v9 offset:2048
  s_waitcnt lgkmcnt(3)
  v_mfma_f32_16x16x32_bf16 v[26:29], a[188:191], v[22:25], v[26:29]
  s_sub_u32 s30, s30, 1
  s_cmp_lg_u32 s30, 0
  s_nop 4
  s_cbranch_scc1 MPD_LOOP
  s_add_u32 s35, s37, s29
  buffer_load_dwordx2 v[94:95], v90, s[16:19], s35 offen
  s_add_u32 s37, s37, 20480
  ds_read_b128 v[22:25], v9 offset:3072
  s_waitcnt lgkmcnt(3)
  v_mfma_f32_16x16x32_bf16 v[42:45], a[0:3], v[10:13], 0
  ds_read_b128 v[10:13], v9 offset:4096
  s_waitcnt lgkmcnt(3)
  v_mfma_f32_16x16x32_bf16 v[42:45], a[4:7], v[14:17], v[42:45]
  ds_read_b128 v[14:17], v9 offset:5120
  s_waitcnt lgkmcnt(3)
  v_mfma_f32_16x16x32_bf16 v[42:45], a[8:11], v[18:21], v[42:45]
  s_waitcnt vmcnt(13)
  ds_read_b128 v[18:21], v9 offset:6144
  s_waitcnt lgkmcnt(3)
  v_mfma_f32_16x16x32_bf16 v[42:45], a[12:15], v[22:25], v[42:45]
  v_lshlrev_b32 v58, 16, v92
  ds_read_b128 v[22:25], v9 offset:7168
  s_waitcnt lgkmcnt(3)
  v_mfma_f32_16x16x32_bf16 v[42:45], a[16:19], v[10:13], v[42:45]
  v_and_b32 v59, 0xffff0000, v92
  ds_read_b128 v[10:13], v9 offset:8192
  s_waitcnt lgkmcnt(3)
  v_mfma_f32_16x16x32_bf16 v[42:45], a[20:23], v[14:17], v[42:45]
  v_lshlrev_b32 v60, 16, v93
  ds_read_b128 v[14:17], v9 offset:9216
  s_waitcnt lgkmcnt(3)
  v_mfma_f32_16x16x32_bf16 v[42:45], a[24:27], v[18:21], v[42:45]
  v_and_b32 v61, 0xffff0000, v93
  ds_read_b128 v[18:21], v9 offset:10240
  s_waitcnt lgkmcnt(3)
  v_mfma_f32_16x16x32_bf16 v[42:45], a[28:31], v[22:25], v[42:45]
  v_add_f32 v58, v58, v26
  ds_read_b128 v[22:25], v9 offset:11264
  s_waitcnt lgkmcnt(3)
  v_mfma_f32_16x16x32_bf16 v[42:45], a[32:35], v[10:13], v[42:45]
  v_add_f32 v59, v59, v27
  ds_read_b128 v[10:13], v9 offset:12288
  s_waitcnt lgkmcnt(3)
  v_mfma_f32_16x16x32_bf16 v[42:45], a[36:39], v[14:17], v[42:45]
  v_add_f32 v60, v60, v28
  ds_read_b128 v[14:17], v9 offset:13312
  s_waitcnt lgkmcnt(3)
  v_mfma_f32_16x16x32_bf16 v[42:45], a[40:43], v[18:21], v[42:45]
  v_add_f32 v61, v61, v29
  ds_read_b128 v[18:21], v9 offset:14336
  s_waitcnt lgkmcnt(3)
  v_mfma_f32_16x16x32_bf16 v[42:45], a[44:47], v[22:25], v[42:45]
  s_add_u32 s35, s34, s28
  ds_read_b128 v[22:25], v9 offset:15360
  s_waitcnt lgkmcnt(3)
  v_mfma_f32_16x16x32_bf16 v[42:45], a[48:51], v[10:13], v[42:45]
  buffer_store_dwordx4 v[58:61], v7, s[4:7], s35 offen sc1
  ds_read_b128 v[10:13], v9 offset:16384
  s_waitcnt lgkmcnt(3)
  v_mfma_f32_16x16x32_bf16 v[42:45], a[52:55], v[14:17], v[42:45]
  s_add_u32 s34, s34, 1024
  ds_read_b128 v[14:17], v9 offset:17408
  s_waitcnt lgkmcnt(3)
  v_mfma_f32_16x16x32_bf16 v[42:45], a[56:59], v[18:21], v[42:45]
  ds_read_b128 v[18:21], v9 offset:18432
  s_waitcnt lgkmcnt(3)
  v_mfma_f32_16x16x32_bf16 v[42:45], a[60:63], v[22:25], v[42:45]
  ds_read_b128 v[22:25], v9 offset:19456
  s_waitcnt lgkmcnt(3)
  v_mfma_f32_16x16x32_bf16 v[42:45], a[64:67], v[10:13], v[42:45]
  ds_read_b128 v[10:13], v9 offset:20480
  s_waitcnt lgkmcnt(3)
  v_mfma_f32_16x16x32_bf16 v[42:45], a[68:71], v[14:17], v[42:45]
  ds_read_b128 v[14:17], v9 offset:21504
  s_waitcnt lgkmcnt(3)
  v_mfma_f32_16x16x32_bf16 v[42:45], a[72:75], v[18:21], v[42:45]
  ds_read_b128 v[18:21], v9 offset:22528
  s_waitcnt lgkmcnt(3)
  v_mfma_f32_16x16x32_bf16 v[42:45], a[76:79], v[22:25], v[42:45]
  ds_read_b128 v[22:25], v9 offset:23552
  s_waitcnt lgkmcnt(3)
  v_mfma_f32_16x16x32_bf16 v[42:45], a[80:83], v[10:13], v[42:45]
  ds_read_b128 v[10:13], v9 offset:24576
  s_waitcnt lgkmcnt(3)
  v_mfma_f32_16x16x32_bf16 v[42:45], a[84:87], v[14:17], v[42:45]
  ds_read_b128 v[14:17], v9 offset:25600
  s_waitcnt lgkmcnt(3)
  v_mfma_f32_16x16x32_bf16 v[42:45], a[88:91], v[18:21], v[42:45]
  ds_read_b128 v[18:21], v9 offset:26624
  s_waitcnt lgkmcnt(3)
  v_mfma_f32_16x16x32_bf16 v[42:45], a[92:95], v[22:25], v[42:45]
  ds_read_b128 v[22:25], v9 offset:27648
  s_waitcnt lgkmcnt(3)
  v_mfma_f32_16x16x32_bf16 v[42:45], a[96:99], v[10:13], v[42:45]
  ds_read_b128 v[10:13], v9 offset:28672
  s_waitcnt lgkmcnt(3)
  v_mfma_f32_16x16x32_bf16 v[42:45], a[100:103], v[14:17], v[42:45]
  ds_read_b128 v[14:17], v9 offset:29696
  s_waitcnt lgkmcnt(3)
  v_mfma_f32_16x16x32_bf16 v[42:45], a[104:107], v[18:21], v[42:45]
  ds_read_b128 v[18:21], v9 offset:30720
  s_waitcnt lgkmcnt(3)
  v_mfma_f32_16x16x32_bf16 v[42:45], a[108:111], v[22:25], v[42:45]
  ds_read_b128 v[22:25], v9 offset:31744
  s_waitcnt lgkmcnt(3)
  v_mfma_f32_16x16x32_bf16 v[42:45], a[112:115], v[10:13], v[42:45]
  ds_read_b128 v[10:13], v9 offset:32768
  s_waitcnt lgkmcnt(3)
  v_mfma_f32_16x16x32_bf16 v[42:45], a[116:119], v[14:17], v[42:45]
  ds_read_b128 v[14:17], v9 offset:33792
  s_waitcnt lgkmcnt(3)
  v_mfma_f32_16x16x32_bf16 v[42:45], a[120:123], v[18:21], v[42:45]
  ds_read_b128 v[18:21], v9 offset:34816
  s_waitcnt lgkmcnt(3)
  v_mfma_f32_16x16x32_bf16 v[42:45], a[124:127], v[22:25], v[42:45]
  ds_read_b128 v[22:25], v9 offset:35840
  s_waitcnt lgkmcnt(3)
  v_mfma_f32_16x16x32_bf16 v[42:45], a[128:131], v[10:13], v[42:45]
  ds_read_b128 v[10:13], v9 offset:36864
  s_waitcnt lgkmcnt(3)
  v_mfma_f32_16x16x32_bf16 v[42:45], a[132:135], v[14:17], v[42:45]
  ds_read_b128 v[14:17], v9 offset:37888
  s_waitcnt lgkmcnt(3)
  v_mfma_f32_16x16x32_bf16 v[42:45], a[136:139], v[18:21], v[42:45]
  ds_read_b128 v[18:21], v9 offset:38912
  s_waitcnt lgkmcnt(3)
  v_mfma_f32_16x16x32_bf16 v[42:45], a[140:143], v[22:25], v[42:45]
  ds_read_b128 v[22:25], v9 offset:39936
  s_waitcnt lgkmcnt(3)
  v_mfma_f32_16x16x32_bf16 v[42:45], a[144:147], v[10:13], v[42:45]
  ds_read_b128 v[10:13], v9 offset:40960
  s_waitcnt lgkmcnt(3)
  v_mfma_f32_16x16x32_bf16 v[42:45], a[148:151], v[14:17], v[42:45]
  ds_read_b128 v[14:17], v9 offset:41984
  s_waitcnt lgkmcnt(3)
  v_mfma_f32_16x16x32_bf16 v[42:45], a[152:155], v[18:21], v[42:45]
  ds_read_b128 v[18:21], v9 offset:43008
  s_waitcnt lgkmcnt(3)
  v_mfma_f32_16x16x32_bf16 v[42:45], a[156:159], v[22:25], v[42:45]
  ds_read_b128 v[22:25], v9 offset:44032
  s_waitcnt lgkmcnt(3)
  v_mfma_f32_16x16x32_bf16 v[42:45], a[160:163], v[10:13], v[42:45]
  ds_read_b128 v[10:13], v9 offset:45056
  s_waitcnt lgkmcnt(3)
  v_mfma_f32_16x16x32_bf16 v[42:45], a[164:167], v[14:17], v[42:45]
  ds_read_b128 v[14:17], v9 offset:46080
  s_waitcnt lgkmcnt(3)
  v_mfma_f32_16x16x32_bf16 v[42:45], a[168:171], v[18:21], v[42:45]
  ds_read_b128 v[18:21], v9 offset:47104
  s_waitcnt lgkmcnt(3)
  v_mfma_f32_16x16x32_bf16 v[42:45], a[172:175], v[22:25], v[42:45]
  ds_read_b128 v[22:25], v9 offset:48128
  s_waitcnt lgkmcnt(3)
  v_mfma_f32_16x16x32_bf16 v[42:45], a[176:179], v[10:13], v[42:45]
  s_cmp_eq_u32 s20, 0
  s_nop 5
  s_cbranch_scc1 MPD_SW70
  s_waitcnt vmcnt(2)
  s_branch MPD_SX70
MPD_SW70:
  s_waitcnt vmcnt(3)
MPD_SX70:
  s_barrier
  v_add_u32 v8, s36, v7
  s_add_u32 s36, s36, 49152
  s_cmp_ge_u32 s36, 147456
  s_cselect_b32 s36, 0, s36
  s_add_u32 s55, s55, 1
  s_min_u32 s57, s55, 128
  s_cmp_ge_u32 s54, s57
  s_cbranch_scc1 MPD_WH71_D
  s_mov_b32 s58, 0
MPD_WH71:
  buffer_load_dword v163, v162, s[4:7], 0 offen sc1
  s_waitcnt vmcnt(0)
  v_cmp_gt_u32 vcc, s57, v163
  s_nop 3
  s_cbranch_vccz MPD_WH71_K
  s_sleep 4
  s_add_u32 s58, s58, 1
  s_cmp_lt_u32 s58, 0x100000
  s_cbranch_scc1 MPD_WH71
MPD_WH71_K:
  v_readlane_b32 s54, v163, 0
  v_readlane_b32 s56, v163, 1
  s_nop 0
  s_min_u32 s54, s54, s56
  v_readlane_b32 s56, v163, 2
  s_nop 0
  s_min_u32 s54, s54, s56
  v_readlane_b32 s56, v163, 3
  s_nop 0
  s_min_u32 s54, s54, s56
  v_readlane_b32 s56, v163, 4
  s_nop 0
  s_min_u32 s54, s54, s56
  v_readlane_b32 s56, v163, 5
  s_nop 0
  s_min_u32 s54, s54, s56
  v_readlane_b32 s56, v163, 6
  s_nop 0
  s_min_u32 s54, s54, s56
  v_readlane_b32 s56, v163, 7
  s_nop 0
  s_min_u32 s54, s54, s56
  v_readlane_b32 s56, v163, 8
  s_nop 0
  s_min_u32 s54, s54, s56
  v_readlane_b32 s56, v163, 9
  s_nop 0
  s_min_u32 s54, s54, s56
  v_readlane_b32 s56, v163, 10
  s_nop 0
  s_min_u32 s54, s54, s56
  v_readlane_b32 s56, v163, 11
  s_nop 0
  s_min_u32 s54, s54, s56
  s_nop 2
MPD_WH71_D:
  s_add_u32 m0, s32, 0
  s_add_u32 s33, s31, 0
  buffer_load_dwordx4 v7, s[4:7], s33 offen offset:0 lds
  buffer_load_dwordx4 v7, s[4:7], s33 offen offset:1024 lds
  buffer_load_dwordx4 v7, s[4:7], s33 offen offset:2048 lds
  buffer_load_dwordx4 v7, s[4:7], s33 offen offset:3072 lds
  s_add_u32 m0, s32, 4096
  s_add_u32 s33, s31, 4096
  buffer_load_dwordx4 v7, s[4:7], s33 offen offset:0 lds
  buffer_load_dwordx4 v7, s[4:7], s33 offen offset:1024 lds
  buffer_load_dwordx4 v7, s[4:7], s33 offen offset:2048 lds
  buffer_load_dwordx4 v7, s[4:7], s33 offen offset:3072 lds
  s_add_u32 m0, s32, 8192
  s_add_u32 s33, s31, 8192
  buffer_load_dwordx4 v7, s[4:7], s33 offen offset:0 lds
  buffer_load_dwordx4 v7, s[4:7], s33 offen offset:1024 lds
  buffer_load_dwordx4 v7, s[4:7], s33 offen offset:2048 lds
  buffer_load_dwordx4 v7, s[4:7], s33 offen offset:3072 lds
  s_add_u32 s31, s31, 49152
  s_add_u32 s32, s32, 49152
  s_sub_u32 s33, s32, 147456
  s_cmp_ge_u32 s32, 147456
  s_cselect_b32 s32, s33, s32
  s_cmp_lg_u32 s20, 0
  s_cbranch_scc1 MPD_NP72
  v_mov_b32 v160, s53
  s_mov_b64 exec, 1
  buffer_store_dword v160, v161, s[4:7], s52 offen sc1
  s_mov_b64 exec, -1
MPD_NP72:
  s_add_u32 s53, s53, 1
  ds_read_b128 v[10:13], v8 offset:0
  s_waitcnt lgkmcnt(3)
  v_mfma_f32_16x16x32_bf16 v[42:45], a[180:183], v[14:17], v[42:45]
  ds_read_b128 v[14:17], v8 offset:1024
  s_waitcnt lgkmcnt(3)
  v_mfma_f32_16x16x32_bf16 v[42:45], a[184:187], v[18:21], v[42:45]
  ds_read_b128 v[18:21], v8 offset:2048
  s_waitcnt lgkmcnt(3)
  v_mfma_f32_16x16x32_bf16 v[42:45], a[188:191], v[22:25], v[42:45]
  s_nop 7
  s_waitcnt vmcnt(0)
  v_lshlrev_b32 v58, 16, v94
  v_and_b32 v59, 0xffff0000, v94
  v_lshlrev_b32 v60, 16, v95
  v_and_b32 v61, 0xffff0000, v95
  v_add_f32 v58, v58, v42
  v_add_f32 v59, v59, v43
  v_add_f32 v60, v60, v44
  v_add_f32 v61, v61, v45
  s_add_u32 s35, s34, s28
  buffer_store_dwordx4 v[58:61], v7, s[4:7], s35 offen sc1
  s_add_u32 s34, s34, 80896
  s_waitcnt vmcnt(0) lgkmcnt(0)
  s_barrier
  s_mov_b32 s53, 128
  v_mov_b32 v160, s53
  s_mov_b64 exec, 1
  buffer_store_dword v160, v161, s[4:7], s52 offen sc1
  s_mov_b64 exec, -1
  s_waitcnt vmcnt(0)
  s_branch MK_TOK
MK_U:
  s_sub_u32 s25, s51, 94
  s_mov_b32 s33, s52
  s_load_dwordx2 s[40:41], s[0:1], 40
  s_waitcnt lgkmcnt(0)
  s_mov_b32 s8, s40
  s_and_b32 s9, s41, 0xffff
  s_mov_b32 s10, 7864320
  s_mov_b32 s11, 0x00020000
  s_lshl_b32 s21, s20, 15
  s_mul_i32 s24, s25, 245760
  s_mul_i32 s31, s20, 320
  s_add_u32 s24, s24, s31
  v_lshrrev_b32 v6, 2, v1
  s_mov_b32 s22, 1280
  v_mul_lo_u32 v4, v6, s22
  v_and_b32 v6, 3, v1
  v_lshlrev_b32 v6, 4, v6
  v_add_u32 v4, v4, v6
  v_lshrrev_b32 v5, 4, v1
  v_lshlrev_b32 v5, 2, v5
  v_bfe_u32 v6, v1, 2, 2
  v_add_u32 v5, v5, v6
  v_mul_u32_u24 v5, 64, v5
  v_and_b32 v6, 3, v1
  v_lshlrev_b32 v6, 3, v6
  v_add_u32 v5, v5, v6
  v_add_u32 v5, s21, v5
  s_add_u32 s31, s24, 0
  s_add_u32 m0, s21, 0
  s_nop 0
  buffer_load_dwordx4 v4, s[8:11], s31 offen lds
  s_add_u32 s31, s24, 20480
  s_add_u32 m0, s21, 1024
  s_nop 0
  buffer_load_dwordx4 v4, s[8:11], s31 offen lds
  s_add_u32 s31, s24, 64
  s_add_u32 m0, s21, 2048
  s_nop 0
  buffer_load_dwordx4 v4, s[8:11], s31 offen lds
  s_add_u32 s31, s24, 20544
  s_add_u32 m0, s21, 3072
  s_nop 0
  buffer_load_dwordx4 v4, s[8:11], s31 offen lds
  s_add_u32 s31, s24, 128
  s_add_u32 m0, s21, 4096
  s_nop 0
  buffer_load_dwordx4 v4, s[8:11], s31 offen lds
  s_add_u32 s31, s24, 20608
  s_add_u32 m0, s21, 5120
  s_nop 0
  buffer_load_dwordx4 v4, s[8:11], s31 offen lds
  s_add_u32 s31, s24, 192
  s_add_u32 m0, s21, 6144
  s_nop 0
  buffer_load_dwordx4 v4, s[8:11], s31 offen lds
  s_add_u32 s31, s24, 20672
  s_add_u32 m0, s21, 7168
  s_nop 0
  buffer_load_dwordx4 v4, s[8:11], s31 offen lds
  s_add_u32 s31, s24, 256
  s_add_u32 m0, s21, 8192
  s_nop 0
  buffer_load_dwordx4 v4, s[8:11], s31 offen lds
  s_add_u32 s31, s24, 20736
  s_add_u32 m0, s21, 9216
  s_nop 0
  buffer_load_dwordx4 v4, s[8:11], s31 offen lds
  s_add_u32 s31, s24, 40960
  s_add_u32 m0, s21, 10240
  s_nop 0
  buffer_load_dwordx4 v4, s[8:11], s31 offen lds
  s_add_u32 s31, s24, 61440
  s_add_u32 m0, s21, 11264
  s_nop 0
  buffer_load_dwordx4 v4, s[8:11], s31 offen lds
  s_add_u32 s31, s24, 41024
  s_add_u32 m0, s21, 12288
  s_nop 0
  buffer_load_dwordx4 v4, s[8:11], s31 offen lds
  s_add_u32 s31, s24, 61504
  s_add_u32 m0, s21, 13312
  s_nop 0
  buffer_load_dwordx4 v4, s[8:11], s31 offen lds
  s_add_u32 s31, s24, 41088
  s_add_u32 m0, s21, 14336
  s_nop 0
  buffer_load_dwordx4 v4, s[8:11], s31 offen lds
  s_add_u32 s31, s24, 61568
  s_add_u32 m0, s21, 15360
  s_nop 0
  buffer_load_dwordx4 v4, s[8:11], s31 offen lds
  s_add_u32 s31, s24, 41152
  s_add_u32 m0, s21, 16384
  s_nop 0
  buffer_load_dwordx4 v4, s[8:11], s31 offen lds
  s_add_u32 s31, s24, 61632
  s_add_u32 m0, s21, 17408
  s_nop 0
  buffer_load_dwordx4 v4, s[8:11], s31 offen lds
  s_add_u32 s31, s24, 41216
  s_add_u32 m0, s21, 18432
  s_nop 0
  buffer_load_dwordx4 v4, s[8:11], s31 offen lds
  s_add_u32 s31, s24, 61696
  s_add_u32 m0, s21, 19456
  s_nop 0
  buffer_load_dwordx4 v4, s[8:11], s31 offen lds
  s_add_u32 s31, s24, 81920
  s_add_u32 m0, s21, 20480
  s_nop 0
  buffer_load_dwordx4 v4, s[8:11], s31 offen lds
  s_add_u32 s31, s24, 102400
  s_add_u32 m0, s21, 21504
  s_nop 0
  buffer_load_dwordx4 v4, s[8:11], s31 offen lds
  s_add_u32 s31, s24, 81984
  s_add_u32 m0, s21, 22528
  s_nop 0
  buffer_load_dwordx4 v4, s[8:11], s31 offen lds
  s_add_u32 s31, s24, 102464
  s_add_u32 m0, s21, 23552
  s_nop 0
  buffer_load_dwordx4 v4, s[8:11], s31 offen lds
  s_add_u32 s31, s24, 82048
  s_add_u32 m0, s21, 24576
  s_nop 0
  buffer_load_dwordx4 v4, s[8:11], s31 offen lds
  s_add_u32 s31, s24, 102528
  s_add_u32 m0, s21, 25600
  s_nop 0
  buffer_load_dwordx4 v4, s[8:11], s31 offen lds
  s_add_u32 s31, s24, 82112
  s_add_u32 m0, s21, 26624
  s_nop 0
  buffer_load_dwordx4 v4, s[8:11], s31 offen lds
  s_add_u32 s31, s24, 102592
  s_add_u32 m0, s21, 27648
  s_nop 0
  buffer_load_dwordx4 v4, s[8:11], s31 offen lds
  s_add_u32 s31, s24, 82176
  s_add_u32 m0, s21, 28672
  s_nop 0
  buffer_load_dwordx4 v4, s[8:11], s31 offen lds
  s_add_u32 s31, s24, 102656
  s_add_u32 m0, s21, 29696
  s_nop 0
  buffer_load_dwordx4 v4, s[8:11], s31 offen lds
  s_add_u32 s31, s24, 122880
  s_add_u32 m0, s21, 30720
  s_nop 0
  buffer_load_dwordx4 v4, s[8:11], s31 offen lds
  s_add_u32 s31, s24, 143360
  s_add_u32 m0, s21, 31744
  s_nop 0
  buffer_load_dwordx4 v4, s[8:11], s31 offen lds
  s_waitcnt vmcnt(28)
  ds_read_b64_tr_b16 a[0:1], v5 offset:0
  ds_read_b64_tr_b16 a[2:3], v5 offset:1024
  ds_read_b64_tr_b16 a[24:25], v5 offset:32
  ds_read_b64_tr_b16 a[26:27], v5 offset:1056
  ds_read_b64_tr_b16 a[48:49], v5 offset:2048
  ds_read_b64_tr_b16 a[50:51], v5 offset:3072
  ds_read_b64_tr_b16 a[72:73], v5 offset:2080
  ds_read_b64_tr_b16 a[74:75], v5 offset:3104
  s_waitcnt lgkmcnt(0)
  s_add_u32 s31, s24, 122944
  s_add_u32 m0, s21, 0
  s_nop 0
  buffer_load_dwordx4 v4, s[8:11], s31 offen lds
  s_add_u32 s31, s24, 143424
  s_add_u32 m0, s21, 1024
  s_nop 0
  buffer_load_dwordx4 v4, s[8:11], s31 offen lds
  s_add_u32 s31, s24, 123008
  s_add_u32 m0, s21, 2048
  s_nop 0
  buffer_load_dwordx4 v4, s[8:11], s31 offen lds
  s_add_u32 s31, s24, 143488
  s_add_u32 m0, s21, 3072
  s_nop 0
  buffer_load_dwordx4 v4, s[8:11], s31 offen lds
  s_waitcnt vmcnt(28)
  ds_read_b64_tr_b16 a[96:97], v5 offset:4096
  ds_read_b64_tr_b16 a[98:99], v5 offset:5120
  ds_read_b64_tr_b16 a[120:121], v5 offset:4128
  ds_read_b64_tr_b16 a[122:123], v5 offset:5152
  ds_read_b64_tr_b16 a[144:145], v5 offset:6144
  ds_read_b64_tr_b16 a[146:147], v5 offset:7168
  ds_read_b64_tr_b16 a[168:169], v5 offset:6176
  ds_read_b64_tr_b16 a[170:171], v5 offset:7200
  s_waitcnt lgkmcnt(0)
  s_add_u32 s31, s24, 123072
  s_add_u32 m0, s21, 4096
  s_nop 0
  buffer_load_dwordx4 v4, s[8:11], s31 offen lds
  s_add_u32 s31, s24, 143552
  s_add_u32 m0, s21, 5120
  s_nop 0
  buffer_load_dwordx4 v4, s[8:11], s31 offen lds
  s_add_u32 s31, s24, 123136
  s_add_u32 m0, s21, 6144
  s_nop 0
  buffer_load_dwordx4 v4, s[8:11], s31 offen lds
  s_add_u32 s31, s24, 143616
  s_add_u32 m0, s21, 7168
  s_nop 0
  buffer_load_dwordx4 v4, s[8:11], s31 offen lds
  s_waitcnt vmcnt(28)
  ds_read_b64_tr_b16 a[192:193], v5 offset:8192
  ds_read_b64_tr_b16 a[194:195], v5 offset:9216
  ds_read_b64_tr_b16 a[216:217], v5 offset:8224
  ds_read_b64_tr_b16 a[218:219], v5 offset:9248
  ds_read_b64_tr_b16 a[4:5], v5 offset:10240
  ds_read_b64_tr_b16 a[6:7], v5 offset:11264
  ds_read_b64_tr_b16 a[28:29], v5 offset:10272
  ds_read_b64_tr_b16 a[30:31], v5 offset:11296
  s_waitcnt lgkmcnt(0)
  s_add_u32 s31, s24, 163840
  s_add_u32 m0, s21, 8192
  s_nop 0
  buffer_load_dwordx4 v4, s[8:11], s31 offen lds
  s_add_u32 s31, s24, 184320
  s_add_u32 m0, s21, 9216
  s_nop 0
  buffer_load_dwordx4 v4, s[8:11], s31 offen lds
  s_add_u32 s31, s24, 163904
  s_add_u32 m0, s21, 10240
  s_nop 0
  buffer_load_dwordx4 v4, s[8:11], s31 offen lds
  s_add_u32 s31, s24, 184384
  s_add_u32 m0, s21, 11264
  s_nop 0
  buffer_load_dwordx4 v4, s[8:11], s31 offen lds
  s_waitcnt vmcnt(28)
  ds_read_b64_tr_b16 a[52:53], v5 offset:12288
  ds_read_b64_tr_b16 a[54:55], v5 offset:13312
  ds_read_b64_tr_b16 a[76:77], v5 offset:12320
  ds_read_b64_tr_b16 a[78:79], v5 offset:13344
  ds_read_b64_tr_b16 a[100:101], v5 offset:14336
  ds_read_b64_tr_b16 a[102:103], v5 offset:15360
  ds_read_b64_tr_b16 a[124:125], v5 offset:14368
  ds_read_b64_tr_b16 a[126:127], v5 offset:15392
  s_waitcnt lgkmcnt(0)
  s_add_u32 s31, s24, 163968
  s_add_u32 m0, s21, 12288
  s_nop 0
  buffer_load_dwordx4 v4, s[8:11], s31 offen lds
  s_add_u32 s31, s24, 184448
  s_add_u32 m0, s21, 13312
  s_nop 0
  buffer_load_dwordx4 v4, s[8:11], s31 offen lds
  s_add_u32 s31, s24, 164032
  s_add_u32 m0, s21, 14336
  s_nop 0
  buffer_load_dwordx4 v4, s[8:11], s31 offen lds
  s_add_u32 s31, s24, 184512
  s_add_u32 m0, s21, 15360
  s_nop 0
  buffer_load_dwordx4 v4, s[8:11], s31 offen lds
  s_waitcnt vmcnt(28)
  ds_read_b64_tr_b16 a[148:149], v5 offset:16384
  ds_read_b64_tr_b16 a[150:151], v5 offset:17408
  ds_read_b64_tr_b16 a[172:173], v5 offset:16416
  ds_read_b64_tr_b16 a[174:175], v5 offset:17440
  ds_read_b64_tr_b16 a[196:197], v5 offset:18432
  ds_read_b64_tr_b16 a[198:199], v5 offset:19456
  ds_read_b64_tr_b16 a[220:221], v5 offset:18464
  ds_read_b64_tr_b16 a[222:223], v5 offset:19488
  s_waitcnt lgkmcnt(0)
  s_add_u32 s31, s24, 164096
  s_add_u32 m0, s21, 16384
  s_nop 0
  buffer_load_dwordx4 v4, s[8:11], s31 offen lds
  s_add_u32 s31, s24, 184576
  s_add_u32 m0, s21, 17408
  s_nop 0
  buffer_load_dwordx4 v4, s[8:11], s31 offen lds
  s_add_u32 s31, s24, 204800
  s_add_u32 m0, s21, 18432
  s_nop 0
  buffer_load_dwordx4 v4, s[8:11], s31 offen lds
  s_add_u32 s31, s24, 225280
  s_add_u32 m0, s21, 19456
  s_nop 0
  buffer_load_dwordx4 v4, s[8:11], s31 offen lds
  s_waitcnt vmcnt(28)
  ds_read_b64_tr_b16 a[8:9], v5 offset:20480
  ds_read_b64_tr_b16 a[10:11], v5 offset:21504
  ds_read_b64_tr_b16 a[32:33], v5 offset:20512
  ds_read_b64_tr_b16 a[34:35], v5 offset:21536
  ds_read_b64_tr_b16 a[56:57], v5 offset:22528
  ds_read_b64_tr_b16 a[58:59], v5 offset:23552
  ds_read_b64_tr_b16 a[80:81], v5 offset:22560
  ds_read_b64_tr_b16 a[82:83], v5 offset:23584
  s_waitcnt lgkmcnt(0)
  s_add_u32 s31, s24, 204864
  s_add_u32 m0, s21, 20480
  s_nop 0
  buffer_load_dwordx4 v4, s[8:11], s31 offen lds
  s_add_u32 s31, s24, 225344
  s_add_u32 m0, s21, 21504
  s_nop 0
  buffer_load_dwordx4 v4, s[8:11], s31 offen lds
  s_add_u32 s31, s24, 204928
  s_add_u32 m0, s21, 22528
  s_nop 0
  buffer_load_dwordx4 v4, s[8:11], s31 offen lds
  s_add_u32 s31, s24, 225408
  s_add_u32 m0, s21, 23552
  s_nop 0
  buffer_load_dwordx4 v4, s[8:11], s31 offen lds
  s_waitcnt vmcnt(28)
  ds_read_b64_tr_b16 a[104:105], v5 offset:24576
  ds_read_b64_tr_b16 a[106:107], v5 offset:25600
  ds_read_b64_tr_b16 a[128:129], v5 offset:24608
  ds_read_b64_tr_b16 a[130:131], v5 offset:25632
  ds_read_b64_tr_b16 a[152:153], v5 offset:26624
  ds_read_b64_tr_b16 a[154:155], v5 offset:27648
  ds_read_b64_tr_b16 a[176:177], v5 offset:26656
  ds_read_b64_tr_b16 a[178:179], v5 offset:27680
  s_waitcnt lgkmcnt(0)
  s_add_u32 s31, s24, 204992
  s_add_u32 m0, s21, 24576
  s_nop 0
  buffer_load_dwordx4 v4, s[8:11], s31 offen lds
  s_add_u32 s31, s24, 225472
  s_add_u32 m0, s21, 25600
  s_nop 0
  buffer_load_dwordx4 v4, s[8:11], s31 offen lds
  s_add_u32 s31, s24, 205056
  s_add_u32 m0, s21, 26624
  s_nop 0
  buffer_load_dwordx4 v4, s[8:11], s31 offen lds
  s_add_u32 s31, s24, 225536
  s_add_u32 m0, s21, 27648
  s_nop 0
  buffer_load_dwordx4 v4, s[8:11], s31 offen lds
  s_waitcnt vmcnt(28)
  ds_read_b64_tr_b16 a[200:201], v5 offset:28672
  ds_read_b64_tr_b16 a[202:203], v5 offset:29696
  ds_read_b64_tr_b16 a[224:225], v5 offset:28704
  ds_read_b64_tr_b16 a[226:227], v5 offset:29728
  ds_read_b64_tr_b16 a[12:13], v5 offset:30720
  ds_read_b64_tr_b16 a[14:15], v5 offset:31744
  ds_read_b64_tr_b16 a[36:37], v5 offset:30752
  ds_read_b64_tr_b16 a[38:39], v5 offset:31776
  s_waitcnt vmcnt(24)
  ds_read_b64_tr_b16 a[60:61], v5 offset:0
  ds_read_b64_tr_b16 a[62:63], v5 offset:1024
  ds_read_b64_tr_b16 a[84:85], v5 offset:32
  ds_read_b64_tr_b16 a[86:87], v5 offset:1056
  ds_read_b64_tr_b16 a[108:109], v5 offset:2048
  ds_read_b64_tr_b16 a[110:111], v5 offset:3072
  ds_read_b64_tr_b16 a[132:133], v5 offset:2080
  ds_read_b64_tr_b16 a[134:135], v5 offset:3104
  s_waitcnt vmcnt(20)
  ds_read_b64_tr_b16 a[156:157], v5 offset:4096
  ds_read_b64_tr_b16 a[158:159], v5 offset:5120
  ds_read_b64_tr_b16 a[180:181], v5 offset:4128
  ds_read_b64_tr_b16 a[182:183], v5 offset:5152
  ds_read_b64_tr_b16 a[204:205], v5 offset:6144
  ds_read_b64_tr_b16 a[206:207], v5 offset:7168
  ds_read_b64_tr_b16 a[228:229], v5 offset:6176
  ds_read_b64_tr_b16 a[230:231], v5 offset:7200
  s_waitcnt vmcnt(16)
  ds_read_b64_tr_b16 a[16:17], v5 offset:8192
  ds_read_b64_tr_b16 a[18:19], v5 offset:9216
  ds_read_b64_tr_b16 a[40:41], v5 offset:8224
  ds_read_b64_tr_b16 a[42:43], v5 offset:9248
  ds_read_b64_tr_b16 a[64:65], v5 offset:10240
  ds_read_b64_tr_b16 a[66:67], v5 offset:11264
  ds_read_b64_tr_b16 a[88:89], v5 offset:10272
  ds_read_b64_tr_b16 a[90:91], v5 offset:11296
  s_waitcnt vmcnt(12)
  ds_read_b64_tr_b16 a[112:113], v5 offset:12288
  ds_read_b64_tr_b16 a[114:115], v5 offset:13312
  ds_read_b64_tr_b16 a[136:137], v5 offset:12320
  ds_read_b64_tr_b16 a[138:139], v5 offset:13344
  ds_read_b64_tr_b16 a[160:161], v5 offset:14336
  ds_read_b64_tr_b16 a[162:163], v5 offset:15360
  ds_read_b64_tr_b16 a[184:185], v5 offset:14368
  ds_read_b64_tr_b16 a[186:187], v5 offset:15392
  s_waitcnt vmcnt(8)
  ds_read_b64_tr_b16 a[208:209], v5 offset:16384
  ds_read_b64_tr_b16 a[210:211], v5 offset:17408
  ds_read_b64_tr_b16 a[232:233], v5 offset:16416
  ds_read_b64_tr_b16 a[234:235], v5 offset:17440
  ds_read_b64_tr_b16 a[20:21], v5 offset:18432
  ds_read_b64_tr_b16 a[22:23], v5 offset:19456
  ds_read_b64_tr_b16 a[44:45], v5 offset:18464
  ds_read_b64_tr_b16 a[46:47], v5 offset:19488
  s_waitcnt vmcnt(4)
  ds_read_b64_tr_b16 a[68:69], v5 offset:20480
  ds_read_b64_tr_b16 a[70:71], v5 offset:21504
  ds_read_b64_tr_b16 a[92:93], v5 offset:20512
  ds_read_b64_tr_b16 a[94:95], v5 offset:21536
  ds_read_b64_tr_b16 a[116:117], v5 offset:22528
  ds_read_b64_tr_b16 a[118:119], v5 offset:23552
  ds_read_b64_tr_b16 a[140:141], v5 offset:22560
  ds_read_b64_tr_b16 a[142:143], v5 offset:23584
  s_waitcnt vmcnt(0)
  ds_read_b64_tr_b16 a[164:165], v5 offset:24576
  ds_read_b64_tr_b16 a[166:167], v5 offset:25600
  ds_read_b64_tr_b16 a[188:189], v5 offset:24608
  ds_read_b64_tr_b16 a[190:191], v5 offset:25632
  ds_read_b64_tr_b16 a[212:213], v5 offset:26624
  ds_read_b64_tr_b16 a[214:215], v5 offset:27648
  ds_read_b64_tr_b16 a[236:237], v5 offset:26656
  ds_read_b64_tr_b16 a[238:239], v5 offset:27680
  s_waitcnt lgkmcnt(0)
  v_mov_b32 v250, 48
  s_mov_b32 s86, 0
  s_nop 0
WI_UP:
  global_load_dword v251, v250, s[76:77] sc1
  s_waitcnt vmcnt(0)
  v_readfirstlane_b32 s88, v251
  s_nop 0
  s_cmp_ge_u32 s88, 80
  s_nop 1
  s_cbranch_scc1 WI_UP_K
  s_sleep 4
  s_add_u32 s86, s86, 1
  s_cmp_lt_u32 s86, 0x100000
  s_cbranch_scc1 WI_UP
WI_UP_K:
  s_barrier
  v_mov_b32 v14, 0x80000000
  v_lshlrev_b32 v7, 4, v1
  s_mul_i32 s31, s25, 12288
  s_mul_i32 s32, s20, 3072
  s_add_u32 s27, s31, s32
  s_add_u32 s27, s27, 37748736
  s_mov_b32 s28, s32
  s_mov_b32 s29, 0
  s_mul_i32 s31, s25, 40
  s_mul_i32 s32, s20, 10
  s_add_u32 s31, s31, s32
  s_lshl_b32 s30, s31, 10
  s_add_u32 s30, s30, 132120576
  s_mul_i32 s31, s25, 6
  s_lshr_b32 s32, s31, 3
  s_add_u32 s31, s31, 5
  s_lshr_b32 s31, s31, 3
  v_mov_b32 v11, s31
  v_mov_b32 v6, s32
  v_cmp_eq_u32 vcc, 0, v1
  s_nop 1
  v_cndmask_b32 v11, v11, v6, vcc
  v_lshlrev_b32 v11, 7, v11
  v_add_u32 v11, 8440832, v11
  v_mov_b32 v10, 0
  s_mov_b32 s34, 0
  s_mov_b32 s35, 0
  s_mov_b32 s36, 0
  s_mov_b32 s59, 0
  s_mov_b32 s61, 0
  v_mov_b32 v13, 8390656
  s_add_u32 s36, s36, 2
  s_min_u32 s42, s36, 128
  s_cmp_ge_u32 s35, s42
  s_cbranch_scc1 MUP_WV73_D
  s_mov_b32 s43, 0
MUP_WV73:
  buffer_load_dword v12, v11, s[4:7], 0 offen sc1
  s_waitcnt vmcnt(0)
  v_cmp_gt_u32 vcc, s42, v12
  s_nop 3
  s_cbranch_vccz MUP_WV73_K
  s_sleep 4
  s_add_u32 s43, s43, 1
  s_cmp_lt_u32 s43, 0x100000
  s_cbranch_scc1 MUP_WV73
MUP_WV73_K:
  v_readlane_b32 s35, v12, 0
  v_readlane_b32 s37, v12, 1
  s_nop 0
  s_min_u32 s35, s35, s37
  s_nop 2
MUP_WV73_D:
  s_mov_b32 m0, s28
  s_nop 0
  buffer_load_dwordx4 v7, s[4:7], s27 offen offset:0 sc1 lds
  buffer_load_dwordx4 v7, s[4:7], s27 offen offset:1024 sc1 lds
  buffer_load_dwordx4 v7, s[4:7], s27 offen offset:2048 sc1 lds
  s_add_u32 s27, s27, 393216
  s_add_u32 s28, s28, 12288
  s_sub_u32 s31, s28, 24576
  s_cmp_ge_u32 s28, 24576
  s_cselect_b32 s28, s31, s28
  s_mov_b32 s26, 0
MUP_LOOP:
  s_cmp_lt_u32 s26, 2
  s_cbranch_scc1 MUP_W0
  s_cmp_eq_u32 s20, 0
  s_cbranch_scc1 MUP_WZ
  s_waitcnt vmcnt(10)
  s_branch MUP_W1
MUP_WZ:
  s_waitcnt vmcnt(11)
  s_branch MUP_W1
MUP_W0:
  s_waitcnt vmcnt(0)
MUP_W1:
  s_barrier
  s_sub_u32 s34, s26, 1
  s_cmp_lt_u32 s26, 2
  s_cselect_b32 s34, s26, s34
  s_add_u32 s36, s36, 2
  s_min_u32 s42, s36, 128
  s_cmp_ge_u32 s35, s42
  s_cbranch_scc1 MUP_WV74_D
  s_mov_b32 s43, 0
MUP_WV74:
  buffer_load_dword v12, v11, s[4:7], 0 offen sc1
  s_waitcnt vmcnt(0)
  v_cmp_gt_u32 vcc, s42, v12
  s_nop 3
  s_cbranch_vccz MUP_WV74_K
  s_sleep 4
  s_add_u32 s43, s43, 1
  s_cmp_lt_u32 s43, 0x100000
  s_cbranch_scc1 MUP_WV74
MUP_WV74_K:
  v_readlane_b32 s35, v12, 0
  v_readlane_b32 s37, v12, 1
  s_nop 0
  s_min_u32 s35, s35, s37
  s_nop 2
MUP_WV74_D:
  s_mov_b32 m0, s28
  s_nop 0
  buffer_load_dwordx4 v7, s[4:7], s27 offen offset:0 sc1 lds
  buffer_load_dwordx4 v7, s[4:7], s27 offen offset:1024 sc1 lds
  buffer_load_dwordx4 v7, s[4:7], s27 offen offset:2048 sc1 lds
  s_add_u32 s27, s27, 393216
  s_add_u32 s28, s28, 12288
  s_sub_u32 s31, s28, 24576
  s_cmp_ge_u32 s28, 24576
  s_cselect_b32 s28, s31, s28
  s_cmp_lg_u32 s20, 0
  s_cbranch_scc1 MUP_NPB
  v_mov_b32 v9, s34
  s_mov_b64 exec, 1
  buffer_store_dword v9, v10, s[4:7], s33 offen sc1
  s_mov_b64 exec, -1
MUP_NPB:
  v_add_u32 v8, s29, v7
  ds_read_b128 v[16:19], v8 offset:0
  ds_read_b128 v[20:23], v8 offset:1024
  ds_read_b128 v[24:27], v8 offset:2048
  ds_read_b128 v[28:31], v8 offset:3072
  ds_read_b128 v[32:35], v8 offset:4096
  ds_read_b128 v[36:39], v8 offset:5120
  ds_read_b128 v[40:43], v8 offset:6144
  ds_read_b128 v[44:47], v8 offset:7168
  ds_read_b128 v[48:51], v8 offset:8192
  ds_read_b128 v[52:55], v8 offset:9216
  ds_read_b128 v[56:59], v8 offset:10240
  ds_read_b128 v[60:63], v8 offset:11264
  s_add_u32 s29, s29, 12288
  s_cmp_ge_u32 s29, 24576
  s_cselect_b32 s29, 0, s29
  s_waitcnt lgkmcnt(0)
  v_mfma_f32_16x16x32_bf16 v[112:115], v[16:19], a[0:3], 0
  v_mfma_f32_16x16x32_bf16 v[116:119], v[40:43], a[0:3], 0
  v_mfma_f32_16x16x32_bf16 v[112:115], v[20:23], a[4:7], v[112:115]
  v_mfma_f32_16x16x32_bf16 v[116:119], v[44:47], a[4:7], v[116:119]
  v_mfma_f32_16x16x32_bf16 v[112:115], v[24:27], a[8:11], v[112:115]
  v_mfma_f32_16x16x32_bf16 v[116:119], v[48:51], a[8:11], v[116:119]
  v_mfma_f32_16x16x32_bf16 v[112:115], v[28:31], a[12:15], v[112:115]
  v_mfma_f32_16x16x32_bf16 v[116:119], v[52:55], a[12:15], v[116:119]
  v_mfma_f32_16x16x32_bf16 v[112:115], v[32:35], a[16:19], v[112:115]
  v_mfma_f32_16x16x32_bf16 v[116:119], v[56:59], a[16:19], v[116:119]
  v_mfma_f32_16x16x32_bf16 v[112:115], v[36:39], a[20:23], v[112:115]
  v_mfma_f32_16x16x32_bf16 v[116:119], v[60:63], a[20:23], v[116:119]
  v_mfma_f32_16x16x32_bf16 v[120:123], v[16:19], a[24:27], 0
  v_mfma_f32_16x16x32_bf16 v[124:127], v[40:43], a[24:27], 0
  v_mfma_f32_16x16x32_bf16 v[120:123], v[20:23], a[28:31], v[120:123]
  v_mfma_f32_16x16x32_bf16 v[124:127], v[44:47], a[28:31], v[124:127]
  v_mfma_f32_16x16x32_bf16 v[120:123], v[24:27], a[32:35], v[120:123]
  v_mfma_f32_16x16x32_bf16 v[124:127], v[48:51], a[32:35], v[124:127]
  v_mfma_f32_16x16x32_bf16 v[120:123], v[28:31], a[36:39], v[120:123]
  v_mfma_f32_16x16x32_bf16 v[124:127], v[52:55], a[36:39], v[124:127]
  v_cvt_pk_bf16_f32 v128, v112, v113
  v_cvt_pk_bf16_f32 v129, v114, v115
  v_mfma_f32_16x16x32_bf16 v[120:123], v[32:35], a[40:43], v[120:123]
  v_mfma_f32_16x16x32_bf16 v[124:127], v[56:59], a[40:43], v[124:127]
  v_cvt_pk_bf16_f32 v130, v116, v117
  v_cvt_pk_bf16_f32 v131, v118, v119
  v_mfma_f32_16x16x32_bf16 v[120:123], v[36:39], a[44:47], v[120:123]
  v_mfma_f32_16x16x32_bf16 v[124:127], v[60:63], a[44:47], v[124:127]
  s_add_u32 s31, s30, 0
  buffer_store_dwordx4 v[128:131], v7, s[4:7], s31 offen sc1
  v_mfma_f32_16x16x32_bf16 v[112:115], v[16:19], a[48:51], 0
  v_mfma_f32_16x16x32_bf16 v[116:119], v[40:43], a[48:51], 0
  v_mfma_f32_16x16x32_bf16 v[112:115], v[20:23], a[52:55], v[112:115]
  v_mfma_f32_16x16x32_bf16 v[116:119], v[44:47], a[52:55], v[116:119]
  v_mfma_f32_16x16x32_bf16 v[112:115], v[24:27], a[56:59], v[112:115]
  v_mfma_f32_16x16x32_bf16 v[116:119], v[48:51], a[56:59], v[116:119]
  v_mfma_f32_16x16x32_bf16 v[112:115], v[28:31], a[60:63], v[112:115]
  v_mfma_f32_16x16x32_bf16 v[116:119], v[52:55], a[60:63], v[116:119]
  v_cvt_pk_bf16_f32 v132, v120, v121
  v_cvt_pk_bf16_f32 v133, v122, v123
  v_mfma_f32_16x16x32_bf16 v[112:115], v[32:35], a[64:67], v[112:115]
  v_mfma_f32_16x16x32_bf16 v[116:119], v[56:59], a[64:67], v[116:119]
  v_cvt_pk_bf16_f32 v134, v124, v125
  v_cvt_pk_bf16_f32 v135, v126, v127
  v_mfma_f32_16x16x32_bf16 v[112:115], v[36:39], a[68:71], v[112:115]
  v_mfma_f32_16x16x32_bf16 v[116:119], v[60:63], a[68:71], v[116:119]
  s_add_u32 s31, s30, 1024
  buffer_store_dwordx4 v[132:135], v7, s[4:7], s31 offen sc1
  v_mfma_f32_16x16x32_bf16 v[120:123], v[16:19], a[72:75], 0
  v_mfma_f32_16x16x32_bf16 v[124:127], v[40:43], a[72:75], 0
  v_mfma_f32_16x16x32_bf16 v[120:123], v[20:23], a[76:79], v[120:123]
  v_mfma_f32_16x16x32_bf16 v[124:127], v[44:47], a[76:79], v[124:127]
  v_mfma_f32_16x16x32_bf16 v[120:123], v[24:27], a[80:83], v[120:123]
  v_mfma_f32_16x16x32_bf16 v[124:127], v[48:51], a[80:83], v[124:127]
  v_mfma_f32_16x16x32_bf16 v[120:123], v[28:31], a[84:87], v[120:123]
  v_mfma_f32_16x16x32_bf16 v[124:127], v[52:55], a[84:87], v[124:127]
  v_cvt_pk_bf16_f32 v128, v112, v113
  v_cvt_pk_bf16_f32 v129, v114, v115
  v_mfma_f32_16x16x32_bf16 v[120:123], v[32:35], a[88:91], v[120:123]
  v_mfma_f32_16x16x32_bf16 v[124:127], v[56:59], a[88:91], v[124:127]
  v_cvt_pk_bf16_f32 v130, v116, v117
  v_cvt_pk_bf16_f32 v131, v118, v119
  v_mfma_f32_16x16x32_bf16 v[120:123], v[36:39], a[92:95], v[120:123]
  v_mfma_f32_16x16x32_bf16 v[124:127], v[60:63], a[92:95], v[124:127]
  s_add_u32 s31, s30, 2048
  buffer_store_dwordx4 v[128:131], v7, s[4:7], s31 offen sc1
  v_mfma_f32_16x16x32_bf16 v[112:115], v[16:19], a[96:99], 0
  v_mfma_f32_16x16x32_bf16 v[116:119], v[40:43], a[96:99], 0
  v_mfma_f32_16x16x32_bf16 v[112:115], v[20:23], a[100:103], v[112:115]
  v_mfma_f32_16x16x32_bf16 v[116:119], v[44:47], a[100:103], v[116:119]
  v_mfma_f32_16x16x32_bf16 v[112:115], v[24:27], a[104:107], v[112:115]
  v_mfma_f32_16x16x32_bf16 v[116:119], v[48:51], a[104:107], v[116:119]
  v_mfma_f32_16x16x32_bf16 v[112:115], v[28:31], a[108:111], v[112:115]
  v_mfma_f32_16x16x32_bf16 v[116:119], v[52:55], a[108:111], v[116:119]
  v_cvt_pk_bf16_f32 v132, v120, v121
  v_cvt_pk_bf16_f32 v133, v122, v123
  v_mfma_f32_16x16x32_bf16 v[112:115], v[32:35], a[112:115], v[112:115]
  v_mfma_f32_16x16x32_bf16 v[116:119], v[56:59], a[112:115], v[116:119]
  v_cvt_pk_bf16_f32 v134, v124, v125
  v_cvt_pk_bf16_f32 v135, v126, v127
  v_mfma_f32_16x16x32_bf16 v[112:115], v[36:39], a[116:119], v[112:115]
  v_mfma_f32_16x16x32_bf16 v[116:119], v[60:63], a[116:119], v[116:119]
  s_add_u32 s31, s30, 3072
  buffer_store_dwordx4 v[132:135], v7, s[4:7], s31 offen sc1
  v_mfma_f32_16x16x32_bf16 v[120:123], v[16:19], a[120:123], 0
  v_mfma_f32_16x16x32_bf16 v[124:127], v[40:43], a[120:123], 0
  v_mfma_f32_16x16x32_bf16 v[120:123], v[20:23], a[124:127], v[120:123]
  v_mfma_f32_16x16x32_bf16 v[124:127], v[44:47], a[124:127], v[124:127]
  v_mfma_f32_16x16x32_bf16 v[120:123], v[24:27], a[128:131], v[120:123]
  v_mfma_f32_16x16x32_bf16 v[124:127], v[48:51], a[128:131], v[124:127]
  v_mfma_f32_16x16x32_bf16 v[120:123], v[28:31], a[132:135], v[120:123]
  v_mfma_f32_16x16x32_bf16 v[124:127], v[52:55], a[132:135], v[124:127]
  v_cvt_pk_bf16_f32 v128, v112, v113
  v_cvt_pk_bf16_f32 v129, v114, v115
  v_mfma_f32_16x16x32_bf16 v[120:123], v[32:35], a[136:139], v[120:123]
  v_mfma_f32_16x16x32_bf16 v[124:127], v[56:59], a[136:139], v[124:127]
  v_cvt_pk_bf16_f32 v130, v116, v117
  v_cvt_pk_bf16_f32 v131, v118, v119
  v_mfma_f32_16x16x32_bf16 v[120:123], v[36:39], a[140:143], v[120:123]
  v_mfma_f32_16x16x32_bf16 v[124:127], v[60:63], a[140:143], v[124:127]
  s_add_u32 s31, s30, 4096
  buffer_store_dwordx4 v[128:131], v7, s[4:7], s31 offen sc1
  v_mfma_f32_16x16x32_bf16 v[112:115], v[16:19], a[144:147], 0
  v_mfma_f32_16x16x32_bf16 v[116:119], v[40:43], a[144:147], 0
  v_mfma_f32_16x16x32_bf16 v[112:115], v[20:23], a[148:151], v[112:115]
  v_mfma_f32_16x16x32_bf16 v[116:119], v[44:47], a[148:151], v[116:119]
  v_mfma_f32_16x16x32_bf16 v[112:115], v[24:27], a[152:155], v[112:115]
  v_mfma_f32_16x16x32_bf16 v[116:119], v[48:51], a[152:155], v[116:119]
  v_mfma_f32_16x16x32_bf16 v[112:115], v[28:31], a[156:159], v[112:115]
  v_mfma_f32_16x16x32_bf16 v[116:119], v[52:55], a[156:159], v[116:119]
  v_cvt_pk_bf16_f32 v132, v120, v121
  v_cvt_pk_bf16_f32 v133, v122, v123
  v_mfma_f32_16x16x32_bf16 v[112:115], v[32:35], a[160:163], v[112:115]
  v_mfma_f32_16x16x32_bf16 v[116:119], v[56:59], a[160:163], v[116:119]
  v_cvt_pk_bf16_f32 v134, v124, v125
  v_cvt_pk_bf16_f32 v135, v126, v127
  v_mfma_f32_16x16x32_bf16 v[112:115], v[36:39], a[164:167], v[112:115]
  v_mfma_f32_16x16x32_bf16 v[116:119], v[60:63], a[164:167], v[116:119]
  s_add_u32 s31, s30, 5120
  buffer_store_dwordx4 v[132:135], v7, s[4:7], s31 offen sc1
  v_mfma_f32_16x16x32_bf16 v[120:123], v[16:19], a[168:171], 0
  v_mfma_f32_16x16x32_bf16 v[124:127], v[40:43], a[168:171], 0
  v_mfma_f32_16x16x32_bf16 v[120:123], v[20:23], a[172:175], v[120:123]
  v_mfma_f32_16x16x32_bf16 v[124:127], v[44:47], a[172:175], v[124:127]
  v_mfma_f32_16x16x32_bf16 v[120:123], v[24:27], a[176:179], v[120:123]
  v_mfma_f32_16x16x32_bf16 v[124:127], v[48:51], a[176:179], v[124:127]
  v_mfma_f32_16x16x32_bf16 v[120:123], v[28:31], a[180:183], v[120:123]
  v_mfma_f32_16x16x32_bf16 v[124:127], v[52:55], a[180:183], v[124:127]
  v_cvt_pk_bf16_f32 v128, v112, v113
  v_cvt_pk_bf16_f32 v129, v114, v115
  v_mfma_f32_16x16x32_bf16 v[120:123], v[32:35], a[184:187], v[120:123]
  v_mfma_f32_16x16x32_bf16 v[124:127], v[56:59], a[184:187], v[124:127]
  v_cvt_pk_bf16_f32 v130, v116, v117
  v_cvt_pk_bf16_f32 v131, v118, v119
  v_mfma_f32_16x16x32_bf16 v[120:123], v[36:39], a[188:191], v[120:123]
  v_mfma_f32_16x16x32_bf16 v[124:127], v[60:63], a[188:191], v[124:127]
  s_add_u32 s31, s30, 6144
  buffer_store_dwordx4 v[128:131], v7, s[4:7], s31 offen sc1
  v_mfma_f32_16x16x32_bf16 v[112:115], v[16:19], a[192:195], 0
  v_mfma_f32_16x16x32_bf16 v[116:119], v[40:43], a[192:195], 0
  v_mfma_f32_16x16x32_bf16 v[112:115], v[20:23], a[196:199], v[112:115]
  v_mfma_f32_16x16x32_bf16 v[116:119], v[44:47], a[196:199], v[116:119]
  v_mfma_f32_16x16x32_bf16 v[112:115], v[24:27], a[200:203], v[112:115]
  v_mfma_f32_16x16x32_bf16 v[116:119], v[48:51], a[200:203], v[116:119]
  v_mfma_f32_16x16x32_bf16 v[112:115], v[28:31], a[204:207], v[112:115]
  v_mfma_f32_16x16x32_bf16 v[116:119], v[52:55], a[204:207], v[116:119]
  v_cvt_pk_bf16_f32 v132, v120, v121
  v_cvt_pk_bf16_f32 v133, v122, v123
  v_mfma_f32_16x16x32_bf16 v[112:115], v[32:35], a[208:211], v[112:115]
  v_mfma_f32_16x16x32_bf16 v[116:119], v[56:59], a[208:211], v[116:119]
  v_cvt_pk_bf16_f32 v134, v124, v125
  v_cvt_pk_bf16_f32 v135, v126, v127
  v_mfma_f32_16x16x32_bf16 v[112:115], v[36:39], a[212:215], v[112:115]
  v_mfma_f32_16x16x32_bf16 v[116:119], v[60:63], a[212:215], v[116:119]
  s_add_u32 s31, s30, 7168
  buffer_store_dwordx4 v[132:135], v7, s[4:7], s31 offen sc1
  v_mfma_f32_16x16x32_bf16 v[120:123], v[16:19], a[216:219], 0
  v_mfma_f32_16x16x32_bf16 v[124:127], v[40:43], a[216:219], 0
  v_mfma_f32_16x16x32_bf16 v[120:123], v[20:23], a[220:223], v[120:123]
  v_mfma_f32_16x16x32_bf16 v[124:127], v[44:47], a[220:223], v[124:127]
  v_mfma_f32_16x16x32_bf16 v[120:123], v[24:27], a[224:227], v[120:123]
  v_mfma_f32_16x16x32_bf16 v[124:127], v[48:51], a[224:227], v[124:127]
  v_mfma_f32_16x16x32_bf16 v[120:123], v[28:31], a[228:231], v[120:123]
  v_mfma_f32_16x16x32_bf16 v[124:127], v[52:55], a[228:231], v[124:127]
  v_cvt_pk_bf16_f32 v128, v112, v113
  v_cvt_pk_bf16_f32 v129, v114, v115
  v_mfma_f32_16x16x32_bf16 v[120:123], v[32:35], a[232:235], v[120:123]
  v_mfma_f32_16x16x32_bf16 v[124:127], v[56:59], a[232:235], v[124:127]
  v_cvt_pk_bf16_f32 v130, v116, v117
  v_cvt_pk_bf16_f32 v131, v118, v119
  v_mfma_f32_16x16x32_bf16 v[120:123], v[36:39], a[236:239], v[120:123]
  v_mfma_f32_16x16x32_bf16 v[124:127], v[60:63], a[236:239], v[124:127]
  s_add_u32 s31, s30, 8192
  buffer_store_dwordx4 v[128:131], v7, s[4:7], s31 offen sc1
  s_nop 4
  v_cvt_pk_bf16_f32 v132, v120, v121
  v_cvt_pk_bf16_f32 v133, v122, v123
  v_cvt_pk_bf16_f32 v134, v124, v125
  v_cvt_pk_bf16_f32 v135, v126, v127
  s_add_u32 s31, s30, 9216
  buffer_store_dwordx4 v[132:135], v7, s[4:7], s31 offen sc1
  s_add_u32 s30, s30, 1310720
  s_add_u32 s26, s26, 1
  s_cmp_lt_u32 s26, 64
  s_cbranch_scc1 MUP_LOOP
  s_waitcnt vmcnt(0)
  s_barrier
  s_mov_b32 s34, 64
  v_mov_b32 v9, s34
  s_mov_b64 exec, 1
  buffer_store_dword v9, v10, s[4:7], s33 offen sc1
  s_mov_b64 exec, -1
  s_waitcnt vmcnt(0)
MK_TOK:
  v_mov_b32 v250, 48
  s_mov_b32 s86, 0
  s_nop 0
WI_T:
  global_load_dword v251, v250, s[76:77] sc1
  s_waitcnt vmcnt(0)
  v_readfirstlane_b32 s88, v251
  s_nop 0
  s_cmp_ge_u32 s88, 80
  s_nop 1
  s_cbranch_scc1 WI_T_K
  s_sleep 4
  s_add_u32 s86, s86, 1
  s_cmp_lt_u32 s86, 0x100000
  s_cbranch_scc1 WI_T
WI_T_K:
  s_barrier
  s_load_dwordx2 s[40:41], s[0:1], 88
  s_load_dwordx2 s[48:49], s[0:1], 96
  s_waitcnt lgkmcnt(0)
  s_mov_b32 s8, s40
  s_and_b32 s9, s41, 0xffff
  s_mov_b32 s10, 2621440
  s_mov_b32 s11, 0x00020000
  v_lshrrev_b32 v2, 6, v0
  s_nop 0
  v_readfirstlane_b32 s20, v2
  v_and_b32 v1, 63, v0
  v_lshrrev_b32 v2, 4, v1
  v_and_b32 v3, 15, v1
  v_lshlrev_b32 v5, 4, v1
  v_lshlrev_b32 v8, 3, v1
  v_lshlrev_b32 v6, 7, v2
  v_and_b32 v4, 7, v1
  v_lshlrev_b32 v4, 4, v4
  v_add_u32 v6, v6, v4
  v_mov_b32 v7, 0xff800000
  s_mov_b32 s26, 0x3dd53b95
  s_mov_b32 s36, 0
  s_mov_b32 s37, -1
  v_lshlrev_b32 v4, 2, v2
  v_add_u32 v9, 0, v4
  v_cmp_gt_u32 s[28:29], v9, v3
  v_add_u32 v9, 1, v4
  v_cmp_gt_u32 s[30:31], v9, v3
  v_add_u32 v9, 2, v4
  v_cmp_gt_u32 s[32:33], v9, v3
  v_add_u32 v9, 3, v4
  v_cmp_gt_u32 s[34:35], v9, v3
  v_mul_u32_u24 v10, 1280, v3
  v_lshlrev_b32 v4, 3, v2
  v_add_u32 v10, v10, v4
  v_and_b32 v4, 31, v1
  v_lshlrev_b32 v4, 3, v4
  v_lshrrev_b32 v9, 5, v1
  v_mul_u32_u24 v11, 10240, v9
  v_add_u32 v11, v11, v4
  v_mul_u32_u24 v12, 2560, v9
  v_add_u32 v12, v12, v4
  v_mov_b32 v15, 0
  s_nop 1
TOK_LOOP:
  s_cmp_lg_u32 s20, 0
  s_cbranch_scc1 TOK_NT
  v_mov_b32 v14, 1
  v_mov_b32 v13, 36
  s_mov_b64 exec, 1
  global_atomic_add v14, v13, v14, s[48:49] sc0 sc1
  s_waitcnt vmcnt(0)
  v_mov_b32 v13, 65536
  ds_write_b32 v13, v14
  s_waitcnt lgkmcnt(0)
  s_mov_b64 exec, -1
TOK_NT:
  s_barrier
  v_mov_b32 v13, 65536
  ds_read_b32 v14, v13
  s_waitcnt lgkmcnt(0)
  v_readfirstlane_b32 s50, v14
  s_barrier
  s_cmp_ge_u32 s50, 1024
  s_nop 1
  s_cbranch_scc1 TOK_END
  s_lshr_b32 s21, s50, 4
  s_and_b32 s22, s50, 15
  s_cmp_ge_u32 s22, 8
  s_cbranch_scc1 TOK_PU
  s_cmp_lg_u32 s20, 0
  s_cbranch_scc1 TOK_SC_GO
  v_mul_u32_u24 v14, 21846, v1
  v_lshrrev_b32 v14, 16, v14
  v_mul_u32_u24 v13, 3, v14
  v_sub_u32 v13, v1, v13
  v_cmp_eq_u32 vcc, 0, v14
  v_mov_b32 v14, 48
  s_nop 0
  v_cndmask_b32 v14, 0, v14, vcc
  v_add_u32 v13, v13, v14
  s_mul_i32 s23, s22, 3
  v_add_u32 v13, s23, v13
  v_lshlrev_b32 v13, 7, v13
  v_add_u32 v13, 8437760, v13
  s_lshl_b32 s51, s21, 1
  s_add_u32 s51, s51, 2
  s_mov_b32 s52, 0
TSC_W3:
  buffer_load_dword v14, v13, s[4:7], 0 offen sc1
  s_waitcnt vmcnt(0)
  v_cmp_gt_u32 vcc, s51, v14
  s_nop 3
  s_cbranch_vccz TSC_W3_K
  s_sleep 16
  s_add_u32 s52, s52, 1
  s_cmp_lt_u32 s52, 0x100000
  s_cbranch_scc1 TSC_W3
TSC_W3_K:
TSC_W3_D:
TOK_SC_GO:
  s_barrier
  s_lshl_b32 s23, s22, 2
  s_add_u32 s23, s23, s20
  s_lshl_b32 s24, s21, 5
  s_add_u32 s23, s23, s24
  s_mul_i32 s24, s23, 12288
  s_add_u32 s25, s24, 62914560
  buffer_load_dwordx4 v[16:19], v5, s[4:7], s25 offen offset:0 sc1
  buffer_load_dwordx4 v[20:23], v5, s[4:7], s25 offen offset:1024 sc1
  buffer_load_dwordx4 v[24:27], v5, s[4:7], s25 offen offset:2048 sc1
  buffer_load_dwordx4 v[28:31], v5, s[4:7], s25 offen offset:3072 sc1
  s_add_u32 s25, s25, 4096
  buffer_load_dwordx4 v[32:35], v5, s[4:7], s25 offen offset:0 sc1
  buffer_load_dwordx4 v[36:39], v5, s[4:7], s25 offen offset:1024 sc1
  buffer_load_dwordx4 v[40:43], v5, s[4:7], s25 offen offset:2048 sc1
  buffer_load_dwordx4 v[44:47], v5, s[4:7], s25 offen offset:3072 sc1
  s_add_u32 s25, s25, 4096
  buffer_load_dwordx4 v[48:51], v5, s[4:7], s25 offen offset:0 sc1
  buffer_load_dwordx4 v[52:55], v5, s[4:7], s25 offen offset:1024 sc1
  buffer_load_dwordx4 v[56:59], v5, s[4:7], s25 offen offset:2048 sc1
  buffer_load_dwordx4 v[60:63], v5, s[4:7], s25 offen offset:3072 sc1
  s_add_u32 s25, s24, 12582912
  buffer_load_dwordx4 v[64:67], v5, s[4:7], s25 offen offset:0 sc1
  buffer_load_dwordx4 v[68:71], v5, s[4:7], s25 offen offset:1024 sc1
  buffer_load_dwordx4 v[72:75], v5, s[4:7], s25 offen offset:2048 sc1
  buffer_load_dwordx4 v[76:79], v5, s[4:7], s25 offen offset:3072 sc1
  s_add_u32 s25, s25, 4096
  buffer_load_dwordx4 v[80:83], v5, s[4:7], s25 offen offset:0 sc1
  buffer_load_dwordx4 v[84:87], v5, s[4:7], s25 offen offset:1024 sc1
  buffer_load_dwordx4 v[88:91], v5, s[4:7], s25 offen offset:2048 sc1
  buffer_load_dwordx4 v[92:95], v5, s[4:7], s25 offen offset:3072 sc1
  s_add_u32 s25, s25, 4096
  buffer_load_dwordx4 v[96:99], v5, s[4:7], s25 offen offset:0 sc1
  buffer_load_dwordx4 v[100:103], v5, s[4:7], s25 offen offset:1024 sc1
  buffer_load_dwordx4 v[104:107], v5, s[4:7], s25 offen offset:2048 sc1
  buffer_load_dwordx4 v[108:111], v5, s[4:7], s25 offen offset:3072 sc1
  s_mov_b32 s47, s23
  s_cmp_lg_u32 s20, 0
  s_cbranch_scc1 TOK_SC_GO2
  s_add_u32 s51, s21, 1
  s_min_u32 s53, s51, 62
  v_mov_b32 v13, 8390656
  s_mov_b32 s52, 0
  s_nop 0
TSC_W0:
  buffer_load_dword v14, v13, s[4:7], 0 offen sc1
  s_waitcnt vmcnt(0)
  v_cmp_gt_u32 vcc, s53, v14
  s_nop 3
  s_cbranch_vccz TSC_W0_K
  v_readfirstlane_b32 s54, v14
  s_nop 0
  s_add_u32 s54, s54, 1
  s_cmp_lt_u32 s54, s53
  s_nop 0
  s_cbranch_scc0 TSC_W0_N
  s_sleep 0
TSC_W0_N:
  s_sleep 10
  s_add_u32 s52, s52, 1
  s_cmp_lt_u32 s52, 0x100000
  s_cbranch_scc1 TSC_W0
TSC_W0_K:
TSC_W0_D:
  v_and_b32 v13, 3, v1
  s_lshl_b32 s23, s22, 2
  v_add_u32 v13, s23, v13
  v_lshlrev_b32 v13, 9, v13
  v_add_u32 v13, 8392704, v13
  s_mov_b32 s52, 0
  s_nop 0
TSC_W1:
  buffer_load_dword v14, v13, s[4:7], 0 offen sc1
  s_waitcnt vmcnt(0)
  v_cmp_gt_u32 vcc, s51, v14
  s_nop 3
  s_cbranch_vccz TSC_W1_K
  s_sleep 3
  s_add_u32 s52, s52, 1
  s_cmp_lt_u32 s52, 0x100000
  s_cbranch_scc1 TSC_W1
TSC_W1_K:
TSC_W1_D:
TOK_SC_GO2:
  s_barrier
  s_mov_b32 s23, s47
  s_mul_i32 s24, s23, 3072
  s_add_u32 s25, s24, 99614720
  buffer_load_dwordx4 v[112:115], v6, s[4:7], s25 offen offset:0 sc1
  buffer_load_dwordx4 v[116:119], v6, s[4:7], s25 offen offset:512 sc1
  buffer_load_dwordx4 v[120:123], v6, s[4:7], s25 offen offset:1024 sc1
  buffer_load_dwordx4 v[124:127], v6, s[4:7], s25 offen offset:1536 sc1
  buffer_load_dwordx4 v[128:131], v6, s[4:7], s25 offen offset:2048 sc1
  buffer_load_dwordx4 v[132:135], v6, s[4:7], s25 offen offset:2560 sc1
  s_mul_i32 s24, s23, 2560
  s_add_u32 s25, s24, 105906176
  s_waitcnt vmcnt(0)
  v_mfma_f32_16x16x32_bf16 v[136:139], v[112:115], v[16:19], 0
  v_mfma_f32_16x16x32_bf16 v[140:143], v[112:115], v[40:43], 0
  v_mfma_f32_16x16x32_bf16 v[144:147], v[64:67], v[16:19], 0
  v_mfma_f32_16x16x32_bf16 v[148:151], v[64:67], v[40:43], 0
  v_mfma_f32_16x16x32_bf16 v[152:155], v[88:91], v[40:43], 0
  v_mfma_f32_16x16x32_bf16 v[136:139], v[116:119], v[20:23], v[136:139]
  v_mfma_f32_16x16x32_bf16 v[140:143], v[116:119], v[44:47], v[140:143]
  v_mfma_f32_16x16x32_bf16 v[144:147], v[68:71], v[20:23], v[144:147]
  v_mfma_f32_16x16x32_bf16 v[148:151], v[68:71], v[44:47], v[148:151]
  v_mfma_f32_16x16x32_bf16 v[152:155], v[92:95], v[44:47], v[152:155]
  v_mfma_f32_16x16x32_bf16 v[136:139], v[120:123], v[24:27], v[136:139]
  v_mfma_f32_16x16x32_bf16 v[140:143], v[120:123], v[48:51], v[140:143]
  v_mfma_f32_16x16x32_bf16 v[144:147], v[72:75], v[24:27], v[144:147]
  v_mfma_f32_16x16x32_bf16 v[148:151], v[72:75], v[48:51], v[148:151]
  v_mfma_f32_16x16x32_bf16 v[152:155], v[96:99], v[48:51], v[152:155]
  v_mfma_f32_16x16x32_bf16 v[136:139], v[124:127], v[28:31], v[136:139]
  v_mfma_f32_16x16x32_bf16 v[140:143], v[124:127], v[52:55], v[140:143]
  v_mfma_f32_16x16x32_bf16 v[144:147], v[76:79], v[28:31], v[144:147]
  v_mfma_f32_16x16x32_bf16 v[148:151], v[76:79], v[52:55], v[148:151]
  v_mfma_f32_16x16x32_bf16 v[152:155], v[100:103], v[52:55], v[152:155]
  v_mfma_f32_16x16x32_bf16 v[136:139], v[128:131], v[32:35], v[136:139]
  v_mfma_f32_16x16x32_bf16 v[140:143], v[128:131], v[56:59], v[140:143]
  v_mfma_f32_16x16x32_bf16 v[144:147], v[80:83], v[32:35], v[144:147]
  v_mfma_f32_16x16x32_bf16 v[148:151], v[80:83], v[56:59], v[148:151]
  v_mfma_f32_16x16x32_bf16 v[152:155], v[104:107], v[56:59], v[152:155]
  v_mfma_f32_16x16x32_bf16 v[136:139], v[132:135], v[36:39], v[136:139]
  v_mfma_f32_16x16x32_bf16 v[140:143], v[132:135], v[60:63], v[140:143]
  v_mfma_f32_16x16x32_bf16 v[144:147], v[84:87], v[36:39], v[144:147]
  v_mfma_f32_16x16x32_bf16 v[148:151], v[84:87], v[60:63], v[148:151]
  v_mfma_f32_16x16x32_bf16 v[152:155], v[108:111], v[60:63], v[152:155]
  s_nop 3
  v_cndmask_b32 v156, v136, v7, s[36:37]
  v_cndmask_b32 v157, v137, v7, s[36:37]
  v_cndmask_b32 v158, v138, v7, s[36:37]
  v_cndmask_b32 v159, v139, v7, s[36:37]
  v_cndmask_b32 v160, v144, v7, s[28:29]
  v_cndmask_b32 v161, v145, v7, s[30:31]
  v_cndmask_b32 v162, v146, v7, s[32:33]
  v_cndmask_b32 v163, v147, v7, s[34:35]
  v_max3_f32 v168, v156, v157, v158
  v_max3_f32 v168, v168, v159, v160
  v_max3_f32 v168, v168, v161, v162
  v_max_f32 v168, v168, v163
  v_mov_b32 v169, v168
  s_nop 1
  v_permlane16_swap_b32 v168, v169
  v_max_f32 v168, v168, v169
  v_mov_b32 v169, v168
  s_nop 1
  v_permlane32_swap_b32 v168, v169
  v_max_f32 v168, v168, v169
  v_mul_f32 v168, s26, v168
  v_fma_f32 v156, v156, s26, -v168
  v_fma_f32 v157, v157, s26, -v168
  v_fma_f32 v158, v158, s26, -v168
  v_fma_f32 v159, v159, s26, -v168
  v_fma_f32 v160, v160, s26, -v168
  v_fma_f32 v161, v161, s26, -v168
  v_fma_f32 v162, v162, s26, -v168
  v_fma_f32 v163, v163, s26, -v168
  v_exp_f32 v156, v156
  v_exp_f32 v157, v157
  v_exp_f32 v158, v158
  v_exp_f32 v159, v159
  v_exp_f32 v160, v160
  v_exp_f32 v161, v161
  v_exp_f32 v162, v162
  v_exp_f32 v163, v163
  v_add_f32 v170, v156, v157
  v_add_f32 v170, v170, v158
  v_add_f32 v170, v170, v159
  v_add_f32 v170, v170, v160
  v_add_f32 v170, v170, v161
  v_add_f32 v170, v170, v162
  v_add_f32 v170, v170, v163
  v_mov_b32 v169, v170
  s_nop 1
  v_permlane16_swap_b32 v170, v169
  v_add_f32 v170, v170, v169
  v_mov_b32 v169, v170
  s_nop 1
  v_permlane32_swap_b32 v170, v169
  v_add_f32 v170, v170, v169
  v_rcp_f32 v170, v170
  s_nop 0
  v_mul_f32 v156, v156, v170
  v_mul_f32 v157, v157, v170
  v_mul_f32 v158, v158, v170
  v_mul_f32 v159, v159, v170
  v_mul_f32 v160, v160, v170
  v_mul_f32 v161, v161, v170
  v_mul_f32 v162, v162, v170
  v_mul_f32 v163, v163, v170
  v_cvt_pk_bf16_f32 v172, v160, v161
  v_cvt_pk_bf16_f32 v173, v162, v163
  v_mov_b32 v174, 0
  v_mov_b32 v175, 0
  v_cvt_pk_bf16_f32 v176, v156, v157
  v_cvt_pk_bf16_f32 v177, v158, v159
  buffer_store_dwordx4 v[172:175], v5, s[4:7], s25 offen offset:0 sc1
  s_mov_b32 exec_hi, 0
  buffer_store_dwordx2 v[176:177], v8, s[4:7], s25 offen offset:1024 sc1
  s_mov_b64 exec, -1
  v_cndmask_b32 v156, v140, v7, s[36:37]
  v_cndmask_b32 v157, v141, v7, s[36:37]
  v_cndmask_b32 v158, v142, v7, s[36:37]
  v_cndmask_b32 v159, v143, v7, s[36:37]
  v_mov_b32 v160, v148
  v_mov_b32 v161, v149
  v_mov_b32 v162, v150
  v_mov_b32 v163, v151
  v_cndmask_b32 v164, v152, v7, s[28:29]
  v_cndmask_b32 v165, v153, v7, s[30:31]
  v_cndmask_b32 v166, v154, v7, s[32:33]
  v_cndmask_b32 v167, v155, v7, s[34:35]
  v_max3_f32 v168, v156, v157, v158
  v_max3_f32 v168, v168, v159, v160
  v_max3_f32 v168, v168, v161, v162
  v_max3_f32 v168, v168, v163, v164
  v_max3_f32 v168, v168, v165, v166
  v_max_f32 v168, v168, v167
  v_mov_b32 v169, v168
  s_nop 1
  v_permlane16_swap_b32 v168, v169
  v_max_f32 v168, v168, v169
  v_mov_b32 v169, v168
  s_nop 1
  v_permlane32_swap_b32 v168, v169
  v_max_f32 v168, v168, v169
  v_mul_f32 v168, s26, v168
  v_fma_f32 v156, v156, s26, -v168
  v_fma_f32 v157, v157, s26, -v168
  v_fma_f32 v158, v158, s26, -v168
  v_fma_f32 v159, v159, s26, -v168
  v_fma_f32 v160, v160, s26, -v168
  v_fma_f32 v161, v161, s26, -v168
  v_fma_f32 v162, v162, s26, -v168
  v_fma_f32 v163, v163, s26, -v168
  v_fma_f32 v164, v164, s26, -v168
  v_fma_f32 v165, v165, s26, -v168
  v_fma_f32 v166, v166, s26, -v168
  v_fma_f32 v167, v167, s26, -v168
  v_exp_f32 v156, v156
  v_exp_f32 v157, v157
  v_exp_f32 v158, v158
  v_exp_f32 v159, v159
  v_exp_f32 v160, v160
  v_exp_f32 v161, v161
  v_exp_f32 v162, v162
  v_exp_f32 v163, v163
  v_exp_f32 v164, v164
  v_exp_f32 v165, v165
  v_exp_f32 v166, v166
  v_exp_f32 v167, v167
  v_add_f32 v170, v156, v157
  v_add_f32 v170, v170, v158
  v_add_f32 v170, v170, v159
  v_add_f32 v170, v170, v160
  v_add_f32 v170, v170, v161
  v_add_f32 v170, v170, v162
  v_add_f32 v170, v170, v163
  v_add_f32 v170, v170, v164
  v_add_f32 v170, v170, v165
  v_add_f32 v170, v170, v166
  v_add_f32 v170, v170, v167
  v_mov_b32 v169, v170
  s_nop 1
  v_permlane16_swap_b32 v170, v169
  v_add_f32 v170, v170, v169
  v_mov_b32 v169, v170
  s_nop 1
  v_permlane32_swap_b32 v170, v169
  v_add_f32 v170, v170, v169
  v_rcp_f32 v170, v170
  s_nop 0
  v_mul_f32 v156, v156, v170
  v_mul_f32 v157, v157, v170
  v_mul_f32 v158, v158, v170
  v_mul_f32 v159, v159, v170
  v_mul_f32 v160, v160, v170
  v_mul_f32 v161, v161, v170
  v_mul_f32 v162, v162, v170
  v_mul_f32 v163, v163, v170
  v_mul_f32 v164, v164, v170
  v_mul_f32 v165, v165, v170
  v_mul_f32 v166, v166, v170
  v_mul_f32 v167, v167, v170
  v_cvt_pk_bf16_f32 v180, v160, v161
  v_cvt_pk_bf16_f32 v181, v162, v163
  v_cvt_pk_bf16_f32 v182, v164, v165
  v_cvt_pk_bf16_f32 v183, v166, v167
  v_cvt_pk_bf16_f32 v184, v156, v157
  v_cvt_pk_bf16_f32 v185, v158, v159
  buffer_store_dwordx4 v[180:183], v5, s[4:7], s25 offen offset:1280 sc1
  s_mov_b32 exec_hi, 0
  buffer_store_dwordx2 v[184:185], v8, s[4:7], s25 offen offset:2304 sc1
  s_mov_b64 exec, -1
  s_waitcnt vmcnt(0)
  s_barrier
  s_cmp_lg_u32 s20, 0
  s_cbranch_scc1 TOK_LOOP
  s_lshl_b32 s23, s21, 7
  s_lshl_b32 s24, s22, 2
  s_add_u32 s23, s23, s24
  s_add_u32 s23, s23, 8429568
  s_mov_b32 s51, 1
  v_mov_b32 v14, s51
  s_mov_b64 exec, 1
  buffer_store_dword v14, v15, s[4:7], s23 offen sc1
  s_mov_b64 exec, -1
  s_branch TOK_LOOP
TOK_PU:
  s_sub_u32 s22, s22, 8
  s_cmp_lg_u32 s20, 0
  s_cbranch_scc1 TOK_PU_GO
  v_and_b32 v13, 31, v1
  v_lshlrev_b32 v13, 7, v13
  v_add_u32 v13, 8449792, v13
  s_add_u32 s51, s21, 1
  s_mov_b32 s52, 0
TPU_W1:
  buffer_load_dword v14, v13, s[4:7], 0 offen sc1
  s_waitcnt vmcnt(0)
  v_cmp_gt_u32 vcc, s51, v14
  s_nop 3
  s_cbranch_vccz TPU_W1_K
  s_sleep 16
  s_add_u32 s52, s52, 1
  s_cmp_lt_u32 s52, 0x100000
  s_cbranch_scc1 TPU_W1
TPU_W1_K:
TPU_W1_D:
  s_mul_i32 s23, s22, 5
  s_lshr_b32 s24, s23, 2
  s_add_u32 s23, s23, 4
  s_lshr_b32 s23, s23, 2
  v_mov_b32 v13, s23
  v_mov_b32 v14, s24
  v_and_b32 v4, 1, v1
  v_cmp_eq_u32 vcc, 0, v4
  s_nop 1
  v_cndmask_b32 v13, v13, v14, vcc
  v_lshlrev_b32 v13, 7, v13
  v_add_u32 v13, 8448512, v13
  s_lshl_b32 s51, s21, 1
  s_add_u32 s51, s51, 2
  s_mov_b32 s52, 0
TPU_W2:
  buffer_load_dword v14, v13, s[4:7], 0 offen sc1
  s_waitcnt vmcnt(0)
  v_cmp_gt_u32 vcc, s51, v14
  s_nop 3
  s_cbranch_vccz TPU_W2_K
  s_sleep 16
  s_add_u32 s52, s52, 1
  s_cmp_lt_u32 s52, 0x100000
  s_cbranch_scc1 TPU_W2
TPU_W2_K:
TPU_W2_D:
TOK_PU_GO:
  s_barrier
  s_lshl_b32 s23, s21, 5
  s_lshl_b32 s24, s20, 3
  s_add_u32 s23, s23, s24
  s_mul_i32 s40, s23, 40960
  s_mul_i32 s24, s22, 5120
  s_add_u32 s40, s40, s24
  s_add_u32 s40, s40, 132120576
  s_mul_i32 s41, s23, 2560
  s_add_u32 s41, s41, 105906176
  s_mul_i32 s42, s23, 10240
  s_mul_i32 s24, s22, 1280
  s_add_u32 s42, s42, s24
  s_add_u32 s42, s42, 111149056
  s_mul_i32 s43, s21, 80
  s_mul_i32 s24, s22, 10
  s_add_u32 s43, s43, s24
  s_add_u32 s43, s43, s20
  s_lshl_b32 s43, s43, 10
  s_add_u32 s43, s43, 94371840
  s_add_u32 s44, s40, 0
  buffer_load_dwordx4 a[0:3], v5, s[4:7], s44 offen offset:0 sc1
  buffer_load_dwordx4 a[4:7], v5, s[4:7], s44 offen offset:1024 sc1
  buffer_load_dwordx4 a[8:11], v5, s[4:7], s44 offen offset:2048 sc1
  buffer_load_dwordx4 a[12:15], v5, s[4:7], s44 offen offset:3072 sc1
  s_add_u32 s44, s44, 4096
  buffer_load_dwordx4 a[16:19], v5, s[4:7], s44 offen sc1
  s_add_u32 s44, s40, 40960
  buffer_load_dwordx4 a[20:23], v5, s[4:7], s44 offen offset:0 sc1
  buffer_load_dwordx4 a[24:27], v5, s[4:7], s44 offen offset:1024 sc1
  buffer_load_dwordx4 a[28:31], v5, s[4:7], s44 offen offset:2048 sc1
  buffer_load_dwordx4 a[32:35], v5, s[4:7], s44 offen offset:3072 sc1
  s_add_u32 s44, s44, 4096
  buffer_load_dwordx4 a[36:39], v5, s[4:7], s44 offen sc1
  s_add_u32 s44, s40, 81920
  buffer_load_dwordx4 a[40:43], v5, s[4:7], s44 offen offset:0 sc1
  buffer_load_dwordx4 a[44:47], v5, s[4:7], s44 offen offset:1024 sc1
  buffer_load_dwordx4 a[48:51], v5, s[4:7], s44 offen offset:2048 sc1
  buffer_load_dwordx4 a[52:55], v5, s[4:7], s44 offen offset:3072 sc1
  s_add_u32 s44, s44, 4096
  buffer_load_dwordx4 a[56:59], v5, s[4:7], s44 offen sc1
  s_add_u32 s44, s40, 122880
  buffer_load_dwordx4 a[60:63], v5, s[4:7], s44 offen offset:0 sc1
  buffer_load_dwordx4 a[64:67], v5, s[4:7], s44 offen offset:1024 sc1
  buffer_load_dwordx4 a[68:71], v5, s[4:7], s44 offen offset:2048 sc1
  buffer_load_dwordx4 a[72:75], v5, s[4:7], s44 offen offset:3072 sc1
  s_add_u32 s44, s44, 4096
  buffer_load_dwordx4 a[76:79], v5, s[4:7], s44 offen sc1
  s_add_u32 s44, s40, 163840
  buffer_load_dwordx4 a[80:83], v5, s[4:7], s44 offen offset:0 sc1
  buffer_load_dwordx4 a[84:87], v5, s[4:7], s44 offen offset:1024 sc1
  buffer_load_dwordx4 a[88:91], v5, s[4:7], s44 offen offset:2048 sc1
  buffer_load_dwordx4 a[92:95], v5, s[4:7], s44 offen offset:3072 sc1
  s_add_u32 s44, s44, 4096
  buffer_load_dwordx4 a[96:99], v5, s[4:7], s44 offen sc1
  s_add_u32 s44, s40, 204800
  buffer_load_dwordx4 a[100:103], v5, s[4:7], s44 offen offset:0 sc1
  buffer_load_dwordx4 a[104:107], v5, s[4:7], s44 offen offset:1024 sc1
  buffer_load_dwordx4 a[108:111], v5, s[4:7], s44 offen offset:2048 sc1
  buffer_load_dwordx4 a[112:115], v5, s[4:7], s44 offen offset:3072 sc1
  s_add_u32 s44, s44, 4096
  buffer_load_dwordx4 a[116:119], v5, s[4:7], s44 offen sc1
  s_add_u32 s44, s40, 245760
  buffer_load_dwordx4 a[120:123], v5, s[4:7], s44 offen offset:0 sc1
  buffer_load_dwordx4 a[124:127], v5, s[4:7], s44 offen offset:1024 sc1
  buffer_load_dwordx4 a[128:131], v5, s[4:7], s44 offen offset:2048 sc1
  buffer_load_dwordx4 a[132:135], v5, s[4:7], s44 offen offset:3072 sc1
  s_add_u32 s44, s44, 4096
  buffer_load_dwordx4 a[136:139], v5, s[4:7], s44 offen sc1
  s_add_u32 s44, s40, 286720
  buffer_load_dwordx4 a[140:143], v5, s[4:7], s44 offen offset:0 sc1
  buffer_load_dwordx4 a[144:147], v5, s[4:7], s44 offen offset:1024 sc1
  buffer_load_dwordx4 a[148:151], v5, s[4:7], s44 offen offset:2048 sc1
  buffer_load_dwordx4 a[152:155], v5, s[4:7], s44 offen offset:3072 sc1
  s_add_u32 s44, s44, 4096
  buffer_load_dwordx4 a[156:159], v5, s[4:7], s44 offen sc1
  s_add_u32 s44, s43, 0
  buffer_load_dwordx4 v[196:199], v5, s[4:7], s44 offen sc1
  s_add_u32 s44, s43, 4096
  buffer_load_dwordx4 v[200:203], v5, s[4:7], s44 offen sc1
  s_add_u32 s44, s43, 8192
  buffer_load_dwordx4 v[204:207], v5, s[4:7], s44 offen sc1
  s_cmp_lg_u32 s20, 0
  s_cbranch_scc1 TOK_PU_GO2
  s_add_u32 s51, s21, 1
  s_min_u32 s53, s51, 62
  v_mov_b32 v13, 8390656
  s_mov_b32 s52, 0
  s_nop 0
TPU_W5:
  buffer_load_dword v14, v13, s[4:7], 0 offen sc1
  s_waitcnt vmcnt(0)
  v_cmp_gt_u32 vcc, s53, v14
  s_nop 3
  s_cbranch_vccz TPU_W5_K
  v_readfirstlane_b32 s54, v14
  s_nop 0
  s_add_u32 s54, s54, 1
  s_cmp_lt_u32 s54, s53
  s_nop 0
  s_cbranch_scc0 TPU_W5_N
  s_sleep 0
TPU_W5_N:
  s_sleep 10
  s_add_u32 s52, s52, 1
  s_cmp_lt_u32 s52, 0x100000
  s_cbranch_scc1 TPU_W5
TPU_W5_K:
TPU_W5_D:
  v_lshlrev_b32 v13, 7, v1
  v_add_u32 v13, 8392704, v13
  s_mov_b32 s52, 0
  s_nop 0
TPU_W3:
  buffer_load_dword v14, v13, s[4:7], 0 offen sc1
  s_waitcnt vmcnt(0)
  v_cmp_gt_u32 vcc, s51, v14
  s_nop 3
  s_cbranch_vccz TPU_W3_K
  s_sleep 6
  s_add_u32 s52, s52, 1
  s_cmp_lt_u32 s52, 0x100000
  s_cbranch_scc1 TPU_W3
TPU_W3_K:
TPU_W3_D:
  v_add_u32 v13, 8192, v13
  s_mov_b32 s52, 0
  s_nop 0
TPU_W4:
  buffer_load_dword v14, v13, s[4:7], 0 offen sc1
  s_waitcnt vmcnt(0)
  v_cmp_gt_u32 vcc, s51, v14
  s_nop 3
  s_cbranch_vccz TPU_W4_K
  s_sleep 2
  s_add_u32 s52, s52, 1
  s_cmp_lt_u32 s52, 0x100000
  s_cbranch_scc1 TPU_W4
TPU_W4_K:
TPU_W4_D:
  s_lshl_b32 s23, s21, 7
  s_add_u32 s23, s23, 8429568
  v_and_b32 v13, 7, v1
  v_lshlrev_b32 v13, 2, v13
  v_add_u32 v13, s23, v13
  s_mov_b32 s52, 0
  s_nop 0
TPU_W0:
  buffer_load_dword v14, v13, s[4:7], 0 offen sc1
  s_waitcnt vmcnt(0)
  v_cmp_gt_u32 vcc, 1, v14
  s_nop 3
  s_cbranch_vccz TPU_W0_K
  s_sleep 3
  s_add_u32 s52, s52, 1
  s_cmp_lt_u32 s52, 0x100000
  s_cbranch_scc1 TPU_W0
TPU_W0_K:
TPU_W0_D:
TOK_PU_GO2:
  s_barrier
  s_add_u32 s44, s41, 0
  buffer_load_dwordx4 v[56:59], v5, s[4:7], s44 offen sc1
  buffer_load_dwordx4 v[60:63], v5, s[4:7], s44 offen offset:1280 sc1
  s_add_u32 s44, s41, 2560
  buffer_load_dwordx4 v[64:67], v5, s[4:7], s44 offen sc1
  buffer_load_dwordx4 v[68:71], v5, s[4:7], s44 offen offset:1280 sc1
  s_add_u32 s44, s41, 5120
  buffer_load_dwordx4 v[72:75], v5, s[4:7], s44 offen sc1
  buffer_load_dwordx4 v[76:79], v5, s[4:7], s44 offen offset:1280 sc1
  s_add_u32 s44, s41, 7680
  buffer_load_dwordx4 v[80:83], v5, s[4:7], s44 offen sc1
  buffer_load_dwordx4 v[84:87], v5, s[4:7], s44 offen offset:1280 sc1
  s_add_u32 s44, s41, 10240
  buffer_load_dwordx4 v[88:91], v5, s[4:7], s44 offen sc1
  buffer_load_dwordx4 v[92:95], v5, s[4:7], s44 offen offset:1280 sc1
  s_add_u32 s44, s41, 12800
  buffer_load_dwordx4 v[96:99], v5, s[4:7], s44 offen sc1
  buffer_load_dwordx4 v[100:103], v5, s[4:7], s44 offen offset:1280 sc1
  s_add_u32 s44, s41, 15360
  buffer_load_dwordx4 v[104:107], v5, s[4:7], s44 offen sc1
  buffer_load_dwordx4 v[108:111], v5, s[4:7], s44 offen offset:1280 sc1
  s_add_u32 s44, s41, 17920
  buffer_load_dwordx4 v[112:115], v5, s[4:7], s44 offen sc1
  buffer_load_dwordx4 v[116:119], v5, s[4:7], s44 offen offset:1280 sc1
  s_add_u32 s44, s42, 0
  buffer_load_dwordx2 v[120:121], v11, s[4:7], s44 offen offset:0 sc1
  buffer_load_dwordx2 v[124:125], v11, s[4:7], s44 offen offset:256 sc1
  buffer_load_dwordx2 v[128:129], v11, s[4:7], s44 offen offset:512 sc1
  buffer_load_dwordx2 v[132:133], v11, s[4:7], s44 offen offset:768 sc1
  buffer_load_dwordx2 v[136:137], v11, s[4:7], s44 offen offset:1024 sc1
  s_add_u32 s44, s41, 0
  buffer_load_dwordx2 v[160:161], v12, s[4:7], s44 offen offset:1024 sc1
  buffer_load_dwordx2 v[164:165], v12, s[4:7], s44 offen offset:2304 sc1
  s_add_u32 s44, s42, 20480
  buffer_load_dwordx2 v[122:123], v11, s[4:7], s44 offen offset:0 sc1
  buffer_load_dwordx2 v[126:127], v11, s[4:7], s44 offen offset:256 sc1
  buffer_load_dwordx2 v[130:131], v11, s[4:7], s44 offen offset:512 sc1
  buffer_load_dwordx2 v[134:135], v11, s[4:7], s44 offen offset:768 sc1
  buffer_load_dwordx2 v[138:139], v11, s[4:7], s44 offen offset:1024 sc1
  s_add_u32 s44, s41, 5120
  buffer_load_dwordx2 v[162:163], v12, s[4:7], s44 offen offset:1024 sc1
  buffer_load_dwordx2 v[166:167], v12, s[4:7], s44 offen offset:2304 sc1
  s_add_u32 s44, s42, 40960
  buffer_load_dwordx2 v[140:141], v11, s[4:7], s44 offen offset:0 sc1
  buffer_load_dwordx2 v[144:145], v11, s[4:7], s44 offen offset:256 sc1
  buffer_load_dwordx2 v[148:149], v11, s[4:7], s44 offen offset:512 sc1
  buffer_load_dwordx2 v[152:153], v11, s[4:7], s44 offen offset:768 sc1
  buffer_load_dwordx2 v[156:157], v11, s[4:7], s44 offen offset:1024 sc1
  s_add_u32 s44, s41, 10240
  buffer_load_dwordx2 v[168:169], v12, s[4:7], s44 offen offset:1024 sc1
  buffer_load_dwordx2 v[172:173], v12, s[4:7], s44 offen offset:2304 sc1
  s_add_u32 s44, s42, 61440
  buffer_load_dwordx2 v[142:143], v11, s[4:7], s44 offen offset:0 sc1
  buffer_load_dwordx2 v[146:147], v11, s[4:7], s44 offen offset:256 sc1
  buffer_load_dwordx2 v[150:151], v11, s[4:7], s44 offen offset:512 sc1
  buffer_load_dwordx2 v[154:155], v11, s[4:7], s44 offen offset:768 sc1
  buffer_load_dwordx2 v[158:159], v11, s[4:7], s44 offen offset:1024 sc1
  s_add_u32 s44, s41, 15360
  buffer_load_dwordx2 v[170:171], v12, s[4:7], s44 offen offset:1024 sc1
  buffer_load_dwordx2 v[174:175], v12, s[4:7], s44 offen offset:2304 sc1
  s_waitcnt vmcnt(42)
  v_mfma_f32_16x16x32_bf16 v[16:19], a[0:3], v[56:59], 0
  v_mfma_f32_16x16x32_bf16 v[20:23], a[0:3], v[60:63], 0
  v_mfma_f32_16x16x32_bf16 v[24:27], a[4:7], v[56:59], 0
  v_mfma_f32_16x16x32_bf16 v[28:31], a[4:7], v[60:63], 0
  v_mfma_f32_16x16x32_bf16 v[32:35], a[8:11], v[56:59], 0
  v_mfma_f32_16x16x32_bf16 v[36:39], a[8:11], v[60:63], 0
  v_mfma_f32_16x16x32_bf16 v[40:43], a[12:15], v[56:59], 0
  v_mfma_f32_16x16x32_bf16 v[44:47], a[12:15], v[60:63], 0
  v_mfma_f32_16x16x32_bf16 v[48:51], a[16:19], v[56:59], 0
  v_mfma_f32_16x16x32_bf16 v[52:55], a[16:19], v[60:63], 0
  s_waitcnt vmcnt(40)
  v_mfma_f32_16x16x32_bf16 v[16:19], a[20:23], v[64:67], v[16:19]
  v_mfma_f32_16x16x32_bf16 v[20:23], a[20:23], v[68:71], v[20:23]
  v_mfma_f32_16x16x32_bf16 v[24:27], a[24:27], v[64:67], v[24:27]
  v_mfma_f32_16x16x32_bf16 v[28:31], a[24:27], v[68:71], v[28:31]
  v_mfma_f32_16x16x32_bf16 v[32:35], a[28:31], v[64:67], v[32:35]
  v_mfma_f32_16x16x32_bf16 v[36:39], a[28:31], v[68:71], v[36:39]
  v_mfma_f32_16x16x32_bf16 v[40:43], a[32:35], v[64:67], v[40:43]
  v_mfma_f32_16x16x32_bf16 v[44:47], a[32:35], v[68:71], v[44:47]
  v_mfma_f32_16x16x32_bf16 v[48:51], a[36:39], v[64:67], v[48:51]
  v_mfma_f32_16x16x32_bf16 v[52:55], a[36:39], v[68:71], v[52:55]
  s_waitcnt vmcnt(38)
  v_mfma_f32_16x16x32_bf16 v[16:19], a[40:43], v[72:75], v[16:19]
  v_mfma_f32_16x16x32_bf16 v[20:23], a[40:43], v[76:79], v[20:23]
  v_mfma_f32_16x16x32_bf16 v[24:27], a[44:47], v[72:75], v[24:27]
  v_mfma_f32_16x16x32_bf16 v[28:31], a[44:47], v[76:79], v[28:31]
  v_mfma_f32_16x16x32_bf16 v[32:35], a[48:51], v[72:75], v[32:35]
  v_mfma_f32_16x16x32_bf16 v[36:39], a[48:51], v[76:79], v[36:39]
  v_mfma_f32_16x16x32_bf16 v[40:43], a[52:55], v[72:75], v[40:43]
  v_mfma_f32_16x16x32_bf16 v[44:47], a[52:55], v[76:79], v[44:47]
  v_mfma_f32_16x16x32_bf16 v[48:51], a[56:59], v[72:75], v[48:51]
  v_mfma_f32_16x16x32_bf16 v[52:55], a[56:59], v[76:79], v[52:55]
  s_waitcnt vmcnt(36)
  v_mfma_f32_16x16x32_bf16 v[16:19], a[60:63], v[80:83], v[16:19]
  v_mfma_f32_16x16x32_bf16 v[20:23], a[60:63], v[84:87], v[20:23]
  v_mfma_f32_16x16x32_bf16 v[24:27], a[64:67], v[80:83], v[24:27]
  v_mfma_f32_16x16x32_bf16 v[28:31], a[64:67], v[84:87], v[28:31]
  v_mfma_f32_16x16x32_bf16 v[32:35], a[68:71], v[80:83], v[32:35]
  v_mfma_f32_16x16x32_bf16 v[36:39], a[68:71], v[84:87], v[36:39]
  v_mfma_f32_16x16x32_bf16 v[40:43], a[72:75], v[80:83], v[40:43]
  v_mfma_f32_16x16x32_bf16 v[44:47], a[72:75], v[84:87], v[44:47]
  v_mfma_f32_16x16x32_bf16 v[48:51], a[76:79], v[80:83], v[48:51]
  v_mfma_f32_16x16x32_bf16 v[52:55], a[76:79], v[84:87], v[52:55]
  s_waitcnt vmcnt(34)
  v_mfma_f32_16x16x32_bf16 v[16:19], a[80:83], v[88:91], v[16:19]
  v_mfma_f32_16x16x32_bf16 v[20:23], a[80:83], v[92:95], v[20:23]
  v_mfma_f32_16x16x32_bf16 v[24:27], a[84:87], v[88:91], v[24:27]
  v_mfma_f32_16x16x32_bf16 v[28:31], a[84:87], v[92:95], v[28:31]
  v_mfma_f32_16x16x32_bf16 v[32:35], a[88:91], v[88:91], v[32:35]
  v_mfma_f32_16x16x32_bf16 v[36:39], a[88:91], v[92:95], v[36:39]
  v_mfma_f32_16x16x32_bf16 v[40:43], a[92:95], v[88:91], v[40:43]
  v_mfma_f32_16x16x32_bf16 v[44:47], a[92:95], v[92:95], v[44:47]
  v_mfma_f32_16x16x32_bf16 v[48:51], a[96:99], v[88:91], v[48:51]
  v_mfma_f32_16x16x32_bf16 v[52:55], a[96:99], v[92:95], v[52:55]
  s_waitcnt vmcnt(32)
  v_mfma_f32_16x16x32_bf16 v[16:19], a[100:103], v[96:99], v[16:19]
  v_mfma_f32_16x16x32_bf16 v[20:23], a[100:103], v[100:103], v[20:23]
  v_mfma_f32_16x16x32_bf16 v[24:27], a[104:107], v[96:99], v[24:27]
  v_mfma_f32_16x16x32_bf16 v[28:31], a[104:107], v[100:103], v[28:31]
  v_mfma_f32_16x16x32_bf16 v[32:35], a[108:111], v[96:99], v[32:35]
  v_mfma_f32_16x16x32_bf16 v[36:39], a[108:111], v[100:103], v[36:39]
  v_mfma_f32_16x16x32_bf16 v[40:43], a[112:115], v[96:99], v[40:43]
  v_mfma_f32_16x16x32_bf16 v[44:47], a[112:115], v[100:103], v[44:47]
  v_mfma_f32_16x16x32_bf16 v[48:51], a[116:119], v[96:99], v[48:51]
  v_mfma_f32_16x16x32_bf16 v[52:55], a[116:119], v[100:103], v[52:55]
  s_waitcnt vmcnt(30)
  v_mfma_f32_16x16x32_bf16 v[16:19], a[120:123], v[104:107], v[16:19]
  v_mfma_f32_16x16x32_bf16 v[20:23], a[120:123], v[108:111], v[20:23]
  v_mfma_f32_16x16x32_bf16 v[24:27], a[124:127], v[104:107], v[24:27]
  v_mfma_f32_16x16x32_bf16 v[28:31], a[124:127], v[108:111], v[28:31]
  v_mfma_f32_16x16x32_bf16 v[32:35], a[128:131], v[104:107], v[32:35]
  v_mfma_f32_16x16x32_bf16 v[36:39], a[128:131], v[108:111], v[36:39]
  v_mfma_f32_16x16x32_bf16 v[40:43], a[132:135], v[104:107], v[40:43]
  v_mfma_f32_16x16x32_bf16 v[44:47], a[132:135], v[108:111], v[44:47]
  v_mfma_f32_16x16x32_bf16 v[48:51], a[136:139], v[104:107], v[48:51]
  v_mfma_f32_16x16x32_bf16 v[52:55], a[136:139], v[108:111], v[52:55]
  s_waitcnt vmcnt(28)
  v_mfma_f32_16x16x32_bf16 v[16:19], a[140:143], v[112:115], v[16:19]
  v_mfma_f32_16x16x32_bf16 v[20:23], a[140:143], v[116:119], v[20:23]
  v_mfma_f32_16x16x32_bf16 v[24:27], a[144:147], v[112:115], v[24:27]
  v_mfma_f32_16x16x32_bf16 v[28:31], a[144:147], v[116:119], v[28:31]
  v_mfma_f32_16x16x32_bf16 v[32:35], a[148:151], v[112:115], v[32:35]
  v_mfma_f32_16x16x32_bf16 v[36:39], a[148:151], v[116:119], v[36:39]
  v_mfma_f32_16x16x32_bf16 v[40:43], a[152:155], v[112:115], v[40:43]
  v_mfma_f32_16x16x32_bf16 v[44:47], a[152:155], v[116:119], v[44:47]
  v_mfma_f32_16x16x32_bf16 v[48:51], a[156:159], v[112:115], v[48:51]
  v_mfma_f32_16x16x32_bf16 v[52:55], a[156:159], v[116:119], v[52:55]
  s_waitcnt vmcnt(14)
  v_mfma_f32_16x16x32_bf16 v[16:19], v[120:123], v[160:163], v[16:19]
  v_mfma_f32_16x16x32_bf16 v[20:23], v[120:123], v[164:167], v[20:23]
  v_mfma_f32_16x16x32_bf16 v[24:27], v[124:127], v[160:163], v[24:27]
  v_mfma_f32_16x16x32_bf16 v[28:31], v[124:127], v[164:167], v[28:31]
  v_mfma_f32_16x16x32_bf16 v[32:35], v[128:131], v[160:163], v[32:35]
  v_mfma_f32_16x16x32_bf16 v[36:39], v[128:131], v[164:167], v[36:39]
  v_mfma_f32_16x16x32_bf16 v[40:43], v[132:135], v[160:163], v[40:43]
  v_mfma_f32_16x16x32_bf16 v[44:47], v[132:135], v[164:167], v[44:47]
  v_mfma_f32_16x16x32_bf16 v[48:51], v[136:139], v[160:163], v[48:51]
  v_mfma_f32_16x16x32_bf16 v[52:55], v[136:139], v[164:167], v[52:55]
  s_waitcnt vmcnt(0)
  v_mfma_f32_16x16x32_bf16 v[16:19], v[140:143], v[168:171], v[16:19]
  v_mfma_f32_16x16x32_bf16 v[20:23], v[140:143], v[172:175], v[20:23]
  v_mfma_f32_16x16x32_bf16 v[24:27], v[144:147], v[168:171], v[24:27]
  v_mfma_f32_16x16x32_bf16 v[28:31], v[144:147], v[172:175], v[28:31]
  v_mfma_f32_16x16x32_bf16 v[32:35], v[148:151], v[168:171], v[32:35]
  v_mfma_f32_16x16x32_bf16 v[36:39], v[148:151], v[172:175], v[36:39]
  v_mfma_f32_16x16x32_bf16 v[40:43], v[152:155], v[168:171], v[40:43]
  v_mfma_f32_16x16x32_bf16 v[44:47], v[152:155], v[172:175], v[44:47]
  v_mfma_f32_16x16x32_bf16 v[48:51], v[156:159], v[168:171], v[48:51]
  v_mfma_f32_16x16x32_bf16 v[52:55], v[156:159], v[172:175], v[52:55]
  s_mul_i32 s44, s20, 10240
  v_add_u32 v4, s44, v5
  ds_write_b128 v4, v[16:19] offset:0
  ds_write_b128 v4, v[20:23] offset:1024
  ds_write_b128 v4, v[24:27] offset:2048
  ds_write_b128 v4, v[28:31] offset:3072
  ds_write_b128 v4, v[32:35] offset:4096
  ds_write_b128 v4, v[36:39] offset:5120
  ds_write_b128 v4, v[40:43] offset:6144
  ds_write_b128 v4, v[44:47] offset:7168
  ds_write_b128 v4, v[48:51] offset:8192
  ds_write_b128 v4, v[52:55] offset:9216
  s_waitcnt lgkmcnt(0)
  s_barrier
  s_lshl_b32 s44, s20, 10
  v_add_u32 v4, s44, v5
  ds_read_b128 v[208:211], v4 offset:0
  ds_read_b128 v[212:215], v4 offset:10240
  ds_read_b128 v[216:219], v4 offset:20480
  ds_read_b128 v[220:223], v4 offset:30720
  s_add_u32 s44, s20, 0
  s_lshr_b32 s45, s44, 1
  s_and_b32 s44, s44, 1
  s_mul_i32 s46, s22, 5
  s_add_u32 s45, s45, s46
  s_lshl_b32 s45, s45, 5
  s_lshl_b32 s46, s21, 1
  s_add_u32 s46, s46, s44
  s_mul_i32 s46, s46, 20480
  s_add_u32 s45, s45, s46
  s_waitcnt vmcnt(0) lgkmcnt(0)
  v_add_f32 v208, v208, v212
  v_add_f32 v216, v216, v220
  v_add_f32 v209, v209, v213
  v_add_f32 v217, v217, v221
  v_add_f32 v210, v210, v214
  v_add_f32 v218, v218, v222
  v_add_f32 v211, v211, v215
  v_add_f32 v219, v219, v223
  v_add_f32 v208, v208, v216
  v_add_f32 v208, v208, v196
  v_add_f32 v209, v209, v217
  v_add_f32 v209, v209, v197
  v_add_f32 v210, v210, v218
  v_add_f32 v210, v210, v198
  v_add_f32 v211, v211, v219
  v_add_f32 v211, v211, v199
  v_cvt_pk_bf16_f32 v212, v208, v209
  v_cvt_pk_bf16_f32 v213, v210, v211
  buffer_store_dwordx2 v[212:213], v10, s[8:11], s45 offen
  ds_read_b128 v[208:211], v4 offset:4096
  ds_read_b128 v[212:215], v4 offset:14336
  ds_read_b128 v[216:219], v4 offset:24576
  ds_read_b128 v[220:223], v4 offset:34816
  s_add_u32 s44, s20, 4
  s_lshr_b32 s45, s44, 1
  s_and_b32 s44, s44, 1
  s_mul_i32 s46, s22, 5
  s_add_u32 s45, s45, s46
  s_lshl_b32 s45, s45, 5
  s_lshl_b32 s46, s21, 1
  s_add_u32 s46, s46, s44
  s_mul_i32 s46, s46, 20480
  s_add_u32 s45, s45, s46
  s_waitcnt vmcnt(0) lgkmcnt(0)
  v_add_f32 v208, v208, v212
  v_add_f32 v216, v216, v220
  v_add_f32 v209, v209, v213
  v_add_f32 v217, v217, v221
  v_add_f32 v210, v210, v214
  v_add_f32 v218, v218, v222
  v_add_f32 v211, v211, v215
  v_add_f32 v219, v219, v223
  v_add_f32 v208, v208, v216
  v_add_f32 v208, v208, v200
  v_add_f32 v209, v209, v217
  v_add_f32 v209, v209, v201
  v_add_f32 v210, v210, v218
  v_add_f32 v210, v210, v202
  v_add_f32 v211, v211, v219
  v_add_f32 v211, v211, v203
  v_cvt_pk_bf16_f32 v212, v208, v209
  v_cvt_pk_bf16_f32 v213, v210, v211
  buffer_store_dwordx2 v[212:213], v10, s[8:11], s45 offen
  s_cmp_ge_u32 s20, 2
  s_cbranch_scc1 MPU_RD
  ds_read_b128 v[208:211], v4 offset:8192
  ds_read_b128 v[212:215], v4 offset:18432
  ds_read_b128 v[216:219], v4 offset:28672
  ds_read_b128 v[220:223], v4 offset:38912
  s_add_u32 s44, s20, 8
  s_lshr_b32 s45, s44, 1
  s_and_b32 s44, s44, 1
  s_mul_i32 s46, s22, 5
  s_add_u32 s45, s45, s46
  s_lshl_b32 s45, s45, 5
  s_lshl_b32 s46, s21, 1
  s_add_u32 s46, s46, s44
  s_mul_i32 s46, s46, 20480
  s_add_u32 s45, s45, s46
  s_waitcnt vmcnt(0) lgkmcnt(0)
  v_add_f32 v208, v208, v212
  v_add_f32 v216, v216, v220
  v_add_f32 v209, v209, v213
  v_add_f32 v217, v217, v221
  v_add_f32 v210, v210, v214
  v_add_f32 v218, v218, v222
  v_add_f32 v211, v211, v215
  v_add_f32 v219, v219, v223
  v_add_f32 v208, v208, v216
  v_add_f32 v208, v208, v204
  v_add_f32 v209, v209, v217
  v_add_f32 v209, v209, v205
  v_add_f32 v210, v210, v218
  v_add_f32 v210, v210, v206
  v_add_f32 v211, v211, v219
  v_add_f32 v211, v211, v207
  v_cvt_pk_bf16_f32 v212, v208, v209
  v_cvt_pk_bf16_f32 v213, v210, v211
  buffer_store_dwordx2 v[212:213], v10, s[8:11], s45 offen
  s_nop 0
MPU_RD:
  s_barrier
  s_branch TOK_LOOP
TOK_END:
  s_waitcnt vmcnt(0)
  s_endpgm
MK_END:
  s_endpgm
.section .rodata,"a"
.p2align 6
.amdhsa_kernel parallel_sum__memory_aug_recurrent_mem_tr__geglu_ffn__prompt_kernel
  .amdhsa_next_free_vgpr 512
  .amdhsa_next_free_sgpr 102
  .amdhsa_accum_offset 256
  .amdhsa_group_segment_fixed_size 0
  .amdhsa_kernarg_size 112
  .amdhsa_user_sgpr_count 2
  .amdhsa_user_sgpr_kernarg_segment_ptr 1
  .amdhsa_system_sgpr_workgroup_id_x 1
.end_amdhsa_kernel
```
